```python
import torch

def _softmax(x, axis=-1):
    return torch.softmax(x, dim=axis)
def _gelu(x):
    return torch.nn.functional.gelu(x, approximate="tanh")
def _silu(x):
    return torch.nn.functional.silu(x)
def _sigmoid(x):
    return torch.sigmoid(x)
def _layernorm(x, axis=-1, eps=1e-5):
    m = x.mean(dim=axis, keepdim=True)
    v = x.var(dim=axis, keepdim=True, unbiased=False)
    return (x - m) / torch.sqrt(v + eps)
def _scatter_add(tgt, idx, src, axis=0):
    return tgt.clone().index_add_(axis, idx, src)
def _segment_sum(src, seg, n):
    out = torch.zeros((n,) + src.shape[1:], dtype=src.dtype)
    return out.index_add_(0, seg, src)
def _pad(x, pw):
    flat = tuple(v for pair in reversed(pw) for v in pair)
    return torch.nn.functional.pad(x, flat)

kernel_name = 'gather_scatter__hybrid_graph_tf_nagphormer__graph'

def setup_inputs():

    _w = (lambda a: (lambda t: t.to(torch.bfloat16) if t.is_floating_point() else t)(torch.as_tensor(a)))
    N, deg, D = 25000, 16, 128
    E = N * deg
    src = (lambda lo, hi, *s: torch.randint(lo, hi, s))(0, N, E).to(torch.int64)
    dst = (lambda lo, hi, *s: torch.randint(lo, hi, s))(0, N, E).to(torch.int64)
    deg_cnt = torch.bincount(dst, minlength=N).to(float) + 1.0
    sc = 1.0 / D ** 0.5
    return {
        "x": _w((lambda *s: torch.randn(*s, dtype=torch.bfloat16) * 0.1)(N, D)),
        "src": _w(src),
        "dst": _w(dst),
        "deg_inv_sqrt": _w(1.0 / (lambda _x: torch.sqrt(torch.as_tensor(_x)))(deg_cnt)),
        "wq": _w((lambda *s: torch.randn(*s, dtype=torch.bfloat16) * 1.6)(D, D) * sc),
        "wk": _w((lambda *s: torch.randn(*s, dtype=torch.bfloat16) * 1.6)(D, D) * sc),
        "wv": _w((lambda *s: torch.randn(*s, dtype=torch.bfloat16) * 0.1)(D, D) * sc),
        "wo": _w((lambda *s: torch.randn(*s, dtype=torch.bfloat16) * 0.1)(D, D) * sc),
        "w_r": _w((lambda *s: torch.randn(*s, dtype=torch.bfloat16) * 0.1)(D)),
    }

def reference(x, src, dst, deg_inv_sqrt, wq, wk, wv, wo, w_r):
    N, D = x.shape[0], x.shape[1]
    K = 7
    h = x
    toks = [x]
    for _ in range(K):
        msg = h[src] * deg_inv_sqrt[src, None] * deg_inv_sqrt[dst, None]
        h = _segment_sum(msg, dst, N)
        toks.append(h)
    tok = torch.stack(toks, axis=1)
    t = _layernorm(tok, axis=-1)
    q   = torch.einsum('nkd,de->nke', t, wq)
    key = torch.einsum('nkd,de->nke', t, wk)
    v   = torch.einsum('nkd,de->nke', t, wv)
    scale = 1.0 / (D ** 0.5)
    attn = _softmax(torch.einsum('nkd,nld->nkl', q, key) * scale, axis=-1)
    o = torch.einsum('nkl,nld->nkd', attn, v)
    o = tok + torch.einsum('nkd,de->nke', o, wo)
    r = _layernorm(o, axis=-1)
    alpha = _softmax(torch.einsum('nkd,d->nk', r, w_r), axis=-1)
    return torch.einsum('nk,nkd->nd', alpha, o)
```

```asm
; @launch kernel=prep_kernel grid=(251,1,1) block=(800,1,1) lds=14336
; @launch kernel=hops_kernel grid=(252,1,1) block=(832,1,1) lds=100864
; @launch kernel=tf_kernel grid=(256,1,1) block=(256,1,1) lds=100352
.amdgcn_target "amdgcn-amd-amdhsa--gfx950"
.text
.globl prep_kernel
.p2align 8
.type prep_kernel,@function
prep_kernel:
    s_cmp_ge_u32 s2, 251
    s_cbranch_scc1 prep_done
    s_load_dwordx2 s[4:5], s[0:1], 88
    s_cmp_ge_u32 s2, 250
    s_cbranch_scc1 prep_misc
    s_cmp_ge_u32 s2, 125
    s_cbranch_scc1 prep_x
    s_load_dwordx4 s[8:11], s[0:1], 8
    v_lshlrev_b32 v1, 2, v0
    v_mov_b32 v2, 0
    v_cmp_gt_u32 vcc, 128, v0
    s_and_saveexec_b64 s[20:21], vcc
    ds_write_b32 v1, v2
    s_mov_b64 exec, s[20:21]
    s_waitcnt lgkmcnt(0)
    s_mov_b32 s12, s8
    s_mov_b32 s13, s9
    s_mov_b32 s14, 1600000
    s_mov_b32 s15, 0x20000
    s_mov_b32 s16, s10
    s_mov_b32 s17, s11
    s_mov_b32 s18, 1600000
    s_mov_b32 s19, 0x20000
    s_mul_i32 s3, s2, 12800
    v_lshlrev_b32 v3, 4, v0
    buffer_load_dwordx4 v[4:7], v3, s[16:19], s3 offen
    buffer_load_dwordx4 v[8:11], v3, s[12:15], s3 offen
    s_barrier
    s_mov_b32 s22, 41944
    s_waitcnt vmcnt(1)
    v_mul_u32_u24 v12, s22, v4
    v_lshrrev_b32 v12, 23, v12
    v_mul_u32_u24 v16, 200, v12
    v_sub_u32 v16, v4, v16
    v_lshlrev_b32 v12, 2, v12
    v_mul_u32_u24 v13, s22, v5
    v_lshrrev_b32 v13, 23, v13
    v_mul_u32_u24 v17, 200, v13
    v_sub_u32 v17, v5, v17
    v_lshlrev_b32 v13, 2, v13
    v_mul_u32_u24 v14, s22, v6
    v_lshrrev_b32 v14, 23, v14
    v_mul_u32_u24 v18, 200, v14
    v_sub_u32 v18, v6, v18
    v_lshlrev_b32 v14, 2, v14
    v_mul_u32_u24 v15, s22, v7
    v_lshrrev_b32 v15, 23, v15
    v_mul_u32_u24 v19, 200, v15
    v_sub_u32 v19, v7, v19
    v_lshlrev_b32 v15, 2, v15
    v_mov_b32 v2, 1
    ds_add_rtn_u32 v20, v12, v2
    ds_add_rtn_u32 v21, v13, v2
    ds_add_rtn_u32 v22, v14, v2
    ds_add_rtn_u32 v23, v15, v2
    s_waitcnt vmcnt(0)
    v_lshl_or_b32 v16, v16, 16, v8
    v_lshl_or_b32 v16, v12, 22, v16
    v_lshl_or_b32 v17, v17, 16, v9
    v_lshl_or_b32 v17, v13, 22, v17
    v_lshl_or_b32 v18, v18, 16, v10
    v_lshl_or_b32 v18, v14, 22, v18
    v_lshl_or_b32 v19, v19, 16, v11
    v_lshl_or_b32 v19, v15, 22, v19
    s_waitcnt lgkmcnt(0)
    s_barrier
    v_cmp_gt_u32 vcc, 64, v0
    s_and_saveexec_b64 s[20:21], vcc
    s_cbranch_execz es_1
    v_lshlrev_b32 v3, 3, v0
    ds_read_b64 v[24:25], v3
    s_waitcnt lgkmcnt(0)
    v_add_u32 v26, v24, v25
    v_mov_b32 v27, v26
    s_nop 1
    v_add_u32_dpp v26, v26, v26 row_shr:1 row_mask:0xf bank_mask:0xf
    s_nop 1
    v_add_u32_dpp v26, v26, v26 row_shr:2 row_mask:0xf bank_mask:0xf
    s_nop 1
    v_add_u32_dpp v26, v26, v26 row_shr:4 row_mask:0xf bank_mask:0xf
    s_nop 1
    v_add_u32_dpp v26, v26, v26 row_shr:8 row_mask:0xf bank_mask:0xf
    s_nop 1
    v_add_u32_dpp v26, v26, v26 row_bcast:15 row_mask:0xa bank_mask:0xf
    s_nop 1
    v_add_u32_dpp v26, v26, v26 row_bcast:31 row_mask:0xc bank_mask:0xf
    s_nop 1
    v_sub_u32 v26, v26, v27
    v_add_u32 v27, v26, v24
    ds_write_b64 v3, v[26:27] offset:512
    s_add_u32 s24, s4, 52800000
    s_addc_u32 s25, s5, 0
    s_mov_b32 s26, 64000
    s_mov_b32 s27, 0x20000
    s_lshl_b32 s23, s2, 9
    buffer_store_dwordx2 v[26:27], v3, s[24:27], s23 offen
es_1:
    s_mov_b64 exec, s[20:21]
    s_waitcnt lgkmcnt(0)
    s_barrier
    ds_read_b32 v24, v12 offset:512
    ds_read_b32 v25, v13 offset:512
    ds_read_b32 v26, v14 offset:512
    ds_read_b32 v27, v15 offset:512
    s_waitcnt lgkmcnt(0)
    v_add_lshl_u32 v24, v24, v20, 2
    v_add_lshl_u32 v25, v25, v21, 2
    v_add_lshl_u32 v26, v26, v22, 2
    v_add_lshl_u32 v27, v27, v23, 2
    ds_write_b32 v24, v16 offset:1024
    ds_write_b32 v25, v17 offset:1024
    ds_write_b32 v26, v18 offset:1024
    ds_write_b32 v27, v19 offset:1024
    s_waitcnt lgkmcnt(0)
    s_barrier
    v_lshlrev_b32 v3, 4, v0
    ds_read_b128 v[4:7], v3 offset:1024
    s_add_u32 s24, s4, 51200000
    s_addc_u32 s25, s5, 0
    s_mov_b32 s26, 1600000
    s_mov_b32 s27, 0x20000
    s_add_u32 s28, s4, 57826816
    s_addc_u32 s29, s5, 0
    s_mov_b32 s30, 4000000
    s_mov_b32 s31, 0x20000
    s_waitcnt lgkmcnt(0)
    buffer_store_dwordx4 v[4:7], v3, s[24:27], s3 offen
    s_endpgm
prep_x:
    s_load_dwordx2 s[8:9], s[0:1], 0
    s_load_dwordx2 s[10:11], s[0:1], 24
    s_sub_u32 s3, s2, 125
    s_waitcnt lgkmcnt(0)
    s_mov_b32 s12, s8
    s_mov_b32 s13, s9
    s_mov_b32 s14, 6400000
    s_mov_b32 s15, 0x20000
    s_mov_b32 s16, s10
    s_mov_b32 s17, s11
    s_mov_b32 s18, 50000
    s_mov_b32 s19, 0x20000
    s_mov_b32 s24, s4
    s_mov_b32 s25, s5
    s_mov_b32 s26, 6400000
    s_mov_b32 s27, 0x20000
    s_mul_i32 s20, s3, 51200
    s_mul_i32 s21, s3, 400
    s_mul_i32 s22, s3, 25600
    v_add_u32 v1, 0, v0
    v_lshlrev_b32 v2, 4, v1
    buffer_load_dwordx4 v[8:11], v2, s[12:15], s20 offen
    v_lshrrev_b32 v3, 4, v1
    v_lshlrev_b32 v4, 1, v3
    buffer_load_ushort v24, v4, s[16:19], s21 offen
    v_and_b32 v4, 7, v1
    v_lshlrev_b32 v4, 4, v4
    v_lshl_add_u32 v4, v3, 7, v4
    v_bfe_u32 v5, v1, 3, 1
    s_mov_b32 s23, 3200000
    v_mad_u32_u24 v28, v5, s23, v4
    v_add_u32 v1, 800, v0
    v_lshlrev_b32 v2, 4, v1
    buffer_load_dwordx4 v[12:15], v2, s[12:15], s20 offen
    v_lshrrev_b32 v3, 4, v1
    v_lshlrev_b32 v4, 1, v3
    buffer_load_ushort v25, v4, s[16:19], s21 offen
    v_and_b32 v4, 7, v1
    v_lshlrev_b32 v4, 4, v4
    v_lshl_add_u32 v4, v3, 7, v4
    v_bfe_u32 v5, v1, 3, 1
    s_mov_b32 s23, 3200000
    v_mad_u32_u24 v29, v5, s23, v4
    v_add_u32 v1, 1600, v0
    v_lshlrev_b32 v2, 4, v1
    buffer_load_dwordx4 v[16:19], v2, s[12:15], s20 offen
    v_lshrrev_b32 v3, 4, v1
    v_lshlrev_b32 v4, 1, v3
    buffer_load_ushort v26, v4, s[16:19], s21 offen
    v_and_b32 v4, 7, v1
    v_lshlrev_b32 v4, 4, v4
    v_lshl_add_u32 v4, v3, 7, v4
    v_bfe_u32 v5, v1, 3, 1
    s_mov_b32 s23, 3200000
    v_mad_u32_u24 v30, v5, s23, v4
    v_add_u32 v1, 2400, v0
    v_lshlrev_b32 v2, 4, v1
    buffer_load_dwordx4 v[20:23], v2, s[12:15], s20 offen
    v_lshrrev_b32 v3, 4, v1
    v_lshlrev_b32 v4, 1, v3
    buffer_load_ushort v27, v4, s[16:19], s21 offen
    v_and_b32 v4, 7, v1
    v_lshlrev_b32 v4, 4, v4
    v_lshl_add_u32 v4, v3, 7, v4
    v_bfe_u32 v5, v1, 3, 1
    s_mov_b32 s23, 3200000
    v_mad_u32_u24 v31, v5, s23, v4
    s_mov_b32 s23, 0xffff0000
    s_add_u32 s28, s4, 54626816
    s_addc_u32 s29, s5, 0
    s_mov_b32 s30, 400000
    s_mov_b32 s31, 0x20000
    s_mul_i32 s32, s3, 3200
    s_mov_b32 s34, 0x01010101
    s_mov_b32 s35, 0x01010101
    s_waitcnt vmcnt(6)
    v_lshlrev_b32 v24, 16, v24
    v_mov_b32 v32, 0
    v_mov_b32 v33, 0
    v_lshlrev_b32 v2, 16, v8
    v_and_b32 v3, s23, v8
    v_add_f32 v32, v32, v2
    v_fmac_f32 v33, v2, v2
    v_add_f32 v32, v32, v3
    v_fmac_f32 v33, v3, v3
    v_mul_f32 v2, v2, v24
    v_mul_f32 v3, v3, v24
    v_cvt_pk_bf16_f32 v8, v2, v3
    v_lshlrev_b32 v2, 16, v9
    v_and_b32 v3, s23, v9
    v_add_f32 v32, v32, v2
    v_fmac_f32 v33, v2, v2
    v_add_f32 v32, v32, v3
    v_fmac_f32 v33, v3, v3
    v_mul_f32 v2, v2, v24
    v_mul_f32 v3, v3, v24
    v_cvt_pk_bf16_f32 v9, v2, v3
    v_lshlrev_b32 v2, 16, v10
    v_and_b32 v3, s23, v10
    v_add_f32 v32, v32, v2
    v_fmac_f32 v33, v2, v2
    v_add_f32 v32, v32, v3
    v_fmac_f32 v33, v3, v3
    v_mul_f32 v2, v2, v24
    v_mul_f32 v3, v3, v24
    v_cvt_pk_bf16_f32 v10, v2, v3
    v_lshlrev_b32 v2, 16, v11
    v_and_b32 v3, s23, v11
    v_add_f32 v32, v32, v2
    v_fmac_f32 v33, v2, v2
    v_add_f32 v32, v32, v3
    v_fmac_f32 v33, v3, v3
    v_mul_f32 v2, v2, v24
    v_mul_f32 v3, v3, v24
    v_cvt_pk_bf16_f32 v11, v2, v3
    buffer_store_dwordx4 v[8:11], v28, s[24:27], s22 offen
    s_nop 0
    v_add_f32_dpp v32, v32, v32 quad_perm:[1,0,3,2] row_mask:0xf bank_mask:0xf
    v_add_f32_dpp v33, v33, v33 quad_perm:[1,0,3,2] row_mask:0xf bank_mask:0xf
    s_nop 0
    v_add_f32_dpp v32, v32, v32 quad_perm:[2,3,0,1] row_mask:0xf bank_mask:0xf
    v_add_f32_dpp v33, v33, v33 quad_perm:[2,3,0,1] row_mask:0xf bank_mask:0xf
    s_nop 0
    v_add_f32_dpp v32, v32, v32 row_half_mirror row_mask:0xf bank_mask:0xf
    v_add_f32_dpp v33, v33, v33 row_half_mirror row_mask:0xf bank_mask:0xf
    v_add_u32 v34, 0, v0
    v_and_b32 v34, -8, v34
    s_mov_b64 s[36:37], exec
    s_and_b64 exec, exec, s[34:35]
    buffer_store_dwordx2 v[32:33], v34, s[28:31], s32 offen
    s_mov_b64 exec, s[36:37]
    s_waitcnt vmcnt(6)
    v_lshlrev_b32 v25, 16, v25
    v_mov_b32 v32, 0
    v_mov_b32 v33, 0
    v_lshlrev_b32 v2, 16, v12
    v_and_b32 v3, s23, v12
    v_add_f32 v32, v32, v2
    v_fmac_f32 v33, v2, v2
    v_add_f32 v32, v32, v3
    v_fmac_f32 v33, v3, v3
    v_mul_f32 v2, v2, v25
    v_mul_f32 v3, v3, v25
    v_cvt_pk_bf16_f32 v12, v2, v3
    v_lshlrev_b32 v2, 16, v13
    v_and_b32 v3, s23, v13
    v_add_f32 v32, v32, v2
    v_fmac_f32 v33, v2, v2
    v_add_f32 v32, v32, v3
    v_fmac_f32 v33, v3, v3
    v_mul_f32 v2, v2, v25
    v_mul_f32 v3, v3, v25
    v_cvt_pk_bf16_f32 v13, v2, v3
    v_lshlrev_b32 v2, 16, v14
    v_and_b32 v3, s23, v14
    v_add_f32 v32, v32, v2
    v_fmac_f32 v33, v2, v2
    v_add_f32 v32, v32, v3
    v_fmac_f32 v33, v3, v3
    v_mul_f32 v2, v2, v25
    v_mul_f32 v3, v3, v25
    v_cvt_pk_bf16_f32 v14, v2, v3
    v_lshlrev_b32 v2, 16, v15
    v_and_b32 v3, s23, v15
    v_add_f32 v32, v32, v2
    v_fmac_f32 v33, v2, v2
    v_add_f32 v32, v32, v3
    v_fmac_f32 v33, v3, v3
    v_mul_f32 v2, v2, v25
    v_mul_f32 v3, v3, v25
    v_cvt_pk_bf16_f32 v15, v2, v3
    buffer_store_dwordx4 v[12:15], v29, s[24:27], s22 offen
    s_nop 0
    v_add_f32_dpp v32, v32, v32 quad_perm:[1,0,3,2] row_mask:0xf bank_mask:0xf
    v_add_f32_dpp v33, v33, v33 quad_perm:[1,0,3,2] row_mask:0xf bank_mask:0xf
    s_nop 0
    v_add_f32_dpp v32, v32, v32 quad_perm:[2,3,0,1] row_mask:0xf bank_mask:0xf
    v_add_f32_dpp v33, v33, v33 quad_perm:[2,3,0,1] row_mask:0xf bank_mask:0xf
    s_nop 0
    v_add_f32_dpp v32, v32, v32 row_half_mirror row_mask:0xf bank_mask:0xf
    v_add_f32_dpp v33, v33, v33 row_half_mirror row_mask:0xf bank_mask:0xf
    v_add_u32 v34, 800, v0
    v_and_b32 v34, -8, v34
    s_mov_b64 s[36:37], exec
    s_and_b64 exec, exec, s[34:35]
    buffer_store_dwordx2 v[32:33], v34, s[28:31], s32 offen
    s_mov_b64 exec, s[36:37]
    s_waitcnt vmcnt(6)
    v_lshlrev_b32 v26, 16, v26
    v_mov_b32 v32, 0
    v_mov_b32 v33, 0
    v_lshlrev_b32 v2, 16, v16
    v_and_b32 v3, s23, v16
    v_add_f32 v32, v32, v2
    v_fmac_f32 v33, v2, v2
    v_add_f32 v32, v32, v3
    v_fmac_f32 v33, v3, v3
    v_mul_f32 v2, v2, v26
    v_mul_f32 v3, v3, v26
    v_cvt_pk_bf16_f32 v16, v2, v3
    v_lshlrev_b32 v2, 16, v17
    v_and_b32 v3, s23, v17
    v_add_f32 v32, v32, v2
    v_fmac_f32 v33, v2, v2
    v_add_f32 v32, v32, v3
    v_fmac_f32 v33, v3, v3
    v_mul_f32 v2, v2, v26
    v_mul_f32 v3, v3, v26
    v_cvt_pk_bf16_f32 v17, v2, v3
    v_lshlrev_b32 v2, 16, v18
    v_and_b32 v3, s23, v18
    v_add_f32 v32, v32, v2
    v_fmac_f32 v33, v2, v2
    v_add_f32 v32, v32, v3
    v_fmac_f32 v33, v3, v3
    v_mul_f32 v2, v2, v26
    v_mul_f32 v3, v3, v26
    v_cvt_pk_bf16_f32 v18, v2, v3
    v_lshlrev_b32 v2, 16, v19
    v_and_b32 v3, s23, v19
    v_add_f32 v32, v32, v2
    v_fmac_f32 v33, v2, v2
    v_add_f32 v32, v32, v3
    v_fmac_f32 v33, v3, v3
    v_mul_f32 v2, v2, v26
    v_mul_f32 v3, v3, v26
    v_cvt_pk_bf16_f32 v19, v2, v3
    buffer_store_dwordx4 v[16:19], v30, s[24:27], s22 offen
    s_nop 0
    v_add_f32_dpp v32, v32, v32 quad_perm:[1,0,3,2] row_mask:0xf bank_mask:0xf
    v_add_f32_dpp v33, v33, v33 quad_perm:[1,0,3,2] row_mask:0xf bank_mask:0xf
    s_nop 0
    v_add_f32_dpp v32, v32, v32 quad_perm:[2,3,0,1] row_mask:0xf bank_mask:0xf
    v_add_f32_dpp v33, v33, v33 quad_perm:[2,3,0,1] row_mask:0xf bank_mask:0xf
    s_nop 0
    v_add_f32_dpp v32, v32, v32 row_half_mirror row_mask:0xf bank_mask:0xf
    v_add_f32_dpp v33, v33, v33 row_half_mirror row_mask:0xf bank_mask:0xf
    v_add_u32 v34, 1600, v0
    v_and_b32 v34, -8, v34
    s_mov_b64 s[36:37], exec
    s_and_b64 exec, exec, s[34:35]
    buffer_store_dwordx2 v[32:33], v34, s[28:31], s32 offen
    s_mov_b64 exec, s[36:37]
    s_waitcnt vmcnt(6)
    v_lshlrev_b32 v27, 16, v27
    v_mov_b32 v32, 0
    v_mov_b32 v33, 0
    v_lshlrev_b32 v2, 16, v20
    v_and_b32 v3, s23, v20
    v_add_f32 v32, v32, v2
    v_fmac_f32 v33, v2, v2
    v_add_f32 v32, v32, v3
    v_fmac_f32 v33, v3, v3
    v_mul_f32 v2, v2, v27
    v_mul_f32 v3, v3, v27
    v_cvt_pk_bf16_f32 v20, v2, v3
    v_lshlrev_b32 v2, 16, v21
    v_and_b32 v3, s23, v21
    v_add_f32 v32, v32, v2
    v_fmac_f32 v33, v2, v2
    v_add_f32 v32, v32, v3
    v_fmac_f32 v33, v3, v3
    v_mul_f32 v2, v2, v27
    v_mul_f32 v3, v3, v27
    v_cvt_pk_bf16_f32 v21, v2, v3
    v_lshlrev_b32 v2, 16, v22
    v_and_b32 v3, s23, v22
    v_add_f32 v32, v32, v2
    v_fmac_f32 v33, v2, v2
    v_add_f32 v32, v32, v3
    v_fmac_f32 v33, v3, v3
    v_mul_f32 v2, v2, v27
    v_mul_f32 v3, v3, v27
    v_cvt_pk_bf16_f32 v22, v2, v3
    v_lshlrev_b32 v2, 16, v23
    v_and_b32 v3, s23, v23
    v_add_f32 v32, v32, v2
    v_fmac_f32 v33, v2, v2
    v_add_f32 v32, v32, v3
    v_fmac_f32 v33, v3, v3
    v_mul_f32 v2, v2, v27
    v_mul_f32 v3, v3, v27
    v_cvt_pk_bf16_f32 v23, v2, v3
    buffer_store_dwordx4 v[20:23], v31, s[24:27], s22 offen
    s_nop 0
    v_add_f32_dpp v32, v32, v32 quad_perm:[1,0,3,2] row_mask:0xf bank_mask:0xf
    v_add_f32_dpp v33, v33, v33 quad_perm:[1,0,3,2] row_mask:0xf bank_mask:0xf
    s_nop 0
    v_add_f32_dpp v32, v32, v32 quad_perm:[2,3,0,1] row_mask:0xf bank_mask:0xf
    v_add_f32_dpp v33, v33, v33 quad_perm:[2,3,0,1] row_mask:0xf bank_mask:0xf
    s_nop 0
    v_add_f32_dpp v32, v32, v32 row_half_mirror row_mask:0xf bank_mask:0xf
    v_add_f32_dpp v33, v33, v33 row_half_mirror row_mask:0xf bank_mask:0xf
    v_add_u32 v34, 2400, v0
    v_and_b32 v34, -8, v34
    s_mov_b64 s[36:37], exec
    s_and_b64 exec, exec, s[34:35]
    buffer_store_dwordx2 v[32:33], v34, s[28:31], s32 offen
    s_mov_b64 exec, s[36:37]
    s_endpgm
prep_misc:
    s_waitcnt lgkmcnt(0)
    s_add_u32 s24, s4, 52928000
    s_addc_u32 s25, s5, 0
    s_mov_b32 s26, 32768
    s_mov_b32 s27, 0x20000
    v_lshlrev_b32 v1, 4, v0
    v_mov_b32 v4, 0
    v_mov_b32 v5, 0
    v_mov_b32 v6, 0
    v_mov_b32 v7, 0
    s_mov_b32 s3, 0
    buffer_store_dwordx4 v[4:7], v1, s[24:27], s3 offen
    s_mov_b32 s3, 12800
    buffer_store_dwordx4 v[4:7], v1, s[24:27], s3 offen
    s_mov_b32 s3, 25600
    buffer_store_dwordx4 v[4:7], v1, s[24:27], s3 offen
    s_endpgm
prep_done:
    s_endpgm
.globl hops_kernel
.p2align 8
.type hops_kernel,@function
hops_kernel:
    s_cmp_ge_u32 s2, 252
    s_cbranch_scc1 hops_done
    s_load_dwordx2 s[4:5], s[0:1], 88
    s_cmp_ge_u32 s2, 250
    s_cbranch_scc1 hops_wprep
    s_load_dwordx2 s[44:45], s[0:1], 24
    s_and_b32 s7, s2, 1
    s_lshr_b32 s8, s2, 1
    v_lshrrev_b32 v4, 2, v0
    v_and_b32 v5, 3, v0
    v_lshlrev_b32 v6, 9, v4
    s_lshl_b32 s9, s8, 2
    s_mul_i32 s10, s8, 400
    v_lshlrev_b32 v7, 1, v0
    s_waitcnt lgkmcnt(0)
    s_add_u32 s12, s4, 52800000
    s_addc_u32 s13, s5, 0
    s_mov_b32 s14, 64000
    s_mov_b32 s15, 0x20000
    buffer_load_dwordx2 v[8:9], v6, s[12:15], s9 offen
    s_mov_b32 s60, s44
    s_mov_b32 s61, s45
    s_mov_b32 s62, 50000
    s_mov_b32 s63, 0x20000
    buffer_load_ushort v43, v7, s[60:63], s10 offen
    s_add_u32 s16, s4, 51200000
    s_addc_u32 s17, s5, 0
    s_mov_b32 s18, 1600000
    s_mov_b32 s19, 0x20000
    v_lshrrev_b32 v1, 6, v0
    s_nop 0
    v_readfirstlane_b32 s6, v1
    v_lshlrev_b32 v1, 2, v0
    v_mov_b32 v2, 0
    v_mov_b32 v3, -1
    ds_write_b32 v1, v2 offset:0
    ds_write_b32 v1, v2 offset:3328
    ds_write_b32 v1, v3 offset:11968
    ds_write_b32 v1, v3 offset:15296
    ds_write_b32 v1, v3 offset:18624
    ds_write_b32 v1, v3 offset:21952
    ds_write_b32 v1, v3 offset:25280
    v_cmp_gt_u32 vcc, 208, v0
    s_and_saveexec_b64 s[20:21], vcc
    ds_write_b32 v1, v3 offset:7744
    ds_write_b32 v1, v2 offset:8576
    s_mov_b64 exec, s[20:21]
    v_cmp_gt_u32 vcc, 16, v0
    s_and_saveexec_b64 s[20:21], vcc
    ds_write_b32 v1, v2 offset:11904
    s_mov_b64 exec, s[20:21]
    s_waitcnt lgkmcnt(0)
    s_waitcnt vmcnt(1)
    v_sub_u32 v10, v9, v8
    v_mul_u32_u24 v11, 3200, v4
    v_add_u32 v11, v11, v8
    v_lshl_add_u32 v11, v5, 2, v11
    v_lshlrev_b32 v11, 2, v11
    v_lshlrev_b32 v12, 2, v5
    buffer_load_dwordx4 v[44:47], v11, s[16:19], 0 offen offset:0
    buffer_load_dwordx4 v[48:51], v11, s[16:19], 0 offen offset:64
    buffer_load_dwordx4 v[52:55], v11, s[16:19], 0 offen offset:128
    buffer_load_dwordx4 v[56:59], v11, s[16:19], 0 offen offset:192
    s_barrier
    v_cmp_eq_u32 vcc, 0, v5
    s_and_saveexec_b64 s[20:21], vcc
    v_mov_b32 v13, 11904
    ds_add_u32 v13, v8
    s_mov_b64 exec, s[20:21]
    s_waitcnt vmcnt(0)
    v_mov_b32 v30, 1
    s_mov_b64 s[22:23], exec
    v_add_u32 v15, 0, v12
    v_cmp_lt_u32 vcc, v15, v10
    s_cbranch_vccz epd_2
    v_bfe_u32 v24, v44, 16, 8
    v_bfe_u32 v25, v44, 12, 4
    v_lshl_add_u32 v25, v24, 3, v25
    v_lshlrev_b32 v25, 2, v25
    v_bfe_u32 v24, v45, 16, 8
    v_bfe_u32 v26, v45, 12, 4
    v_lshl_add_u32 v26, v24, 3, v26
    v_lshlrev_b32 v26, 2, v26
    v_bfe_u32 v24, v46, 16, 8
    v_bfe_u32 v27, v46, 12, 4
    v_lshl_add_u32 v27, v24, 3, v27
    v_lshlrev_b32 v27, 2, v27
    v_bfe_u32 v24, v47, 16, 8
    v_bfe_u32 v28, v47, 12, 4
    v_lshl_add_u32 v28, v24, 3, v28
    v_lshlrev_b32 v28, 2, v28
    v_add_u32 v24, 0, v15
    v_cmp_lt_u32 vcc, v24, v10
    s_and_b64 exec, s[22:23], vcc
    ds_add_u32 v25, v30 offset:0
    v_add_u32 v24, 1, v15
    v_cmp_lt_u32 vcc, v24, v10
    s_and_b64 exec, s[22:23], vcc
    ds_add_u32 v26, v30 offset:0
    v_add_u32 v24, 2, v15
    v_cmp_lt_u32 vcc, v24, v10
    s_and_b64 exec, s[22:23], vcc
    ds_add_u32 v27, v30 offset:0
    v_add_u32 v24, 3, v15
    v_cmp_lt_u32 vcc, v24, v10
    s_and_b64 exec, s[22:23], vcc
    ds_add_u32 v28, v30 offset:0
    s_mov_b64 exec, s[22:23]
    v_add_u32 v15, 16, v12
    v_cmp_lt_u32 vcc, v15, v10
    s_cbranch_vccz epd_2
    v_bfe_u32 v24, v48, 16, 8
    v_bfe_u32 v25, v48, 12, 4
    v_lshl_add_u32 v25, v24, 3, v25
    v_lshlrev_b32 v25, 2, v25
    v_bfe_u32 v24, v49, 16, 8
    v_bfe_u32 v26, v49, 12, 4
    v_lshl_add_u32 v26, v24, 3, v26
    v_lshlrev_b32 v26, 2, v26
    v_bfe_u32 v24, v50, 16, 8
    v_bfe_u32 v27, v50, 12, 4
    v_lshl_add_u32 v27, v24, 3, v27
    v_lshlrev_b32 v27, 2, v27
    v_bfe_u32 v24, v51, 16, 8
    v_bfe_u32 v28, v51, 12, 4
    v_lshl_add_u32 v28, v24, 3, v28
    v_lshlrev_b32 v28, 2, v28
    v_add_u32 v24, 0, v15
    v_cmp_lt_u32 vcc, v24, v10
    s_and_b64 exec, s[22:23], vcc
    ds_add_u32 v25, v30 offset:0
    v_add_u32 v24, 1, v15
    v_cmp_lt_u32 vcc, v24, v10
    s_and_b64 exec, s[22:23], vcc
    ds_add_u32 v26, v30 offset:0
    v_add_u32 v24, 2, v15
    v_cmp_lt_u32 vcc, v24, v10
    s_and_b64 exec, s[22:23], vcc
    ds_add_u32 v27, v30 offset:0
    v_add_u32 v24, 3, v15
    v_cmp_lt_u32 vcc, v24, v10
    s_and_b64 exec, s[22:23], vcc
    ds_add_u32 v28, v30 offset:0
    s_mov_b64 exec, s[22:23]
    v_add_u32 v15, 32, v12
    v_cmp_lt_u32 vcc, v15, v10
    s_cbranch_vccz epd_2
    v_bfe_u32 v24, v52, 16, 8
    v_bfe_u32 v25, v52, 12, 4
    v_lshl_add_u32 v25, v24, 3, v25
    v_lshlrev_b32 v25, 2, v25
    v_bfe_u32 v24, v53, 16, 8
    v_bfe_u32 v26, v53, 12, 4
    v_lshl_add_u32 v26, v24, 3, v26
    v_lshlrev_b32 v26, 2, v26
    v_bfe_u32 v24, v54, 16, 8
    v_bfe_u32 v27, v54, 12, 4
    v_lshl_add_u32 v27, v24, 3, v27
    v_lshlrev_b32 v27, 2, v27
    v_bfe_u32 v24, v55, 16, 8
    v_bfe_u32 v28, v55, 12, 4
    v_lshl_add_u32 v28, v24, 3, v28
    v_lshlrev_b32 v28, 2, v28
    v_add_u32 v24, 0, v15
    v_cmp_lt_u32 vcc, v24, v10
    s_and_b64 exec, s[22:23], vcc
    ds_add_u32 v25, v30 offset:0
    v_add_u32 v24, 1, v15
    v_cmp_lt_u32 vcc, v24, v10
    s_and_b64 exec, s[22:23], vcc
    ds_add_u32 v26, v30 offset:0
    v_add_u32 v24, 2, v15
    v_cmp_lt_u32 vcc, v24, v10
    s_and_b64 exec, s[22:23], vcc
    ds_add_u32 v27, v30 offset:0
    v_add_u32 v24, 3, v15
    v_cmp_lt_u32 vcc, v24, v10
    s_and_b64 exec, s[22:23], vcc
    ds_add_u32 v28, v30 offset:0
    s_mov_b64 exec, s[22:23]
    v_add_u32 v15, 48, v12
    v_cmp_lt_u32 vcc, v15, v10
    s_cbranch_vccz epd_2
    v_bfe_u32 v24, v56, 16, 8
    v_bfe_u32 v25, v56, 12, 4
    v_lshl_add_u32 v25, v24, 3, v25
    v_lshlrev_b32 v25, 2, v25
    v_bfe_u32 v24, v57, 16, 8
    v_bfe_u32 v26, v57, 12, 4
    v_lshl_add_u32 v26, v24, 3, v26
    v_lshlrev_b32 v26, 2, v26
    v_bfe_u32 v24, v58, 16, 8
    v_bfe_u32 v27, v58, 12, 4
    v_lshl_add_u32 v27, v24, 3, v27
    v_lshlrev_b32 v27, 2, v27
    v_bfe_u32 v24, v59, 16, 8
    v_bfe_u32 v28, v59, 12, 4
    v_lshl_add_u32 v28, v24, 3, v28
    v_lshlrev_b32 v28, 2, v28
    v_add_u32 v24, 0, v15
    v_cmp_lt_u32 vcc, v24, v10
    s_and_b64 exec, s[22:23], vcc
    ds_add_u32 v25, v30 offset:0
    v_add_u32 v24, 1, v15
    v_cmp_lt_u32 vcc, v24, v10
    s_and_b64 exec, s[22:23], vcc
    ds_add_u32 v26, v30 offset:0
    v_add_u32 v24, 2, v15
    v_cmp_lt_u32 vcc, v24, v10
    s_and_b64 exec, s[22:23], vcc
    ds_add_u32 v27, v30 offset:0
    v_add_u32 v24, 3, v15
    v_cmp_lt_u32 vcc, v24, v10
    s_and_b64 exec, s[22:23], vcc
    ds_add_u32 v28, v30 offset:0
    s_mov_b64 exec, s[22:23]
    v_add_u32 v14, 256, v11
    v_add_u32 v15, 64, v12
ep_3:
    v_cmp_lt_u32 vcc, v15, v10
    s_cbranch_vccz epd_2
    buffer_load_dwordx4 v[16:19], v14, s[16:19], 0 offen
    s_waitcnt vmcnt(0)
    v_bfe_u32 v24, v16, 16, 8
    v_bfe_u32 v25, v16, 12, 4
    v_lshl_add_u32 v25, v24, 3, v25
    v_lshlrev_b32 v25, 2, v25
    v_bfe_u32 v24, v17, 16, 8
    v_bfe_u32 v26, v17, 12, 4
    v_lshl_add_u32 v26, v24, 3, v26
    v_lshlrev_b32 v26, 2, v26
    v_bfe_u32 v24, v18, 16, 8
    v_bfe_u32 v27, v18, 12, 4
    v_lshl_add_u32 v27, v24, 3, v27
    v_lshlrev_b32 v27, 2, v27
    v_bfe_u32 v24, v19, 16, 8
    v_bfe_u32 v28, v19, 12, 4
    v_lshl_add_u32 v28, v24, 3, v28
    v_lshlrev_b32 v28, 2, v28
    v_add_u32 v24, 0, v15
    v_cmp_lt_u32 vcc, v24, v10
    s_and_b64 exec, s[22:23], vcc
    ds_add_u32 v25, v30 offset:0
    v_add_u32 v24, 1, v15
    v_cmp_lt_u32 vcc, v24, v10
    s_and_b64 exec, s[22:23], vcc
    ds_add_u32 v26, v30 offset:0
    v_add_u32 v24, 2, v15
    v_cmp_lt_u32 vcc, v24, v10
    s_and_b64 exec, s[22:23], vcc
    ds_add_u32 v27, v30 offset:0
    v_add_u32 v24, 3, v15
    v_cmp_lt_u32 vcc, v24, v10
    s_and_b64 exec, s[22:23], vcc
    ds_add_u32 v28, v30 offset:0
    s_mov_b64 exec, s[22:23]
    v_add_u32 v14, 64, v14
    v_add_u32 v15, 16, v15
    s_branch ep_3
epd_2:
    s_waitcnt lgkmcnt(0)
    s_barrier
    v_cmp_gt_u32 vcc, 200, v0
    s_and_saveexec_b64 s[20:21], vcc
    s_cbranch_execz np_4
    v_lshlrev_b32 v1, 5, v0
    ds_read_b128 v[16:19], v1 offset:0
    ds_read_b128 v[20:23], v1 offset:16
    s_waitcnt lgkmcnt(0)
    v_mov_b32 v24, 0
    v_mov_b32 v25, v16
    v_mov_b32 v16, v24
    v_add_u32 v24, v24, v25
    v_mov_b32 v25, v17
    v_mov_b32 v17, v24
    v_add_u32 v24, v24, v25
    v_mov_b32 v25, v18
    v_mov_b32 v18, v24
    v_add_u32 v24, v24, v25
    v_mov_b32 v25, v19
    v_mov_b32 v19, v24
    v_add_u32 v24, v24, v25
    v_mov_b32 v25, v20
    v_mov_b32 v20, v24
    v_add_u32 v24, v24, v25
    v_mov_b32 v25, v21
    v_mov_b32 v21, v24
    v_add_u32 v24, v24, v25
    v_mov_b32 v25, v22
    v_mov_b32 v22, v24
    v_add_u32 v24, v24, v25
    v_mov_b32 v25, v23
    v_mov_b32 v23, v24
    v_add_u32 v24, v24, v25
    ds_write_b128 v1, v[16:19] offset:0
    ds_write_b128 v1, v[20:23] offset:16
    v_mov_b32 v40, v24
    v_min_u32 v41, 40, v24
    v_lshlrev_b32 v41, 2, v41
    v_mov_b32 v30, 1
    ds_add_rtn_u32 v42, v41, v30 offset:6400
    v_lshlrev_b32 v1, 2, v0
    ds_write_b32 v1, v40 offset:9408
    v_lshlrev_b32 v43, 16, v43
    v_mul_f32 v43, v43, v43
    ds_write_b32 v1, v43 offset:11072
    v_cmp_lt_u32 vcc, 40, v40
    s_and_b64 exec, exec, vcc
    v_mov_b32 v13, 11908
    ds_write_b32 v13, v30
np_4:
    s_mov_b64 exec, s[20:21]
    s_waitcnt lgkmcnt(0)
    s_barrier
    s_cmp_eq_u32 s6, 0
    s_cbranch_scc0 w0_5
    v_lshlrev_b32 v1, 2, v0
    ds_read_b32 v16, v1 offset:6400
    v_mov_b32 v13, 11904
    ds_read_b64 v[18:19], v13
    s_waitcnt lgkmcnt(0)
    s_nop 1
    v_add_u32_dpp v16, v16, v16 row_shr:1 row_mask:0xf bank_mask:0xf
    s_nop 1
    v_add_u32_dpp v16, v16, v16 row_shr:2 row_mask:0xf bank_mask:0xf
    s_nop 1
    v_add_u32_dpp v16, v16, v16 row_shr:4 row_mask:0xf bank_mask:0xf
    s_nop 1
    v_add_u32_dpp v16, v16, v16 row_shr:8 row_mask:0xf bank_mask:0xf
    s_nop 1
    v_add_u32_dpp v16, v16, v16 row_bcast:15 row_mask:0xa bank_mask:0xf
    s_nop 1
    v_add_u32_dpp v16, v16, v16 row_bcast:31 row_mask:0xc bank_mask:0xf
    s_nop 1
    v_sub_u32 v16, 200, v16
    ds_write_b32 v1, v16 offset:6656
    v_readfirstlane_b32 s9, v18
    v_readfirstlane_b32 s10, v19
    s_nop 3
    s_cmp_eq_u32 s10, 0
    s_cbranch_scc1 w0_5
    s_mov_b32 s11, 0
ov_6:
    s_lshl_b32 s20, s11, 2
    v_mov_b32 v1, s20
    ds_read_b32 v16, v1 offset:9408
    v_mov_b32 v17, s9
    ds_write_b32 v1, v17 offset:10240
    s_waitcnt lgkmcnt(0)
    v_readfirstlane_b32 s20, v16
    s_nop 3
    s_max_u32 s20, s20, 40
    s_sub_u32 s20, s20, 40
    s_add_u32 s9, s9, s20
    s_add_u32 s11, s11, 1
    s_cmp_lt_u32 s11, 200
    s_cbranch_scc1 ov_6
w0_5:
    s_waitcnt lgkmcnt(0)
    s_barrier
    v_cmp_gt_u32 vcc, 200, v0
    s_and_saveexec_b64 s[20:21], vcc
    s_cbranch_execz np_7
    ds_read_b32 v16, v41 offset:6656
    s_waitcnt lgkmcnt(0)
    v_add_u32 v16, v16, v42
    v_lshlrev_b32 v1, 2, v0
    ds_write_b32 v1, v16 offset:6912
    v_lshlrev_b32 v16, 2, v16
    ds_write_b32 v16, v0 offset:7744
    ds_write_b32 v16, v40 offset:8576
np_7:
    s_mov_b64 exec, s[20:21]
    s_mul_i32 s9, s7, 800000
    s_add_u32 s9, s9, 53026816
    s_add_u32 s48, s4, s9
    s_addc_u32 s49, s5, 0
    s_mov_b32 s50, 800000
    s_mov_b32 s51, 0x20000
    s_waitcnt lgkmcnt(0)
    s_barrier
    v_mov_b32 v30, 1
    s_mov_b64 s[22:23], exec
    v_add_u32 v15, 0, v12
    v_cmp_lt_u32 vcc, v15, v10
    s_cbranch_vccz fa_9
    v_bfe_u32 v24, v44, 16, 8
    v_bfe_u32 v25, v44, 12, 4
    v_lshl_add_u32 v25, v24, 3, v25
    v_lshlrev_b32 v25, 2, v25
    v_bfe_u32 v20, v44, 16, 8
    v_lshlrev_b32 v20, 2, v20
    v_bfe_u32 v24, v45, 16, 8
    v_bfe_u32 v26, v45, 12, 4
    v_lshl_add_u32 v26, v24, 3, v26
    v_lshlrev_b32 v26, 2, v26
    v_bfe_u32 v21, v45, 16, 8
    v_lshlrev_b32 v21, 2, v21
    v_bfe_u32 v24, v46, 16, 8
    v_bfe_u32 v27, v46, 12, 4
    v_lshl_add_u32 v27, v24, 3, v27
    v_lshlrev_b32 v27, 2, v27
    v_bfe_u32 v22, v46, 16, 8
    v_lshlrev_b32 v22, 2, v22
    v_bfe_u32 v24, v47, 16, 8
    v_bfe_u32 v28, v47, 12, 4
    v_lshl_add_u32 v28, v24, 3, v28
    v_lshlrev_b32 v28, 2, v28
    v_bfe_u32 v23, v47, 16, 8
    v_lshlrev_b32 v23, 2, v23
    v_add_u32 v24, 0, v15
    v_cmp_lt_u32 vcc, v24, v10
    s_and_b64 exec, s[22:23], vcc
    ds_add_rtn_u32 v60, v25, v30 offset:0
    ds_read_b32 v76, v20 offset:6912
    v_add_u32 v24, 1, v15
    v_cmp_lt_u32 vcc, v24, v10
    s_and_b64 exec, s[22:23], vcc
    ds_add_rtn_u32 v61, v26, v30 offset:0
    ds_read_b32 v77, v21 offset:6912
    v_add_u32 v24, 2, v15
    v_cmp_lt_u32 vcc, v24, v10
    s_and_b64 exec, s[22:23], vcc
    ds_add_rtn_u32 v62, v27, v30 offset:0
    ds_read_b32 v78, v22 offset:6912
    v_add_u32 v24, 3, v15
    v_cmp_lt_u32 vcc, v24, v10
    s_and_b64 exec, s[22:23], vcc
    ds_add_rtn_u32 v63, v28, v30 offset:0
    ds_read_b32 v79, v23 offset:6912
    s_mov_b64 exec, s[22:23]
    s_waitcnt lgkmcnt(6)
    v_add_u32 v15, 16, v12
    v_cmp_lt_u32 vcc, v15, v10
    s_cbranch_vccz fa_9
    v_bfe_u32 v24, v48, 16, 8
    v_bfe_u32 v25, v48, 12, 4
    v_lshl_add_u32 v25, v24, 3, v25
    v_lshlrev_b32 v25, 2, v25
    v_bfe_u32 v20, v48, 16, 8
    v_lshlrev_b32 v20, 2, v20
    v_bfe_u32 v24, v49, 16, 8
    v_bfe_u32 v26, v49, 12, 4
    v_lshl_add_u32 v26, v24, 3, v26
    v_lshlrev_b32 v26, 2, v26
    v_bfe_u32 v21, v49, 16, 8
    v_lshlrev_b32 v21, 2, v21
    v_bfe_u32 v24, v50, 16, 8
    v_bfe_u32 v27, v50, 12, 4
    v_lshl_add_u32 v27, v24, 3, v27
    v_lshlrev_b32 v27, 2, v27
    v_bfe_u32 v22, v50, 16, 8
    v_lshlrev_b32 v22, 2, v22
    v_bfe_u32 v24, v51, 16, 8
    v_bfe_u32 v28, v51, 12, 4
    v_lshl_add_u32 v28, v24, 3, v28
    v_lshlrev_b32 v28, 2, v28
    v_bfe_u32 v23, v51, 16, 8
    v_lshlrev_b32 v23, 2, v23
    v_add_u32 v24, 0, v15
    v_cmp_lt_u32 vcc, v24, v10
    s_and_b64 exec, s[22:23], vcc
    ds_add_rtn_u32 v64, v25, v30 offset:0
    ds_read_b32 v80, v20 offset:6912
    v_add_u32 v24, 1, v15
    v_cmp_lt_u32 vcc, v24, v10
    s_and_b64 exec, s[22:23], vcc
    ds_add_rtn_u32 v65, v26, v30 offset:0
    ds_read_b32 v81, v21 offset:6912
    v_add_u32 v24, 2, v15
    v_cmp_lt_u32 vcc, v24, v10
    s_and_b64 exec, s[22:23], vcc
    ds_add_rtn_u32 v66, v27, v30 offset:0
    ds_read_b32 v82, v22 offset:6912
    v_add_u32 v24, 3, v15
    v_cmp_lt_u32 vcc, v24, v10
    s_and_b64 exec, s[22:23], vcc
    ds_add_rtn_u32 v67, v28, v30 offset:0
    ds_read_b32 v83, v23 offset:6912
    s_mov_b64 exec, s[22:23]
    s_waitcnt lgkmcnt(6)
    v_add_u32 v15, 32, v12
    v_cmp_lt_u32 vcc, v15, v10
    s_cbranch_vccz fa_9
    v_bfe_u32 v24, v52, 16, 8
    v_bfe_u32 v25, v52, 12, 4
    v_lshl_add_u32 v25, v24, 3, v25
    v_lshlrev_b32 v25, 2, v25
    v_bfe_u32 v20, v52, 16, 8
    v_lshlrev_b32 v20, 2, v20
    v_bfe_u32 v24, v53, 16, 8
    v_bfe_u32 v26, v53, 12, 4
    v_lshl_add_u32 v26, v24, 3, v26
    v_lshlrev_b32 v26, 2, v26
    v_bfe_u32 v21, v53, 16, 8
    v_lshlrev_b32 v21, 2, v21
    v_bfe_u32 v24, v54, 16, 8
    v_bfe_u32 v27, v54, 12, 4
    v_lshl_add_u32 v27, v24, 3, v27
    v_lshlrev_b32 v27, 2, v27
    v_bfe_u32 v22, v54, 16, 8
    v_lshlrev_b32 v22, 2, v22
    v_bfe_u32 v24, v55, 16, 8
    v_bfe_u32 v28, v55, 12, 4
    v_lshl_add_u32 v28, v24, 3, v28
    v_lshlrev_b32 v28, 2, v28
    v_bfe_u32 v23, v55, 16, 8
    v_lshlrev_b32 v23, 2, v23
    v_add_u32 v24, 0, v15
    v_cmp_lt_u32 vcc, v24, v10
    s_and_b64 exec, s[22:23], vcc
    ds_add_rtn_u32 v68, v25, v30 offset:0
    ds_read_b32 v84, v20 offset:6912
    v_add_u32 v24, 1, v15
    v_cmp_lt_u32 vcc, v24, v10
    s_and_b64 exec, s[22:23], vcc
    ds_add_rtn_u32 v69, v26, v30 offset:0
    ds_read_b32 v85, v21 offset:6912
    v_add_u32 v24, 2, v15
    v_cmp_lt_u32 vcc, v24, v10
    s_and_b64 exec, s[22:23], vcc
    ds_add_rtn_u32 v70, v27, v30 offset:0
    ds_read_b32 v86, v22 offset:6912
    v_add_u32 v24, 3, v15
    v_cmp_lt_u32 vcc, v24, v10
    s_and_b64 exec, s[22:23], vcc
    ds_add_rtn_u32 v71, v28, v30 offset:0
    ds_read_b32 v87, v23 offset:6912
    s_mov_b64 exec, s[22:23]
    s_waitcnt lgkmcnt(6)
    v_add_u32 v15, 48, v12
    v_cmp_lt_u32 vcc, v15, v10
    s_cbranch_vccz fa_9
    v_bfe_u32 v24, v56, 16, 8
    v_bfe_u32 v25, v56, 12, 4
    v_lshl_add_u32 v25, v24, 3, v25
    v_lshlrev_b32 v25, 2, v25
    v_bfe_u32 v20, v56, 16, 8
    v_lshlrev_b32 v20, 2, v20
    v_bfe_u32 v24, v57, 16, 8
    v_bfe_u32 v26, v57, 12, 4
    v_lshl_add_u32 v26, v24, 3, v26
    v_lshlrev_b32 v26, 2, v26
    v_bfe_u32 v21, v57, 16, 8
    v_lshlrev_b32 v21, 2, v21
    v_bfe_u32 v24, v58, 16, 8
    v_bfe_u32 v27, v58, 12, 4
    v_lshl_add_u32 v27, v24, 3, v27
    v_lshlrev_b32 v27, 2, v27
    v_bfe_u32 v22, v58, 16, 8
    v_lshlrev_b32 v22, 2, v22
    v_bfe_u32 v24, v59, 16, 8
    v_bfe_u32 v28, v59, 12, 4
    v_lshl_add_u32 v28, v24, 3, v28
    v_lshlrev_b32 v28, 2, v28
    v_bfe_u32 v23, v59, 16, 8
    v_lshlrev_b32 v23, 2, v23
    v_add_u32 v24, 0, v15
    v_cmp_lt_u32 vcc, v24, v10
    s_and_b64 exec, s[22:23], vcc
    ds_add_rtn_u32 v72, v25, v30 offset:0
    ds_read_b32 v88, v20 offset:6912
    v_add_u32 v24, 1, v15
    v_cmp_lt_u32 vcc, v24, v10
    s_and_b64 exec, s[22:23], vcc
    ds_add_rtn_u32 v73, v26, v30 offset:0
    ds_read_b32 v89, v21 offset:6912
    v_add_u32 v24, 2, v15
    v_cmp_lt_u32 vcc, v24, v10
    s_and_b64 exec, s[22:23], vcc
    ds_add_rtn_u32 v74, v27, v30 offset:0
    ds_read_b32 v90, v22 offset:6912
    v_add_u32 v24, 3, v15
    v_cmp_lt_u32 vcc, v24, v10
    s_and_b64 exec, s[22:23], vcc
    ds_add_rtn_u32 v75, v28, v30 offset:0
    ds_read_b32 v91, v23 offset:6912
    s_mov_b64 exec, s[22:23]
    s_waitcnt lgkmcnt(6)
fa_9:
    s_waitcnt lgkmcnt(0)
    v_add_u32 v15, 0, v12
    v_cmp_lt_u32 vcc, v15, v10
    s_cbranch_vccz epd_8
    s_mov_b64 exec, s[22:23]
    v_add_u32 v24, 0, v15
    v_cmp_lt_u32 s[24:25], v24, v10
    v_cmp_gt_u32 vcc, 40, v60
    v_mul_u32_u24 v24, 80, v76
    v_lshl_add_u32 v24, v60, 1, v24
    s_and_b64 exec, s[24:25], vcc
    ds_write_b16 v24, v44 offset:11968
    s_andn2_b64 exec, s[24:25], vcc
    s_cbranch_execz no_11
    v_bfe_u32 v24, v44, 16, 8
    v_lshlrev_b32 v24, 2, v24
    ds_read_b32 v24, v24 offset:10240
    s_waitcnt lgkmcnt(0)
    v_add_u32 v24, v24, v60
    v_subrev_u32 v24, 40, v24
    v_lshlrev_b32 v24, 1, v24
    buffer_store_short v44, v24, s[48:51], 0 offen
no_11:
    s_mov_b64 exec, s[22:23]
    v_add_u32 v24, 1, v15
    v_cmp_lt_u32 s[24:25], v24, v10
    v_cmp_gt_u32 vcc, 40, v61
    v_mul_u32_u24 v24, 80, v77
    v_lshl_add_u32 v24, v61, 1, v24
    s_and_b64 exec, s[24:25], vcc
    ds_write_b16 v24, v45 offset:11968
    s_andn2_b64 exec, s[24:25], vcc
    s_cbranch_execz no_12
    v_bfe_u32 v24, v45, 16, 8
    v_lshlrev_b32 v24, 2, v24
    ds_read_b32 v24, v24 offset:10240
    s_waitcnt lgkmcnt(0)
    v_add_u32 v24, v24, v61
    v_subrev_u32 v24, 40, v24
    v_lshlrev_b32 v24, 1, v24
    buffer_store_short v45, v24, s[48:51], 0 offen
no_12:
    s_mov_b64 exec, s[22:23]
    v_add_u32 v24, 2, v15
    v_cmp_lt_u32 s[24:25], v24, v10
    v_cmp_gt_u32 vcc, 40, v62
    v_mul_u32_u24 v24, 80, v78
    v_lshl_add_u32 v24, v62, 1, v24
    s_and_b64 exec, s[24:25], vcc
    ds_write_b16 v24, v46 offset:11968
    s_andn2_b64 exec, s[24:25], vcc
    s_cbranch_execz no_13
    v_bfe_u32 v24, v46, 16, 8
    v_lshlrev_b32 v24, 2, v24
    ds_read_b32 v24, v24 offset:10240
    s_waitcnt lgkmcnt(0)
    v_add_u32 v24, v24, v62
    v_subrev_u32 v24, 40, v24
    v_lshlrev_b32 v24, 1, v24
    buffer_store_short v46, v24, s[48:51], 0 offen
no_13:
    s_mov_b64 exec, s[22:23]
    v_add_u32 v24, 3, v15
    v_cmp_lt_u32 s[24:25], v24, v10
    v_cmp_gt_u32 vcc, 40, v63
    v_mul_u32_u24 v24, 80, v79
    v_lshl_add_u32 v24, v63, 1, v24
    s_and_b64 exec, s[24:25], vcc
    ds_write_b16 v24, v47 offset:11968
    s_andn2_b64 exec, s[24:25], vcc
    s_cbranch_execz no_14
    v_bfe_u32 v24, v47, 16, 8
    v_lshlrev_b32 v24, 2, v24
    ds_read_b32 v24, v24 offset:10240
    s_waitcnt lgkmcnt(0)
    v_add_u32 v24, v24, v63
    v_subrev_u32 v24, 40, v24
    v_lshlrev_b32 v24, 1, v24
    buffer_store_short v47, v24, s[48:51], 0 offen
no_14:
    s_mov_b64 exec, s[22:23]
    v_add_u32 v15, 16, v12
    v_cmp_lt_u32 vcc, v15, v10
    s_cbranch_vccz epd_8
    s_mov_b64 exec, s[22:23]
    v_add_u32 v24, 0, v15
    v_cmp_lt_u32 s[24:25], v24, v10
    v_cmp_gt_u32 vcc, 40, v64
    v_mul_u32_u24 v24, 80, v80
    v_lshl_add_u32 v24, v64, 1, v24
    s_and_b64 exec, s[24:25], vcc
    ds_write_b16 v24, v48 offset:11968
    s_andn2_b64 exec, s[24:25], vcc
    s_cbranch_execz no_15
    v_bfe_u32 v24, v48, 16, 8
    v_lshlrev_b32 v24, 2, v24
    ds_read_b32 v24, v24 offset:10240
    s_waitcnt lgkmcnt(0)
    v_add_u32 v24, v24, v64
    v_subrev_u32 v24, 40, v24
    v_lshlrev_b32 v24, 1, v24
    buffer_store_short v48, v24, s[48:51], 0 offen
no_15:
    s_mov_b64 exec, s[22:23]
    v_add_u32 v24, 1, v15
    v_cmp_lt_u32 s[24:25], v24, v10
    v_cmp_gt_u32 vcc, 40, v65
    v_mul_u32_u24 v24, 80, v81
    v_lshl_add_u32 v24, v65, 1, v24
    s_and_b64 exec, s[24:25], vcc
    ds_write_b16 v24, v49 offset:11968
    s_andn2_b64 exec, s[24:25], vcc
    s_cbranch_execz no_16
    v_bfe_u32 v24, v49, 16, 8
    v_lshlrev_b32 v24, 2, v24
    ds_read_b32 v24, v24 offset:10240
    s_waitcnt lgkmcnt(0)
    v_add_u32 v24, v24, v65
    v_subrev_u32 v24, 40, v24
    v_lshlrev_b32 v24, 1, v24
    buffer_store_short v49, v24, s[48:51], 0 offen
no_16:
    s_mov_b64 exec, s[22:23]
    v_add_u32 v24, 2, v15
    v_cmp_lt_u32 s[24:25], v24, v10
    v_cmp_gt_u32 vcc, 40, v66
    v_mul_u32_u24 v24, 80, v82
    v_lshl_add_u32 v24, v66, 1, v24
    s_and_b64 exec, s[24:25], vcc
    ds_write_b16 v24, v50 offset:11968
    s_andn2_b64 exec, s[24:25], vcc
    s_cbranch_execz no_17
    v_bfe_u32 v24, v50, 16, 8
    v_lshlrev_b32 v24, 2, v24
    ds_read_b32 v24, v24 offset:10240
    s_waitcnt lgkmcnt(0)
    v_add_u32 v24, v24, v66
    v_subrev_u32 v24, 40, v24
    v_lshlrev_b32 v24, 1, v24
    buffer_store_short v50, v24, s[48:51], 0 offen
no_17:
    s_mov_b64 exec, s[22:23]
    v_add_u32 v24, 3, v15
    v_cmp_lt_u32 s[24:25], v24, v10
    v_cmp_gt_u32 vcc, 40, v67
    v_mul_u32_u24 v24, 80, v83
    v_lshl_add_u32 v24, v67, 1, v24
    s_and_b64 exec, s[24:25], vcc
    ds_write_b16 v24, v51 offset:11968
    s_andn2_b64 exec, s[24:25], vcc
    s_cbranch_execz no_18
    v_bfe_u32 v24, v51, 16, 8
    v_lshlrev_b32 v24, 2, v24
    ds_read_b32 v24, v24 offset:10240
    s_waitcnt lgkmcnt(0)
    v_add_u32 v24, v24, v67
    v_subrev_u32 v24, 40, v24
    v_lshlrev_b32 v24, 1, v24
    buffer_store_short v51, v24, s[48:51], 0 offen
no_18:
    s_mov_b64 exec, s[22:23]
    v_add_u32 v15, 32, v12
    v_cmp_lt_u32 vcc, v15, v10
    s_cbranch_vccz epd_8
    s_mov_b64 exec, s[22:23]
    v_add_u32 v24, 0, v15
    v_cmp_lt_u32 s[24:25], v24, v10
    v_cmp_gt_u32 vcc, 40, v68
    v_mul_u32_u24 v24, 80, v84
    v_lshl_add_u32 v24, v68, 1, v24
    s_and_b64 exec, s[24:25], vcc
    ds_write_b16 v24, v52 offset:11968
    s_andn2_b64 exec, s[24:25], vcc
    s_cbranch_execz no_19
    v_bfe_u32 v24, v52, 16, 8
    v_lshlrev_b32 v24, 2, v24
    ds_read_b32 v24, v24 offset:10240
    s_waitcnt lgkmcnt(0)
    v_add_u32 v24, v24, v68
    v_subrev_u32 v24, 40, v24
    v_lshlrev_b32 v24, 1, v24
    buffer_store_short v52, v24, s[48:51], 0 offen
no_19:
    s_mov_b64 exec, s[22:23]
    v_add_u32 v24, 1, v15
    v_cmp_lt_u32 s[24:25], v24, v10
    v_cmp_gt_u32 vcc, 40, v69
    v_mul_u32_u24 v24, 80, v85
    v_lshl_add_u32 v24, v69, 1, v24
    s_and_b64 exec, s[24:25], vcc
    ds_write_b16 v24, v53 offset:11968
    s_andn2_b64 exec, s[24:25], vcc
    s_cbranch_execz no_20
    v_bfe_u32 v24, v53, 16, 8
    v_lshlrev_b32 v24, 2, v24
    ds_read_b32 v24, v24 offset:10240
    s_waitcnt lgkmcnt(0)
    v_add_u32 v24, v24, v69
    v_subrev_u32 v24, 40, v24
    v_lshlrev_b32 v24, 1, v24
    buffer_store_short v53, v24, s[48:51], 0 offen
no_20:
    s_mov_b64 exec, s[22:23]
    v_add_u32 v24, 2, v15
    v_cmp_lt_u32 s[24:25], v24, v10
    v_cmp_gt_u32 vcc, 40, v70
    v_mul_u32_u24 v24, 80, v86
    v_lshl_add_u32 v24, v70, 1, v24
    s_and_b64 exec, s[24:25], vcc
    ds_write_b16 v24, v54 offset:11968
    s_andn2_b64 exec, s[24:25], vcc
    s_cbranch_execz no_21
    v_bfe_u32 v24, v54, 16, 8
    v_lshlrev_b32 v24, 2, v24
    ds_read_b32 v24, v24 offset:10240
    s_waitcnt lgkmcnt(0)
    v_add_u32 v24, v24, v70
    v_subrev_u32 v24, 40, v24
    v_lshlrev_b32 v24, 1, v24
    buffer_store_short v54, v24, s[48:51], 0 offen
no_21:
    s_mov_b64 exec, s[22:23]
    v_add_u32 v24, 3, v15
    v_cmp_lt_u32 s[24:25], v24, v10
    v_cmp_gt_u32 vcc, 40, v71
    v_mul_u32_u24 v24, 80, v87
    v_lshl_add_u32 v24, v71, 1, v24
    s_and_b64 exec, s[24:25], vcc
    ds_write_b16 v24, v55 offset:11968
    s_andn2_b64 exec, s[24:25], vcc
    s_cbranch_execz no_22
    v_bfe_u32 v24, v55, 16, 8
    v_lshlrev_b32 v24, 2, v24
    ds_read_b32 v24, v24 offset:10240
    s_waitcnt lgkmcnt(0)
    v_add_u32 v24, v24, v71
    v_subrev_u32 v24, 40, v24
    v_lshlrev_b32 v24, 1, v24
    buffer_store_short v55, v24, s[48:51], 0 offen
no_22:
    s_mov_b64 exec, s[22:23]
    v_add_u32 v15, 48, v12
    v_cmp_lt_u32 vcc, v15, v10
    s_cbranch_vccz epd_8
    s_mov_b64 exec, s[22:23]
    v_add_u32 v24, 0, v15
    v_cmp_lt_u32 s[24:25], v24, v10
    v_cmp_gt_u32 vcc, 40, v72
    v_mul_u32_u24 v24, 80, v88
    v_lshl_add_u32 v24, v72, 1, v24
    s_and_b64 exec, s[24:25], vcc
    ds_write_b16 v24, v56 offset:11968
    s_andn2_b64 exec, s[24:25], vcc
    s_cbranch_execz no_23
    v_bfe_u32 v24, v56, 16, 8
    v_lshlrev_b32 v24, 2, v24
    ds_read_b32 v24, v24 offset:10240
    s_waitcnt lgkmcnt(0)
    v_add_u32 v24, v24, v72
    v_subrev_u32 v24, 40, v24
    v_lshlrev_b32 v24, 1, v24
    buffer_store_short v56, v24, s[48:51], 0 offen
no_23:
    s_mov_b64 exec, s[22:23]
    v_add_u32 v24, 1, v15
    v_cmp_lt_u32 s[24:25], v24, v10
    v_cmp_gt_u32 vcc, 40, v73
    v_mul_u32_u24 v24, 80, v89
    v_lshl_add_u32 v24, v73, 1, v24
    s_and_b64 exec, s[24:25], vcc
    ds_write_b16 v24, v57 offset:11968
    s_andn2_b64 exec, s[24:25], vcc
    s_cbranch_execz no_24
    v_bfe_u32 v24, v57, 16, 8
    v_lshlrev_b32 v24, 2, v24
    ds_read_b32 v24, v24 offset:10240
    s_waitcnt lgkmcnt(0)
    v_add_u32 v24, v24, v73
    v_subrev_u32 v24, 40, v24
    v_lshlrev_b32 v24, 1, v24
    buffer_store_short v57, v24, s[48:51], 0 offen
no_24:
    s_mov_b64 exec, s[22:23]
    v_add_u32 v24, 2, v15
    v_cmp_lt_u32 s[24:25], v24, v10
    v_cmp_gt_u32 vcc, 40, v74
    v_mul_u32_u24 v24, 80, v90
    v_lshl_add_u32 v24, v74, 1, v24
    s_and_b64 exec, s[24:25], vcc
    ds_write_b16 v24, v58 offset:11968
    s_andn2_b64 exec, s[24:25], vcc
    s_cbranch_execz no_25
    v_bfe_u32 v24, v58, 16, 8
    v_lshlrev_b32 v24, 2, v24
    ds_read_b32 v24, v24 offset:10240
    s_waitcnt lgkmcnt(0)
    v_add_u32 v24, v24, v74
    v_subrev_u32 v24, 40, v24
    v_lshlrev_b32 v24, 1, v24
    buffer_store_short v58, v24, s[48:51], 0 offen
no_25:
    s_mov_b64 exec, s[22:23]
    v_add_u32 v24, 3, v15
    v_cmp_lt_u32 s[24:25], v24, v10
    v_cmp_gt_u32 vcc, 40, v75
    v_mul_u32_u24 v24, 80, v91
    v_lshl_add_u32 v24, v75, 1, v24
    s_and_b64 exec, s[24:25], vcc
    ds_write_b16 v24, v59 offset:11968
    s_andn2_b64 exec, s[24:25], vcc
    s_cbranch_execz no_26
    v_bfe_u32 v24, v59, 16, 8
    v_lshlrev_b32 v24, 2, v24
    ds_read_b32 v24, v24 offset:10240
    s_waitcnt lgkmcnt(0)
    v_add_u32 v24, v24, v75
    v_subrev_u32 v24, 40, v24
    v_lshlrev_b32 v24, 1, v24
    buffer_store_short v59, v24, s[48:51], 0 offen
no_26:
    s_mov_b64 exec, s[22:23]
    v_add_u32 v14, 256, v11
    v_add_u32 v15, 64, v12
ep_27:
    v_cmp_lt_u32 vcc, v15, v10
    s_cbranch_vccz epd_8
    buffer_load_dwordx4 v[16:19], v14, s[16:19], 0 offen
    s_waitcnt vmcnt(0)
    v_bfe_u32 v24, v16, 16, 8
    v_bfe_u32 v25, v16, 12, 4
    v_lshl_add_u32 v25, v24, 3, v25
    v_lshlrev_b32 v25, 2, v25
    v_bfe_u32 v20, v16, 16, 8
    v_bfe_u32 v24, v17, 16, 8
    v_bfe_u32 v26, v17, 12, 4
    v_lshl_add_u32 v26, v24, 3, v26
    v_lshlrev_b32 v26, 2, v26
    v_bfe_u32 v21, v17, 16, 8
    v_bfe_u32 v24, v18, 16, 8
    v_bfe_u32 v27, v18, 12, 4
    v_lshl_add_u32 v27, v24, 3, v27
    v_lshlrev_b32 v27, 2, v27
    v_bfe_u32 v22, v18, 16, 8
    v_bfe_u32 v24, v19, 16, 8
    v_bfe_u32 v28, v19, 12, 4
    v_lshl_add_u32 v28, v24, 3, v28
    v_lshlrev_b32 v28, 2, v28
    v_bfe_u32 v23, v19, 16, 8
    v_add_u32 v24, 0, v15
    v_cmp_lt_u32 s[24:25], v24, v10
    v_add_u32 v24, 1, v15
    v_cmp_lt_u32 s[26:27], v24, v10
    v_add_u32 v24, 2, v15
    v_cmp_lt_u32 s[28:29], v24, v10
    v_add_u32 v24, 3, v15
    v_cmp_lt_u32 s[30:31], v24, v10
    s_and_b64 exec, s[22:23], s[24:25]
    ds_add_rtn_u32 v32, v25, v30 offset:0
    v_lshlrev_b32 v24, 2, v20
    ds_read_b32 v36, v24 offset:6912
    s_and_b64 exec, s[22:23], s[26:27]
    ds_add_rtn_u32 v33, v26, v30 offset:0
    v_lshlrev_b32 v24, 2, v21
    ds_read_b32 v37, v24 offset:6912
    s_and_b64 exec, s[22:23], s[28:29]
    ds_add_rtn_u32 v34, v27, v30 offset:0
    v_lshlrev_b32 v24, 2, v22
    ds_read_b32 v38, v24 offset:6912
    s_and_b64 exec, s[22:23], s[30:31]
    ds_add_rtn_u32 v35, v28, v30 offset:0
    v_lshlrev_b32 v24, 2, v23
    ds_read_b32 v39, v24 offset:6912
    s_mov_b64 exec, s[22:23]
    s_waitcnt lgkmcnt(0)
    s_mov_b64 exec, s[22:23]
    v_cmp_gt_u32 vcc, 40, v32
    s_and_b64 s[32:33], s[24:25], vcc
    s_and_b64 exec, s[22:23], s[32:33]
    v_mul_u32_u24 v24, 80, v36
    v_lshl_add_u32 v24, v32, 1, v24
    ds_write_b16 v24, v16 offset:11968
    s_andn2_b64 s[32:33], s[24:25], vcc
    s_and_b64 exec, s[22:23], s[32:33]
    s_cbranch_execz no_28
    v_lshlrev_b32 v24, 2, v20
    ds_read_b32 v24, v24 offset:10240
    s_waitcnt lgkmcnt(0)
    v_add_u32 v24, v24, v32
    v_subrev_u32 v24, 40, v24
    v_lshlrev_b32 v24, 1, v24
    buffer_store_short v16, v24, s[48:51], 0 offen
no_28:
    s_mov_b64 exec, s[22:23]
    v_cmp_gt_u32 vcc, 40, v33
    s_and_b64 s[32:33], s[26:27], vcc
    s_and_b64 exec, s[22:23], s[32:33]
    v_mul_u32_u24 v24, 80, v37
    v_lshl_add_u32 v24, v33, 1, v24
    ds_write_b16 v24, v17 offset:11968
    s_andn2_b64 s[32:33], s[26:27], vcc
    s_and_b64 exec, s[22:23], s[32:33]
    s_cbranch_execz no_29
    v_lshlrev_b32 v24, 2, v21
    ds_read_b32 v24, v24 offset:10240
    s_waitcnt lgkmcnt(0)
    v_add_u32 v24, v24, v33
    v_subrev_u32 v24, 40, v24
    v_lshlrev_b32 v24, 1, v24
    buffer_store_short v17, v24, s[48:51], 0 offen
no_29:
    s_mov_b64 exec, s[22:23]
    v_cmp_gt_u32 vcc, 40, v34
    s_and_b64 s[32:33], s[28:29], vcc
    s_and_b64 exec, s[22:23], s[32:33]
    v_mul_u32_u24 v24, 80, v38
    v_lshl_add_u32 v24, v34, 1, v24
    ds_write_b16 v24, v18 offset:11968
    s_andn2_b64 s[32:33], s[28:29], vcc
    s_and_b64 exec, s[22:23], s[32:33]
    s_cbranch_execz no_30
    v_lshlrev_b32 v24, 2, v22
    ds_read_b32 v24, v24 offset:10240
    s_waitcnt lgkmcnt(0)
    v_add_u32 v24, v24, v34
    v_subrev_u32 v24, 40, v24
    v_lshlrev_b32 v24, 1, v24
    buffer_store_short v18, v24, s[48:51], 0 offen
no_30:
    s_mov_b64 exec, s[22:23]
    v_cmp_gt_u32 vcc, 40, v35
    s_and_b64 s[32:33], s[30:31], vcc
    s_and_b64 exec, s[22:23], s[32:33]
    v_mul_u32_u24 v24, 80, v39
    v_lshl_add_u32 v24, v35, 1, v24
    ds_write_b16 v24, v19 offset:11968
    s_andn2_b64 s[32:33], s[30:31], vcc
    s_and_b64 exec, s[22:23], s[32:33]
    s_cbranch_execz no_31
    v_lshlrev_b32 v24, 2, v23
    ds_read_b32 v24, v24 offset:10240
    s_waitcnt lgkmcnt(0)
    v_add_u32 v24, v24, v35
    v_subrev_u32 v24, 40, v24
    v_lshlrev_b32 v24, 1, v24
    buffer_store_short v19, v24, s[48:51], 0 offen
no_31:
    s_mov_b64 exec, s[22:23]
    v_add_u32 v14, 64, v14
    v_add_u32 v15, 16, v15
    s_branch ep_27
epd_8:
    s_waitcnt vmcnt(0) lgkmcnt(0)
    s_barrier
    v_and_b32 v0, 63, v0
    v_and_b32 v8, 7, v0
    v_lshlrev_b32 v8, 4, v8
    v_lshrrev_b32 v5, 3, v0
    s_mov_b32 s58, 0x34692105
    s_mov_b32 s59, 0xc78ba
    s_lshl_b32 s9, s6, 2
    s_lshr_b64 s[58:59], s[58:59], s9
    s_and_b32 s56, s58, 15
    s_lshl_b32 s9, s56, 4
    v_add_u32 v5, s9, v5
    s_mul_i32 s10, s8, 200
    v_add_u32 v6, 0, v5
    v_mul_u32_u24 v7, 80, v6
    v_lshlrev_b32 v6, 2, v6
    ds_read_b32 v2, v6 offset:7744
    ds_read_b32 v3, v6 offset:8576
    ds_read_b32 v26, v7 offset:11968
    ds_read_b32 v27, v7 offset:11972
    ds_read_b32 v28, v7 offset:11976
    ds_read_b32 v29, v7 offset:11980
    ds_read_b32 v30, v7 offset:11984
    ds_read_b32 v31, v7 offset:11988
    ds_read_b32 v32, v7 offset:11992
    ds_read_b32 v33, v7 offset:11996
    s_waitcnt lgkmcnt(4)
    ds_read_b32 v34, v7 offset:12000
    ds_read_b32 v35, v7 offset:12004
    ds_read_b32 v36, v7 offset:12008
    ds_read_b32 v37, v7 offset:12012
    ds_read_b32 v38, v7 offset:12016
    ds_read_b32 v39, v7 offset:12020
    ds_read_b32 v40, v7 offset:12024
    ds_read_b32 v41, v7 offset:12028
    s_waitcnt lgkmcnt(4)
    ds_read_b32 v42, v7 offset:12032
    ds_read_b32 v43, v7 offset:12036
    ds_read_b32 v44, v7 offset:12040
    ds_read_b32 v45, v7 offset:12044
    s_waitcnt lgkmcnt(4)
    v_cmp_gt_u32 vcc, 200, v2
    v_min_u32 v6, 199, v2
    v_lshlrev_b32 v6, 2, v6
    ds_read_b32 v70, v6 offset:11072
    v_add_u32 v2, s10, v2
    v_lshl_add_u32 v2, v2, 7, v8
    v_cndmask_b32_e64 v68, -1, v2, vcc
    v_add_u32 v6, 8, v5
    v_mul_u32_u24 v7, 80, v6
    v_lshlrev_b32 v6, 2, v6
    ds_read_b32 v2, v6 offset:7744
    ds_read_b32 v4, v6 offset:8576
    ds_read_b32 v46, v7 offset:11968
    ds_read_b32 v47, v7 offset:11972
    ds_read_b32 v48, v7 offset:11976
    ds_read_b32 v49, v7 offset:11980
    ds_read_b32 v50, v7 offset:11984
    ds_read_b32 v51, v7 offset:11988
    ds_read_b32 v52, v7 offset:11992
    ds_read_b32 v53, v7 offset:11996
    s_waitcnt lgkmcnt(4)
    ds_read_b32 v54, v7 offset:12000
    ds_read_b32 v55, v7 offset:12004
    ds_read_b32 v56, v7 offset:12008
    ds_read_b32 v57, v7 offset:12012
    ds_read_b32 v58, v7 offset:12016
    ds_read_b32 v59, v7 offset:12020
    ds_read_b32 v60, v7 offset:12024
    ds_read_b32 v61, v7 offset:12028
    s_waitcnt lgkmcnt(4)
    ds_read_b32 v62, v7 offset:12032
    ds_read_b32 v63, v7 offset:12036
    ds_read_b32 v64, v7 offset:12040
    ds_read_b32 v65, v7 offset:12044
    s_waitcnt lgkmcnt(4)
    v_cmp_gt_u32 vcc, 200, v2
    v_min_u32 v6, 199, v2
    v_lshlrev_b32 v6, 2, v6
    ds_read_b32 v71, v6 offset:11072
    v_add_u32 v2, s10, v2
    v_lshl_add_u32 v2, v2, 7, v8
    v_cndmask_b32_e64 v69, -1, v2, vcc
    v_max_u32 v3, v3, v4
    s_nop 0
    v_readfirstlane_b32 s40, v3
    s_nop 3
    s_cmp_gt_u32 s40, 40
    s_cselect_b32 s41, 1, 0
    s_min_u32 s40, s40, 40
    s_add_u32 s40, s40, 1
    s_lshr_b32 s40, s40, 1
    s_waitcnt lgkmcnt(0)
    s_mov_b32 s28, 0x3f80
    s_mov_b32 s29, 0x3f800000
    s_mov_b32 s30, 128
    s_mul_i32 s19, s7, 3200000
    s_add_u32 s20, s4, s19
    s_addc_u32 s21, s5, 0
    s_mov_b32 s22, 3200000
    s_mov_b32 s23, 0x20000
    s_add_u32 s24, s20, 6400000
    s_addc_u32 s25, s21, 0
    s_mov_b32 s26, 3200000
    s_mov_b32 s27, 0x20000
    s_mul_i32 s19, s7, 16384
    s_add_u32 s19, s19, 52928000
    s_add_u32 s32, s4, s19
    s_addc_u32 s33, s5, 0
    s_mov_b32 s34, 16384
    s_mov_b32 s35, 0x20000
    s_lshl_b32 s19, s7, 3
    s_add_u32 s19, s19, 55026816
    s_add_u32 s76, s4, s19
    s_addc_u32 s77, s5, 0
    s_mov_b32 s78, 399992
    s_mov_b32 s79, 0x20000
    s_mov_b32 s36, 0
hop_loop:
    v_mov_b32 v10, 0
    v_mov_b32 v11, 0
    v_mov_b32 v12, 0
    v_mov_b32 v13, 0
    v_mov_b32 v14, 0
    v_mov_b32 v15, 0
    v_mov_b32 v16, 0
    v_mov_b32 v17, 0
    v_mov_b32 v18, 0
    v_mov_b32 v19, 0
    v_mov_b32 v20, 0
    v_mov_b32 v21, 0
    v_mov_b32 v22, 0
    v_mov_b32 v23, 0
    v_mov_b32 v24, 0
    v_mov_b32 v25, 0
    s_cmp_ge_u32 s40, 10
    s_cbranch_scc1 bt_32
    s_cmp_ge_u32 s40, 5
    s_cbranch_scc1 bt_33
    s_cmp_ge_u32 s40, 2
    s_cbranch_scc1 bt_34
    s_cmp_ge_u32 s40, 1
    s_cbranch_scc1 bt_35
    s_branch hop_w0
bt_35:
    s_branch hop_w1
bt_34:
    s_cmp_ge_u32 s40, 3
    s_cbranch_scc1 bt_36
    s_branch hop_w2
bt_36:
    s_cmp_ge_u32 s40, 4
    s_cbranch_scc1 bt_37
    s_branch hop_w3
bt_37:
    s_branch hop_w4
bt_33:
    s_cmp_ge_u32 s40, 7
    s_cbranch_scc1 bt_38
    s_cmp_ge_u32 s40, 6
    s_cbranch_scc1 bt_39
    s_branch hop_w5
bt_39:
    s_branch hop_w6
bt_38:
    s_cmp_ge_u32 s40, 8
    s_cbranch_scc1 bt_40
    s_branch hop_w7
bt_40:
    s_cmp_ge_u32 s40, 9
    s_cbranch_scc1 bt_41
    s_branch hop_w8
bt_41:
    s_branch hop_w9
bt_32:
    s_cmp_ge_u32 s40, 15
    s_cbranch_scc1 bt_42
    s_cmp_ge_u32 s40, 12
    s_cbranch_scc1 bt_43
    s_cmp_ge_u32 s40, 11
    s_cbranch_scc1 bt_44
    s_branch hop_w10
bt_44:
    s_branch hop_w11
bt_43:
    s_cmp_ge_u32 s40, 13
    s_cbranch_scc1 bt_45
    s_branch hop_w12
bt_45:
    s_cmp_ge_u32 s40, 14
    s_cbranch_scc1 bt_46
    s_branch hop_w13
bt_46:
    s_branch hop_w14
bt_42:
    s_cmp_ge_u32 s40, 18
    s_cbranch_scc1 bt_47
    s_cmp_ge_u32 s40, 16
    s_cbranch_scc1 bt_48
    s_branch hop_w15
bt_48:
    s_cmp_ge_u32 s40, 17
    s_cbranch_scc1 bt_49
    s_branch hop_w16
bt_49:
    s_branch hop_w17
bt_47:
    s_cmp_ge_u32 s40, 19
    s_cbranch_scc1 bt_50
    s_branch hop_w18
bt_50:
    s_cmp_ge_u32 s40, 20
    s_cbranch_scc1 bt_51
    s_branch hop_w19
bt_51:
    s_branch hop_w20
hop_w0:
    s_branch hop_fin
hop_w1:
    s_setprio 3
    v_mad_u32_u16 v66, v26, s30, v8 op_sel:[0,0,0,0]
    buffer_load_dwordx4 v[72:75], v66, s[20:23], 0 offen sc1
    v_mad_u32_u16 v67, v46, s30, v8 op_sel:[0,0,0,0]
    buffer_load_dwordx4 v[76:79], v67, s[20:23], 0 offen sc1
    s_setprio 1
    v_mad_u32_u16 v66, v26, s30, v8 op_sel:[1,0,0,0]
    buffer_load_dwordx4 v[80:83], v66, s[20:23], 0 offen sc1
    v_mad_u32_u16 v67, v46, s30, v8 op_sel:[1,0,0,0]
    buffer_load_dwordx4 v[84:87], v67, s[20:23], 0 offen sc1
    s_waitcnt vmcnt(3)
    v_dot2c_f32_bf16 v10, s28, v72
    v_dot2c_f32_bf16 v11, s29, v72
    v_dot2c_f32_bf16 v12, s28, v73
    v_dot2c_f32_bf16 v13, s29, v73
    v_dot2c_f32_bf16 v14, s28, v74
    v_dot2c_f32_bf16 v15, s29, v74
    v_dot2c_f32_bf16 v16, s28, v75
    v_dot2c_f32_bf16 v17, s29, v75
    s_waitcnt vmcnt(2)
    v_dot2c_f32_bf16 v18, s28, v76
    v_dot2c_f32_bf16 v19, s29, v76
    v_dot2c_f32_bf16 v20, s28, v77
    v_dot2c_f32_bf16 v21, s29, v77
    v_dot2c_f32_bf16 v22, s28, v78
    v_dot2c_f32_bf16 v23, s29, v78
    v_dot2c_f32_bf16 v24, s28, v79
    v_dot2c_f32_bf16 v25, s29, v79
    s_waitcnt vmcnt(1)
    v_dot2c_f32_bf16 v10, s28, v80
    v_dot2c_f32_bf16 v11, s29, v80
    v_dot2c_f32_bf16 v12, s28, v81
    v_dot2c_f32_bf16 v13, s29, v81
    v_dot2c_f32_bf16 v14, s28, v82
    v_dot2c_f32_bf16 v15, s29, v82
    v_dot2c_f32_bf16 v16, s28, v83
    v_dot2c_f32_bf16 v17, s29, v83
    s_waitcnt vmcnt(0)
    v_dot2c_f32_bf16 v18, s28, v84
    v_dot2c_f32_bf16 v19, s29, v84
    v_dot2c_f32_bf16 v20, s28, v85
    v_dot2c_f32_bf16 v21, s29, v85
    v_dot2c_f32_bf16 v22, s28, v86
    v_dot2c_f32_bf16 v23, s29, v86
    v_dot2c_f32_bf16 v24, s28, v87
    v_dot2c_f32_bf16 v25, s29, v87
    s_branch hop_fin
hop_w2:
    s_setprio 3
    v_mad_u32_u16 v66, v26, s30, v8 op_sel:[0,0,0,0]
    buffer_load_dwordx4 v[72:75], v66, s[20:23], 0 offen sc1
    v_mad_u32_u16 v67, v46, s30, v8 op_sel:[0,0,0,0]
    buffer_load_dwordx4 v[76:79], v67, s[20:23], 0 offen sc1
    s_setprio 2
    v_mad_u32_u16 v66, v26, s30, v8 op_sel:[1,0,0,0]
    buffer_load_dwordx4 v[80:83], v66, s[20:23], 0 offen sc1
    v_mad_u32_u16 v67, v46, s30, v8 op_sel:[1,0,0,0]
    buffer_load_dwordx4 v[84:87], v67, s[20:23], 0 offen sc1
    s_setprio 1
    v_mad_u32_u16 v66, v27, s30, v8 op_sel:[0,0,0,0]
    buffer_load_dwordx4 v[88:91], v66, s[20:23], 0 offen sc1
    v_mad_u32_u16 v67, v47, s30, v8 op_sel:[0,0,0,0]
    buffer_load_dwordx4 v[92:95], v67, s[20:23], 0 offen sc1
    s_setprio 0
    v_mad_u32_u16 v66, v27, s30, v8 op_sel:[1,0,0,0]
    buffer_load_dwordx4 v[96:99], v66, s[20:23], 0 offen sc1
    v_mad_u32_u16 v67, v47, s30, v8 op_sel:[1,0,0,0]
    buffer_load_dwordx4 v[100:103], v67, s[20:23], 0 offen sc1
    s_waitcnt vmcnt(7)
    v_dot2c_f32_bf16 v10, s28, v72
    v_dot2c_f32_bf16 v11, s29, v72
    v_dot2c_f32_bf16 v12, s28, v73
    v_dot2c_f32_bf16 v13, s29, v73
    v_dot2c_f32_bf16 v14, s28, v74
    v_dot2c_f32_bf16 v15, s29, v74
    v_dot2c_f32_bf16 v16, s28, v75
    v_dot2c_f32_bf16 v17, s29, v75
    s_waitcnt vmcnt(6)
    v_dot2c_f32_bf16 v18, s28, v76
    v_dot2c_f32_bf16 v19, s29, v76
    v_dot2c_f32_bf16 v20, s28, v77
    v_dot2c_f32_bf16 v21, s29, v77
    v_dot2c_f32_bf16 v22, s28, v78
    v_dot2c_f32_bf16 v23, s29, v78
    v_dot2c_f32_bf16 v24, s28, v79
    v_dot2c_f32_bf16 v25, s29, v79
    s_waitcnt vmcnt(5)
    v_dot2c_f32_bf16 v10, s28, v80
    v_dot2c_f32_bf16 v11, s29, v80
    v_dot2c_f32_bf16 v12, s28, v81
    v_dot2c_f32_bf16 v13, s29, v81
    v_dot2c_f32_bf16 v14, s28, v82
    v_dot2c_f32_bf16 v15, s29, v82
    v_dot2c_f32_bf16 v16, s28, v83
    v_dot2c_f32_bf16 v17, s29, v83
    s_waitcnt vmcnt(4)
    v_dot2c_f32_bf16 v18, s28, v84
    v_dot2c_f32_bf16 v19, s29, v84
    v_dot2c_f32_bf16 v20, s28, v85
    v_dot2c_f32_bf16 v21, s29, v85
    v_dot2c_f32_bf16 v22, s28, v86
    v_dot2c_f32_bf16 v23, s29, v86
    v_dot2c_f32_bf16 v24, s28, v87
    v_dot2c_f32_bf16 v25, s29, v87
    s_waitcnt vmcnt(3)
    v_dot2c_f32_bf16 v10, s28, v88
    v_dot2c_f32_bf16 v11, s29, v88
    v_dot2c_f32_bf16 v12, s28, v89
    v_dot2c_f32_bf16 v13, s29, v89
    v_dot2c_f32_bf16 v14, s28, v90
    v_dot2c_f32_bf16 v15, s29, v90
    v_dot2c_f32_bf16 v16, s28, v91
    v_dot2c_f32_bf16 v17, s29, v91
    s_waitcnt vmcnt(2)
    v_dot2c_f32_bf16 v18, s28, v92
    v_dot2c_f32_bf16 v19, s29, v92
    v_dot2c_f32_bf16 v20, s28, v93
    v_dot2c_f32_bf16 v21, s29, v93
    v_dot2c_f32_bf16 v22, s28, v94
    v_dot2c_f32_bf16 v23, s29, v94
    v_dot2c_f32_bf16 v24, s28, v95
    v_dot2c_f32_bf16 v25, s29, v95
    s_waitcnt vmcnt(1)
    v_dot2c_f32_bf16 v10, s28, v96
    v_dot2c_f32_bf16 v11, s29, v96
    v_dot2c_f32_bf16 v12, s28, v97
    v_dot2c_f32_bf16 v13, s29, v97
    v_dot2c_f32_bf16 v14, s28, v98
    v_dot2c_f32_bf16 v15, s29, v98
    v_dot2c_f32_bf16 v16, s28, v99
    v_dot2c_f32_bf16 v17, s29, v99
    s_waitcnt vmcnt(0)
    v_dot2c_f32_bf16 v18, s28, v100
    v_dot2c_f32_bf16 v19, s29, v100
    v_dot2c_f32_bf16 v20, s28, v101
    v_dot2c_f32_bf16 v21, s29, v101
    v_dot2c_f32_bf16 v22, s28, v102
    v_dot2c_f32_bf16 v23, s29, v102
    v_dot2c_f32_bf16 v24, s28, v103
    v_dot2c_f32_bf16 v25, s29, v103
    s_branch hop_fin
hop_w3:
    s_setprio 3
    v_mad_u32_u16 v66, v26, s30, v8 op_sel:[0,0,0,0]
    buffer_load_dwordx4 v[72:75], v66, s[20:23], 0 offen sc1
    v_mad_u32_u16 v67, v46, s30, v8 op_sel:[0,0,0,0]
    buffer_load_dwordx4 v[76:79], v67, s[20:23], 0 offen sc1
    v_mad_u32_u16 v66, v26, s30, v8 op_sel:[1,0,0,0]
    buffer_load_dwordx4 v[80:83], v66, s[20:23], 0 offen sc1
    v_mad_u32_u16 v67, v46, s30, v8 op_sel:[1,0,0,0]
    buffer_load_dwordx4 v[84:87], v67, s[20:23], 0 offen sc1
    s_setprio 2
    v_mad_u32_u16 v66, v27, s30, v8 op_sel:[0,0,0,0]
    buffer_load_dwordx4 v[88:91], v66, s[20:23], 0 offen sc1
    v_mad_u32_u16 v67, v47, s30, v8 op_sel:[0,0,0,0]
    buffer_load_dwordx4 v[92:95], v67, s[20:23], 0 offen sc1
    s_setprio 1
    v_mad_u32_u16 v66, v27, s30, v8 op_sel:[1,0,0,0]
    buffer_load_dwordx4 v[96:99], v66, s[20:23], 0 offen sc1
    v_mad_u32_u16 v67, v47, s30, v8 op_sel:[1,0,0,0]
    buffer_load_dwordx4 v[100:103], v67, s[20:23], 0 offen sc1
    s_waitcnt vmcnt(7)
    v_dot2c_f32_bf16 v10, s28, v72
    v_dot2c_f32_bf16 v11, s29, v72
    v_dot2c_f32_bf16 v12, s28, v73
    v_dot2c_f32_bf16 v13, s29, v73
    v_dot2c_f32_bf16 v14, s28, v74
    v_dot2c_f32_bf16 v15, s29, v74
    v_dot2c_f32_bf16 v16, s28, v75
    v_dot2c_f32_bf16 v17, s29, v75
    s_waitcnt vmcnt(6)
    v_dot2c_f32_bf16 v18, s28, v76
    v_dot2c_f32_bf16 v19, s29, v76
    v_dot2c_f32_bf16 v20, s28, v77
    v_dot2c_f32_bf16 v21, s29, v77
    v_dot2c_f32_bf16 v22, s28, v78
    v_dot2c_f32_bf16 v23, s29, v78
    v_dot2c_f32_bf16 v24, s28, v79
    v_dot2c_f32_bf16 v25, s29, v79
    v_mad_u32_u16 v66, v28, s30, v8 op_sel:[0,0,0,0]
    buffer_load_dwordx4 v[72:75], v66, s[20:23], 0 offen sc1
    v_mad_u32_u16 v67, v48, s30, v8 op_sel:[0,0,0,0]
    buffer_load_dwordx4 v[76:79], v67, s[20:23], 0 offen sc1
    s_waitcnt vmcnt(7)
    v_dot2c_f32_bf16 v10, s28, v80
    v_dot2c_f32_bf16 v11, s29, v80
    v_dot2c_f32_bf16 v12, s28, v81
    v_dot2c_f32_bf16 v13, s29, v81
    v_dot2c_f32_bf16 v14, s28, v82
    v_dot2c_f32_bf16 v15, s29, v82
    v_dot2c_f32_bf16 v16, s28, v83
    v_dot2c_f32_bf16 v17, s29, v83
    s_waitcnt vmcnt(6)
    v_dot2c_f32_bf16 v18, s28, v84
    v_dot2c_f32_bf16 v19, s29, v84
    v_dot2c_f32_bf16 v20, s28, v85
    v_dot2c_f32_bf16 v21, s29, v85
    v_dot2c_f32_bf16 v22, s28, v86
    v_dot2c_f32_bf16 v23, s29, v86
    v_dot2c_f32_bf16 v24, s28, v87
    v_dot2c_f32_bf16 v25, s29, v87
    s_setprio 0
    v_mad_u32_u16 v66, v28, s30, v8 op_sel:[1,0,0,0]
    buffer_load_dwordx4 v[80:83], v66, s[20:23], 0 offen sc1
    v_mad_u32_u16 v67, v48, s30, v8 op_sel:[1,0,0,0]
    buffer_load_dwordx4 v[84:87], v67, s[20:23], 0 offen sc1
    s_waitcnt vmcnt(7)
    v_dot2c_f32_bf16 v10, s28, v88
    v_dot2c_f32_bf16 v11, s29, v88
    v_dot2c_f32_bf16 v12, s28, v89
    v_dot2c_f32_bf16 v13, s29, v89
    v_dot2c_f32_bf16 v14, s28, v90
    v_dot2c_f32_bf16 v15, s29, v90
    v_dot2c_f32_bf16 v16, s28, v91
    v_dot2c_f32_bf16 v17, s29, v91
    s_waitcnt vmcnt(6)
    v_dot2c_f32_bf16 v18, s28, v92
    v_dot2c_f32_bf16 v19, s29, v92
    v_dot2c_f32_bf16 v20, s28, v93
    v_dot2c_f32_bf16 v21, s29, v93
    v_dot2c_f32_bf16 v22, s28, v94
    v_dot2c_f32_bf16 v23, s29, v94
    v_dot2c_f32_bf16 v24, s28, v95
    v_dot2c_f32_bf16 v25, s29, v95
    s_waitcnt vmcnt(5)
    v_dot2c_f32_bf16 v10, s28, v96
    v_dot2c_f32_bf16 v11, s29, v96
    v_dot2c_f32_bf16 v12, s28, v97
    v_dot2c_f32_bf16 v13, s29, v97
    v_dot2c_f32_bf16 v14, s28, v98
    v_dot2c_f32_bf16 v15, s29, v98
    v_dot2c_f32_bf16 v16, s28, v99
    v_dot2c_f32_bf16 v17, s29, v99
    s_waitcnt vmcnt(4)
    v_dot2c_f32_bf16 v18, s28, v100
    v_dot2c_f32_bf16 v19, s29, v100
    v_dot2c_f32_bf16 v20, s28, v101
    v_dot2c_f32_bf16 v21, s29, v101
    v_dot2c_f32_bf16 v22, s28, v102
    v_dot2c_f32_bf16 v23, s29, v102
    v_dot2c_f32_bf16 v24, s28, v103
    v_dot2c_f32_bf16 v25, s29, v103
    s_waitcnt vmcnt(3)
    v_dot2c_f32_bf16 v10, s28, v72
    v_dot2c_f32_bf16 v11, s29, v72
    v_dot2c_f32_bf16 v12, s28, v73
    v_dot2c_f32_bf16 v13, s29, v73
    v_dot2c_f32_bf16 v14, s28, v74
    v_dot2c_f32_bf16 v15, s29, v74
    v_dot2c_f32_bf16 v16, s28, v75
    v_dot2c_f32_bf16 v17, s29, v75
    s_waitcnt vmcnt(2)
    v_dot2c_f32_bf16 v18, s28, v76
    v_dot2c_f32_bf16 v19, s29, v76
    v_dot2c_f32_bf16 v20, s28, v77
    v_dot2c_f32_bf16 v21, s29, v77
    v_dot2c_f32_bf16 v22, s28, v78
    v_dot2c_f32_bf16 v23, s29, v78
    v_dot2c_f32_bf16 v24, s28, v79
    v_dot2c_f32_bf16 v25, s29, v79
    s_waitcnt vmcnt(1)
    v_dot2c_f32_bf16 v10, s28, v80
    v_dot2c_f32_bf16 v11, s29, v80
    v_dot2c_f32_bf16 v12, s28, v81
    v_dot2c_f32_bf16 v13, s29, v81
    v_dot2c_f32_bf16 v14, s28, v82
    v_dot2c_f32_bf16 v15, s29, v82
    v_dot2c_f32_bf16 v16, s28, v83
    v_dot2c_f32_bf16 v17, s29, v83
    s_waitcnt vmcnt(0)
    v_dot2c_f32_bf16 v18, s28, v84
    v_dot2c_f32_bf16 v19, s29, v84
    v_dot2c_f32_bf16 v20, s28, v85
    v_dot2c_f32_bf16 v21, s29, v85
    v_dot2c_f32_bf16 v22, s28, v86
    v_dot2c_f32_bf16 v23, s29, v86
    v_dot2c_f32_bf16 v24, s28, v87
    v_dot2c_f32_bf16 v25, s29, v87
    s_branch hop_fin
hop_w4:
    s_setprio 3
    v_mad_u32_u16 v66, v26, s30, v8 op_sel:[0,0,0,0]
    buffer_load_dwordx4 v[72:75], v66, s[20:23], 0 offen sc1
    v_mad_u32_u16 v67, v46, s30, v8 op_sel:[0,0,0,0]
    buffer_load_dwordx4 v[76:79], v67, s[20:23], 0 offen sc1
    v_mad_u32_u16 v66, v26, s30, v8 op_sel:[1,0,0,0]
    buffer_load_dwordx4 v[80:83], v66, s[20:23], 0 offen sc1
    v_mad_u32_u16 v67, v46, s30, v8 op_sel:[1,0,0,0]
    buffer_load_dwordx4 v[84:87], v67, s[20:23], 0 offen sc1
    s_setprio 2
    v_mad_u32_u16 v66, v27, s30, v8 op_sel:[0,0,0,0]
    buffer_load_dwordx4 v[88:91], v66, s[20:23], 0 offen sc1
    v_mad_u32_u16 v67, v47, s30, v8 op_sel:[0,0,0,0]
    buffer_load_dwordx4 v[92:95], v67, s[20:23], 0 offen sc1
    v_mad_u32_u16 v66, v27, s30, v8 op_sel:[1,0,0,0]
    buffer_load_dwordx4 v[96:99], v66, s[20:23], 0 offen sc1
    v_mad_u32_u16 v67, v47, s30, v8 op_sel:[1,0,0,0]
    buffer_load_dwordx4 v[100:103], v67, s[20:23], 0 offen sc1
    s_waitcnt vmcnt(7)
    v_dot2c_f32_bf16 v10, s28, v72
    v_dot2c_f32_bf16 v11, s29, v72
    v_dot2c_f32_bf16 v12, s28, v73
    v_dot2c_f32_bf16 v13, s29, v73
    v_dot2c_f32_bf16 v14, s28, v74
    v_dot2c_f32_bf16 v15, s29, v74
    v_dot2c_f32_bf16 v16, s28, v75
    v_dot2c_f32_bf16 v17, s29, v75
    s_waitcnt vmcnt(6)
    v_dot2c_f32_bf16 v18, s28, v76
    v_dot2c_f32_bf16 v19, s29, v76
    v_dot2c_f32_bf16 v20, s28, v77
    v_dot2c_f32_bf16 v21, s29, v77
    v_dot2c_f32_bf16 v22, s28, v78
    v_dot2c_f32_bf16 v23, s29, v78
    v_dot2c_f32_bf16 v24, s28, v79
    v_dot2c_f32_bf16 v25, s29, v79
    s_setprio 1
    v_mad_u32_u16 v66, v28, s30, v8 op_sel:[0,0,0,0]
    buffer_load_dwordx4 v[72:75], v66, s[20:23], 0 offen sc1
    v_mad_u32_u16 v67, v48, s30, v8 op_sel:[0,0,0,0]
    buffer_load_dwordx4 v[76:79], v67, s[20:23], 0 offen sc1
    s_waitcnt vmcnt(7)
    v_dot2c_f32_bf16 v10, s28, v80
    v_dot2c_f32_bf16 v11, s29, v80
    v_dot2c_f32_bf16 v12, s28, v81
    v_dot2c_f32_bf16 v13, s29, v81
    v_dot2c_f32_bf16 v14, s28, v82
    v_dot2c_f32_bf16 v15, s29, v82
    v_dot2c_f32_bf16 v16, s28, v83
    v_dot2c_f32_bf16 v17, s29, v83
    s_waitcnt vmcnt(6)
    v_dot2c_f32_bf16 v18, s28, v84
    v_dot2c_f32_bf16 v19, s29, v84
    v_dot2c_f32_bf16 v20, s28, v85
    v_dot2c_f32_bf16 v21, s29, v85
    v_dot2c_f32_bf16 v22, s28, v86
    v_dot2c_f32_bf16 v23, s29, v86
    v_dot2c_f32_bf16 v24, s28, v87
    v_dot2c_f32_bf16 v25, s29, v87
    v_mad_u32_u16 v66, v28, s30, v8 op_sel:[1,0,0,0]
    buffer_load_dwordx4 v[80:83], v66, s[20:23], 0 offen sc1
    v_mad_u32_u16 v67, v48, s30, v8 op_sel:[1,0,0,0]
    buffer_load_dwordx4 v[84:87], v67, s[20:23], 0 offen sc1
    s_waitcnt vmcnt(7)
    v_dot2c_f32_bf16 v10, s28, v88
    v_dot2c_f32_bf16 v11, s29, v88
    v_dot2c_f32_bf16 v12, s28, v89
    v_dot2c_f32_bf16 v13, s29, v89
    v_dot2c_f32_bf16 v14, s28, v90
    v_dot2c_f32_bf16 v15, s29, v90
    v_dot2c_f32_bf16 v16, s28, v91
    v_dot2c_f32_bf16 v17, s29, v91
    s_waitcnt vmcnt(6)
    v_dot2c_f32_bf16 v18, s28, v92
    v_dot2c_f32_bf16 v19, s29, v92
    v_dot2c_f32_bf16 v20, s28, v93
    v_dot2c_f32_bf16 v21, s29, v93
    v_dot2c_f32_bf16 v22, s28, v94
    v_dot2c_f32_bf16 v23, s29, v94
    v_dot2c_f32_bf16 v24, s28, v95
    v_dot2c_f32_bf16 v25, s29, v95
    s_setprio 0
    v_mad_u32_u16 v66, v29, s30, v8 op_sel:[0,0,0,0]
    buffer_load_dwordx4 v[88:91], v66, s[20:23], 0 offen sc1
    v_mad_u32_u16 v67, v49, s30, v8 op_sel:[0,0,0,0]
    buffer_load_dwordx4 v[92:95], v67, s[20:23], 0 offen sc1
    s_waitcnt vmcnt(7)
    v_dot2c_f32_bf16 v10, s28, v96
    v_dot2c_f32_bf16 v11, s29, v96
    v_dot2c_f32_bf16 v12, s28, v97
    v_dot2c_f32_bf16 v13, s29, v97
    v_dot2c_f32_bf16 v14, s28, v98
    v_dot2c_f32_bf16 v15, s29, v98
    v_dot2c_f32_bf16 v16, s28, v99
    v_dot2c_f32_bf16 v17, s29, v99
    s_waitcnt vmcnt(6)
    v_dot2c_f32_bf16 v18, s28, v100
    v_dot2c_f32_bf16 v19, s29, v100
    v_dot2c_f32_bf16 v20, s28, v101
    v_dot2c_f32_bf16 v21, s29, v101
    v_dot2c_f32_bf16 v22, s28, v102
    v_dot2c_f32_bf16 v23, s29, v102
    v_dot2c_f32_bf16 v24, s28, v103
    v_dot2c_f32_bf16 v25, s29, v103
    v_mad_u32_u16 v66, v29, s30, v8 op_sel:[1,0,0,0]
    buffer_load_dwordx4 v[96:99], v66, s[20:23], 0 offen sc1
    v_mad_u32_u16 v67, v49, s30, v8 op_sel:[1,0,0,0]
    buffer_load_dwordx4 v[100:103], v67, s[20:23], 0 offen sc1
    s_waitcnt vmcnt(7)
    v_dot2c_f32_bf16 v10, s28, v72
    v_dot2c_f32_bf16 v11, s29, v72
    v_dot2c_f32_bf16 v12, s28, v73
    v_dot2c_f32_bf16 v13, s29, v73
    v_dot2c_f32_bf16 v14, s28, v74
    v_dot2c_f32_bf16 v15, s29, v74
    v_dot2c_f32_bf16 v16, s28, v75
    v_dot2c_f32_bf16 v17, s29, v75
    s_waitcnt vmcnt(6)
    v_dot2c_f32_bf16 v18, s28, v76
    v_dot2c_f32_bf16 v19, s29, v76
    v_dot2c_f32_bf16 v20, s28, v77
    v_dot2c_f32_bf16 v21, s29, v77
    v_dot2c_f32_bf16 v22, s28, v78
    v_dot2c_f32_bf16 v23, s29, v78
    v_dot2c_f32_bf16 v24, s28, v79
    v_dot2c_f32_bf16 v25, s29, v79
    s_waitcnt vmcnt(5)
    v_dot2c_f32_bf16 v10, s28, v80
    v_dot2c_f32_bf16 v11, s29, v80
    v_dot2c_f32_bf16 v12, s28, v81
    v_dot2c_f32_bf16 v13, s29, v81
    v_dot2c_f32_bf16 v14, s28, v82
    v_dot2c_f32_bf16 v15, s29, v82
    v_dot2c_f32_bf16 v16, s28, v83
    v_dot2c_f32_bf16 v17, s29, v83
    s_waitcnt vmcnt(4)
    v_dot2c_f32_bf16 v18, s28, v84
    v_dot2c_f32_bf16 v19, s29, v84
    v_dot2c_f32_bf16 v20, s28, v85
    v_dot2c_f32_bf16 v21, s29, v85
    v_dot2c_f32_bf16 v22, s28, v86
    v_dot2c_f32_bf16 v23, s29, v86
    v_dot2c_f32_bf16 v24, s28, v87
    v_dot2c_f32_bf16 v25, s29, v87
    s_waitcnt vmcnt(3)
    v_dot2c_f32_bf16 v10, s28, v88
    v_dot2c_f32_bf16 v11, s29, v88
    v_dot2c_f32_bf16 v12, s28, v89
    v_dot2c_f32_bf16 v13, s29, v89
    v_dot2c_f32_bf16 v14, s28, v90
    v_dot2c_f32_bf16 v15, s29, v90
    v_dot2c_f32_bf16 v16, s28, v91
    v_dot2c_f32_bf16 v17, s29, v91
    s_waitcnt vmcnt(2)
    v_dot2c_f32_bf16 v18, s28, v92
    v_dot2c_f32_bf16 v19, s29, v92
    v_dot2c_f32_bf16 v20, s28, v93
    v_dot2c_f32_bf16 v21, s29, v93
    v_dot2c_f32_bf16 v22, s28, v94
    v_dot2c_f32_bf16 v23, s29, v94
    v_dot2c_f32_bf16 v24, s28, v95
    v_dot2c_f32_bf16 v25, s29, v95
    s_waitcnt vmcnt(1)
    v_dot2c_f32_bf16 v10, s28, v96
    v_dot2c_f32_bf16 v11, s29, v96
    v_dot2c_f32_bf16 v12, s28, v97
    v_dot2c_f32_bf16 v13, s29, v97
    v_dot2c_f32_bf16 v14, s28, v98
    v_dot2c_f32_bf16 v15, s29, v98
    v_dot2c_f32_bf16 v16, s28, v99
    v_dot2c_f32_bf16 v17, s29, v99
    s_waitcnt vmcnt(0)
    v_dot2c_f32_bf16 v18, s28, v100
    v_dot2c_f32_bf16 v19, s29, v100
    v_dot2c_f32_bf16 v20, s28, v101
    v_dot2c_f32_bf16 v21, s29, v101
    v_dot2c_f32_bf16 v22, s28, v102
    v_dot2c_f32_bf16 v23, s29, v102
    v_dot2c_f32_bf16 v24, s28, v103
    v_dot2c_f32_bf16 v25, s29, v103
    s_branch hop_fin
hop_w5:
    s_setprio 3
    v_mad_u32_u16 v66, v26, s30, v8 op_sel:[0,0,0,0]
    buffer_load_dwordx4 v[72:75], v66, s[20:23], 0 offen sc1
    v_mad_u32_u16 v67, v46, s30, v8 op_sel:[0,0,0,0]
    buffer_load_dwordx4 v[76:79], v67, s[20:23], 0 offen sc1
    v_mad_u32_u16 v66, v26, s30, v8 op_sel:[1,0,0,0]
    buffer_load_dwordx4 v[80:83], v66, s[20:23], 0 offen sc1
    v_mad_u32_u16 v67, v46, s30, v8 op_sel:[1,0,0,0]
    buffer_load_dwordx4 v[84:87], v67, s[20:23], 0 offen sc1
    v_mad_u32_u16 v66, v27, s30, v8 op_sel:[0,0,0,0]
    buffer_load_dwordx4 v[88:91], v66, s[20:23], 0 offen sc1
    v_mad_u32_u16 v67, v47, s30, v8 op_sel:[0,0,0,0]
    buffer_load_dwordx4 v[92:95], v67, s[20:23], 0 offen sc1
    s_setprio 2
    v_mad_u32_u16 v66, v27, s30, v8 op_sel:[1,0,0,0]
    buffer_load_dwordx4 v[96:99], v66, s[20:23], 0 offen sc1
    v_mad_u32_u16 v67, v47, s30, v8 op_sel:[1,0,0,0]
    buffer_load_dwordx4 v[100:103], v67, s[20:23], 0 offen sc1
    s_waitcnt vmcnt(7)
    v_dot2c_f32_bf16 v10, s28, v72
    v_dot2c_f32_bf16 v11, s29, v72
    v_dot2c_f32_bf16 v12, s28, v73
    v_dot2c_f32_bf16 v13, s29, v73
    v_dot2c_f32_bf16 v14, s28, v74
    v_dot2c_f32_bf16 v15, s29, v74
    v_dot2c_f32_bf16 v16, s28, v75
    v_dot2c_f32_bf16 v17, s29, v75
    s_waitcnt vmcnt(6)
    v_dot2c_f32_bf16 v18, s28, v76
    v_dot2c_f32_bf16 v19, s29, v76
    v_dot2c_f32_bf16 v20, s28, v77
    v_dot2c_f32_bf16 v21, s29, v77
    v_dot2c_f32_bf16 v22, s28, v78
    v_dot2c_f32_bf16 v23, s29, v78
    v_dot2c_f32_bf16 v24, s28, v79
    v_dot2c_f32_bf16 v25, s29, v79
    v_mad_u32_u16 v66, v28, s30, v8 op_sel:[0,0,0,0]
    buffer_load_dwordx4 v[72:75], v66, s[20:23], 0 offen sc1
    v_mad_u32_u16 v67, v48, s30, v8 op_sel:[0,0,0,0]
    buffer_load_dwordx4 v[76:79], v67, s[20:23], 0 offen sc1
    s_waitcnt vmcnt(7)
    v_dot2c_f32_bf16 v10, s28, v80
    v_dot2c_f32_bf16 v11, s29, v80
    v_dot2c_f32_bf16 v12, s28, v81
    v_dot2c_f32_bf16 v13, s29, v81
    v_dot2c_f32_bf16 v14, s28, v82
    v_dot2c_f32_bf16 v15, s29, v82
    v_dot2c_f32_bf16 v16, s28, v83
    v_dot2c_f32_bf16 v17, s29, v83
    s_waitcnt vmcnt(6)
    v_dot2c_f32_bf16 v18, s28, v84
    v_dot2c_f32_bf16 v19, s29, v84
    v_dot2c_f32_bf16 v20, s28, v85
    v_dot2c_f32_bf16 v21, s29, v85
    v_dot2c_f32_bf16 v22, s28, v86
    v_dot2c_f32_bf16 v23, s29, v86
    v_dot2c_f32_bf16 v24, s28, v87
    v_dot2c_f32_bf16 v25, s29, v87
    s_setprio 1
    v_mad_u32_u16 v66, v28, s30, v8 op_sel:[1,0,0,0]
    buffer_load_dwordx4 v[80:83], v66, s[20:23], 0 offen sc1
    v_mad_u32_u16 v67, v48, s30, v8 op_sel:[1,0,0,0]
    buffer_load_dwordx4 v[84:87], v67, s[20:23], 0 offen sc1
    s_waitcnt vmcnt(7)
    v_dot2c_f32_bf16 v10, s28, v88
    v_dot2c_f32_bf16 v11, s29, v88
    v_dot2c_f32_bf16 v12, s28, v89
    v_dot2c_f32_bf16 v13, s29, v89
    v_dot2c_f32_bf16 v14, s28, v90
    v_dot2c_f32_bf16 v15, s29, v90
    v_dot2c_f32_bf16 v16, s28, v91
    v_dot2c_f32_bf16 v17, s29, v91
    s_waitcnt vmcnt(6)
    v_dot2c_f32_bf16 v18, s28, v92
    v_dot2c_f32_bf16 v19, s29, v92
    v_dot2c_f32_bf16 v20, s28, v93
    v_dot2c_f32_bf16 v21, s29, v93
    v_dot2c_f32_bf16 v22, s28, v94
    v_dot2c_f32_bf16 v23, s29, v94
    v_dot2c_f32_bf16 v24, s28, v95
    v_dot2c_f32_bf16 v25, s29, v95
    v_mad_u32_u16 v66, v29, s30, v8 op_sel:[0,0,0,0]
    buffer_load_dwordx4 v[88:91], v66, s[20:23], 0 offen sc1
    v_mad_u32_u16 v67, v49, s30, v8 op_sel:[0,0,0,0]
    buffer_load_dwordx4 v[92:95], v67, s[20:23], 0 offen sc1
    s_waitcnt vmcnt(7)
    v_dot2c_f32_bf16 v10, s28, v96
    v_dot2c_f32_bf16 v11, s29, v96
    v_dot2c_f32_bf16 v12, s28, v97
    v_dot2c_f32_bf16 v13, s29, v97
    v_dot2c_f32_bf16 v14, s28, v98
    v_dot2c_f32_bf16 v15, s29, v98
    v_dot2c_f32_bf16 v16, s28, v99
    v_dot2c_f32_bf16 v17, s29, v99
    s_waitcnt vmcnt(6)
    v_dot2c_f32_bf16 v18, s28, v100
    v_dot2c_f32_bf16 v19, s29, v100
    v_dot2c_f32_bf16 v20, s28, v101
    v_dot2c_f32_bf16 v21, s29, v101
    v_dot2c_f32_bf16 v22, s28, v102
    v_dot2c_f32_bf16 v23, s29, v102
    v_dot2c_f32_bf16 v24, s28, v103
    v_dot2c_f32_bf16 v25, s29, v103
    v_mad_u32_u16 v66, v29, s30, v8 op_sel:[1,0,0,0]
    buffer_load_dwordx4 v[96:99], v66, s[20:23], 0 offen sc1
    v_mad_u32_u16 v67, v49, s30, v8 op_sel:[1,0,0,0]
    buffer_load_dwordx4 v[100:103], v67, s[20:23], 0 offen sc1
    s_waitcnt vmcnt(7)
    v_dot2c_f32_bf16 v10, s28, v72
    v_dot2c_f32_bf16 v11, s29, v72
    v_dot2c_f32_bf16 v12, s28, v73
    v_dot2c_f32_bf16 v13, s29, v73
    v_dot2c_f32_bf16 v14, s28, v74
    v_dot2c_f32_bf16 v15, s29, v74
    v_dot2c_f32_bf16 v16, s28, v75
    v_dot2c_f32_bf16 v17, s29, v75
    s_waitcnt vmcnt(6)
    v_dot2c_f32_bf16 v18, s28, v76
    v_dot2c_f32_bf16 v19, s29, v76
    v_dot2c_f32_bf16 v20, s28, v77
    v_dot2c_f32_bf16 v21, s29, v77
    v_dot2c_f32_bf16 v22, s28, v78
    v_dot2c_f32_bf16 v23, s29, v78
    v_dot2c_f32_bf16 v24, s28, v79
    v_dot2c_f32_bf16 v25, s29, v79
    s_setprio 0
    v_mad_u32_u16 v66, v30, s30, v8 op_sel:[0,0,0,0]
    buffer_load_dwordx4 v[72:75], v66, s[20:23], 0 offen sc1
    v_mad_u32_u16 v67, v50, s30, v8 op_sel:[0,0,0,0]
    buffer_load_dwordx4 v[76:79], v67, s[20:23], 0 offen sc1
    s_waitcnt vmcnt(7)
    v_dot2c_f32_bf16 v10, s28, v80
    v_dot2c_f32_bf16 v11, s29, v80
    v_dot2c_f32_bf16 v12, s28, v81
    v_dot2c_f32_bf16 v13, s29, v81
    v_dot2c_f32_bf16 v14, s28, v82
    v_dot2c_f32_bf16 v15, s29, v82
    v_dot2c_f32_bf16 v16, s28, v83
    v_dot2c_f32_bf16 v17, s29, v83
    s_waitcnt vmcnt(6)
    v_dot2c_f32_bf16 v18, s28, v84
    v_dot2c_f32_bf16 v19, s29, v84
    v_dot2c_f32_bf16 v20, s28, v85
    v_dot2c_f32_bf16 v21, s29, v85
    v_dot2c_f32_bf16 v22, s28, v86
    v_dot2c_f32_bf16 v23, s29, v86
    v_dot2c_f32_bf16 v24, s28, v87
    v_dot2c_f32_bf16 v25, s29, v87
    v_mad_u32_u16 v66, v30, s30, v8 op_sel:[1,0,0,0]
    buffer_load_dwordx4 v[80:83], v66, s[20:23], 0 offen sc1
    v_mad_u32_u16 v67, v50, s30, v8 op_sel:[1,0,0,0]
    buffer_load_dwordx4 v[84:87], v67, s[20:23], 0 offen sc1
    s_waitcnt vmcnt(7)
    v_dot2c_f32_bf16 v10, s28, v88
    v_dot2c_f32_bf16 v11, s29, v88
    v_dot2c_f32_bf16 v12, s28, v89
    v_dot2c_f32_bf16 v13, s29, v89
    v_dot2c_f32_bf16 v14, s28, v90
    v_dot2c_f32_bf16 v15, s29, v90
    v_dot2c_f32_bf16 v16, s28, v91
    v_dot2c_f32_bf16 v17, s29, v91
    s_waitcnt vmcnt(6)
    v_dot2c_f32_bf16 v18, s28, v92
    v_dot2c_f32_bf16 v19, s29, v92
    v_dot2c_f32_bf16 v20, s28, v93
    v_dot2c_f32_bf16 v21, s29, v93
    v_dot2c_f32_bf16 v22, s28, v94
    v_dot2c_f32_bf16 v23, s29, v94
    v_dot2c_f32_bf16 v24, s28, v95
    v_dot2c_f32_bf16 v25, s29, v95
    s_waitcnt vmcnt(5)
    v_dot2c_f32_bf16 v10, s28, v96
    v_dot2c_f32_bf16 v11, s29, v96
    v_dot2c_f32_bf16 v12, s28, v97
    v_dot2c_f32_bf16 v13, s29, v97
    v_dot2c_f32_bf16 v14, s28, v98
    v_dot2c_f32_bf16 v15, s29, v98
    v_dot2c_f32_bf16 v16, s28, v99
    v_dot2c_f32_bf16 v17, s29, v99
    s_waitcnt vmcnt(4)
    v_dot2c_f32_bf16 v18, s28, v100
    v_dot2c_f32_bf16 v19, s29, v100
    v_dot2c_f32_bf16 v20, s28, v101
    v_dot2c_f32_bf16 v21, s29, v101
    v_dot2c_f32_bf16 v22, s28, v102
    v_dot2c_f32_bf16 v23, s29, v102
    v_dot2c_f32_bf16 v24, s28, v103
    v_dot2c_f32_bf16 v25, s29, v103
    s_waitcnt vmcnt(3)
    v_dot2c_f32_bf16 v10, s28, v72
    v_dot2c_f32_bf16 v11, s29, v72
    v_dot2c_f32_bf16 v12, s28, v73
    v_dot2c_f32_bf16 v13, s29, v73
    v_dot2c_f32_bf16 v14, s28, v74
    v_dot2c_f32_bf16 v15, s29, v74
    v_dot2c_f32_bf16 v16, s28, v75
    v_dot2c_f32_bf16 v17, s29, v75
    s_waitcnt vmcnt(2)
    v_dot2c_f32_bf16 v18, s28, v76
    v_dot2c_f32_bf16 v19, s29, v76
    v_dot2c_f32_bf16 v20, s28, v77
    v_dot2c_f32_bf16 v21, s29, v77
    v_dot2c_f32_bf16 v22, s28, v78
    v_dot2c_f32_bf16 v23, s29, v78
    v_dot2c_f32_bf16 v24, s28, v79
    v_dot2c_f32_bf16 v25, s29, v79
    s_waitcnt vmcnt(1)
    v_dot2c_f32_bf16 v10, s28, v80
    v_dot2c_f32_bf16 v11, s29, v80
    v_dot2c_f32_bf16 v12, s28, v81
    v_dot2c_f32_bf16 v13, s29, v81
    v_dot2c_f32_bf16 v14, s28, v82
    v_dot2c_f32_bf16 v15, s29, v82
    v_dot2c_f32_bf16 v16, s28, v83
    v_dot2c_f32_bf16 v17, s29, v83
    s_waitcnt vmcnt(0)
    v_dot2c_f32_bf16 v18, s28, v84
    v_dot2c_f32_bf16 v19, s29, v84
    v_dot2c_f32_bf16 v20, s28, v85
    v_dot2c_f32_bf16 v21, s29, v85
    v_dot2c_f32_bf16 v22, s28, v86
    v_dot2c_f32_bf16 v23, s29, v86
    v_dot2c_f32_bf16 v24, s28, v87
    v_dot2c_f32_bf16 v25, s29, v87
    s_branch hop_fin
hop_w6:
    s_setprio 3
    v_mad_u32_u16 v66, v26, s30, v8 op_sel:[0,0,0,0]
    buffer_load_dwordx4 v[72:75], v66, s[20:23], 0 offen sc1
    v_mad_u32_u16 v67, v46, s30, v8 op_sel:[0,0,0,0]
    buffer_load_dwordx4 v[76:79], v67, s[20:23], 0 offen sc1
    v_mad_u32_u16 v66, v26, s30, v8 op_sel:[1,0,0,0]
    buffer_load_dwordx4 v[80:83], v66, s[20:23], 0 offen sc1
    v_mad_u32_u16 v67, v46, s30, v8 op_sel:[1,0,0,0]
    buffer_load_dwordx4 v[84:87], v67, s[20:23], 0 offen sc1
    v_mad_u32_u16 v66, v27, s30, v8 op_sel:[0,0,0,0]
    buffer_load_dwordx4 v[88:91], v66, s[20:23], 0 offen sc1
    v_mad_u32_u16 v67, v47, s30, v8 op_sel:[0,0,0,0]
    buffer_load_dwordx4 v[92:95], v67, s[20:23], 0 offen sc1
    s_setprio 2
    v_mad_u32_u16 v66, v27, s30, v8 op_sel:[1,0,0,0]
    buffer_load_dwordx4 v[96:99], v66, s[20:23], 0 offen sc1
    v_mad_u32_u16 v67, v47, s30, v8 op_sel:[1,0,0,0]
    buffer_load_dwordx4 v[100:103], v67, s[20:23], 0 offen sc1
    s_waitcnt vmcnt(7)
    v_dot2c_f32_bf16 v10, s28, v72
    v_dot2c_f32_bf16 v11, s29, v72
    v_dot2c_f32_bf16 v12, s28, v73
    v_dot2c_f32_bf16 v13, s29, v73
    v_dot2c_f32_bf16 v14, s28, v74
    v_dot2c_f32_bf16 v15, s29, v74
    v_dot2c_f32_bf16 v16, s28, v75
    v_dot2c_f32_bf16 v17, s29, v75
    s_waitcnt vmcnt(6)
    v_dot2c_f32_bf16 v18, s28, v76
    v_dot2c_f32_bf16 v19, s29, v76
    v_dot2c_f32_bf16 v20, s28, v77
    v_dot2c_f32_bf16 v21, s29, v77
    v_dot2c_f32_bf16 v22, s28, v78
    v_dot2c_f32_bf16 v23, s29, v78
    v_dot2c_f32_bf16 v24, s28, v79
    v_dot2c_f32_bf16 v25, s29, v79
    v_mad_u32_u16 v66, v28, s30, v8 op_sel:[0,0,0,0]
    buffer_load_dwordx4 v[72:75], v66, s[20:23], 0 offen sc1
    v_mad_u32_u16 v67, v48, s30, v8 op_sel:[0,0,0,0]
    buffer_load_dwordx4 v[76:79], v67, s[20:23], 0 offen sc1
    s_waitcnt vmcnt(7)
    v_dot2c_f32_bf16 v10, s28, v80
    v_dot2c_f32_bf16 v11, s29, v80
    v_dot2c_f32_bf16 v12, s28, v81
    v_dot2c_f32_bf16 v13, s29, v81
    v_dot2c_f32_bf16 v14, s28, v82
    v_dot2c_f32_bf16 v15, s29, v82
    v_dot2c_f32_bf16 v16, s28, v83
    v_dot2c_f32_bf16 v17, s29, v83
    s_waitcnt vmcnt(6)
    v_dot2c_f32_bf16 v18, s28, v84
    v_dot2c_f32_bf16 v19, s29, v84
    v_dot2c_f32_bf16 v20, s28, v85
    v_dot2c_f32_bf16 v21, s29, v85
    v_dot2c_f32_bf16 v22, s28, v86
    v_dot2c_f32_bf16 v23, s29, v86
    v_dot2c_f32_bf16 v24, s28, v87
    v_dot2c_f32_bf16 v25, s29, v87
    v_mad_u32_u16 v66, v28, s30, v8 op_sel:[1,0,0,0]
    buffer_load_dwordx4 v[80:83], v66, s[20:23], 0 offen sc1
    v_mad_u32_u16 v67, v48, s30, v8 op_sel:[1,0,0,0]
    buffer_load_dwordx4 v[84:87], v67, s[20:23], 0 offen sc1
    s_waitcnt vmcnt(7)
    v_dot2c_f32_bf16 v10, s28, v88
    v_dot2c_f32_bf16 v11, s29, v88
    v_dot2c_f32_bf16 v12, s28, v89
    v_dot2c_f32_bf16 v13, s29, v89
    v_dot2c_f32_bf16 v14, s28, v90
    v_dot2c_f32_bf16 v15, s29, v90
    v_dot2c_f32_bf16 v16, s28, v91
    v_dot2c_f32_bf16 v17, s29, v91
    s_waitcnt vmcnt(6)
    v_dot2c_f32_bf16 v18, s28, v92
    v_dot2c_f32_bf16 v19, s29, v92
    v_dot2c_f32_bf16 v20, s28, v93
    v_dot2c_f32_bf16 v21, s29, v93
    v_dot2c_f32_bf16 v22, s28, v94
    v_dot2c_f32_bf16 v23, s29, v94
    v_dot2c_f32_bf16 v24, s28, v95
    v_dot2c_f32_bf16 v25, s29, v95
    s_setprio 1
    v_mad_u32_u16 v66, v29, s30, v8 op_sel:[0,0,0,0]
    buffer_load_dwordx4 v[88:91], v66, s[20:23], 0 offen sc1
    v_mad_u32_u16 v67, v49, s30, v8 op_sel:[0,0,0,0]
    buffer_load_dwordx4 v[92:95], v67, s[20:23], 0 offen sc1
    s_waitcnt vmcnt(7)
    v_dot2c_f32_bf16 v10, s28, v96
    v_dot2c_f32_bf16 v11, s29, v96
    v_dot2c_f32_bf16 v12, s28, v97
    v_dot2c_f32_bf16 v13, s29, v97
    v_dot2c_f32_bf16 v14, s28, v98
    v_dot2c_f32_bf16 v15, s29, v98
    v_dot2c_f32_bf16 v16, s28, v99
    v_dot2c_f32_bf16 v17, s29, v99
    s_waitcnt vmcnt(6)
    v_dot2c_f32_bf16 v18, s28, v100
    v_dot2c_f32_bf16 v19, s29, v100
    v_dot2c_f32_bf16 v20, s28, v101
    v_dot2c_f32_bf16 v21, s29, v101
    v_dot2c_f32_bf16 v22, s28, v102
    v_dot2c_f32_bf16 v23, s29, v102
    v_dot2c_f32_bf16 v24, s28, v103
    v_dot2c_f32_bf16 v25, s29, v103
    v_mad_u32_u16 v66, v29, s30, v8 op_sel:[1,0,0,0]
    buffer_load_dwordx4 v[96:99], v66, s[20:23], 0 offen sc1
    v_mad_u32_u16 v67, v49, s30, v8 op_sel:[1,0,0,0]
    buffer_load_dwordx4 v[100:103], v67, s[20:23], 0 offen sc1
    s_waitcnt vmcnt(7)
    v_dot2c_f32_bf16 v10, s28, v72
    v_dot2c_f32_bf16 v11, s29, v72
    v_dot2c_f32_bf16 v12, s28, v73
    v_dot2c_f32_bf16 v13, s29, v73
    v_dot2c_f32_bf16 v14, s28, v74
    v_dot2c_f32_bf16 v15, s29, v74
    v_dot2c_f32_bf16 v16, s28, v75
    v_dot2c_f32_bf16 v17, s29, v75
    s_waitcnt vmcnt(6)
    v_dot2c_f32_bf16 v18, s28, v76
    v_dot2c_f32_bf16 v19, s29, v76
    v_dot2c_f32_bf16 v20, s28, v77
    v_dot2c_f32_bf16 v21, s29, v77
    v_dot2c_f32_bf16 v22, s28, v78
    v_dot2c_f32_bf16 v23, s29, v78
    v_dot2c_f32_bf16 v24, s28, v79
    v_dot2c_f32_bf16 v25, s29, v79
    v_mad_u32_u16 v66, v30, s30, v8 op_sel:[0,0,0,0]
    buffer_load_dwordx4 v[72:75], v66, s[20:23], 0 offen sc1
    v_mad_u32_u16 v67, v50, s30, v8 op_sel:[0,0,0,0]
    buffer_load_dwordx4 v[76:79], v67, s[20:23], 0 offen sc1
    s_waitcnt vmcnt(7)
    v_dot2c_f32_bf16 v10, s28, v80
    v_dot2c_f32_bf16 v11, s29, v80
    v_dot2c_f32_bf16 v12, s28, v81
    v_dot2c_f32_bf16 v13, s29, v81
    v_dot2c_f32_bf16 v14, s28, v82
    v_dot2c_f32_bf16 v15, s29, v82
    v_dot2c_f32_bf16 v16, s28, v83
    v_dot2c_f32_bf16 v17, s29, v83
    s_waitcnt vmcnt(6)
    v_dot2c_f32_bf16 v18, s28, v84
    v_dot2c_f32_bf16 v19, s29, v84
    v_dot2c_f32_bf16 v20, s28, v85
    v_dot2c_f32_bf16 v21, s29, v85
    v_dot2c_f32_bf16 v22, s28, v86
    v_dot2c_f32_bf16 v23, s29, v86
    v_dot2c_f32_bf16 v24, s28, v87
    v_dot2c_f32_bf16 v25, s29, v87
    s_setprio 0
    v_mad_u32_u16 v66, v30, s30, v8 op_sel:[1,0,0,0]
    buffer_load_dwordx4 v[80:83], v66, s[20:23], 0 offen sc1
    v_mad_u32_u16 v67, v50, s30, v8 op_sel:[1,0,0,0]
    buffer_load_dwordx4 v[84:87], v67, s[20:23], 0 offen sc1
    s_waitcnt vmcnt(7)
    v_dot2c_f32_bf16 v10, s28, v88
    v_dot2c_f32_bf16 v11, s29, v88
    v_dot2c_f32_bf16 v12, s28, v89
    v_dot2c_f32_bf16 v13, s29, v89
    v_dot2c_f32_bf16 v14, s28, v90
    v_dot2c_f32_bf16 v15, s29, v90
    v_dot2c_f32_bf16 v16, s28, v91
    v_dot2c_f32_bf16 v17, s29, v91
    s_waitcnt vmcnt(6)
    v_dot2c_f32_bf16 v18, s28, v92
    v_dot2c_f32_bf16 v19, s29, v92
    v_dot2c_f32_bf16 v20, s28, v93
    v_dot2c_f32_bf16 v21, s29, v93
    v_dot2c_f32_bf16 v22, s28, v94
    v_dot2c_f32_bf16 v23, s29, v94
    v_dot2c_f32_bf16 v24, s28, v95
    v_dot2c_f32_bf16 v25, s29, v95
    v_mad_u32_u16 v66, v31, s30, v8 op_sel:[0,0,0,0]
    buffer_load_dwordx4 v[88:91], v66, s[20:23], 0 offen sc1
    v_mad_u32_u16 v67, v51, s30, v8 op_sel:[0,0,0,0]
    buffer_load_dwordx4 v[92:95], v67, s[20:23], 0 offen sc1
    s_waitcnt vmcnt(7)
    v_dot2c_f32_bf16 v10, s28, v96
    v_dot2c_f32_bf16 v11, s29, v96
    v_dot2c_f32_bf16 v12, s28, v97
    v_dot2c_f32_bf16 v13, s29, v97
    v_dot2c_f32_bf16 v14, s28, v98
    v_dot2c_f32_bf16 v15, s29, v98
    v_dot2c_f32_bf16 v16, s28, v99
    v_dot2c_f32_bf16 v17, s29, v99
    s_waitcnt vmcnt(6)
    v_dot2c_f32_bf16 v18, s28, v100
    v_dot2c_f32_bf16 v19, s29, v100
    v_dot2c_f32_bf16 v20, s28, v101
    v_dot2c_f32_bf16 v21, s29, v101
    v_dot2c_f32_bf16 v22, s28, v102
    v_dot2c_f32_bf16 v23, s29, v102
    v_dot2c_f32_bf16 v24, s28, v103
    v_dot2c_f32_bf16 v25, s29, v103
    v_mad_u32_u16 v66, v31, s30, v8 op_sel:[1,0,0,0]
    buffer_load_dwordx4 v[96:99], v66, s[20:23], 0 offen sc1
    v_mad_u32_u16 v67, v51, s30, v8 op_sel:[1,0,0,0]
    buffer_load_dwordx4 v[100:103], v67, s[20:23], 0 offen sc1
    s_waitcnt vmcnt(7)
    v_dot2c_f32_bf16 v10, s28, v72
    v_dot2c_f32_bf16 v11, s29, v72
    v_dot2c_f32_bf16 v12, s28, v73
    v_dot2c_f32_bf16 v13, s29, v73
    v_dot2c_f32_bf16 v14, s28, v74
    v_dot2c_f32_bf16 v15, s29, v74
    v_dot2c_f32_bf16 v16, s28, v75
    v_dot2c_f32_bf16 v17, s29, v75
    s_waitcnt vmcnt(6)
    v_dot2c_f32_bf16 v18, s28, v76
    v_dot2c_f32_bf16 v19, s29, v76
    v_dot2c_f32_bf16 v20, s28, v77
    v_dot2c_f32_bf16 v21, s29, v77
    v_dot2c_f32_bf16 v22, s28, v78
    v_dot2c_f32_bf16 v23, s29, v78
    v_dot2c_f32_bf16 v24, s28, v79
    v_dot2c_f32_bf16 v25, s29, v79
    s_waitcnt vmcnt(5)
    v_dot2c_f32_bf16 v10, s28, v80
    v_dot2c_f32_bf16 v11, s29, v80
    v_dot2c_f32_bf16 v12, s28, v81
    v_dot2c_f32_bf16 v13, s29, v81
    v_dot2c_f32_bf16 v14, s28, v82
    v_dot2c_f32_bf16 v15, s29, v82
    v_dot2c_f32_bf16 v16, s28, v83
    v_dot2c_f32_bf16 v17, s29, v83
    s_waitcnt vmcnt(4)
    v_dot2c_f32_bf16 v18, s28, v84
    v_dot2c_f32_bf16 v19, s29, v84
    v_dot2c_f32_bf16 v20, s28, v85
    v_dot2c_f32_bf16 v21, s29, v85
    v_dot2c_f32_bf16 v22, s28, v86
    v_dot2c_f32_bf16 v23, s29, v86
    v_dot2c_f32_bf16 v24, s28, v87
    v_dot2c_f32_bf16 v25, s29, v87
    s_waitcnt vmcnt(3)
    v_dot2c_f32_bf16 v10, s28, v88
    v_dot2c_f32_bf16 v11, s29, v88
    v_dot2c_f32_bf16 v12, s28, v89
    v_dot2c_f32_bf16 v13, s29, v89
    v_dot2c_f32_bf16 v14, s28, v90
    v_dot2c_f32_bf16 v15, s29, v90
    v_dot2c_f32_bf16 v16, s28, v91
    v_dot2c_f32_bf16 v17, s29, v91
    s_waitcnt vmcnt(2)
    v_dot2c_f32_bf16 v18, s28, v92
    v_dot2c_f32_bf16 v19, s29, v92
    v_dot2c_f32_bf16 v20, s28, v93
    v_dot2c_f32_bf16 v21, s29, v93
    v_dot2c_f32_bf16 v22, s28, v94
    v_dot2c_f32_bf16 v23, s29, v94
    v_dot2c_f32_bf16 v24, s28, v95
    v_dot2c_f32_bf16 v25, s29, v95
    s_waitcnt vmcnt(1)
    v_dot2c_f32_bf16 v10, s28, v96
    v_dot2c_f32_bf16 v11, s29, v96
    v_dot2c_f32_bf16 v12, s28, v97
    v_dot2c_f32_bf16 v13, s29, v97
    v_dot2c_f32_bf16 v14, s28, v98
    v_dot2c_f32_bf16 v15, s29, v98
    v_dot2c_f32_bf16 v16, s28, v99
    v_dot2c_f32_bf16 v17, s29, v99
    s_waitcnt vmcnt(0)
    v_dot2c_f32_bf16 v18, s28, v100
    v_dot2c_f32_bf16 v19, s29, v100
    v_dot2c_f32_bf16 v20, s28, v101
    v_dot2c_f32_bf16 v21, s29, v101
    v_dot2c_f32_bf16 v22, s28, v102
    v_dot2c_f32_bf16 v23, s29, v102
    v_dot2c_f32_bf16 v24, s28, v103
    v_dot2c_f32_bf16 v25, s29, v103
    s_branch hop_fin
hop_w7:
    s_setprio 3
    v_mad_u32_u16 v66, v26, s30, v8 op_sel:[0,0,0,0]
    buffer_load_dwordx4 v[72:75], v66, s[20:23], 0 offen sc1
    v_mad_u32_u16 v67, v46, s30, v8 op_sel:[0,0,0,0]
    buffer_load_dwordx4 v[76:79], v67, s[20:23], 0 offen sc1
    v_mad_u32_u16 v66, v26, s30, v8 op_sel:[1,0,0,0]
    buffer_load_dwordx4 v[80:83], v66, s[20:23], 0 offen sc1
    v_mad_u32_u16 v67, v46, s30, v8 op_sel:[1,0,0,0]
    buffer_load_dwordx4 v[84:87], v67, s[20:23], 0 offen sc1
    v_mad_u32_u16 v66, v27, s30, v8 op_sel:[0,0,0,0]
    buffer_load_dwordx4 v[88:91], v66, s[20:23], 0 offen sc1
    v_mad_u32_u16 v67, v47, s30, v8 op_sel:[0,0,0,0]
    buffer_load_dwordx4 v[92:95], v67, s[20:23], 0 offen sc1
    v_mad_u32_u16 v66, v27, s30, v8 op_sel:[1,0,0,0]
    buffer_load_dwordx4 v[96:99], v66, s[20:23], 0 offen sc1
    v_mad_u32_u16 v67, v47, s30, v8 op_sel:[1,0,0,0]
    buffer_load_dwordx4 v[100:103], v67, s[20:23], 0 offen sc1
    s_waitcnt vmcnt(7)
    v_dot2c_f32_bf16 v10, s28, v72
    v_dot2c_f32_bf16 v11, s29, v72
    v_dot2c_f32_bf16 v12, s28, v73
    v_dot2c_f32_bf16 v13, s29, v73
    v_dot2c_f32_bf16 v14, s28, v74
    v_dot2c_f32_bf16 v15, s29, v74
    v_dot2c_f32_bf16 v16, s28, v75
    v_dot2c_f32_bf16 v17, s29, v75
    s_waitcnt vmcnt(6)
    v_dot2c_f32_bf16 v18, s28, v76
    v_dot2c_f32_bf16 v19, s29, v76
    v_dot2c_f32_bf16 v20, s28, v77
    v_dot2c_f32_bf16 v21, s29, v77
    v_dot2c_f32_bf16 v22, s28, v78
    v_dot2c_f32_bf16 v23, s29, v78
    v_dot2c_f32_bf16 v24, s28, v79
    v_dot2c_f32_bf16 v25, s29, v79
    s_setprio 2
    v_mad_u32_u16 v66, v28, s30, v8 op_sel:[0,0,0,0]
    buffer_load_dwordx4 v[72:75], v66, s[20:23], 0 offen sc1
    v_mad_u32_u16 v67, v48, s30, v8 op_sel:[0,0,0,0]
    buffer_load_dwordx4 v[76:79], v67, s[20:23], 0 offen sc1
    s_waitcnt vmcnt(7)
    v_dot2c_f32_bf16 v10, s28, v80
    v_dot2c_f32_bf16 v11, s29, v80
    v_dot2c_f32_bf16 v12, s28, v81
    v_dot2c_f32_bf16 v13, s29, v81
    v_dot2c_f32_bf16 v14, s28, v82
    v_dot2c_f32_bf16 v15, s29, v82
    v_dot2c_f32_bf16 v16, s28, v83
    v_dot2c_f32_bf16 v17, s29, v83
    s_waitcnt vmcnt(6)
    v_dot2c_f32_bf16 v18, s28, v84
    v_dot2c_f32_bf16 v19, s29, v84
    v_dot2c_f32_bf16 v20, s28, v85
    v_dot2c_f32_bf16 v21, s29, v85
    v_dot2c_f32_bf16 v22, s28, v86
    v_dot2c_f32_bf16 v23, s29, v86
    v_dot2c_f32_bf16 v24, s28, v87
    v_dot2c_f32_bf16 v25, s29, v87
    v_mad_u32_u16 v66, v28, s30, v8 op_sel:[1,0,0,0]
    buffer_load_dwordx4 v[80:83], v66, s[20:23], 0 offen sc1
    v_mad_u32_u16 v67, v48, s30, v8 op_sel:[1,0,0,0]
    buffer_load_dwordx4 v[84:87], v67, s[20:23], 0 offen sc1
    s_waitcnt vmcnt(7)
    v_dot2c_f32_bf16 v10, s28, v88
    v_dot2c_f32_bf16 v11, s29, v88
    v_dot2c_f32_bf16 v12, s28, v89
    v_dot2c_f32_bf16 v13, s29, v89
    v_dot2c_f32_bf16 v14, s28, v90
    v_dot2c_f32_bf16 v15, s29, v90
    v_dot2c_f32_bf16 v16, s28, v91
    v_dot2c_f32_bf16 v17, s29, v91
    s_waitcnt vmcnt(6)
    v_dot2c_f32_bf16 v18, s28, v92
    v_dot2c_f32_bf16 v19, s29, v92
    v_dot2c_f32_bf16 v20, s28, v93
    v_dot2c_f32_bf16 v21, s29, v93
    v_dot2c_f32_bf16 v22, s28, v94
    v_dot2c_f32_bf16 v23, s29, v94
    v_dot2c_f32_bf16 v24, s28, v95
    v_dot2c_f32_bf16 v25, s29, v95
    v_mad_u32_u16 v66, v29, s30, v8 op_sel:[0,0,0,0]
    buffer_load_dwordx4 v[88:91], v66, s[20:23], 0 offen sc1
    v_mad_u32_u16 v67, v49, s30, v8 op_sel:[0,0,0,0]
    buffer_load_dwordx4 v[92:95], v67, s[20:23], 0 offen sc1
    s_waitcnt vmcnt(7)
    v_dot2c_f32_bf16 v10, s28, v96
    v_dot2c_f32_bf16 v11, s29, v96
    v_dot2c_f32_bf16 v12, s28, v97
    v_dot2c_f32_bf16 v13, s29, v97
    v_dot2c_f32_bf16 v14, s28, v98
    v_dot2c_f32_bf16 v15, s29, v98
    v_dot2c_f32_bf16 v16, s28, v99
    v_dot2c_f32_bf16 v17, s29, v99
    s_waitcnt vmcnt(6)
    v_dot2c_f32_bf16 v18, s28, v100
    v_dot2c_f32_bf16 v19, s29, v100
    v_dot2c_f32_bf16 v20, s28, v101
    v_dot2c_f32_bf16 v21, s29, v101
    v_dot2c_f32_bf16 v22, s28, v102
    v_dot2c_f32_bf16 v23, s29, v102
    v_dot2c_f32_bf16 v24, s28, v103
    v_dot2c_f32_bf16 v25, s29, v103
    s_setprio 1
    v_mad_u32_u16 v66, v29, s30, v8 op_sel:[1,0,0,0]
    buffer_load_dwordx4 v[96:99], v66, s[20:23], 0 offen sc1
    v_mad_u32_u16 v67, v49, s30, v8 op_sel:[1,0,0,0]
    buffer_load_dwordx4 v[100:103], v67, s[20:23], 0 offen sc1
    s_waitcnt vmcnt(7)
    v_dot2c_f32_bf16 v10, s28, v72
    v_dot2c_f32_bf16 v11, s29, v72
    v_dot2c_f32_bf16 v12, s28, v73
    v_dot2c_f32_bf16 v13, s29, v73
    v_dot2c_f32_bf16 v14, s28, v74
    v_dot2c_f32_bf16 v15, s29, v74
    v_dot2c_f32_bf16 v16, s28, v75
    v_dot2c_f32_bf16 v17, s29, v75
    s_waitcnt vmcnt(6)
    v_dot2c_f32_bf16 v18, s28, v76
    v_dot2c_f32_bf16 v19, s29, v76
    v_dot2c_f32_bf16 v20, s28, v77
    v_dot2c_f32_bf16 v21, s29, v77
    v_dot2c_f32_bf16 v22, s28, v78
    v_dot2c_f32_bf16 v23, s29, v78
    v_dot2c_f32_bf16 v24, s28, v79
    v_dot2c_f32_bf16 v25, s29, v79
    v_mad_u32_u16 v66, v30, s30, v8 op_sel:[0,0,0,0]
    buffer_load_dwordx4 v[72:75], v66, s[20:23], 0 offen sc1
    v_mad_u32_u16 v67, v50, s30, v8 op_sel:[0,0,0,0]
    buffer_load_dwordx4 v[76:79], v67, s[20:23], 0 offen sc1
    s_waitcnt vmcnt(7)
    v_dot2c_f32_bf16 v10, s28, v80
    v_dot2c_f32_bf16 v11, s29, v80
    v_dot2c_f32_bf16 v12, s28, v81
    v_dot2c_f32_bf16 v13, s29, v81
    v_dot2c_f32_bf16 v14, s28, v82
    v_dot2c_f32_bf16 v15, s29, v82
    v_dot2c_f32_bf16 v16, s28, v83
    v_dot2c_f32_bf16 v17, s29, v83
    s_waitcnt vmcnt(6)
    v_dot2c_f32_bf16 v18, s28, v84
    v_dot2c_f32_bf16 v19, s29, v84
    v_dot2c_f32_bf16 v20, s28, v85
    v_dot2c_f32_bf16 v21, s29, v85
    v_dot2c_f32_bf16 v22, s28, v86
    v_dot2c_f32_bf16 v23, s29, v86
    v_dot2c_f32_bf16 v24, s28, v87
    v_dot2c_f32_bf16 v25, s29, v87
    v_mad_u32_u16 v66, v30, s30, v8 op_sel:[1,0,0,0]
    buffer_load_dwordx4 v[80:83], v66, s[20:23], 0 offen sc1
    v_mad_u32_u16 v67, v50, s30, v8 op_sel:[1,0,0,0]
    buffer_load_dwordx4 v[84:87], v67, s[20:23], 0 offen sc1
    s_waitcnt vmcnt(7)
    v_dot2c_f32_bf16 v10, s28, v88
    v_dot2c_f32_bf16 v11, s29, v88
    v_dot2c_f32_bf16 v12, s28, v89
    v_dot2c_f32_bf16 v13, s29, v89
    v_dot2c_f32_bf16 v14, s28, v90
    v_dot2c_f32_bf16 v15, s29, v90
    v_dot2c_f32_bf16 v16, s28, v91
    v_dot2c_f32_bf16 v17, s29, v91
    s_waitcnt vmcnt(6)
    v_dot2c_f32_bf16 v18, s28, v92
    v_dot2c_f32_bf16 v19, s29, v92
    v_dot2c_f32_bf16 v20, s28, v93
    v_dot2c_f32_bf16 v21, s29, v93
    v_dot2c_f32_bf16 v22, s28, v94
    v_dot2c_f32_bf16 v23, s29, v94
    v_dot2c_f32_bf16 v24, s28, v95
    v_dot2c_f32_bf16 v25, s29, v95
    v_mad_u32_u16 v66, v31, s30, v8 op_sel:[0,0,0,0]
    buffer_load_dwordx4 v[88:91], v66, s[20:23], 0 offen sc1
    v_mad_u32_u16 v67, v51, s30, v8 op_sel:[0,0,0,0]
    buffer_load_dwordx4 v[92:95], v67, s[20:23], 0 offen sc1
    s_waitcnt vmcnt(7)
    v_dot2c_f32_bf16 v10, s28, v96
    v_dot2c_f32_bf16 v11, s29, v96
    v_dot2c_f32_bf16 v12, s28, v97
    v_dot2c_f32_bf16 v13, s29, v97
    v_dot2c_f32_bf16 v14, s28, v98
    v_dot2c_f32_bf16 v15, s29, v98
    v_dot2c_f32_bf16 v16, s28, v99
    v_dot2c_f32_bf16 v17, s29, v99
    s_waitcnt vmcnt(6)
    v_dot2c_f32_bf16 v18, s28, v100
    v_dot2c_f32_bf16 v19, s29, v100
    v_dot2c_f32_bf16 v20, s28, v101
    v_dot2c_f32_bf16 v21, s29, v101
    v_dot2c_f32_bf16 v22, s28, v102
    v_dot2c_f32_bf16 v23, s29, v102
    v_dot2c_f32_bf16 v24, s28, v103
    v_dot2c_f32_bf16 v25, s29, v103
    s_setprio 0
    v_mad_u32_u16 v66, v31, s30, v8 op_sel:[1,0,0,0]
    buffer_load_dwordx4 v[96:99], v66, s[20:23], 0 offen sc1
    v_mad_u32_u16 v67, v51, s30, v8 op_sel:[1,0,0,0]
    buffer_load_dwordx4 v[100:103], v67, s[20:23], 0 offen sc1
    s_waitcnt vmcnt(7)
    v_dot2c_f32_bf16 v10, s28, v72
    v_dot2c_f32_bf16 v11, s29, v72
    v_dot2c_f32_bf16 v12, s28, v73
    v_dot2c_f32_bf16 v13, s29, v73
    v_dot2c_f32_bf16 v14, s28, v74
    v_dot2c_f32_bf16 v15, s29, v74
    v_dot2c_f32_bf16 v16, s28, v75
    v_dot2c_f32_bf16 v17, s29, v75
    s_waitcnt vmcnt(6)
    v_dot2c_f32_bf16 v18, s28, v76
    v_dot2c_f32_bf16 v19, s29, v76
    v_dot2c_f32_bf16 v20, s28, v77
    v_dot2c_f32_bf16 v21, s29, v77
    v_dot2c_f32_bf16 v22, s28, v78
    v_dot2c_f32_bf16 v23, s29, v78
    v_dot2c_f32_bf16 v24, s28, v79
    v_dot2c_f32_bf16 v25, s29, v79
    v_mad_u32_u16 v66, v32, s30, v8 op_sel:[0,0,0,0]
    buffer_load_dwordx4 v[72:75], v66, s[20:23], 0 offen sc1
    v_mad_u32_u16 v67, v52, s30, v8 op_sel:[0,0,0,0]
    buffer_load_dwordx4 v[76:79], v67, s[20:23], 0 offen sc1
    s_waitcnt vmcnt(7)
    v_dot2c_f32_bf16 v10, s28, v80
    v_dot2c_f32_bf16 v11, s29, v80
    v_dot2c_f32_bf16 v12, s28, v81
    v_dot2c_f32_bf16 v13, s29, v81
    v_dot2c_f32_bf16 v14, s28, v82
    v_dot2c_f32_bf16 v15, s29, v82
    v_dot2c_f32_bf16 v16, s28, v83
    v_dot2c_f32_bf16 v17, s29, v83
    s_waitcnt vmcnt(6)
    v_dot2c_f32_bf16 v18, s28, v84
    v_dot2c_f32_bf16 v19, s29, v84
    v_dot2c_f32_bf16 v20, s28, v85
    v_dot2c_f32_bf16 v21, s29, v85
    v_dot2c_f32_bf16 v22, s28, v86
    v_dot2c_f32_bf16 v23, s29, v86
    v_dot2c_f32_bf16 v24, s28, v87
    v_dot2c_f32_bf16 v25, s29, v87
    v_mad_u32_u16 v66, v32, s30, v8 op_sel:[1,0,0,0]
    buffer_load_dwordx4 v[80:83], v66, s[20:23], 0 offen sc1
    v_mad_u32_u16 v67, v52, s30, v8 op_sel:[1,0,0,0]
    buffer_load_dwordx4 v[84:87], v67, s[20:23], 0 offen sc1
    s_waitcnt vmcnt(7)
    v_dot2c_f32_bf16 v10, s28, v88
    v_dot2c_f32_bf16 v11, s29, v88
    v_dot2c_f32_bf16 v12, s28, v89
    v_dot2c_f32_bf16 v13, s29, v89
    v_dot2c_f32_bf16 v14, s28, v90
    v_dot2c_f32_bf16 v15, s29, v90
    v_dot2c_f32_bf16 v16, s28, v91
    v_dot2c_f32_bf16 v17, s29, v91
    s_waitcnt vmcnt(6)
    v_dot2c_f32_bf16 v18, s28, v92
    v_dot2c_f32_bf16 v19, s29, v92
    v_dot2c_f32_bf16 v20, s28, v93
    v_dot2c_f32_bf16 v21, s29, v93
    v_dot2c_f32_bf16 v22, s28, v94
    v_dot2c_f32_bf16 v23, s29, v94
    v_dot2c_f32_bf16 v24, s28, v95
    v_dot2c_f32_bf16 v25, s29, v95
    s_waitcnt vmcnt(5)
    v_dot2c_f32_bf16 v10, s28, v96
    v_dot2c_f32_bf16 v11, s29, v96
    v_dot2c_f32_bf16 v12, s28, v97
    v_dot2c_f32_bf16 v13, s29, v97
    v_dot2c_f32_bf16 v14, s28, v98
    v_dot2c_f32_bf16 v15, s29, v98
    v_dot2c_f32_bf16 v16, s28, v99
    v_dot2c_f32_bf16 v17, s29, v99
    s_waitcnt vmcnt(4)
    v_dot2c_f32_bf16 v18, s28, v100
    v_dot2c_f32_bf16 v19, s29, v100
    v_dot2c_f32_bf16 v20, s28, v101
    v_dot2c_f32_bf16 v21, s29, v101
    v_dot2c_f32_bf16 v22, s28, v102
    v_dot2c_f32_bf16 v23, s29, v102
    v_dot2c_f32_bf16 v24, s28, v103
    v_dot2c_f32_bf16 v25, s29, v103
    s_waitcnt vmcnt(3)
    v_dot2c_f32_bf16 v10, s28, v72
    v_dot2c_f32_bf16 v11, s29, v72
    v_dot2c_f32_bf16 v12, s28, v73
    v_dot2c_f32_bf16 v13, s29, v73
    v_dot2c_f32_bf16 v14, s28, v74
    v_dot2c_f32_bf16 v15, s29, v74
    v_dot2c_f32_bf16 v16, s28, v75
    v_dot2c_f32_bf16 v17, s29, v75
    s_waitcnt vmcnt(2)
    v_dot2c_f32_bf16 v18, s28, v76
    v_dot2c_f32_bf16 v19, s29, v76
    v_dot2c_f32_bf16 v20, s28, v77
    v_dot2c_f32_bf16 v21, s29, v77
    v_dot2c_f32_bf16 v22, s28, v78
    v_dot2c_f32_bf16 v23, s29, v78
    v_dot2c_f32_bf16 v24, s28, v79
    v_dot2c_f32_bf16 v25, s29, v79
    s_waitcnt vmcnt(1)
    v_dot2c_f32_bf16 v10, s28, v80
    v_dot2c_f32_bf16 v11, s29, v80
    v_dot2c_f32_bf16 v12, s28, v81
    v_dot2c_f32_bf16 v13, s29, v81
    v_dot2c_f32_bf16 v14, s28, v82
    v_dot2c_f32_bf16 v15, s29, v82
    v_dot2c_f32_bf16 v16, s28, v83
    v_dot2c_f32_bf16 v17, s29, v83
    s_waitcnt vmcnt(0)
    v_dot2c_f32_bf16 v18, s28, v84
    v_dot2c_f32_bf16 v19, s29, v84
    v_dot2c_f32_bf16 v20, s28, v85
    v_dot2c_f32_bf16 v21, s29, v85
    v_dot2c_f32_bf16 v22, s28, v86
    v_dot2c_f32_bf16 v23, s29, v86
    v_dot2c_f32_bf16 v24, s28, v87
    v_dot2c_f32_bf16 v25, s29, v87
    s_branch hop_fin
hop_w8:
    s_setprio 3
    v_mad_u32_u16 v66, v26, s30, v8 op_sel:[0,0,0,0]
    buffer_load_dwordx4 v[72:75], v66, s[20:23], 0 offen sc1
    v_mad_u32_u16 v67, v46, s30, v8 op_sel:[0,0,0,0]
    buffer_load_dwordx4 v[76:79], v67, s[20:23], 0 offen sc1
    v_mad_u32_u16 v66, v26, s30, v8 op_sel:[1,0,0,0]
    buffer_load_dwordx4 v[80:83], v66, s[20:23], 0 offen sc1
    v_mad_u32_u16 v67, v46, s30, v8 op_sel:[1,0,0,0]
    buffer_load_dwordx4 v[84:87], v67, s[20:23], 0 offen sc1
    v_mad_u32_u16 v66, v27, s30, v8 op_sel:[0,0,0,0]
    buffer_load_dwordx4 v[88:91], v66, s[20:23], 0 offen sc1
    v_mad_u32_u16 v67, v47, s30, v8 op_sel:[0,0,0,0]
    buffer_load_dwordx4 v[92:95], v67, s[20:23], 0 offen sc1
    v_mad_u32_u16 v66, v27, s30, v8 op_sel:[1,0,0,0]
    buffer_load_dwordx4 v[96:99], v66, s[20:23], 0 offen sc1
    v_mad_u32_u16 v67, v47, s30, v8 op_sel:[1,0,0,0]
    buffer_load_dwordx4 v[100:103], v67, s[20:23], 0 offen sc1
    s_waitcnt vmcnt(7)
    v_dot2c_f32_bf16 v10, s28, v72
    v_dot2c_f32_bf16 v11, s29, v72
    v_dot2c_f32_bf16 v12, s28, v73
    v_dot2c_f32_bf16 v13, s29, v73
    v_dot2c_f32_bf16 v14, s28, v74
    v_dot2c_f32_bf16 v15, s29, v74
    v_dot2c_f32_bf16 v16, s28, v75
    v_dot2c_f32_bf16 v17, s29, v75
    s_waitcnt vmcnt(6)
    v_dot2c_f32_bf16 v18, s28, v76
    v_dot2c_f32_bf16 v19, s29, v76
    v_dot2c_f32_bf16 v20, s28, v77
    v_dot2c_f32_bf16 v21, s29, v77
    v_dot2c_f32_bf16 v22, s28, v78
    v_dot2c_f32_bf16 v23, s29, v78
    v_dot2c_f32_bf16 v24, s28, v79
    v_dot2c_f32_bf16 v25, s29, v79
    s_setprio 2
    v_mad_u32_u16 v66, v28, s30, v8 op_sel:[0,0,0,0]
    buffer_load_dwordx4 v[72:75], v66, s[20:23], 0 offen sc1
    v_mad_u32_u16 v67, v48, s30, v8 op_sel:[0,0,0,0]
    buffer_load_dwordx4 v[76:79], v67, s[20:23], 0 offen sc1
    s_waitcnt vmcnt(7)
    v_dot2c_f32_bf16 v10, s28, v80
    v_dot2c_f32_bf16 v11, s29, v80
    v_dot2c_f32_bf16 v12, s28, v81
    v_dot2c_f32_bf16 v13, s29, v81
    v_dot2c_f32_bf16 v14, s28, v82
    v_dot2c_f32_bf16 v15, s29, v82
    v_dot2c_f32_bf16 v16, s28, v83
    v_dot2c_f32_bf16 v17, s29, v83
    s_waitcnt vmcnt(6)
    v_dot2c_f32_bf16 v18, s28, v84
    v_dot2c_f32_bf16 v19, s29, v84
    v_dot2c_f32_bf16 v20, s28, v85
    v_dot2c_f32_bf16 v21, s29, v85
    v_dot2c_f32_bf16 v22, s28, v86
    v_dot2c_f32_bf16 v23, s29, v86
    v_dot2c_f32_bf16 v24, s28, v87
    v_dot2c_f32_bf16 v25, s29, v87
    v_mad_u32_u16 v66, v28, s30, v8 op_sel:[1,0,0,0]
    buffer_load_dwordx4 v[80:83], v66, s[20:23], 0 offen sc1
    v_mad_u32_u16 v67, v48, s30, v8 op_sel:[1,0,0,0]
    buffer_load_dwordx4 v[84:87], v67, s[20:23], 0 offen sc1
    s_waitcnt vmcnt(7)
    v_dot2c_f32_bf16 v10, s28, v88
    v_dot2c_f32_bf16 v11, s29, v88
    v_dot2c_f32_bf16 v12, s28, v89
    v_dot2c_f32_bf16 v13, s29, v89
    v_dot2c_f32_bf16 v14, s28, v90
    v_dot2c_f32_bf16 v15, s29, v90
    v_dot2c_f32_bf16 v16, s28, v91
    v_dot2c_f32_bf16 v17, s29, v91
    s_waitcnt vmcnt(6)
    v_dot2c_f32_bf16 v18, s28, v92
    v_dot2c_f32_bf16 v19, s29, v92
    v_dot2c_f32_bf16 v20, s28, v93
    v_dot2c_f32_bf16 v21, s29, v93
    v_dot2c_f32_bf16 v22, s28, v94
    v_dot2c_f32_bf16 v23, s29, v94
    v_dot2c_f32_bf16 v24, s28, v95
    v_dot2c_f32_bf16 v25, s29, v95
    v_mad_u32_u16 v66, v29, s30, v8 op_sel:[0,0,0,0]
    buffer_load_dwordx4 v[88:91], v66, s[20:23], 0 offen sc1
    v_mad_u32_u16 v67, v49, s30, v8 op_sel:[0,0,0,0]
    buffer_load_dwordx4 v[92:95], v67, s[20:23], 0 offen sc1
    s_waitcnt vmcnt(7)
    v_dot2c_f32_bf16 v10, s28, v96
    v_dot2c_f32_bf16 v11, s29, v96
    v_dot2c_f32_bf16 v12, s28, v97
    v_dot2c_f32_bf16 v13, s29, v97
    v_dot2c_f32_bf16 v14, s28, v98
    v_dot2c_f32_bf16 v15, s29, v98
    v_dot2c_f32_bf16 v16, s28, v99
    v_dot2c_f32_bf16 v17, s29, v99
    s_waitcnt vmcnt(6)
    v_dot2c_f32_bf16 v18, s28, v100
    v_dot2c_f32_bf16 v19, s29, v100
    v_dot2c_f32_bf16 v20, s28, v101
    v_dot2c_f32_bf16 v21, s29, v101
    v_dot2c_f32_bf16 v22, s28, v102
    v_dot2c_f32_bf16 v23, s29, v102
    v_dot2c_f32_bf16 v24, s28, v103
    v_dot2c_f32_bf16 v25, s29, v103
    v_mad_u32_u16 v66, v29, s30, v8 op_sel:[1,0,0,0]
    buffer_load_dwordx4 v[96:99], v66, s[20:23], 0 offen sc1
    v_mad_u32_u16 v67, v49, s30, v8 op_sel:[1,0,0,0]
    buffer_load_dwordx4 v[100:103], v67, s[20:23], 0 offen sc1
    s_waitcnt vmcnt(7)
    v_dot2c_f32_bf16 v10, s28, v72
    v_dot2c_f32_bf16 v11, s29, v72
    v_dot2c_f32_bf16 v12, s28, v73
    v_dot2c_f32_bf16 v13, s29, v73
    v_dot2c_f32_bf16 v14, s28, v74
    v_dot2c_f32_bf16 v15, s29, v74
    v_dot2c_f32_bf16 v16, s28, v75
    v_dot2c_f32_bf16 v17, s29, v75
    s_waitcnt vmcnt(6)
    v_dot2c_f32_bf16 v18, s28, v76
    v_dot2c_f32_bf16 v19, s29, v76
    v_dot2c_f32_bf16 v20, s28, v77
    v_dot2c_f32_bf16 v21, s29, v77
    v_dot2c_f32_bf16 v22, s28, v78
    v_dot2c_f32_bf16 v23, s29, v78
    v_dot2c_f32_bf16 v24, s28, v79
    v_dot2c_f32_bf16 v25, s29, v79
    s_setprio 1
    v_mad_u32_u16 v66, v30, s30, v8 op_sel:[0,0,0,0]
    buffer_load_dwordx4 v[72:75], v66, s[20:23], 0 offen sc1
    v_mad_u32_u16 v67, v50, s30, v8 op_sel:[0,0,0,0]
    buffer_load_dwordx4 v[76:79], v67, s[20:23], 0 offen sc1
    s_waitcnt vmcnt(7)
    v_dot2c_f32_bf16 v10, s28, v80
    v_dot2c_f32_bf16 v11, s29, v80
    v_dot2c_f32_bf16 v12, s28, v81
    v_dot2c_f32_bf16 v13, s29, v81
    v_dot2c_f32_bf16 v14, s28, v82
    v_dot2c_f32_bf16 v15, s29, v82
    v_dot2c_f32_bf16 v16, s28, v83
    v_dot2c_f32_bf16 v17, s29, v83
    s_waitcnt vmcnt(6)
    v_dot2c_f32_bf16 v18, s28, v84
    v_dot2c_f32_bf16 v19, s29, v84
    v_dot2c_f32_bf16 v20, s28, v85
    v_dot2c_f32_bf16 v21, s29, v85
    v_dot2c_f32_bf16 v22, s28, v86
    v_dot2c_f32_bf16 v23, s29, v86
    v_dot2c_f32_bf16 v24, s28, v87
    v_dot2c_f32_bf16 v25, s29, v87
    v_mad_u32_u16 v66, v30, s30, v8 op_sel:[1,0,0,0]
    buffer_load_dwordx4 v[80:83], v66, s[20:23], 0 offen sc1
    v_mad_u32_u16 v67, v50, s30, v8 op_sel:[1,0,0,0]
    buffer_load_dwordx4 v[84:87], v67, s[20:23], 0 offen sc1
    s_waitcnt vmcnt(7)
    v_dot2c_f32_bf16 v10, s28, v88
    v_dot2c_f32_bf16 v11, s29, v88
    v_dot2c_f32_bf16 v12, s28, v89
    v_dot2c_f32_bf16 v13, s29, v89
    v_dot2c_f32_bf16 v14, s28, v90
    v_dot2c_f32_bf16 v15, s29, v90
    v_dot2c_f32_bf16 v16, s28, v91
    v_dot2c_f32_bf16 v17, s29, v91
    s_waitcnt vmcnt(6)
    v_dot2c_f32_bf16 v18, s28, v92
    v_dot2c_f32_bf16 v19, s29, v92
    v_dot2c_f32_bf16 v20, s28, v93
    v_dot2c_f32_bf16 v21, s29, v93
    v_dot2c_f32_bf16 v22, s28, v94
    v_dot2c_f32_bf16 v23, s29, v94
    v_dot2c_f32_bf16 v24, s28, v95
    v_dot2c_f32_bf16 v25, s29, v95
    v_mad_u32_u16 v66, v31, s30, v8 op_sel:[0,0,0,0]
    buffer_load_dwordx4 v[88:91], v66, s[20:23], 0 offen sc1
    v_mad_u32_u16 v67, v51, s30, v8 op_sel:[0,0,0,0]
    buffer_load_dwordx4 v[92:95], v67, s[20:23], 0 offen sc1
    s_waitcnt vmcnt(7)
    v_dot2c_f32_bf16 v10, s28, v96
    v_dot2c_f32_bf16 v11, s29, v96
    v_dot2c_f32_bf16 v12, s28, v97
    v_dot2c_f32_bf16 v13, s29, v97
    v_dot2c_f32_bf16 v14, s28, v98
    v_dot2c_f32_bf16 v15, s29, v98
    v_dot2c_f32_bf16 v16, s28, v99
    v_dot2c_f32_bf16 v17, s29, v99
    s_waitcnt vmcnt(6)
    v_dot2c_f32_bf16 v18, s28, v100
    v_dot2c_f32_bf16 v19, s29, v100
    v_dot2c_f32_bf16 v20, s28, v101
    v_dot2c_f32_bf16 v21, s29, v101
    v_dot2c_f32_bf16 v22, s28, v102
    v_dot2c_f32_bf16 v23, s29, v102
    v_dot2c_f32_bf16 v24, s28, v103
    v_dot2c_f32_bf16 v25, s29, v103
    v_mad_u32_u16 v66, v31, s30, v8 op_sel:[1,0,0,0]
    buffer_load_dwordx4 v[96:99], v66, s[20:23], 0 offen sc1
    v_mad_u32_u16 v67, v51, s30, v8 op_sel:[1,0,0,0]
    buffer_load_dwordx4 v[100:103], v67, s[20:23], 0 offen sc1
    s_waitcnt vmcnt(7)
    v_dot2c_f32_bf16 v10, s28, v72
    v_dot2c_f32_bf16 v11, s29, v72
    v_dot2c_f32_bf16 v12, s28, v73
    v_dot2c_f32_bf16 v13, s29, v73
    v_dot2c_f32_bf16 v14, s28, v74
    v_dot2c_f32_bf16 v15, s29, v74
    v_dot2c_f32_bf16 v16, s28, v75
    v_dot2c_f32_bf16 v17, s29, v75
    s_waitcnt vmcnt(6)
    v_dot2c_f32_bf16 v18, s28, v76
    v_dot2c_f32_bf16 v19, s29, v76
    v_dot2c_f32_bf16 v20, s28, v77
    v_dot2c_f32_bf16 v21, s29, v77
    v_dot2c_f32_bf16 v22, s28, v78
    v_dot2c_f32_bf16 v23, s29, v78
    v_dot2c_f32_bf16 v24, s28, v79
    v_dot2c_f32_bf16 v25, s29, v79
    s_setprio 0
    v_mad_u32_u16 v66, v32, s30, v8 op_sel:[0,0,0,0]
    buffer_load_dwordx4 v[72:75], v66, s[20:23], 0 offen sc1
    v_mad_u32_u16 v67, v52, s30, v8 op_sel:[0,0,0,0]
    buffer_load_dwordx4 v[76:79], v67, s[20:23], 0 offen sc1
    s_waitcnt vmcnt(7)
    v_dot2c_f32_bf16 v10, s28, v80
    v_dot2c_f32_bf16 v11, s29, v80
    v_dot2c_f32_bf16 v12, s28, v81
    v_dot2c_f32_bf16 v13, s29, v81
    v_dot2c_f32_bf16 v14, s28, v82
    v_dot2c_f32_bf16 v15, s29, v82
    v_dot2c_f32_bf16 v16, s28, v83
    v_dot2c_f32_bf16 v17, s29, v83
    s_waitcnt vmcnt(6)
    v_dot2c_f32_bf16 v18, s28, v84
    v_dot2c_f32_bf16 v19, s29, v84
    v_dot2c_f32_bf16 v20, s28, v85
    v_dot2c_f32_bf16 v21, s29, v85
    v_dot2c_f32_bf16 v22, s28, v86
    v_dot2c_f32_bf16 v23, s29, v86
    v_dot2c_f32_bf16 v24, s28, v87
    v_dot2c_f32_bf16 v25, s29, v87
    v_mad_u32_u16 v66, v32, s30, v8 op_sel:[1,0,0,0]
    buffer_load_dwordx4 v[80:83], v66, s[20:23], 0 offen sc1
    v_mad_u32_u16 v67, v52, s30, v8 op_sel:[1,0,0,0]
    buffer_load_dwordx4 v[84:87], v67, s[20:23], 0 offen sc1
    s_waitcnt vmcnt(7)
    v_dot2c_f32_bf16 v10, s28, v88
    v_dot2c_f32_bf16 v11, s29, v88
    v_dot2c_f32_bf16 v12, s28, v89
    v_dot2c_f32_bf16 v13, s29, v89
    v_dot2c_f32_bf16 v14, s28, v90
    v_dot2c_f32_bf16 v15, s29, v90
    v_dot2c_f32_bf16 v16, s28, v91
    v_dot2c_f32_bf16 v17, s29, v91
    s_waitcnt vmcnt(6)
    v_dot2c_f32_bf16 v18, s28, v92
    v_dot2c_f32_bf16 v19, s29, v92
    v_dot2c_f32_bf16 v20, s28, v93
    v_dot2c_f32_bf16 v21, s29, v93
    v_dot2c_f32_bf16 v22, s28, v94
    v_dot2c_f32_bf16 v23, s29, v94
    v_dot2c_f32_bf16 v24, s28, v95
    v_dot2c_f32_bf16 v25, s29, v95
    v_mad_u32_u16 v66, v33, s30, v8 op_sel:[0,0,0,0]
    buffer_load_dwordx4 v[88:91], v66, s[20:23], 0 offen sc1
    v_mad_u32_u16 v67, v53, s30, v8 op_sel:[0,0,0,0]
    buffer_load_dwordx4 v[92:95], v67, s[20:23], 0 offen sc1
    s_waitcnt vmcnt(7)
    v_dot2c_f32_bf16 v10, s28, v96
    v_dot2c_f32_bf16 v11, s29, v96
    v_dot2c_f32_bf16 v12, s28, v97
    v_dot2c_f32_bf16 v13, s29, v97
    v_dot2c_f32_bf16 v14, s28, v98
    v_dot2c_f32_bf16 v15, s29, v98
    v_dot2c_f32_bf16 v16, s28, v99
    v_dot2c_f32_bf16 v17, s29, v99
    s_waitcnt vmcnt(6)
    v_dot2c_f32_bf16 v18, s28, v100
    v_dot2c_f32_bf16 v19, s29, v100
    v_dot2c_f32_bf16 v20, s28, v101
    v_dot2c_f32_bf16 v21, s29, v101
    v_dot2c_f32_bf16 v22, s28, v102
    v_dot2c_f32_bf16 v23, s29, v102
    v_dot2c_f32_bf16 v24, s28, v103
    v_dot2c_f32_bf16 v25, s29, v103
    v_mad_u32_u16 v66, v33, s30, v8 op_sel:[1,0,0,0]
    buffer_load_dwordx4 v[96:99], v66, s[20:23], 0 offen sc1
    v_mad_u32_u16 v67, v53, s30, v8 op_sel:[1,0,0,0]
    buffer_load_dwordx4 v[100:103], v67, s[20:23], 0 offen sc1
    s_waitcnt vmcnt(7)
    v_dot2c_f32_bf16 v10, s28, v72
    v_dot2c_f32_bf16 v11, s29, v72
    v_dot2c_f32_bf16 v12, s28, v73
    v_dot2c_f32_bf16 v13, s29, v73
    v_dot2c_f32_bf16 v14, s28, v74
    v_dot2c_f32_bf16 v15, s29, v74
    v_dot2c_f32_bf16 v16, s28, v75
    v_dot2c_f32_bf16 v17, s29, v75
    s_waitcnt vmcnt(6)
    v_dot2c_f32_bf16 v18, s28, v76
    v_dot2c_f32_bf16 v19, s29, v76
    v_dot2c_f32_bf16 v20, s28, v77
    v_dot2c_f32_bf16 v21, s29, v77
    v_dot2c_f32_bf16 v22, s28, v78
    v_dot2c_f32_bf16 v23, s29, v78
    v_dot2c_f32_bf16 v24, s28, v79
    v_dot2c_f32_bf16 v25, s29, v79
    s_waitcnt vmcnt(5)
    v_dot2c_f32_bf16 v10, s28, v80
    v_dot2c_f32_bf16 v11, s29, v80
    v_dot2c_f32_bf16 v12, s28, v81
    v_dot2c_f32_bf16 v13, s29, v81
    v_dot2c_f32_bf16 v14, s28, v82
    v_dot2c_f32_bf16 v15, s29, v82
    v_dot2c_f32_bf16 v16, s28, v83
    v_dot2c_f32_bf16 v17, s29, v83
    s_waitcnt vmcnt(4)
    v_dot2c_f32_bf16 v18, s28, v84
    v_dot2c_f32_bf16 v19, s29, v84
    v_dot2c_f32_bf16 v20, s28, v85
    v_dot2c_f32_bf16 v21, s29, v85
    v_dot2c_f32_bf16 v22, s28, v86
    v_dot2c_f32_bf16 v23, s29, v86
    v_dot2c_f32_bf16 v24, s28, v87
    v_dot2c_f32_bf16 v25, s29, v87
    s_waitcnt vmcnt(3)
    v_dot2c_f32_bf16 v10, s28, v88
    v_dot2c_f32_bf16 v11, s29, v88
    v_dot2c_f32_bf16 v12, s28, v89
    v_dot2c_f32_bf16 v13, s29, v89
    v_dot2c_f32_bf16 v14, s28, v90
    v_dot2c_f32_bf16 v15, s29, v90
    v_dot2c_f32_bf16 v16, s28, v91
    v_dot2c_f32_bf16 v17, s29, v91
    s_waitcnt vmcnt(2)
    v_dot2c_f32_bf16 v18, s28, v92
    v_dot2c_f32_bf16 v19, s29, v92
    v_dot2c_f32_bf16 v20, s28, v93
    v_dot2c_f32_bf16 v21, s29, v93
    v_dot2c_f32_bf16 v22, s28, v94
    v_dot2c_f32_bf16 v23, s29, v94
    v_dot2c_f32_bf16 v24, s28, v95
    v_dot2c_f32_bf16 v25, s29, v95
    s_waitcnt vmcnt(1)
    v_dot2c_f32_bf16 v10, s28, v96
    v_dot2c_f32_bf16 v11, s29, v96
    v_dot2c_f32_bf16 v12, s28, v97
    v_dot2c_f32_bf16 v13, s29, v97
    v_dot2c_f32_bf16 v14, s28, v98
    v_dot2c_f32_bf16 v15, s29, v98
    v_dot2c_f32_bf16 v16, s28, v99
    v_dot2c_f32_bf16 v17, s29, v99
    s_waitcnt vmcnt(0)
    v_dot2c_f32_bf16 v18, s28, v100
    v_dot2c_f32_bf16 v19, s29, v100
    v_dot2c_f32_bf16 v20, s28, v101
    v_dot2c_f32_bf16 v21, s29, v101
    v_dot2c_f32_bf16 v22, s28, v102
    v_dot2c_f32_bf16 v23, s29, v102
    v_dot2c_f32_bf16 v24, s28, v103
    v_dot2c_f32_bf16 v25, s29, v103
    s_branch hop_fin
hop_w9:
    s_setprio 3
    v_mad_u32_u16 v66, v26, s30, v8 op_sel:[0,0,0,0]
    buffer_load_dwordx4 v[72:75], v66, s[20:23], 0 offen sc1
    v_mad_u32_u16 v67, v46, s30, v8 op_sel:[0,0,0,0]
    buffer_load_dwordx4 v[76:79], v67, s[20:23], 0 offen sc1
    v_mad_u32_u16 v66, v26, s30, v8 op_sel:[1,0,0,0]
    buffer_load_dwordx4 v[80:83], v66, s[20:23], 0 offen sc1
    v_mad_u32_u16 v67, v46, s30, v8 op_sel:[1,0,0,0]
    buffer_load_dwordx4 v[84:87], v67, s[20:23], 0 offen sc1
    v_mad_u32_u16 v66, v27, s30, v8 op_sel:[0,0,0,0]
    buffer_load_dwordx4 v[88:91], v66, s[20:23], 0 offen sc1
    v_mad_u32_u16 v67, v47, s30, v8 op_sel:[0,0,0,0]
    buffer_load_dwordx4 v[92:95], v67, s[20:23], 0 offen sc1
    v_mad_u32_u16 v66, v27, s30, v8 op_sel:[1,0,0,0]
    buffer_load_dwordx4 v[96:99], v66, s[20:23], 0 offen sc1
    v_mad_u32_u16 v67, v47, s30, v8 op_sel:[1,0,0,0]
    buffer_load_dwordx4 v[100:103], v67, s[20:23], 0 offen sc1
    s_waitcnt vmcnt(7)
    v_dot2c_f32_bf16 v10, s28, v72
    v_dot2c_f32_bf16 v11, s29, v72
    v_dot2c_f32_bf16 v12, s28, v73
    v_dot2c_f32_bf16 v13, s29, v73
    v_dot2c_f32_bf16 v14, s28, v74
    v_dot2c_f32_bf16 v15, s29, v74
    v_dot2c_f32_bf16 v16, s28, v75
    v_dot2c_f32_bf16 v17, s29, v75
    s_waitcnt vmcnt(6)
    v_dot2c_f32_bf16 v18, s28, v76
    v_dot2c_f32_bf16 v19, s29, v76
    v_dot2c_f32_bf16 v20, s28, v77
    v_dot2c_f32_bf16 v21, s29, v77
    v_dot2c_f32_bf16 v22, s28, v78
    v_dot2c_f32_bf16 v23, s29, v78
    v_dot2c_f32_bf16 v24, s28, v79
    v_dot2c_f32_bf16 v25, s29, v79
    v_mad_u32_u16 v66, v28, s30, v8 op_sel:[0,0,0,0]
    buffer_load_dwordx4 v[72:75], v66, s[20:23], 0 offen sc1
    v_mad_u32_u16 v67, v48, s30, v8 op_sel:[0,0,0,0]
    buffer_load_dwordx4 v[76:79], v67, s[20:23], 0 offen sc1
    s_waitcnt vmcnt(7)
    v_dot2c_f32_bf16 v10, s28, v80
    v_dot2c_f32_bf16 v11, s29, v80
    v_dot2c_f32_bf16 v12, s28, v81
    v_dot2c_f32_bf16 v13, s29, v81
    v_dot2c_f32_bf16 v14, s28, v82
    v_dot2c_f32_bf16 v15, s29, v82
    v_dot2c_f32_bf16 v16, s28, v83
    v_dot2c_f32_bf16 v17, s29, v83
    s_waitcnt vmcnt(6)
    v_dot2c_f32_bf16 v18, s28, v84
    v_dot2c_f32_bf16 v19, s29, v84
    v_dot2c_f32_bf16 v20, s28, v85
    v_dot2c_f32_bf16 v21, s29, v85
    v_dot2c_f32_bf16 v22, s28, v86
    v_dot2c_f32_bf16 v23, s29, v86
    v_dot2c_f32_bf16 v24, s28, v87
    v_dot2c_f32_bf16 v25, s29, v87
    s_setprio 2
    v_mad_u32_u16 v66, v28, s30, v8 op_sel:[1,0,0,0]
    buffer_load_dwordx4 v[80:83], v66, s[20:23], 0 offen sc1
    v_mad_u32_u16 v67, v48, s30, v8 op_sel:[1,0,0,0]
    buffer_load_dwordx4 v[84:87], v67, s[20:23], 0 offen sc1
    s_waitcnt vmcnt(7)
    v_dot2c_f32_bf16 v10, s28, v88
    v_dot2c_f32_bf16 v11, s29, v88
    v_dot2c_f32_bf16 v12, s28, v89
    v_dot2c_f32_bf16 v13, s29, v89
    v_dot2c_f32_bf16 v14, s28, v90
    v_dot2c_f32_bf16 v15, s29, v90
    v_dot2c_f32_bf16 v16, s28, v91
    v_dot2c_f32_bf16 v17, s29, v91
    s_waitcnt vmcnt(6)
    v_dot2c_f32_bf16 v18, s28, v92
    v_dot2c_f32_bf16 v19, s29, v92
    v_dot2c_f32_bf16 v20, s28, v93
    v_dot2c_f32_bf16 v21, s29, v93
    v_dot2c_f32_bf16 v22, s28, v94
    v_dot2c_f32_bf16 v23, s29, v94
    v_dot2c_f32_bf16 v24, s28, v95
    v_dot2c_f32_bf16 v25, s29, v95
    v_mad_u32_u16 v66, v29, s30, v8 op_sel:[0,0,0,0]
    buffer_load_dwordx4 v[88:91], v66, s[20:23], 0 offen sc1
    v_mad_u32_u16 v67, v49, s30, v8 op_sel:[0,0,0,0]
    buffer_load_dwordx4 v[92:95], v67, s[20:23], 0 offen sc1
    s_waitcnt vmcnt(7)
    v_dot2c_f32_bf16 v10, s28, v96
    v_dot2c_f32_bf16 v11, s29, v96
    v_dot2c_f32_bf16 v12, s28, v97
    v_dot2c_f32_bf16 v13, s29, v97
    v_dot2c_f32_bf16 v14, s28, v98
    v_dot2c_f32_bf16 v15, s29, v98
    v_dot2c_f32_bf16 v16, s28, v99
    v_dot2c_f32_bf16 v17, s29, v99
    s_waitcnt vmcnt(6)
    v_dot2c_f32_bf16 v18, s28, v100
    v_dot2c_f32_bf16 v19, s29, v100
    v_dot2c_f32_bf16 v20, s28, v101
    v_dot2c_f32_bf16 v21, s29, v101
    v_dot2c_f32_bf16 v22, s28, v102
    v_dot2c_f32_bf16 v23, s29, v102
    v_dot2c_f32_bf16 v24, s28, v103
    v_dot2c_f32_bf16 v25, s29, v103
    v_mad_u32_u16 v66, v29, s30, v8 op_sel:[1,0,0,0]
    buffer_load_dwordx4 v[96:99], v66, s[20:23], 0 offen sc1
    v_mad_u32_u16 v67, v49, s30, v8 op_sel:[1,0,0,0]
    buffer_load_dwordx4 v[100:103], v67, s[20:23], 0 offen sc1
    s_waitcnt vmcnt(7)
    v_dot2c_f32_bf16 v10, s28, v72
    v_dot2c_f32_bf16 v11, s29, v72
    v_dot2c_f32_bf16 v12, s28, v73
    v_dot2c_f32_bf16 v13, s29, v73
    v_dot2c_f32_bf16 v14, s28, v74
    v_dot2c_f32_bf16 v15, s29, v74
    v_dot2c_f32_bf16 v16, s28, v75
    v_dot2c_f32_bf16 v17, s29, v75
    s_waitcnt vmcnt(6)
    v_dot2c_f32_bf16 v18, s28, v76
    v_dot2c_f32_bf16 v19, s29, v76
    v_dot2c_f32_bf16 v20, s28, v77
    v_dot2c_f32_bf16 v21, s29, v77
    v_dot2c_f32_bf16 v22, s28, v78
    v_dot2c_f32_bf16 v23, s29, v78
    v_dot2c_f32_bf16 v24, s28, v79
    v_dot2c_f32_bf16 v25, s29, v79
    v_mad_u32_u16 v66, v30, s30, v8 op_sel:[0,0,0,0]
    buffer_load_dwordx4 v[72:75], v66, s[20:23], 0 offen sc1
    v_mad_u32_u16 v67, v50, s30, v8 op_sel:[0,0,0,0]
    buffer_load_dwordx4 v[76:79], v67, s[20:23], 0 offen sc1
    s_waitcnt vmcnt(7)
    v_dot2c_f32_bf16 v10, s28, v80
    v_dot2c_f32_bf16 v11, s29, v80
    v_dot2c_f32_bf16 v12, s28, v81
    v_dot2c_f32_bf16 v13, s29, v81
    v_dot2c_f32_bf16 v14, s28, v82
    v_dot2c_f32_bf16 v15, s29, v82
    v_dot2c_f32_bf16 v16, s28, v83
    v_dot2c_f32_bf16 v17, s29, v83
    s_waitcnt vmcnt(6)
    v_dot2c_f32_bf16 v18, s28, v84
    v_dot2c_f32_bf16 v19, s29, v84
    v_dot2c_f32_bf16 v20, s28, v85
    v_dot2c_f32_bf16 v21, s29, v85
    v_dot2c_f32_bf16 v22, s28, v86
    v_dot2c_f32_bf16 v23, s29, v86
    v_dot2c_f32_bf16 v24, s28, v87
    v_dot2c_f32_bf16 v25, s29, v87
    s_setprio 1
    v_mad_u32_u16 v66, v30, s30, v8 op_sel:[1,0,0,0]
    buffer_load_dwordx4 v[80:83], v66, s[20:23], 0 offen sc1
    v_mad_u32_u16 v67, v50, s30, v8 op_sel:[1,0,0,0]
    buffer_load_dwordx4 v[84:87], v67, s[20:23], 0 offen sc1
    s_waitcnt vmcnt(7)
    v_dot2c_f32_bf16 v10, s28, v88
    v_dot2c_f32_bf16 v11, s29, v88
    v_dot2c_f32_bf16 v12, s28, v89
    v_dot2c_f32_bf16 v13, s29, v89
    v_dot2c_f32_bf16 v14, s28, v90
    v_dot2c_f32_bf16 v15, s29, v90
    v_dot2c_f32_bf16 v16, s28, v91
    v_dot2c_f32_bf16 v17, s29, v91
    s_waitcnt vmcnt(6)
    v_dot2c_f32_bf16 v18, s28, v92
    v_dot2c_f32_bf16 v19, s29, v92
    v_dot2c_f32_bf16 v20, s28, v93
    v_dot2c_f32_bf16 v21, s29, v93
    v_dot2c_f32_bf16 v22, s28, v94
    v_dot2c_f32_bf16 v23, s29, v94
    v_dot2c_f32_bf16 v24, s28, v95
    v_dot2c_f32_bf16 v25, s29, v95
    v_mad_u32_u16 v66, v31, s30, v8 op_sel:[0,0,0,0]
    buffer_load_dwordx4 v[88:91], v66, s[20:23], 0 offen sc1
    v_mad_u32_u16 v67, v51, s30, v8 op_sel:[0,0,0,0]
    buffer_load_dwordx4 v[92:95], v67, s[20:23], 0 offen sc1
    s_waitcnt vmcnt(7)
    v_dot2c_f32_bf16 v10, s28, v96
    v_dot2c_f32_bf16 v11, s29, v96
    v_dot2c_f32_bf16 v12, s28, v97
    v_dot2c_f32_bf16 v13, s29, v97
    v_dot2c_f32_bf16 v14, s28, v98
    v_dot2c_f32_bf16 v15, s29, v98
    v_dot2c_f32_bf16 v16, s28, v99
    v_dot2c_f32_bf16 v17, s29, v99
    s_waitcnt vmcnt(6)
    v_dot2c_f32_bf16 v18, s28, v100
    v_dot2c_f32_bf16 v19, s29, v100
    v_dot2c_f32_bf16 v20, s28, v101
    v_dot2c_f32_bf16 v21, s29, v101
    v_dot2c_f32_bf16 v22, s28, v102
    v_dot2c_f32_bf16 v23, s29, v102
    v_dot2c_f32_bf16 v24, s28, v103
    v_dot2c_f32_bf16 v25, s29, v103
    v_mad_u32_u16 v66, v31, s30, v8 op_sel:[1,0,0,0]
    buffer_load_dwordx4 v[96:99], v66, s[20:23], 0 offen sc1
    v_mad_u32_u16 v67, v51, s30, v8 op_sel:[1,0,0,0]
    buffer_load_dwordx4 v[100:103], v67, s[20:23], 0 offen sc1
    s_waitcnt vmcnt(7)
    v_dot2c_f32_bf16 v10, s28, v72
    v_dot2c_f32_bf16 v11, s29, v72
    v_dot2c_f32_bf16 v12, s28, v73
    v_dot2c_f32_bf16 v13, s29, v73
    v_dot2c_f32_bf16 v14, s28, v74
    v_dot2c_f32_bf16 v15, s29, v74
    v_dot2c_f32_bf16 v16, s28, v75
    v_dot2c_f32_bf16 v17, s29, v75
    s_waitcnt vmcnt(6)
    v_dot2c_f32_bf16 v18, s28, v76
    v_dot2c_f32_bf16 v19, s29, v76
    v_dot2c_f32_bf16 v20, s28, v77
    v_dot2c_f32_bf16 v21, s29, v77
    v_dot2c_f32_bf16 v22, s28, v78
    v_dot2c_f32_bf16 v23, s29, v78
    v_dot2c_f32_bf16 v24, s28, v79
    v_dot2c_f32_bf16 v25, s29, v79
    v_mad_u32_u16 v66, v32, s30, v8 op_sel:[0,0,0,0]
    buffer_load_dwordx4 v[72:75], v66, s[20:23], 0 offen sc1
    v_mad_u32_u16 v67, v52, s30, v8 op_sel:[0,0,0,0]
    buffer_load_dwordx4 v[76:79], v67, s[20:23], 0 offen sc1
    s_waitcnt vmcnt(7)
    v_dot2c_f32_bf16 v10, s28, v80
    v_dot2c_f32_bf16 v11, s29, v80
    v_dot2c_f32_bf16 v12, s28, v81
    v_dot2c_f32_bf16 v13, s29, v81
    v_dot2c_f32_bf16 v14, s28, v82
    v_dot2c_f32_bf16 v15, s29, v82
    v_dot2c_f32_bf16 v16, s28, v83
    v_dot2c_f32_bf16 v17, s29, v83
    s_waitcnt vmcnt(6)
    v_dot2c_f32_bf16 v18, s28, v84
    v_dot2c_f32_bf16 v19, s29, v84
    v_dot2c_f32_bf16 v20, s28, v85
    v_dot2c_f32_bf16 v21, s29, v85
    v_dot2c_f32_bf16 v22, s28, v86
    v_dot2c_f32_bf16 v23, s29, v86
    v_dot2c_f32_bf16 v24, s28, v87
    v_dot2c_f32_bf16 v25, s29, v87
    v_mad_u32_u16 v66, v32, s30, v8 op_sel:[1,0,0,0]
    buffer_load_dwordx4 v[80:83], v66, s[20:23], 0 offen sc1
    v_mad_u32_u16 v67, v52, s30, v8 op_sel:[1,0,0,0]
    buffer_load_dwordx4 v[84:87], v67, s[20:23], 0 offen sc1
    s_waitcnt vmcnt(7)
    v_dot2c_f32_bf16 v10, s28, v88
    v_dot2c_f32_bf16 v11, s29, v88
    v_dot2c_f32_bf16 v12, s28, v89
    v_dot2c_f32_bf16 v13, s29, v89
    v_dot2c_f32_bf16 v14, s28, v90
    v_dot2c_f32_bf16 v15, s29, v90
    v_dot2c_f32_bf16 v16, s28, v91
    v_dot2c_f32_bf16 v17, s29, v91
    s_waitcnt vmcnt(6)
    v_dot2c_f32_bf16 v18, s28, v92
    v_dot2c_f32_bf16 v19, s29, v92
    v_dot2c_f32_bf16 v20, s28, v93
    v_dot2c_f32_bf16 v21, s29, v93
    v_dot2c_f32_bf16 v22, s28, v94
    v_dot2c_f32_bf16 v23, s29, v94
    v_dot2c_f32_bf16 v24, s28, v95
    v_dot2c_f32_bf16 v25, s29, v95
    s_setprio 0
    v_mad_u32_u16 v66, v33, s30, v8 op_sel:[0,0,0,0]
    buffer_load_dwordx4 v[88:91], v66, s[20:23], 0 offen sc1
    v_mad_u32_u16 v67, v53, s30, v8 op_sel:[0,0,0,0]
    buffer_load_dwordx4 v[92:95], v67, s[20:23], 0 offen sc1
    s_waitcnt vmcnt(7)
    v_dot2c_f32_bf16 v10, s28, v96
    v_dot2c_f32_bf16 v11, s29, v96
    v_dot2c_f32_bf16 v12, s28, v97
    v_dot2c_f32_bf16 v13, s29, v97
    v_dot2c_f32_bf16 v14, s28, v98
    v_dot2c_f32_bf16 v15, s29, v98
    v_dot2c_f32_bf16 v16, s28, v99
    v_dot2c_f32_bf16 v17, s29, v99
    s_waitcnt vmcnt(6)
    v_dot2c_f32_bf16 v18, s28, v100
    v_dot2c_f32_bf16 v19, s29, v100
    v_dot2c_f32_bf16 v20, s28, v101
    v_dot2c_f32_bf16 v21, s29, v101
    v_dot2c_f32_bf16 v22, s28, v102
    v_dot2c_f32_bf16 v23, s29, v102
    v_dot2c_f32_bf16 v24, s28, v103
    v_dot2c_f32_bf16 v25, s29, v103
    v_mad_u32_u16 v66, v33, s30, v8 op_sel:[1,0,0,0]
    buffer_load_dwordx4 v[96:99], v66, s[20:23], 0 offen sc1
    v_mad_u32_u16 v67, v53, s30, v8 op_sel:[1,0,0,0]
    buffer_load_dwordx4 v[100:103], v67, s[20:23], 0 offen sc1
    s_waitcnt vmcnt(7)
    v_dot2c_f32_bf16 v10, s28, v72
    v_dot2c_f32_bf16 v11, s29, v72
    v_dot2c_f32_bf16 v12, s28, v73
    v_dot2c_f32_bf16 v13, s29, v73
    v_dot2c_f32_bf16 v14, s28, v74
    v_dot2c_f32_bf16 v15, s29, v74
    v_dot2c_f32_bf16 v16, s28, v75
    v_dot2c_f32_bf16 v17, s29, v75
    s_waitcnt vmcnt(6)
    v_dot2c_f32_bf16 v18, s28, v76
    v_dot2c_f32_bf16 v19, s29, v76
    v_dot2c_f32_bf16 v20, s28, v77
    v_dot2c_f32_bf16 v21, s29, v77
    v_dot2c_f32_bf16 v22, s28, v78
    v_dot2c_f32_bf16 v23, s29, v78
    v_dot2c_f32_bf16 v24, s28, v79
    v_dot2c_f32_bf16 v25, s29, v79
    v_mad_u32_u16 v66, v34, s30, v8 op_sel:[0,0,0,0]
    buffer_load_dwordx4 v[72:75], v66, s[20:23], 0 offen sc1
    v_mad_u32_u16 v67, v54, s30, v8 op_sel:[0,0,0,0]
    buffer_load_dwordx4 v[76:79], v67, s[20:23], 0 offen sc1
    s_waitcnt vmcnt(7)
    v_dot2c_f32_bf16 v10, s28, v80
    v_dot2c_f32_bf16 v11, s29, v80
    v_dot2c_f32_bf16 v12, s28, v81
    v_dot2c_f32_bf16 v13, s29, v81
    v_dot2c_f32_bf16 v14, s28, v82
    v_dot2c_f32_bf16 v15, s29, v82
    v_dot2c_f32_bf16 v16, s28, v83
    v_dot2c_f32_bf16 v17, s29, v83
    s_waitcnt vmcnt(6)
    v_dot2c_f32_bf16 v18, s28, v84
    v_dot2c_f32_bf16 v19, s29, v84
    v_dot2c_f32_bf16 v20, s28, v85
    v_dot2c_f32_bf16 v21, s29, v85
    v_dot2c_f32_bf16 v22, s28, v86
    v_dot2c_f32_bf16 v23, s29, v86
    v_dot2c_f32_bf16 v24, s28, v87
    v_dot2c_f32_bf16 v25, s29, v87
    v_mad_u32_u16 v66, v34, s30, v8 op_sel:[1,0,0,0]
    buffer_load_dwordx4 v[80:83], v66, s[20:23], 0 offen sc1
    v_mad_u32_u16 v67, v54, s30, v8 op_sel:[1,0,0,0]
    buffer_load_dwordx4 v[84:87], v67, s[20:23], 0 offen sc1
    s_waitcnt vmcnt(7)
    v_dot2c_f32_bf16 v10, s28, v88
    v_dot2c_f32_bf16 v11, s29, v88
    v_dot2c_f32_bf16 v12, s28, v89
    v_dot2c_f32_bf16 v13, s29, v89
    v_dot2c_f32_bf16 v14, s28, v90
    v_dot2c_f32_bf16 v15, s29, v90
    v_dot2c_f32_bf16 v16, s28, v91
    v_dot2c_f32_bf16 v17, s29, v91
    s_waitcnt vmcnt(6)
    v_dot2c_f32_bf16 v18, s28, v92
    v_dot2c_f32_bf16 v19, s29, v92
    v_dot2c_f32_bf16 v20, s28, v93
    v_dot2c_f32_bf16 v21, s29, v93
    v_dot2c_f32_bf16 v22, s28, v94
    v_dot2c_f32_bf16 v23, s29, v94
    v_dot2c_f32_bf16 v24, s28, v95
    v_dot2c_f32_bf16 v25, s29, v95
    s_waitcnt vmcnt(5)
    v_dot2c_f32_bf16 v10, s28, v96
    v_dot2c_f32_bf16 v11, s29, v96
    v_dot2c_f32_bf16 v12, s28, v97
    v_dot2c_f32_bf16 v13, s29, v97
    v_dot2c_f32_bf16 v14, s28, v98
    v_dot2c_f32_bf16 v15, s29, v98
    v_dot2c_f32_bf16 v16, s28, v99
    v_dot2c_f32_bf16 v17, s29, v99
    s_waitcnt vmcnt(4)
    v_dot2c_f32_bf16 v18, s28, v100
    v_dot2c_f32_bf16 v19, s29, v100
    v_dot2c_f32_bf16 v20, s28, v101
    v_dot2c_f32_bf16 v21, s29, v101
    v_dot2c_f32_bf16 v22, s28, v102
    v_dot2c_f32_bf16 v23, s29, v102
    v_dot2c_f32_bf16 v24, s28, v103
    v_dot2c_f32_bf16 v25, s29, v103
    s_waitcnt vmcnt(3)
    v_dot2c_f32_bf16 v10, s28, v72
    v_dot2c_f32_bf16 v11, s29, v72
    v_dot2c_f32_bf16 v12, s28, v73
    v_dot2c_f32_bf16 v13, s29, v73
    v_dot2c_f32_bf16 v14, s28, v74
    v_dot2c_f32_bf16 v15, s29, v74
    v_dot2c_f32_bf16 v16, s28, v75
    v_dot2c_f32_bf16 v17, s29, v75
    s_waitcnt vmcnt(2)
    v_dot2c_f32_bf16 v18, s28, v76
    v_dot2c_f32_bf16 v19, s29, v76
    v_dot2c_f32_bf16 v20, s28, v77
    v_dot2c_f32_bf16 v21, s29, v77
    v_dot2c_f32_bf16 v22, s28, v78
    v_dot2c_f32_bf16 v23, s29, v78
    v_dot2c_f32_bf16 v24, s28, v79
    v_dot2c_f32_bf16 v25, s29, v79
    s_waitcnt vmcnt(1)
    v_dot2c_f32_bf16 v10, s28, v80
    v_dot2c_f32_bf16 v11, s29, v80
    v_dot2c_f32_bf16 v12, s28, v81
    v_dot2c_f32_bf16 v13, s29, v81
    v_dot2c_f32_bf16 v14, s28, v82
    v_dot2c_f32_bf16 v15, s29, v82
    v_dot2c_f32_bf16 v16, s28, v83
    v_dot2c_f32_bf16 v17, s29, v83
    s_waitcnt vmcnt(0)
    v_dot2c_f32_bf16 v18, s28, v84
    v_dot2c_f32_bf16 v19, s29, v84
    v_dot2c_f32_bf16 v20, s28, v85
    v_dot2c_f32_bf16 v21, s29, v85
    v_dot2c_f32_bf16 v22, s28, v86
    v_dot2c_f32_bf16 v23, s29, v86
    v_dot2c_f32_bf16 v24, s28, v87
    v_dot2c_f32_bf16 v25, s29, v87
    s_branch hop_fin
hop_w10:
    s_setprio 3
    v_mad_u32_u16 v66, v26, s30, v8 op_sel:[0,0,0,0]
    buffer_load_dwordx4 v[72:75], v66, s[20:23], 0 offen sc1
    v_mad_u32_u16 v67, v46, s30, v8 op_sel:[0,0,0,0]
    buffer_load_dwordx4 v[76:79], v67, s[20:23], 0 offen sc1
    v_mad_u32_u16 v66, v26, s30, v8 op_sel:[1,0,0,0]
    buffer_load_dwordx4 v[80:83], v66, s[20:23], 0 offen sc1
    v_mad_u32_u16 v67, v46, s30, v8 op_sel:[1,0,0,0]
    buffer_load_dwordx4 v[84:87], v67, s[20:23], 0 offen sc1
    v_mad_u32_u16 v66, v27, s30, v8 op_sel:[0,0,0,0]
    buffer_load_dwordx4 v[88:91], v66, s[20:23], 0 offen sc1
    v_mad_u32_u16 v67, v47, s30, v8 op_sel:[0,0,0,0]
    buffer_load_dwordx4 v[92:95], v67, s[20:23], 0 offen sc1
    v_mad_u32_u16 v66, v27, s30, v8 op_sel:[1,0,0,0]
    buffer_load_dwordx4 v[96:99], v66, s[20:23], 0 offen sc1
    v_mad_u32_u16 v67, v47, s30, v8 op_sel:[1,0,0,0]
    buffer_load_dwordx4 v[100:103], v67, s[20:23], 0 offen sc1
    s_waitcnt vmcnt(7)
    v_dot2c_f32_bf16 v10, s28, v72
    v_dot2c_f32_bf16 v11, s29, v72
    v_dot2c_f32_bf16 v12, s28, v73
    v_dot2c_f32_bf16 v13, s29, v73
    v_dot2c_f32_bf16 v14, s28, v74
    v_dot2c_f32_bf16 v15, s29, v74
    v_dot2c_f32_bf16 v16, s28, v75
    v_dot2c_f32_bf16 v17, s29, v75
    s_waitcnt vmcnt(6)
    v_dot2c_f32_bf16 v18, s28, v76
    v_dot2c_f32_bf16 v19, s29, v76
    v_dot2c_f32_bf16 v20, s28, v77
    v_dot2c_f32_bf16 v21, s29, v77
    v_dot2c_f32_bf16 v22, s28, v78
    v_dot2c_f32_bf16 v23, s29, v78
    v_dot2c_f32_bf16 v24, s28, v79
    v_dot2c_f32_bf16 v25, s29, v79
    v_mad_u32_u16 v66, v28, s30, v8 op_sel:[0,0,0,0]
    buffer_load_dwordx4 v[72:75], v66, s[20:23], 0 offen sc1
    v_mad_u32_u16 v67, v48, s30, v8 op_sel:[0,0,0,0]
    buffer_load_dwordx4 v[76:79], v67, s[20:23], 0 offen sc1
    s_waitcnt vmcnt(7)
    v_dot2c_f32_bf16 v10, s28, v80
    v_dot2c_f32_bf16 v11, s29, v80
    v_dot2c_f32_bf16 v12, s28, v81
    v_dot2c_f32_bf16 v13, s29, v81
    v_dot2c_f32_bf16 v14, s28, v82
    v_dot2c_f32_bf16 v15, s29, v82
    v_dot2c_f32_bf16 v16, s28, v83
    v_dot2c_f32_bf16 v17, s29, v83
    s_waitcnt vmcnt(6)
    v_dot2c_f32_bf16 v18, s28, v84
    v_dot2c_f32_bf16 v19, s29, v84
    v_dot2c_f32_bf16 v20, s28, v85
    v_dot2c_f32_bf16 v21, s29, v85
    v_dot2c_f32_bf16 v22, s28, v86
    v_dot2c_f32_bf16 v23, s29, v86
    v_dot2c_f32_bf16 v24, s28, v87
    v_dot2c_f32_bf16 v25, s29, v87
    s_setprio 2
    v_mad_u32_u16 v66, v28, s30, v8 op_sel:[1,0,0,0]
    buffer_load_dwordx4 v[80:83], v66, s[20:23], 0 offen sc1
    v_mad_u32_u16 v67, v48, s30, v8 op_sel:[1,0,0,0]
    buffer_load_dwordx4 v[84:87], v67, s[20:23], 0 offen sc1
    s_waitcnt vmcnt(7)
    v_dot2c_f32_bf16 v10, s28, v88
    v_dot2c_f32_bf16 v11, s29, v88
    v_dot2c_f32_bf16 v12, s28, v89
    v_dot2c_f32_bf16 v13, s29, v89
    v_dot2c_f32_bf16 v14, s28, v90
    v_dot2c_f32_bf16 v15, s29, v90
    v_dot2c_f32_bf16 v16, s28, v91
    v_dot2c_f32_bf16 v17, s29, v91
    s_waitcnt vmcnt(6)
    v_dot2c_f32_bf16 v18, s28, v92
    v_dot2c_f32_bf16 v19, s29, v92
    v_dot2c_f32_bf16 v20, s28, v93
    v_dot2c_f32_bf16 v21, s29, v93
    v_dot2c_f32_bf16 v22, s28, v94
    v_dot2c_f32_bf16 v23, s29, v94
    v_dot2c_f32_bf16 v24, s28, v95
    v_dot2c_f32_bf16 v25, s29, v95
    v_mad_u32_u16 v66, v29, s30, v8 op_sel:[0,0,0,0]
    buffer_load_dwordx4 v[88:91], v66, s[20:23], 0 offen sc1
    v_mad_u32_u16 v67, v49, s30, v8 op_sel:[0,0,0,0]
    buffer_load_dwordx4 v[92:95], v67, s[20:23], 0 offen sc1
    s_waitcnt vmcnt(7)
    v_dot2c_f32_bf16 v10, s28, v96
    v_dot2c_f32_bf16 v11, s29, v96
    v_dot2c_f32_bf16 v12, s28, v97
    v_dot2c_f32_bf16 v13, s29, v97
    v_dot2c_f32_bf16 v14, s28, v98
    v_dot2c_f32_bf16 v15, s29, v98
    v_dot2c_f32_bf16 v16, s28, v99
    v_dot2c_f32_bf16 v17, s29, v99
    s_waitcnt vmcnt(6)
    v_dot2c_f32_bf16 v18, s28, v100
    v_dot2c_f32_bf16 v19, s29, v100
    v_dot2c_f32_bf16 v20, s28, v101
    v_dot2c_f32_bf16 v21, s29, v101
    v_dot2c_f32_bf16 v22, s28, v102
    v_dot2c_f32_bf16 v23, s29, v102
    v_dot2c_f32_bf16 v24, s28, v103
    v_dot2c_f32_bf16 v25, s29, v103
    v_mad_u32_u16 v66, v29, s30, v8 op_sel:[1,0,0,0]
    buffer_load_dwordx4 v[96:99], v66, s[20:23], 0 offen sc1
    v_mad_u32_u16 v67, v49, s30, v8 op_sel:[1,0,0,0]
    buffer_load_dwordx4 v[100:103], v67, s[20:23], 0 offen sc1
    s_waitcnt vmcnt(7)
    v_dot2c_f32_bf16 v10, s28, v72
    v_dot2c_f32_bf16 v11, s29, v72
    v_dot2c_f32_bf16 v12, s28, v73
    v_dot2c_f32_bf16 v13, s29, v73
    v_dot2c_f32_bf16 v14, s28, v74
    v_dot2c_f32_bf16 v15, s29, v74
    v_dot2c_f32_bf16 v16, s28, v75
    v_dot2c_f32_bf16 v17, s29, v75
    s_waitcnt vmcnt(6)
    v_dot2c_f32_bf16 v18, s28, v76
    v_dot2c_f32_bf16 v19, s29, v76
    v_dot2c_f32_bf16 v20, s28, v77
    v_dot2c_f32_bf16 v21, s29, v77
    v_dot2c_f32_bf16 v22, s28, v78
    v_dot2c_f32_bf16 v23, s29, v78
    v_dot2c_f32_bf16 v24, s28, v79
    v_dot2c_f32_bf16 v25, s29, v79
    v_mad_u32_u16 v66, v30, s30, v8 op_sel:[0,0,0,0]
    buffer_load_dwordx4 v[72:75], v66, s[20:23], 0 offen sc1
    v_mad_u32_u16 v67, v50, s30, v8 op_sel:[0,0,0,0]
    buffer_load_dwordx4 v[76:79], v67, s[20:23], 0 offen sc1
    s_waitcnt vmcnt(7)
    v_dot2c_f32_bf16 v10, s28, v80
    v_dot2c_f32_bf16 v11, s29, v80
    v_dot2c_f32_bf16 v12, s28, v81
    v_dot2c_f32_bf16 v13, s29, v81
    v_dot2c_f32_bf16 v14, s28, v82
    v_dot2c_f32_bf16 v15, s29, v82
    v_dot2c_f32_bf16 v16, s28, v83
    v_dot2c_f32_bf16 v17, s29, v83
    s_waitcnt vmcnt(6)
    v_dot2c_f32_bf16 v18, s28, v84
    v_dot2c_f32_bf16 v19, s29, v84
    v_dot2c_f32_bf16 v20, s28, v85
    v_dot2c_f32_bf16 v21, s29, v85
    v_dot2c_f32_bf16 v22, s28, v86
    v_dot2c_f32_bf16 v23, s29, v86
    v_dot2c_f32_bf16 v24, s28, v87
    v_dot2c_f32_bf16 v25, s29, v87
    v_mad_u32_u16 v66, v30, s30, v8 op_sel:[1,0,0,0]
    buffer_load_dwordx4 v[80:83], v66, s[20:23], 0 offen sc1
    v_mad_u32_u16 v67, v50, s30, v8 op_sel:[1,0,0,0]
    buffer_load_dwordx4 v[84:87], v67, s[20:23], 0 offen sc1
    s_waitcnt vmcnt(7)
    v_dot2c_f32_bf16 v10, s28, v88
    v_dot2c_f32_bf16 v11, s29, v88
    v_dot2c_f32_bf16 v12, s28, v89
    v_dot2c_f32_bf16 v13, s29, v89
    v_dot2c_f32_bf16 v14, s28, v90
    v_dot2c_f32_bf16 v15, s29, v90
    v_dot2c_f32_bf16 v16, s28, v91
    v_dot2c_f32_bf16 v17, s29, v91
    s_waitcnt vmcnt(6)
    v_dot2c_f32_bf16 v18, s28, v92
    v_dot2c_f32_bf16 v19, s29, v92
    v_dot2c_f32_bf16 v20, s28, v93
    v_dot2c_f32_bf16 v21, s29, v93
    v_dot2c_f32_bf16 v22, s28, v94
    v_dot2c_f32_bf16 v23, s29, v94
    v_dot2c_f32_bf16 v24, s28, v95
    v_dot2c_f32_bf16 v25, s29, v95
    s_setprio 1
    v_mad_u32_u16 v66, v31, s30, v8 op_sel:[0,0,0,0]
    buffer_load_dwordx4 v[88:91], v66, s[20:23], 0 offen sc1
    v_mad_u32_u16 v67, v51, s30, v8 op_sel:[0,0,0,0]
    buffer_load_dwordx4 v[92:95], v67, s[20:23], 0 offen sc1
    s_waitcnt vmcnt(7)
    v_dot2c_f32_bf16 v10, s28, v96
    v_dot2c_f32_bf16 v11, s29, v96
    v_dot2c_f32_bf16 v12, s28, v97
    v_dot2c_f32_bf16 v13, s29, v97
    v_dot2c_f32_bf16 v14, s28, v98
    v_dot2c_f32_bf16 v15, s29, v98
    v_dot2c_f32_bf16 v16, s28, v99
    v_dot2c_f32_bf16 v17, s29, v99
    s_waitcnt vmcnt(6)
    v_dot2c_f32_bf16 v18, s28, v100
    v_dot2c_f32_bf16 v19, s29, v100
    v_dot2c_f32_bf16 v20, s28, v101
    v_dot2c_f32_bf16 v21, s29, v101
    v_dot2c_f32_bf16 v22, s28, v102
    v_dot2c_f32_bf16 v23, s29, v102
    v_dot2c_f32_bf16 v24, s28, v103
    v_dot2c_f32_bf16 v25, s29, v103
    v_mad_u32_u16 v66, v31, s30, v8 op_sel:[1,0,0,0]
    buffer_load_dwordx4 v[96:99], v66, s[20:23], 0 offen sc1
    v_mad_u32_u16 v67, v51, s30, v8 op_sel:[1,0,0,0]
    buffer_load_dwordx4 v[100:103], v67, s[20:23], 0 offen sc1
    s_waitcnt vmcnt(7)
    v_dot2c_f32_bf16 v10, s28, v72
    v_dot2c_f32_bf16 v11, s29, v72
    v_dot2c_f32_bf16 v12, s28, v73
    v_dot2c_f32_bf16 v13, s29, v73
    v_dot2c_f32_bf16 v14, s28, v74
    v_dot2c_f32_bf16 v15, s29, v74
    v_dot2c_f32_bf16 v16, s28, v75
    v_dot2c_f32_bf16 v17, s29, v75
    s_waitcnt vmcnt(6)
    v_dot2c_f32_bf16 v18, s28, v76
    v_dot2c_f32_bf16 v19, s29, v76
    v_dot2c_f32_bf16 v20, s28, v77
    v_dot2c_f32_bf16 v21, s29, v77
    v_dot2c_f32_bf16 v22, s28, v78
    v_dot2c_f32_bf16 v23, s29, v78
    v_dot2c_f32_bf16 v24, s28, v79
    v_dot2c_f32_bf16 v25, s29, v79
    v_mad_u32_u16 v66, v32, s30, v8 op_sel:[0,0,0,0]
    buffer_load_dwordx4 v[72:75], v66, s[20:23], 0 offen sc1
    v_mad_u32_u16 v67, v52, s30, v8 op_sel:[0,0,0,0]
    buffer_load_dwordx4 v[76:79], v67, s[20:23], 0 offen sc1
    s_waitcnt vmcnt(7)
    v_dot2c_f32_bf16 v10, s28, v80
    v_dot2c_f32_bf16 v11, s29, v80
    v_dot2c_f32_bf16 v12, s28, v81
    v_dot2c_f32_bf16 v13, s29, v81
    v_dot2c_f32_bf16 v14, s28, v82
    v_dot2c_f32_bf16 v15, s29, v82
    v_dot2c_f32_bf16 v16, s28, v83
    v_dot2c_f32_bf16 v17, s29, v83
    s_waitcnt vmcnt(6)
    v_dot2c_f32_bf16 v18, s28, v84
    v_dot2c_f32_bf16 v19, s29, v84
    v_dot2c_f32_bf16 v20, s28, v85
    v_dot2c_f32_bf16 v21, s29, v85
    v_dot2c_f32_bf16 v22, s28, v86
    v_dot2c_f32_bf16 v23, s29, v86
    v_dot2c_f32_bf16 v24, s28, v87
    v_dot2c_f32_bf16 v25, s29, v87
    v_mad_u32_u16 v66, v32, s30, v8 op_sel:[1,0,0,0]
    buffer_load_dwordx4 v[80:83], v66, s[20:23], 0 offen sc1
    v_mad_u32_u16 v67, v52, s30, v8 op_sel:[1,0,0,0]
    buffer_load_dwordx4 v[84:87], v67, s[20:23], 0 offen sc1
    s_waitcnt vmcnt(7)
    v_dot2c_f32_bf16 v10, s28, v88
    v_dot2c_f32_bf16 v11, s29, v88
    v_dot2c_f32_bf16 v12, s28, v89
    v_dot2c_f32_bf16 v13, s29, v89
    v_dot2c_f32_bf16 v14, s28, v90
    v_dot2c_f32_bf16 v15, s29, v90
    v_dot2c_f32_bf16 v16, s28, v91
    v_dot2c_f32_bf16 v17, s29, v91
    s_waitcnt vmcnt(6)
    v_dot2c_f32_bf16 v18, s28, v92
    v_dot2c_f32_bf16 v19, s29, v92
    v_dot2c_f32_bf16 v20, s28, v93
    v_dot2c_f32_bf16 v21, s29, v93
    v_dot2c_f32_bf16 v22, s28, v94
    v_dot2c_f32_bf16 v23, s29, v94
    v_dot2c_f32_bf16 v24, s28, v95
    v_dot2c_f32_bf16 v25, s29, v95
    v_mad_u32_u16 v66, v33, s30, v8 op_sel:[0,0,0,0]
    buffer_load_dwordx4 v[88:91], v66, s[20:23], 0 offen sc1
    v_mad_u32_u16 v67, v53, s30, v8 op_sel:[0,0,0,0]
    buffer_load_dwordx4 v[92:95], v67, s[20:23], 0 offen sc1
    s_waitcnt vmcnt(7)
    v_dot2c_f32_bf16 v10, s28, v96
    v_dot2c_f32_bf16 v11, s29, v96
    v_dot2c_f32_bf16 v12, s28, v97
    v_dot2c_f32_bf16 v13, s29, v97
    v_dot2c_f32_bf16 v14, s28, v98
    v_dot2c_f32_bf16 v15, s29, v98
    v_dot2c_f32_bf16 v16, s28, v99
    v_dot2c_f32_bf16 v17, s29, v99
    s_waitcnt vmcnt(6)
    v_dot2c_f32_bf16 v18, s28, v100
    v_dot2c_f32_bf16 v19, s29, v100
    v_dot2c_f32_bf16 v20, s28, v101
    v_dot2c_f32_bf16 v21, s29, v101
    v_dot2c_f32_bf16 v22, s28, v102
    v_dot2c_f32_bf16 v23, s29, v102
    v_dot2c_f32_bf16 v24, s28, v103
    v_dot2c_f32_bf16 v25, s29, v103
    s_setprio 0
    v_mad_u32_u16 v66, v33, s30, v8 op_sel:[1,0,0,0]
    buffer_load_dwordx4 v[96:99], v66, s[20:23], 0 offen sc1
    v_mad_u32_u16 v67, v53, s30, v8 op_sel:[1,0,0,0]
    buffer_load_dwordx4 v[100:103], v67, s[20:23], 0 offen sc1
    s_waitcnt vmcnt(7)
    v_dot2c_f32_bf16 v10, s28, v72
    v_dot2c_f32_bf16 v11, s29, v72
    v_dot2c_f32_bf16 v12, s28, v73
    v_dot2c_f32_bf16 v13, s29, v73
    v_dot2c_f32_bf16 v14, s28, v74
    v_dot2c_f32_bf16 v15, s29, v74
    v_dot2c_f32_bf16 v16, s28, v75
    v_dot2c_f32_bf16 v17, s29, v75
    s_waitcnt vmcnt(6)
    v_dot2c_f32_bf16 v18, s28, v76
    v_dot2c_f32_bf16 v19, s29, v76
    v_dot2c_f32_bf16 v20, s28, v77
    v_dot2c_f32_bf16 v21, s29, v77
    v_dot2c_f32_bf16 v22, s28, v78
    v_dot2c_f32_bf16 v23, s29, v78
    v_dot2c_f32_bf16 v24, s28, v79
    v_dot2c_f32_bf16 v25, s29, v79
    v_mad_u32_u16 v66, v34, s30, v8 op_sel:[0,0,0,0]
    buffer_load_dwordx4 v[72:75], v66, s[20:23], 0 offen sc1
    v_mad_u32_u16 v67, v54, s30, v8 op_sel:[0,0,0,0]
    buffer_load_dwordx4 v[76:79], v67, s[20:23], 0 offen sc1
    s_waitcnt vmcnt(7)
    v_dot2c_f32_bf16 v10, s28, v80
    v_dot2c_f32_bf16 v11, s29, v80
    v_dot2c_f32_bf16 v12, s28, v81
    v_dot2c_f32_bf16 v13, s29, v81
    v_dot2c_f32_bf16 v14, s28, v82
    v_dot2c_f32_bf16 v15, s29, v82
    v_dot2c_f32_bf16 v16, s28, v83
    v_dot2c_f32_bf16 v17, s29, v83
    s_waitcnt vmcnt(6)
    v_dot2c_f32_bf16 v18, s28, v84
    v_dot2c_f32_bf16 v19, s29, v84
    v_dot2c_f32_bf16 v20, s28, v85
    v_dot2c_f32_bf16 v21, s29, v85
    v_dot2c_f32_bf16 v22, s28, v86
    v_dot2c_f32_bf16 v23, s29, v86
    v_dot2c_f32_bf16 v24, s28, v87
    v_dot2c_f32_bf16 v25, s29, v87
    v_mad_u32_u16 v66, v34, s30, v8 op_sel:[1,0,0,0]
    buffer_load_dwordx4 v[80:83], v66, s[20:23], 0 offen sc1
    v_mad_u32_u16 v67, v54, s30, v8 op_sel:[1,0,0,0]
    buffer_load_dwordx4 v[84:87], v67, s[20:23], 0 offen sc1
    s_waitcnt vmcnt(7)
    v_dot2c_f32_bf16 v10, s28, v88
    v_dot2c_f32_bf16 v11, s29, v88
    v_dot2c_f32_bf16 v12, s28, v89
    v_dot2c_f32_bf16 v13, s29, v89
    v_dot2c_f32_bf16 v14, s28, v90
    v_dot2c_f32_bf16 v15, s29, v90
    v_dot2c_f32_bf16 v16, s28, v91
    v_dot2c_f32_bf16 v17, s29, v91
    s_waitcnt vmcnt(6)
    v_dot2c_f32_bf16 v18, s28, v92
    v_dot2c_f32_bf16 v19, s29, v92
    v_dot2c_f32_bf16 v20, s28, v93
    v_dot2c_f32_bf16 v21, s29, v93
    v_dot2c_f32_bf16 v22, s28, v94
    v_dot2c_f32_bf16 v23, s29, v94
    v_dot2c_f32_bf16 v24, s28, v95
    v_dot2c_f32_bf16 v25, s29, v95
    v_mad_u32_u16 v66, v35, s30, v8 op_sel:[0,0,0,0]
    buffer_load_dwordx4 v[88:91], v66, s[20:23], 0 offen sc1
    v_mad_u32_u16 v67, v55, s30, v8 op_sel:[0,0,0,0]
    buffer_load_dwordx4 v[92:95], v67, s[20:23], 0 offen sc1
    s_waitcnt vmcnt(7)
    v_dot2c_f32_bf16 v10, s28, v96
    v_dot2c_f32_bf16 v11, s29, v96
    v_dot2c_f32_bf16 v12, s28, v97
    v_dot2c_f32_bf16 v13, s29, v97
    v_dot2c_f32_bf16 v14, s28, v98
    v_dot2c_f32_bf16 v15, s29, v98
    v_dot2c_f32_bf16 v16, s28, v99
    v_dot2c_f32_bf16 v17, s29, v99
    s_waitcnt vmcnt(6)
    v_dot2c_f32_bf16 v18, s28, v100
    v_dot2c_f32_bf16 v19, s29, v100
    v_dot2c_f32_bf16 v20, s28, v101
    v_dot2c_f32_bf16 v21, s29, v101
    v_dot2c_f32_bf16 v22, s28, v102
    v_dot2c_f32_bf16 v23, s29, v102
    v_dot2c_f32_bf16 v24, s28, v103
    v_dot2c_f32_bf16 v25, s29, v103
    v_mad_u32_u16 v66, v35, s30, v8 op_sel:[1,0,0,0]
    buffer_load_dwordx4 v[96:99], v66, s[20:23], 0 offen sc1
    v_mad_u32_u16 v67, v55, s30, v8 op_sel:[1,0,0,0]
    buffer_load_dwordx4 v[100:103], v67, s[20:23], 0 offen sc1
    s_waitcnt vmcnt(7)
    v_dot2c_f32_bf16 v10, s28, v72
    v_dot2c_f32_bf16 v11, s29, v72
    v_dot2c_f32_bf16 v12, s28, v73
    v_dot2c_f32_bf16 v13, s29, v73
    v_dot2c_f32_bf16 v14, s28, v74
    v_dot2c_f32_bf16 v15, s29, v74
    v_dot2c_f32_bf16 v16, s28, v75
    v_dot2c_f32_bf16 v17, s29, v75
    s_waitcnt vmcnt(6)
    v_dot2c_f32_bf16 v18, s28, v76
    v_dot2c_f32_bf16 v19, s29, v76
    v_dot2c_f32_bf16 v20, s28, v77
    v_dot2c_f32_bf16 v21, s29, v77
    v_dot2c_f32_bf16 v22, s28, v78
    v_dot2c_f32_bf16 v23, s29, v78
    v_dot2c_f32_bf16 v24, s28, v79
    v_dot2c_f32_bf16 v25, s29, v79
    s_waitcnt vmcnt(5)
    v_dot2c_f32_bf16 v10, s28, v80
    v_dot2c_f32_bf16 v11, s29, v80
    v_dot2c_f32_bf16 v12, s28, v81
    v_dot2c_f32_bf16 v13, s29, v81
    v_dot2c_f32_bf16 v14, s28, v82
    v_dot2c_f32_bf16 v15, s29, v82
    v_dot2c_f32_bf16 v16, s28, v83
    v_dot2c_f32_bf16 v17, s29, v83
    s_waitcnt vmcnt(4)
    v_dot2c_f32_bf16 v18, s28, v84
    v_dot2c_f32_bf16 v19, s29, v84
    v_dot2c_f32_bf16 v20, s28, v85
    v_dot2c_f32_bf16 v21, s29, v85
    v_dot2c_f32_bf16 v22, s28, v86
    v_dot2c_f32_bf16 v23, s29, v86
    v_dot2c_f32_bf16 v24, s28, v87
    v_dot2c_f32_bf16 v25, s29, v87
    s_waitcnt vmcnt(3)
    v_dot2c_f32_bf16 v10, s28, v88
    v_dot2c_f32_bf16 v11, s29, v88
    v_dot2c_f32_bf16 v12, s28, v89
    v_dot2c_f32_bf16 v13, s29, v89
    v_dot2c_f32_bf16 v14, s28, v90
    v_dot2c_f32_bf16 v15, s29, v90
    v_dot2c_f32_bf16 v16, s28, v91
    v_dot2c_f32_bf16 v17, s29, v91
    s_waitcnt vmcnt(2)
    v_dot2c_f32_bf16 v18, s28, v92
    v_dot2c_f32_bf16 v19, s29, v92
    v_dot2c_f32_bf16 v20, s28, v93
    v_dot2c_f32_bf16 v21, s29, v93
    v_dot2c_f32_bf16 v22, s28, v94
    v_dot2c_f32_bf16 v23, s29, v94
    v_dot2c_f32_bf16 v24, s28, v95
    v_dot2c_f32_bf16 v25, s29, v95
    s_waitcnt vmcnt(1)
    v_dot2c_f32_bf16 v10, s28, v96
    v_dot2c_f32_bf16 v11, s29, v96
    v_dot2c_f32_bf16 v12, s28, v97
    v_dot2c_f32_bf16 v13, s29, v97
    v_dot2c_f32_bf16 v14, s28, v98
    v_dot2c_f32_bf16 v15, s29, v98
    v_dot2c_f32_bf16 v16, s28, v99
    v_dot2c_f32_bf16 v17, s29, v99
    s_waitcnt vmcnt(0)
    v_dot2c_f32_bf16 v18, s28, v100
    v_dot2c_f32_bf16 v19, s29, v100
    v_dot2c_f32_bf16 v20, s28, v101
    v_dot2c_f32_bf16 v21, s29, v101
    v_dot2c_f32_bf16 v22, s28, v102
    v_dot2c_f32_bf16 v23, s29, v102
    v_dot2c_f32_bf16 v24, s28, v103
    v_dot2c_f32_bf16 v25, s29, v103
    s_branch hop_fin
hop_w11:
    s_setprio 3
    v_mad_u32_u16 v66, v26, s30, v8 op_sel:[0,0,0,0]
    buffer_load_dwordx4 v[72:75], v66, s[20:23], 0 offen sc1
    v_mad_u32_u16 v67, v46, s30, v8 op_sel:[0,0,0,0]
    buffer_load_dwordx4 v[76:79], v67, s[20:23], 0 offen sc1
    v_mad_u32_u16 v66, v26, s30, v8 op_sel:[1,0,0,0]
    buffer_load_dwordx4 v[80:83], v66, s[20:23], 0 offen sc1
    v_mad_u32_u16 v67, v46, s30, v8 op_sel:[1,0,0,0]
    buffer_load_dwordx4 v[84:87], v67, s[20:23], 0 offen sc1
    v_mad_u32_u16 v66, v27, s30, v8 op_sel:[0,0,0,0]
    buffer_load_dwordx4 v[88:91], v66, s[20:23], 0 offen sc1
    v_mad_u32_u16 v67, v47, s30, v8 op_sel:[0,0,0,0]
    buffer_load_dwordx4 v[92:95], v67, s[20:23], 0 offen sc1
    v_mad_u32_u16 v66, v27, s30, v8 op_sel:[1,0,0,0]
    buffer_load_dwordx4 v[96:99], v66, s[20:23], 0 offen sc1
    v_mad_u32_u16 v67, v47, s30, v8 op_sel:[1,0,0,0]
    buffer_load_dwordx4 v[100:103], v67, s[20:23], 0 offen sc1
    s_waitcnt vmcnt(7)
    v_dot2c_f32_bf16 v10, s28, v72
    v_dot2c_f32_bf16 v11, s29, v72
    v_dot2c_f32_bf16 v12, s28, v73
    v_dot2c_f32_bf16 v13, s29, v73
    v_dot2c_f32_bf16 v14, s28, v74
    v_dot2c_f32_bf16 v15, s29, v74
    v_dot2c_f32_bf16 v16, s28, v75
    v_dot2c_f32_bf16 v17, s29, v75
    s_waitcnt vmcnt(6)
    v_dot2c_f32_bf16 v18, s28, v76
    v_dot2c_f32_bf16 v19, s29, v76
    v_dot2c_f32_bf16 v20, s28, v77
    v_dot2c_f32_bf16 v21, s29, v77
    v_dot2c_f32_bf16 v22, s28, v78
    v_dot2c_f32_bf16 v23, s29, v78
    v_dot2c_f32_bf16 v24, s28, v79
    v_dot2c_f32_bf16 v25, s29, v79
    v_mad_u32_u16 v66, v28, s30, v8 op_sel:[0,0,0,0]
    buffer_load_dwordx4 v[72:75], v66, s[20:23], 0 offen sc1
    v_mad_u32_u16 v67, v48, s30, v8 op_sel:[0,0,0,0]
    buffer_load_dwordx4 v[76:79], v67, s[20:23], 0 offen sc1
    s_waitcnt vmcnt(7)
    v_dot2c_f32_bf16 v10, s28, v80
    v_dot2c_f32_bf16 v11, s29, v80
    v_dot2c_f32_bf16 v12, s28, v81
    v_dot2c_f32_bf16 v13, s29, v81
    v_dot2c_f32_bf16 v14, s28, v82
    v_dot2c_f32_bf16 v15, s29, v82
    v_dot2c_f32_bf16 v16, s28, v83
    v_dot2c_f32_bf16 v17, s29, v83
    s_waitcnt vmcnt(6)
    v_dot2c_f32_bf16 v18, s28, v84
    v_dot2c_f32_bf16 v19, s29, v84
    v_dot2c_f32_bf16 v20, s28, v85
    v_dot2c_f32_bf16 v21, s29, v85
    v_dot2c_f32_bf16 v22, s28, v86
    v_dot2c_f32_bf16 v23, s29, v86
    v_dot2c_f32_bf16 v24, s28, v87
    v_dot2c_f32_bf16 v25, s29, v87
    v_mad_u32_u16 v66, v28, s30, v8 op_sel:[1,0,0,0]
    buffer_load_dwordx4 v[80:83], v66, s[20:23], 0 offen sc1
    v_mad_u32_u16 v67, v48, s30, v8 op_sel:[1,0,0,0]
    buffer_load_dwordx4 v[84:87], v67, s[20:23], 0 offen sc1
    s_waitcnt vmcnt(7)
    v_dot2c_f32_bf16 v10, s28, v88
    v_dot2c_f32_bf16 v11, s29, v88
    v_dot2c_f32_bf16 v12, s28, v89
    v_dot2c_f32_bf16 v13, s29, v89
    v_dot2c_f32_bf16 v14, s28, v90
    v_dot2c_f32_bf16 v15, s29, v90
    v_dot2c_f32_bf16 v16, s28, v91
    v_dot2c_f32_bf16 v17, s29, v91
    s_waitcnt vmcnt(6)
    v_dot2c_f32_bf16 v18, s28, v92
    v_dot2c_f32_bf16 v19, s29, v92
    v_dot2c_f32_bf16 v20, s28, v93
    v_dot2c_f32_bf16 v21, s29, v93
    v_dot2c_f32_bf16 v22, s28, v94
    v_dot2c_f32_bf16 v23, s29, v94
    v_dot2c_f32_bf16 v24, s28, v95
    v_dot2c_f32_bf16 v25, s29, v95
    s_setprio 2
    v_mad_u32_u16 v66, v29, s30, v8 op_sel:[0,0,0,0]
    buffer_load_dwordx4 v[88:91], v66, s[20:23], 0 offen sc1
    v_mad_u32_u16 v67, v49, s30, v8 op_sel:[0,0,0,0]
    buffer_load_dwordx4 v[92:95], v67, s[20:23], 0 offen sc1
    s_waitcnt vmcnt(7)
    v_dot2c_f32_bf16 v10, s28, v96
    v_dot2c_f32_bf16 v11, s29, v96
    v_dot2c_f32_bf16 v12, s28, v97
    v_dot2c_f32_bf16 v13, s29, v97
    v_dot2c_f32_bf16 v14, s28, v98
    v_dot2c_f32_bf16 v15, s29, v98
    v_dot2c_f32_bf16 v16, s28, v99
    v_dot2c_f32_bf16 v17, s29, v99
    s_waitcnt vmcnt(6)
    v_dot2c_f32_bf16 v18, s28, v100
    v_dot2c_f32_bf16 v19, s29, v100
    v_dot2c_f32_bf16 v20, s28, v101
    v_dot2c_f32_bf16 v21, s29, v101
    v_dot2c_f32_bf16 v22, s28, v102
    v_dot2c_f32_bf16 v23, s29, v102
    v_dot2c_f32_bf16 v24, s28, v103
    v_dot2c_f32_bf16 v25, s29, v103
    v_mad_u32_u16 v66, v29, s30, v8 op_sel:[1,0,0,0]
    buffer_load_dwordx4 v[96:99], v66, s[20:23], 0 offen sc1
    v_mad_u32_u16 v67, v49, s30, v8 op_sel:[1,0,0,0]
    buffer_load_dwordx4 v[100:103], v67, s[20:23], 0 offen sc1
    s_waitcnt vmcnt(7)
    v_dot2c_f32_bf16 v10, s28, v72
    v_dot2c_f32_bf16 v11, s29, v72
    v_dot2c_f32_bf16 v12, s28, v73
    v_dot2c_f32_bf16 v13, s29, v73
    v_dot2c_f32_bf16 v14, s28, v74
    v_dot2c_f32_bf16 v15, s29, v74
    v_dot2c_f32_bf16 v16, s28, v75
    v_dot2c_f32_bf16 v17, s29, v75
    s_waitcnt vmcnt(6)
    v_dot2c_f32_bf16 v18, s28, v76
    v_dot2c_f32_bf16 v19, s29, v76
    v_dot2c_f32_bf16 v20, s28, v77
    v_dot2c_f32_bf16 v21, s29, v77
    v_dot2c_f32_bf16 v22, s28, v78
    v_dot2c_f32_bf16 v23, s29, v78
    v_dot2c_f32_bf16 v24, s28, v79
    v_dot2c_f32_bf16 v25, s29, v79
    v_mad_u32_u16 v66, v30, s30, v8 op_sel:[0,0,0,0]
    buffer_load_dwordx4 v[72:75], v66, s[20:23], 0 offen sc1
    v_mad_u32_u16 v67, v50, s30, v8 op_sel:[0,0,0,0]
    buffer_load_dwordx4 v[76:79], v67, s[20:23], 0 offen sc1
    s_waitcnt vmcnt(7)
    v_dot2c_f32_bf16 v10, s28, v80
    v_dot2c_f32_bf16 v11, s29, v80
    v_dot2c_f32_bf16 v12, s28, v81
    v_dot2c_f32_bf16 v13, s29, v81
    v_dot2c_f32_bf16 v14, s28, v82
    v_dot2c_f32_bf16 v15, s29, v82
    v_dot2c_f32_bf16 v16, s28, v83
    v_dot2c_f32_bf16 v17, s29, v83
    s_waitcnt vmcnt(6)
    v_dot2c_f32_bf16 v18, s28, v84
    v_dot2c_f32_bf16 v19, s29, v84
    v_dot2c_f32_bf16 v20, s28, v85
    v_dot2c_f32_bf16 v21, s29, v85
    v_dot2c_f32_bf16 v22, s28, v86
    v_dot2c_f32_bf16 v23, s29, v86
    v_dot2c_f32_bf16 v24, s28, v87
    v_dot2c_f32_bf16 v25, s29, v87
    v_mad_u32_u16 v66, v30, s30, v8 op_sel:[1,0,0,0]
    buffer_load_dwordx4 v[80:83], v66, s[20:23], 0 offen sc1
    v_mad_u32_u16 v67, v50, s30, v8 op_sel:[1,0,0,0]
    buffer_load_dwordx4 v[84:87], v67, s[20:23], 0 offen sc1
    s_waitcnt vmcnt(7)
    v_dot2c_f32_bf16 v10, s28, v88
    v_dot2c_f32_bf16 v11, s29, v88
    v_dot2c_f32_bf16 v12, s28, v89
    v_dot2c_f32_bf16 v13, s29, v89
    v_dot2c_f32_bf16 v14, s28, v90
    v_dot2c_f32_bf16 v15, s29, v90
    v_dot2c_f32_bf16 v16, s28, v91
    v_dot2c_f32_bf16 v17, s29, v91
    s_waitcnt vmcnt(6)
    v_dot2c_f32_bf16 v18, s28, v92
    v_dot2c_f32_bf16 v19, s29, v92
    v_dot2c_f32_bf16 v20, s28, v93
    v_dot2c_f32_bf16 v21, s29, v93
    v_dot2c_f32_bf16 v22, s28, v94
    v_dot2c_f32_bf16 v23, s29, v94
    v_dot2c_f32_bf16 v24, s28, v95
    v_dot2c_f32_bf16 v25, s29, v95
    v_mad_u32_u16 v66, v31, s30, v8 op_sel:[0,0,0,0]
    buffer_load_dwordx4 v[88:91], v66, s[20:23], 0 offen sc1
    v_mad_u32_u16 v67, v51, s30, v8 op_sel:[0,0,0,0]
    buffer_load_dwordx4 v[92:95], v67, s[20:23], 0 offen sc1
    s_waitcnt vmcnt(7)
    v_dot2c_f32_bf16 v10, s28, v96
    v_dot2c_f32_bf16 v11, s29, v96
    v_dot2c_f32_bf16 v12, s28, v97
    v_dot2c_f32_bf16 v13, s29, v97
    v_dot2c_f32_bf16 v14, s28, v98
    v_dot2c_f32_bf16 v15, s29, v98
    v_dot2c_f32_bf16 v16, s28, v99
    v_dot2c_f32_bf16 v17, s29, v99
    s_waitcnt vmcnt(6)
    v_dot2c_f32_bf16 v18, s28, v100
    v_dot2c_f32_bf16 v19, s29, v100
    v_dot2c_f32_bf16 v20, s28, v101
    v_dot2c_f32_bf16 v21, s29, v101
    v_dot2c_f32_bf16 v22, s28, v102
    v_dot2c_f32_bf16 v23, s29, v102
    v_dot2c_f32_bf16 v24, s28, v103
    v_dot2c_f32_bf16 v25, s29, v103
    s_setprio 1
    v_mad_u32_u16 v66, v31, s30, v8 op_sel:[1,0,0,0]
    buffer_load_dwordx4 v[96:99], v66, s[20:23], 0 offen sc1
    v_mad_u32_u16 v67, v51, s30, v8 op_sel:[1,0,0,0]
    buffer_load_dwordx4 v[100:103], v67, s[20:23], 0 offen sc1
    s_waitcnt vmcnt(7)
    v_dot2c_f32_bf16 v10, s28, v72
    v_dot2c_f32_bf16 v11, s29, v72
    v_dot2c_f32_bf16 v12, s28, v73
    v_dot2c_f32_bf16 v13, s29, v73
    v_dot2c_f32_bf16 v14, s28, v74
    v_dot2c_f32_bf16 v15, s29, v74
    v_dot2c_f32_bf16 v16, s28, v75
    v_dot2c_f32_bf16 v17, s29, v75
    s_waitcnt vmcnt(6)
    v_dot2c_f32_bf16 v18, s28, v76
    v_dot2c_f32_bf16 v19, s29, v76
    v_dot2c_f32_bf16 v20, s28, v77
    v_dot2c_f32_bf16 v21, s29, v77
    v_dot2c_f32_bf16 v22, s28, v78
    v_dot2c_f32_bf16 v23, s29, v78
    v_dot2c_f32_bf16 v24, s28, v79
    v_dot2c_f32_bf16 v25, s29, v79
    v_mad_u32_u16 v66, v32, s30, v8 op_sel:[0,0,0,0]
    buffer_load_dwordx4 v[72:75], v66, s[20:23], 0 offen sc1
    v_mad_u32_u16 v67, v52, s30, v8 op_sel:[0,0,0,0]
    buffer_load_dwordx4 v[76:79], v67, s[20:23], 0 offen sc1
    s_waitcnt vmcnt(7)
    v_dot2c_f32_bf16 v10, s28, v80
    v_dot2c_f32_bf16 v11, s29, v80
    v_dot2c_f32_bf16 v12, s28, v81
    v_dot2c_f32_bf16 v13, s29, v81
    v_dot2c_f32_bf16 v14, s28, v82
    v_dot2c_f32_bf16 v15, s29, v82
    v_dot2c_f32_bf16 v16, s28, v83
    v_dot2c_f32_bf16 v17, s29, v83
    s_waitcnt vmcnt(6)
    v_dot2c_f32_bf16 v18, s28, v84
    v_dot2c_f32_bf16 v19, s29, v84
    v_dot2c_f32_bf16 v20, s28, v85
    v_dot2c_f32_bf16 v21, s29, v85
    v_dot2c_f32_bf16 v22, s28, v86
    v_dot2c_f32_bf16 v23, s29, v86
    v_dot2c_f32_bf16 v24, s28, v87
    v_dot2c_f32_bf16 v25, s29, v87
    v_mad_u32_u16 v66, v32, s30, v8 op_sel:[1,0,0,0]
    buffer_load_dwordx4 v[80:83], v66, s[20:23], 0 offen sc1
    v_mad_u32_u16 v67, v52, s30, v8 op_sel:[1,0,0,0]
    buffer_load_dwordx4 v[84:87], v67, s[20:23], 0 offen sc1
    s_waitcnt vmcnt(7)
    v_dot2c_f32_bf16 v10, s28, v88
    v_dot2c_f32_bf16 v11, s29, v88
    v_dot2c_f32_bf16 v12, s28, v89
    v_dot2c_f32_bf16 v13, s29, v89
    v_dot2c_f32_bf16 v14, s28, v90
    v_dot2c_f32_bf16 v15, s29, v90
    v_dot2c_f32_bf16 v16, s28, v91
    v_dot2c_f32_bf16 v17, s29, v91
    s_waitcnt vmcnt(6)
    v_dot2c_f32_bf16 v18, s28, v92
    v_dot2c_f32_bf16 v19, s29, v92
    v_dot2c_f32_bf16 v20, s28, v93
    v_dot2c_f32_bf16 v21, s29, v93
    v_dot2c_f32_bf16 v22, s28, v94
    v_dot2c_f32_bf16 v23, s29, v94
    v_dot2c_f32_bf16 v24, s28, v95
    v_dot2c_f32_bf16 v25, s29, v95
    v_mad_u32_u16 v66, v33, s30, v8 op_sel:[0,0,0,0]
    buffer_load_dwordx4 v[88:91], v66, s[20:23], 0 offen sc1
    v_mad_u32_u16 v67, v53, s30, v8 op_sel:[0,0,0,0]
    buffer_load_dwordx4 v[92:95], v67, s[20:23], 0 offen sc1
    s_waitcnt vmcnt(7)
    v_dot2c_f32_bf16 v10, s28, v96
    v_dot2c_f32_bf16 v11, s29, v96
    v_dot2c_f32_bf16 v12, s28, v97
    v_dot2c_f32_bf16 v13, s29, v97
    v_dot2c_f32_bf16 v14, s28, v98
    v_dot2c_f32_bf16 v15, s29, v98
    v_dot2c_f32_bf16 v16, s28, v99
    v_dot2c_f32_bf16 v17, s29, v99
    s_waitcnt vmcnt(6)
    v_dot2c_f32_bf16 v18, s28, v100
    v_dot2c_f32_bf16 v19, s29, v100
    v_dot2c_f32_bf16 v20, s28, v101
    v_dot2c_f32_bf16 v21, s29, v101
    v_dot2c_f32_bf16 v22, s28, v102
    v_dot2c_f32_bf16 v23, s29, v102
    v_dot2c_f32_bf16 v24, s28, v103
    v_dot2c_f32_bf16 v25, s29, v103
    v_mad_u32_u16 v66, v33, s30, v8 op_sel:[1,0,0,0]
    buffer_load_dwordx4 v[96:99], v66, s[20:23], 0 offen sc1
    v_mad_u32_u16 v67, v53, s30, v8 op_sel:[1,0,0,0]
    buffer_load_dwordx4 v[100:103], v67, s[20:23], 0 offen sc1
    s_waitcnt vmcnt(7)
    v_dot2c_f32_bf16 v10, s28, v72
    v_dot2c_f32_bf16 v11, s29, v72
    v_dot2c_f32_bf16 v12, s28, v73
    v_dot2c_f32_bf16 v13, s29, v73
    v_dot2c_f32_bf16 v14, s28, v74
    v_dot2c_f32_bf16 v15, s29, v74
    v_dot2c_f32_bf16 v16, s28, v75
    v_dot2c_f32_bf16 v17, s29, v75
    s_waitcnt vmcnt(6)
    v_dot2c_f32_bf16 v18, s28, v76
    v_dot2c_f32_bf16 v19, s29, v76
    v_dot2c_f32_bf16 v20, s28, v77
    v_dot2c_f32_bf16 v21, s29, v77
    v_dot2c_f32_bf16 v22, s28, v78
    v_dot2c_f32_bf16 v23, s29, v78
    v_dot2c_f32_bf16 v24, s28, v79
    v_dot2c_f32_bf16 v25, s29, v79
    v_mad_u32_u16 v66, v34, s30, v8 op_sel:[0,0,0,0]
    buffer_load_dwordx4 v[72:75], v66, s[20:23], 0 offen sc1
    v_mad_u32_u16 v67, v54, s30, v8 op_sel:[0,0,0,0]
    buffer_load_dwordx4 v[76:79], v67, s[20:23], 0 offen sc1
    s_waitcnt vmcnt(7)
    v_dot2c_f32_bf16 v10, s28, v80
    v_dot2c_f32_bf16 v11, s29, v80
    v_dot2c_f32_bf16 v12, s28, v81
    v_dot2c_f32_bf16 v13, s29, v81
    v_dot2c_f32_bf16 v14, s28, v82
    v_dot2c_f32_bf16 v15, s29, v82
    v_dot2c_f32_bf16 v16, s28, v83
    v_dot2c_f32_bf16 v17, s29, v83
    s_waitcnt vmcnt(6)
    v_dot2c_f32_bf16 v18, s28, v84
    v_dot2c_f32_bf16 v19, s29, v84
    v_dot2c_f32_bf16 v20, s28, v85
    v_dot2c_f32_bf16 v21, s29, v85
    v_dot2c_f32_bf16 v22, s28, v86
    v_dot2c_f32_bf16 v23, s29, v86
    v_dot2c_f32_bf16 v24, s28, v87
    v_dot2c_f32_bf16 v25, s29, v87
    s_setprio 0
    v_mad_u32_u16 v66, v34, s30, v8 op_sel:[1,0,0,0]
    buffer_load_dwordx4 v[80:83], v66, s[20:23], 0 offen sc1
    v_mad_u32_u16 v67, v54, s30, v8 op_sel:[1,0,0,0]
    buffer_load_dwordx4 v[84:87], v67, s[20:23], 0 offen sc1
    s_waitcnt vmcnt(7)
    v_dot2c_f32_bf16 v10, s28, v88
    v_dot2c_f32_bf16 v11, s29, v88
    v_dot2c_f32_bf16 v12, s28, v89
    v_dot2c_f32_bf16 v13, s29, v89
    v_dot2c_f32_bf16 v14, s28, v90
    v_dot2c_f32_bf16 v15, s29, v90
    v_dot2c_f32_bf16 v16, s28, v91
    v_dot2c_f32_bf16 v17, s29, v91
    s_waitcnt vmcnt(6)
    v_dot2c_f32_bf16 v18, s28, v92
    v_dot2c_f32_bf16 v19, s29, v92
    v_dot2c_f32_bf16 v20, s28, v93
    v_dot2c_f32_bf16 v21, s29, v93
    v_dot2c_f32_bf16 v22, s28, v94
    v_dot2c_f32_bf16 v23, s29, v94
    v_dot2c_f32_bf16 v24, s28, v95
    v_dot2c_f32_bf16 v25, s29, v95
    v_mad_u32_u16 v66, v35, s30, v8 op_sel:[0,0,0,0]
    buffer_load_dwordx4 v[88:91], v66, s[20:23], 0 offen sc1
    v_mad_u32_u16 v67, v55, s30, v8 op_sel:[0,0,0,0]
    buffer_load_dwordx4 v[92:95], v67, s[20:23], 0 offen sc1
    s_waitcnt vmcnt(7)
    v_dot2c_f32_bf16 v10, s28, v96
    v_dot2c_f32_bf16 v11, s29, v96
    v_dot2c_f32_bf16 v12, s28, v97
    v_dot2c_f32_bf16 v13, s29, v97
    v_dot2c_f32_bf16 v14, s28, v98
    v_dot2c_f32_bf16 v15, s29, v98
    v_dot2c_f32_bf16 v16, s28, v99
    v_dot2c_f32_bf16 v17, s29, v99
    s_waitcnt vmcnt(6)
    v_dot2c_f32_bf16 v18, s28, v100
    v_dot2c_f32_bf16 v19, s29, v100
    v_dot2c_f32_bf16 v20, s28, v101
    v_dot2c_f32_bf16 v21, s29, v101
    v_dot2c_f32_bf16 v22, s28, v102
    v_dot2c_f32_bf16 v23, s29, v102
    v_dot2c_f32_bf16 v24, s28, v103
    v_dot2c_f32_bf16 v25, s29, v103
    v_mad_u32_u16 v66, v35, s30, v8 op_sel:[1,0,0,0]
    buffer_load_dwordx4 v[96:99], v66, s[20:23], 0 offen sc1
    v_mad_u32_u16 v67, v55, s30, v8 op_sel:[1,0,0,0]
    buffer_load_dwordx4 v[100:103], v67, s[20:23], 0 offen sc1
    s_waitcnt vmcnt(7)
    v_dot2c_f32_bf16 v10, s28, v72
    v_dot2c_f32_bf16 v11, s29, v72
    v_dot2c_f32_bf16 v12, s28, v73
    v_dot2c_f32_bf16 v13, s29, v73
    v_dot2c_f32_bf16 v14, s28, v74
    v_dot2c_f32_bf16 v15, s29, v74
    v_dot2c_f32_bf16 v16, s28, v75
    v_dot2c_f32_bf16 v17, s29, v75
    s_waitcnt vmcnt(6)
    v_dot2c_f32_bf16 v18, s28, v76
    v_dot2c_f32_bf16 v19, s29, v76
    v_dot2c_f32_bf16 v20, s28, v77
    v_dot2c_f32_bf16 v21, s29, v77
    v_dot2c_f32_bf16 v22, s28, v78
    v_dot2c_f32_bf16 v23, s29, v78
    v_dot2c_f32_bf16 v24, s28, v79
    v_dot2c_f32_bf16 v25, s29, v79
    v_mad_u32_u16 v66, v36, s30, v8 op_sel:[0,0,0,0]
    buffer_load_dwordx4 v[72:75], v66, s[20:23], 0 offen sc1
    v_mad_u32_u16 v67, v56, s30, v8 op_sel:[0,0,0,0]
    buffer_load_dwordx4 v[76:79], v67, s[20:23], 0 offen sc1
    s_waitcnt vmcnt(7)
    v_dot2c_f32_bf16 v10, s28, v80
    v_dot2c_f32_bf16 v11, s29, v80
    v_dot2c_f32_bf16 v12, s28, v81
    v_dot2c_f32_bf16 v13, s29, v81
    v_dot2c_f32_bf16 v14, s28, v82
    v_dot2c_f32_bf16 v15, s29, v82
    v_dot2c_f32_bf16 v16, s28, v83
    v_dot2c_f32_bf16 v17, s29, v83
    s_waitcnt vmcnt(6)
    v_dot2c_f32_bf16 v18, s28, v84
    v_dot2c_f32_bf16 v19, s29, v84
    v_dot2c_f32_bf16 v20, s28, v85
    v_dot2c_f32_bf16 v21, s29, v85
    v_dot2c_f32_bf16 v22, s28, v86
    v_dot2c_f32_bf16 v23, s29, v86
    v_dot2c_f32_bf16 v24, s28, v87
    v_dot2c_f32_bf16 v25, s29, v87
    v_mad_u32_u16 v66, v36, s30, v8 op_sel:[1,0,0,0]
    buffer_load_dwordx4 v[80:83], v66, s[20:23], 0 offen sc1
    v_mad_u32_u16 v67, v56, s30, v8 op_sel:[1,0,0,0]
    buffer_load_dwordx4 v[84:87], v67, s[20:23], 0 offen sc1
    s_waitcnt vmcnt(7)
    v_dot2c_f32_bf16 v10, s28, v88
    v_dot2c_f32_bf16 v11, s29, v88
    v_dot2c_f32_bf16 v12, s28, v89
    v_dot2c_f32_bf16 v13, s29, v89
    v_dot2c_f32_bf16 v14, s28, v90
    v_dot2c_f32_bf16 v15, s29, v90
    v_dot2c_f32_bf16 v16, s28, v91
    v_dot2c_f32_bf16 v17, s29, v91
    s_waitcnt vmcnt(6)
    v_dot2c_f32_bf16 v18, s28, v92
    v_dot2c_f32_bf16 v19, s29, v92
    v_dot2c_f32_bf16 v20, s28, v93
    v_dot2c_f32_bf16 v21, s29, v93
    v_dot2c_f32_bf16 v22, s28, v94
    v_dot2c_f32_bf16 v23, s29, v94
    v_dot2c_f32_bf16 v24, s28, v95
    v_dot2c_f32_bf16 v25, s29, v95
    s_waitcnt vmcnt(5)
    v_dot2c_f32_bf16 v10, s28, v96
    v_dot2c_f32_bf16 v11, s29, v96
    v_dot2c_f32_bf16 v12, s28, v97
    v_dot2c_f32_bf16 v13, s29, v97
    v_dot2c_f32_bf16 v14, s28, v98
    v_dot2c_f32_bf16 v15, s29, v98
    v_dot2c_f32_bf16 v16, s28, v99
    v_dot2c_f32_bf16 v17, s29, v99
    s_waitcnt vmcnt(4)
    v_dot2c_f32_bf16 v18, s28, v100
    v_dot2c_f32_bf16 v19, s29, v100
    v_dot2c_f32_bf16 v20, s28, v101
    v_dot2c_f32_bf16 v21, s29, v101
    v_dot2c_f32_bf16 v22, s28, v102
    v_dot2c_f32_bf16 v23, s29, v102
    v_dot2c_f32_bf16 v24, s28, v103
    v_dot2c_f32_bf16 v25, s29, v103
    s_waitcnt vmcnt(3)
    v_dot2c_f32_bf16 v10, s28, v72
    v_dot2c_f32_bf16 v11, s29, v72
    v_dot2c_f32_bf16 v12, s28, v73
    v_dot2c_f32_bf16 v13, s29, v73
    v_dot2c_f32_bf16 v14, s28, v74
    v_dot2c_f32_bf16 v15, s29, v74
    v_dot2c_f32_bf16 v16, s28, v75
    v_dot2c_f32_bf16 v17, s29, v75
    s_waitcnt vmcnt(2)
    v_dot2c_f32_bf16 v18, s28, v76
    v_dot2c_f32_bf16 v19, s29, v76
    v_dot2c_f32_bf16 v20, s28, v77
    v_dot2c_f32_bf16 v21, s29, v77
    v_dot2c_f32_bf16 v22, s28, v78
    v_dot2c_f32_bf16 v23, s29, v78
    v_dot2c_f32_bf16 v24, s28, v79
    v_dot2c_f32_bf16 v25, s29, v79
    s_waitcnt vmcnt(1)
    v_dot2c_f32_bf16 v10, s28, v80
    v_dot2c_f32_bf16 v11, s29, v80
    v_dot2c_f32_bf16 v12, s28, v81
    v_dot2c_f32_bf16 v13, s29, v81
    v_dot2c_f32_bf16 v14, s28, v82
    v_dot2c_f32_bf16 v15, s29, v82
    v_dot2c_f32_bf16 v16, s28, v83
    v_dot2c_f32_bf16 v17, s29, v83
    s_waitcnt vmcnt(0)
    v_dot2c_f32_bf16 v18, s28, v84
    v_dot2c_f32_bf16 v19, s29, v84
    v_dot2c_f32_bf16 v20, s28, v85
    v_dot2c_f32_bf16 v21, s29, v85
    v_dot2c_f32_bf16 v22, s28, v86
    v_dot2c_f32_bf16 v23, s29, v86
    v_dot2c_f32_bf16 v24, s28, v87
    v_dot2c_f32_bf16 v25, s29, v87
    s_branch hop_fin
hop_w12:
    s_setprio 3
    v_mad_u32_u16 v66, v26, s30, v8 op_sel:[0,0,0,0]
    buffer_load_dwordx4 v[72:75], v66, s[20:23], 0 offen sc1
    v_mad_u32_u16 v67, v46, s30, v8 op_sel:[0,0,0,0]
    buffer_load_dwordx4 v[76:79], v67, s[20:23], 0 offen sc1
    v_mad_u32_u16 v66, v26, s30, v8 op_sel:[1,0,0,0]
    buffer_load_dwordx4 v[80:83], v66, s[20:23], 0 offen sc1
    v_mad_u32_u16 v67, v46, s30, v8 op_sel:[1,0,0,0]
    buffer_load_dwordx4 v[84:87], v67, s[20:23], 0 offen sc1
    v_mad_u32_u16 v66, v27, s30, v8 op_sel:[0,0,0,0]
    buffer_load_dwordx4 v[88:91], v66, s[20:23], 0 offen sc1
    v_mad_u32_u16 v67, v47, s30, v8 op_sel:[0,0,0,0]
    buffer_load_dwordx4 v[92:95], v67, s[20:23], 0 offen sc1
    v_mad_u32_u16 v66, v27, s30, v8 op_sel:[1,0,0,0]
    buffer_load_dwordx4 v[96:99], v66, s[20:23], 0 offen sc1
    v_mad_u32_u16 v67, v47, s30, v8 op_sel:[1,0,0,0]
    buffer_load_dwordx4 v[100:103], v67, s[20:23], 0 offen sc1
    s_waitcnt vmcnt(7)
    v_dot2c_f32_bf16 v10, s28, v72
    v_dot2c_f32_bf16 v11, s29, v72
    v_dot2c_f32_bf16 v12, s28, v73
    v_dot2c_f32_bf16 v13, s29, v73
    v_dot2c_f32_bf16 v14, s28, v74
    v_dot2c_f32_bf16 v15, s29, v74
    v_dot2c_f32_bf16 v16, s28, v75
    v_dot2c_f32_bf16 v17, s29, v75
    s_waitcnt vmcnt(6)
    v_dot2c_f32_bf16 v18, s28, v76
    v_dot2c_f32_bf16 v19, s29, v76
    v_dot2c_f32_bf16 v20, s28, v77
    v_dot2c_f32_bf16 v21, s29, v77
    v_dot2c_f32_bf16 v22, s28, v78
    v_dot2c_f32_bf16 v23, s29, v78
    v_dot2c_f32_bf16 v24, s28, v79
    v_dot2c_f32_bf16 v25, s29, v79
    v_mad_u32_u16 v66, v28, s30, v8 op_sel:[0,0,0,0]
    buffer_load_dwordx4 v[72:75], v66, s[20:23], 0 offen sc1
    v_mad_u32_u16 v67, v48, s30, v8 op_sel:[0,0,0,0]
    buffer_load_dwordx4 v[76:79], v67, s[20:23], 0 offen sc1
    s_waitcnt vmcnt(7)
    v_dot2c_f32_bf16 v10, s28, v80
    v_dot2c_f32_bf16 v11, s29, v80
    v_dot2c_f32_bf16 v12, s28, v81
    v_dot2c_f32_bf16 v13, s29, v81
    v_dot2c_f32_bf16 v14, s28, v82
    v_dot2c_f32_bf16 v15, s29, v82
    v_dot2c_f32_bf16 v16, s28, v83
    v_dot2c_f32_bf16 v17, s29, v83
    s_waitcnt vmcnt(6)
    v_dot2c_f32_bf16 v18, s28, v84
    v_dot2c_f32_bf16 v19, s29, v84
    v_dot2c_f32_bf16 v20, s28, v85
    v_dot2c_f32_bf16 v21, s29, v85
    v_dot2c_f32_bf16 v22, s28, v86
    v_dot2c_f32_bf16 v23, s29, v86
    v_dot2c_f32_bf16 v24, s28, v87
    v_dot2c_f32_bf16 v25, s29, v87
    v_mad_u32_u16 v66, v28, s30, v8 op_sel:[1,0,0,0]
    buffer_load_dwordx4 v[80:83], v66, s[20:23], 0 offen sc1
    v_mad_u32_u16 v67, v48, s30, v8 op_sel:[1,0,0,0]
    buffer_load_dwordx4 v[84:87], v67, s[20:23], 0 offen sc1
    s_waitcnt vmcnt(7)
    v_dot2c_f32_bf16 v10, s28, v88
    v_dot2c_f32_bf16 v11, s29, v88
    v_dot2c_f32_bf16 v12, s28, v89
    v_dot2c_f32_bf16 v13, s29, v89
    v_dot2c_f32_bf16 v14, s28, v90
    v_dot2c_f32_bf16 v15, s29, v90
    v_dot2c_f32_bf16 v16, s28, v91
    v_dot2c_f32_bf16 v17, s29, v91
    s_waitcnt vmcnt(6)
    v_dot2c_f32_bf16 v18, s28, v92
    v_dot2c_f32_bf16 v19, s29, v92
    v_dot2c_f32_bf16 v20, s28, v93
    v_dot2c_f32_bf16 v21, s29, v93
    v_dot2c_f32_bf16 v22, s28, v94
    v_dot2c_f32_bf16 v23, s29, v94
    v_dot2c_f32_bf16 v24, s28, v95
    v_dot2c_f32_bf16 v25, s29, v95
    s_setprio 2
    v_mad_u32_u16 v66, v29, s30, v8 op_sel:[0,0,0,0]
    buffer_load_dwordx4 v[88:91], v66, s[20:23], 0 offen sc1
    v_mad_u32_u16 v67, v49, s30, v8 op_sel:[0,0,0,0]
    buffer_load_dwordx4 v[92:95], v67, s[20:23], 0 offen sc1
    s_waitcnt vmcnt(7)
    v_dot2c_f32_bf16 v10, s28, v96
    v_dot2c_f32_bf16 v11, s29, v96
    v_dot2c_f32_bf16 v12, s28, v97
    v_dot2c_f32_bf16 v13, s29, v97
    v_dot2c_f32_bf16 v14, s28, v98
    v_dot2c_f32_bf16 v15, s29, v98
    v_dot2c_f32_bf16 v16, s28, v99
    v_dot2c_f32_bf16 v17, s29, v99
    s_waitcnt vmcnt(6)
    v_dot2c_f32_bf16 v18, s28, v100
    v_dot2c_f32_bf16 v19, s29, v100
    v_dot2c_f32_bf16 v20, s28, v101
    v_dot2c_f32_bf16 v21, s29, v101
    v_dot2c_f32_bf16 v22, s28, v102
    v_dot2c_f32_bf16 v23, s29, v102
    v_dot2c_f32_bf16 v24, s28, v103
    v_dot2c_f32_bf16 v25, s29, v103
    v_mad_u32_u16 v66, v29, s30, v8 op_sel:[1,0,0,0]
    buffer_load_dwordx4 v[96:99], v66, s[20:23], 0 offen sc1
    v_mad_u32_u16 v67, v49, s30, v8 op_sel:[1,0,0,0]
    buffer_load_dwordx4 v[100:103], v67, s[20:23], 0 offen sc1
    s_waitcnt vmcnt(7)
    v_dot2c_f32_bf16 v10, s28, v72
    v_dot2c_f32_bf16 v11, s29, v72
    v_dot2c_f32_bf16 v12, s28, v73
    v_dot2c_f32_bf16 v13, s29, v73
    v_dot2c_f32_bf16 v14, s28, v74
    v_dot2c_f32_bf16 v15, s29, v74
    v_dot2c_f32_bf16 v16, s28, v75
    v_dot2c_f32_bf16 v17, s29, v75
    s_waitcnt vmcnt(6)
    v_dot2c_f32_bf16 v18, s28, v76
    v_dot2c_f32_bf16 v19, s29, v76
    v_dot2c_f32_bf16 v20, s28, v77
    v_dot2c_f32_bf16 v21, s29, v77
    v_dot2c_f32_bf16 v22, s28, v78
    v_dot2c_f32_bf16 v23, s29, v78
    v_dot2c_f32_bf16 v24, s28, v79
    v_dot2c_f32_bf16 v25, s29, v79
    v_mad_u32_u16 v66, v30, s30, v8 op_sel:[0,0,0,0]
    buffer_load_dwordx4 v[72:75], v66, s[20:23], 0 offen sc1
    v_mad_u32_u16 v67, v50, s30, v8 op_sel:[0,0,0,0]
    buffer_load_dwordx4 v[76:79], v67, s[20:23], 0 offen sc1
    s_waitcnt vmcnt(7)
    v_dot2c_f32_bf16 v10, s28, v80
    v_dot2c_f32_bf16 v11, s29, v80
    v_dot2c_f32_bf16 v12, s28, v81
    v_dot2c_f32_bf16 v13, s29, v81
    v_dot2c_f32_bf16 v14, s28, v82
    v_dot2c_f32_bf16 v15, s29, v82
    v_dot2c_f32_bf16 v16, s28, v83
    v_dot2c_f32_bf16 v17, s29, v83
    s_waitcnt vmcnt(6)
    v_dot2c_f32_bf16 v18, s28, v84
    v_dot2c_f32_bf16 v19, s29, v84
    v_dot2c_f32_bf16 v20, s28, v85
    v_dot2c_f32_bf16 v21, s29, v85
    v_dot2c_f32_bf16 v22, s28, v86
    v_dot2c_f32_bf16 v23, s29, v86
    v_dot2c_f32_bf16 v24, s28, v87
    v_dot2c_f32_bf16 v25, s29, v87
    v_mad_u32_u16 v66, v30, s30, v8 op_sel:[1,0,0,0]
    buffer_load_dwordx4 v[80:83], v66, s[20:23], 0 offen sc1
    v_mad_u32_u16 v67, v50, s30, v8 op_sel:[1,0,0,0]
    buffer_load_dwordx4 v[84:87], v67, s[20:23], 0 offen sc1
    s_waitcnt vmcnt(7)
    v_dot2c_f32_bf16 v10, s28, v88
    v_dot2c_f32_bf16 v11, s29, v88
    v_dot2c_f32_bf16 v12, s28, v89
    v_dot2c_f32_bf16 v13, s29, v89
    v_dot2c_f32_bf16 v14, s28, v90
    v_dot2c_f32_bf16 v15, s29, v90
    v_dot2c_f32_bf16 v16, s28, v91
    v_dot2c_f32_bf16 v17, s29, v91
    s_waitcnt vmcnt(6)
    v_dot2c_f32_bf16 v18, s28, v92
    v_dot2c_f32_bf16 v19, s29, v92
    v_dot2c_f32_bf16 v20, s28, v93
    v_dot2c_f32_bf16 v21, s29, v93
    v_dot2c_f32_bf16 v22, s28, v94
    v_dot2c_f32_bf16 v23, s29, v94
    v_dot2c_f32_bf16 v24, s28, v95
    v_dot2c_f32_bf16 v25, s29, v95
    v_mad_u32_u16 v66, v31, s30, v8 op_sel:[0,0,0,0]
    buffer_load_dwordx4 v[88:91], v66, s[20:23], 0 offen sc1
    v_mad_u32_u16 v67, v51, s30, v8 op_sel:[0,0,0,0]
    buffer_load_dwordx4 v[92:95], v67, s[20:23], 0 offen sc1
    s_waitcnt vmcnt(7)
    v_dot2c_f32_bf16 v10, s28, v96
    v_dot2c_f32_bf16 v11, s29, v96
    v_dot2c_f32_bf16 v12, s28, v97
    v_dot2c_f32_bf16 v13, s29, v97
    v_dot2c_f32_bf16 v14, s28, v98
    v_dot2c_f32_bf16 v15, s29, v98
    v_dot2c_f32_bf16 v16, s28, v99
    v_dot2c_f32_bf16 v17, s29, v99
    s_waitcnt vmcnt(6)
    v_dot2c_f32_bf16 v18, s28, v100
    v_dot2c_f32_bf16 v19, s29, v100
    v_dot2c_f32_bf16 v20, s28, v101
    v_dot2c_f32_bf16 v21, s29, v101
    v_dot2c_f32_bf16 v22, s28, v102
    v_dot2c_f32_bf16 v23, s29, v102
    v_dot2c_f32_bf16 v24, s28, v103
    v_dot2c_f32_bf16 v25, s29, v103
    v_mad_u32_u16 v66, v31, s30, v8 op_sel:[1,0,0,0]
    buffer_load_dwordx4 v[96:99], v66, s[20:23], 0 offen sc1
    v_mad_u32_u16 v67, v51, s30, v8 op_sel:[1,0,0,0]
    buffer_load_dwordx4 v[100:103], v67, s[20:23], 0 offen sc1
    s_waitcnt vmcnt(7)
    v_dot2c_f32_bf16 v10, s28, v72
    v_dot2c_f32_bf16 v11, s29, v72
    v_dot2c_f32_bf16 v12, s28, v73
    v_dot2c_f32_bf16 v13, s29, v73
    v_dot2c_f32_bf16 v14, s28, v74
    v_dot2c_f32_bf16 v15, s29, v74
    v_dot2c_f32_bf16 v16, s28, v75
    v_dot2c_f32_bf16 v17, s29, v75
    s_waitcnt vmcnt(6)
    v_dot2c_f32_bf16 v18, s28, v76
    v_dot2c_f32_bf16 v19, s29, v76
    v_dot2c_f32_bf16 v20, s28, v77
    v_dot2c_f32_bf16 v21, s29, v77
    v_dot2c_f32_bf16 v22, s28, v78
    v_dot2c_f32_bf16 v23, s29, v78
    v_dot2c_f32_bf16 v24, s28, v79
    v_dot2c_f32_bf16 v25, s29, v79
    s_setprio 1
    v_mad_u32_u16 v66, v32, s30, v8 op_sel:[0,0,0,0]
    buffer_load_dwordx4 v[72:75], v66, s[20:23], 0 offen sc1
    v_mad_u32_u16 v67, v52, s30, v8 op_sel:[0,0,0,0]
    buffer_load_dwordx4 v[76:79], v67, s[20:23], 0 offen sc1
    s_waitcnt vmcnt(7)
    v_dot2c_f32_bf16 v10, s28, v80
    v_dot2c_f32_bf16 v11, s29, v80
    v_dot2c_f32_bf16 v12, s28, v81
    v_dot2c_f32_bf16 v13, s29, v81
    v_dot2c_f32_bf16 v14, s28, v82
    v_dot2c_f32_bf16 v15, s29, v82
    v_dot2c_f32_bf16 v16, s28, v83
    v_dot2c_f32_bf16 v17, s29, v83
    s_waitcnt vmcnt(6)
    v_dot2c_f32_bf16 v18, s28, v84
    v_dot2c_f32_bf16 v19, s29, v84
    v_dot2c_f32_bf16 v20, s28, v85
    v_dot2c_f32_bf16 v21, s29, v85
    v_dot2c_f32_bf16 v22, s28, v86
    v_dot2c_f32_bf16 v23, s29, v86
    v_dot2c_f32_bf16 v24, s28, v87
    v_dot2c_f32_bf16 v25, s29, v87
    v_mad_u32_u16 v66, v32, s30, v8 op_sel:[1,0,0,0]
    buffer_load_dwordx4 v[80:83], v66, s[20:23], 0 offen sc1
    v_mad_u32_u16 v67, v52, s30, v8 op_sel:[1,0,0,0]
    buffer_load_dwordx4 v[84:87], v67, s[20:23], 0 offen sc1
    s_waitcnt vmcnt(7)
    v_dot2c_f32_bf16 v10, s28, v88
    v_dot2c_f32_bf16 v11, s29, v88
    v_dot2c_f32_bf16 v12, s28, v89
    v_dot2c_f32_bf16 v13, s29, v89
    v_dot2c_f32_bf16 v14, s28, v90
    v_dot2c_f32_bf16 v15, s29, v90
    v_dot2c_f32_bf16 v16, s28, v91
    v_dot2c_f32_bf16 v17, s29, v91
    s_waitcnt vmcnt(6)
    v_dot2c_f32_bf16 v18, s28, v92
    v_dot2c_f32_bf16 v19, s29, v92
    v_dot2c_f32_bf16 v20, s28, v93
    v_dot2c_f32_bf16 v21, s29, v93
    v_dot2c_f32_bf16 v22, s28, v94
    v_dot2c_f32_bf16 v23, s29, v94
    v_dot2c_f32_bf16 v24, s28, v95
    v_dot2c_f32_bf16 v25, s29, v95
    v_mad_u32_u16 v66, v33, s30, v8 op_sel:[0,0,0,0]
    buffer_load_dwordx4 v[88:91], v66, s[20:23], 0 offen sc1
    v_mad_u32_u16 v67, v53, s30, v8 op_sel:[0,0,0,0]
    buffer_load_dwordx4 v[92:95], v67, s[20:23], 0 offen sc1
    s_waitcnt vmcnt(7)
    v_dot2c_f32_bf16 v10, s28, v96
    v_dot2c_f32_bf16 v11, s29, v96
    v_dot2c_f32_bf16 v12, s28, v97
    v_dot2c_f32_bf16 v13, s29, v97
    v_dot2c_f32_bf16 v14, s28, v98
    v_dot2c_f32_bf16 v15, s29, v98
    v_dot2c_f32_bf16 v16, s28, v99
    v_dot2c_f32_bf16 v17, s29, v99
    s_waitcnt vmcnt(6)
    v_dot2c_f32_bf16 v18, s28, v100
    v_dot2c_f32_bf16 v19, s29, v100
    v_dot2c_f32_bf16 v20, s28, v101
    v_dot2c_f32_bf16 v21, s29, v101
    v_dot2c_f32_bf16 v22, s28, v102
    v_dot2c_f32_bf16 v23, s29, v102
    v_dot2c_f32_bf16 v24, s28, v103
    v_dot2c_f32_bf16 v25, s29, v103
    v_mad_u32_u16 v66, v33, s30, v8 op_sel:[1,0,0,0]
    buffer_load_dwordx4 v[96:99], v66, s[20:23], 0 offen sc1
    v_mad_u32_u16 v67, v53, s30, v8 op_sel:[1,0,0,0]
    buffer_load_dwordx4 v[100:103], v67, s[20:23], 0 offen sc1
    s_waitcnt vmcnt(7)
    v_dot2c_f32_bf16 v10, s28, v72
    v_dot2c_f32_bf16 v11, s29, v72
    v_dot2c_f32_bf16 v12, s28, v73
    v_dot2c_f32_bf16 v13, s29, v73
    v_dot2c_f32_bf16 v14, s28, v74
    v_dot2c_f32_bf16 v15, s29, v74
    v_dot2c_f32_bf16 v16, s28, v75
    v_dot2c_f32_bf16 v17, s29, v75
    s_waitcnt vmcnt(6)
    v_dot2c_f32_bf16 v18, s28, v76
    v_dot2c_f32_bf16 v19, s29, v76
    v_dot2c_f32_bf16 v20, s28, v77
    v_dot2c_f32_bf16 v21, s29, v77
    v_dot2c_f32_bf16 v22, s28, v78
    v_dot2c_f32_bf16 v23, s29, v78
    v_dot2c_f32_bf16 v24, s28, v79
    v_dot2c_f32_bf16 v25, s29, v79
    v_mad_u32_u16 v66, v34, s30, v8 op_sel:[0,0,0,0]
    buffer_load_dwordx4 v[72:75], v66, s[20:23], 0 offen sc1
    v_mad_u32_u16 v67, v54, s30, v8 op_sel:[0,0,0,0]
    buffer_load_dwordx4 v[76:79], v67, s[20:23], 0 offen sc1
    s_waitcnt vmcnt(7)
    v_dot2c_f32_bf16 v10, s28, v80
    v_dot2c_f32_bf16 v11, s29, v80
    v_dot2c_f32_bf16 v12, s28, v81
    v_dot2c_f32_bf16 v13, s29, v81
    v_dot2c_f32_bf16 v14, s28, v82
    v_dot2c_f32_bf16 v15, s29, v82
    v_dot2c_f32_bf16 v16, s28, v83
    v_dot2c_f32_bf16 v17, s29, v83
    s_waitcnt vmcnt(6)
    v_dot2c_f32_bf16 v18, s28, v84
    v_dot2c_f32_bf16 v19, s29, v84
    v_dot2c_f32_bf16 v20, s28, v85
    v_dot2c_f32_bf16 v21, s29, v85
    v_dot2c_f32_bf16 v22, s28, v86
    v_dot2c_f32_bf16 v23, s29, v86
    v_dot2c_f32_bf16 v24, s28, v87
    v_dot2c_f32_bf16 v25, s29, v87
    v_mad_u32_u16 v66, v34, s30, v8 op_sel:[1,0,0,0]
    buffer_load_dwordx4 v[80:83], v66, s[20:23], 0 offen sc1
    v_mad_u32_u16 v67, v54, s30, v8 op_sel:[1,0,0,0]
    buffer_load_dwordx4 v[84:87], v67, s[20:23], 0 offen sc1
    s_waitcnt vmcnt(7)
    v_dot2c_f32_bf16 v10, s28, v88
    v_dot2c_f32_bf16 v11, s29, v88
    v_dot2c_f32_bf16 v12, s28, v89
    v_dot2c_f32_bf16 v13, s29, v89
    v_dot2c_f32_bf16 v14, s28, v90
    v_dot2c_f32_bf16 v15, s29, v90
    v_dot2c_f32_bf16 v16, s28, v91
    v_dot2c_f32_bf16 v17, s29, v91
    s_waitcnt vmcnt(6)
    v_dot2c_f32_bf16 v18, s28, v92
    v_dot2c_f32_bf16 v19, s29, v92
    v_dot2c_f32_bf16 v20, s28, v93
    v_dot2c_f32_bf16 v21, s29, v93
    v_dot2c_f32_bf16 v22, s28, v94
    v_dot2c_f32_bf16 v23, s29, v94
    v_dot2c_f32_bf16 v24, s28, v95
    v_dot2c_f32_bf16 v25, s29, v95
    s_setprio 0
    v_mad_u32_u16 v66, v35, s30, v8 op_sel:[0,0,0,0]
    buffer_load_dwordx4 v[88:91], v66, s[20:23], 0 offen sc1
    v_mad_u32_u16 v67, v55, s30, v8 op_sel:[0,0,0,0]
    buffer_load_dwordx4 v[92:95], v67, s[20:23], 0 offen sc1
    s_waitcnt vmcnt(7)
    v_dot2c_f32_bf16 v10, s28, v96
    v_dot2c_f32_bf16 v11, s29, v96
    v_dot2c_f32_bf16 v12, s28, v97
    v_dot2c_f32_bf16 v13, s29, v97
    v_dot2c_f32_bf16 v14, s28, v98
    v_dot2c_f32_bf16 v15, s29, v98
    v_dot2c_f32_bf16 v16, s28, v99
    v_dot2c_f32_bf16 v17, s29, v99
    s_waitcnt vmcnt(6)
    v_dot2c_f32_bf16 v18, s28, v100
    v_dot2c_f32_bf16 v19, s29, v100
    v_dot2c_f32_bf16 v20, s28, v101
    v_dot2c_f32_bf16 v21, s29, v101
    v_dot2c_f32_bf16 v22, s28, v102
    v_dot2c_f32_bf16 v23, s29, v102
    v_dot2c_f32_bf16 v24, s28, v103
    v_dot2c_f32_bf16 v25, s29, v103
    v_mad_u32_u16 v66, v35, s30, v8 op_sel:[1,0,0,0]
    buffer_load_dwordx4 v[96:99], v66, s[20:23], 0 offen sc1
    v_mad_u32_u16 v67, v55, s30, v8 op_sel:[1,0,0,0]
    buffer_load_dwordx4 v[100:103], v67, s[20:23], 0 offen sc1
    s_waitcnt vmcnt(7)
    v_dot2c_f32_bf16 v10, s28, v72
    v_dot2c_f32_bf16 v11, s29, v72
    v_dot2c_f32_bf16 v12, s28, v73
    v_dot2c_f32_bf16 v13, s29, v73
    v_dot2c_f32_bf16 v14, s28, v74
    v_dot2c_f32_bf16 v15, s29, v74
    v_dot2c_f32_bf16 v16, s28, v75
    v_dot2c_f32_bf16 v17, s29, v75
    s_waitcnt vmcnt(6)
    v_dot2c_f32_bf16 v18, s28, v76
    v_dot2c_f32_bf16 v19, s29, v76
    v_dot2c_f32_bf16 v20, s28, v77
    v_dot2c_f32_bf16 v21, s29, v77
    v_dot2c_f32_bf16 v22, s28, v78
    v_dot2c_f32_bf16 v23, s29, v78
    v_dot2c_f32_bf16 v24, s28, v79
    v_dot2c_f32_bf16 v25, s29, v79
    v_mad_u32_u16 v66, v36, s30, v8 op_sel:[0,0,0,0]
    buffer_load_dwordx4 v[72:75], v66, s[20:23], 0 offen sc1
    v_mad_u32_u16 v67, v56, s30, v8 op_sel:[0,0,0,0]
    buffer_load_dwordx4 v[76:79], v67, s[20:23], 0 offen sc1
    s_waitcnt vmcnt(7)
    v_dot2c_f32_bf16 v10, s28, v80
    v_dot2c_f32_bf16 v11, s29, v80
    v_dot2c_f32_bf16 v12, s28, v81
    v_dot2c_f32_bf16 v13, s29, v81
    v_dot2c_f32_bf16 v14, s28, v82
    v_dot2c_f32_bf16 v15, s29, v82
    v_dot2c_f32_bf16 v16, s28, v83
    v_dot2c_f32_bf16 v17, s29, v83
    s_waitcnt vmcnt(6)
    v_dot2c_f32_bf16 v18, s28, v84
    v_dot2c_f32_bf16 v19, s29, v84
    v_dot2c_f32_bf16 v20, s28, v85
    v_dot2c_f32_bf16 v21, s29, v85
    v_dot2c_f32_bf16 v22, s28, v86
    v_dot2c_f32_bf16 v23, s29, v86
    v_dot2c_f32_bf16 v24, s28, v87
    v_dot2c_f32_bf16 v25, s29, v87
    v_mad_u32_u16 v66, v36, s30, v8 op_sel:[1,0,0,0]
    buffer_load_dwordx4 v[80:83], v66, s[20:23], 0 offen sc1
    v_mad_u32_u16 v67, v56, s30, v8 op_sel:[1,0,0,0]
    buffer_load_dwordx4 v[84:87], v67, s[20:23], 0 offen sc1
    s_waitcnt vmcnt(7)
    v_dot2c_f32_bf16 v10, s28, v88
    v_dot2c_f32_bf16 v11, s29, v88
    v_dot2c_f32_bf16 v12, s28, v89
    v_dot2c_f32_bf16 v13, s29, v89
    v_dot2c_f32_bf16 v14, s28, v90
    v_dot2c_f32_bf16 v15, s29, v90
    v_dot2c_f32_bf16 v16, s28, v91
    v_dot2c_f32_bf16 v17, s29, v91
    s_waitcnt vmcnt(6)
    v_dot2c_f32_bf16 v18, s28, v92
    v_dot2c_f32_bf16 v19, s29, v92
    v_dot2c_f32_bf16 v20, s28, v93
    v_dot2c_f32_bf16 v21, s29, v93
    v_dot2c_f32_bf16 v22, s28, v94
    v_dot2c_f32_bf16 v23, s29, v94
    v_dot2c_f32_bf16 v24, s28, v95
    v_dot2c_f32_bf16 v25, s29, v95
    v_mad_u32_u16 v66, v37, s30, v8 op_sel:[0,0,0,0]
    buffer_load_dwordx4 v[88:91], v66, s[20:23], 0 offen sc1
    v_mad_u32_u16 v67, v57, s30, v8 op_sel:[0,0,0,0]
    buffer_load_dwordx4 v[92:95], v67, s[20:23], 0 offen sc1
    s_waitcnt vmcnt(7)
    v_dot2c_f32_bf16 v10, s28, v96
    v_dot2c_f32_bf16 v11, s29, v96
    v_dot2c_f32_bf16 v12, s28, v97
    v_dot2c_f32_bf16 v13, s29, v97
    v_dot2c_f32_bf16 v14, s28, v98
    v_dot2c_f32_bf16 v15, s29, v98
    v_dot2c_f32_bf16 v16, s28, v99
    v_dot2c_f32_bf16 v17, s29, v99
    s_waitcnt vmcnt(6)
    v_dot2c_f32_bf16 v18, s28, v100
    v_dot2c_f32_bf16 v19, s29, v100
    v_dot2c_f32_bf16 v20, s28, v101
    v_dot2c_f32_bf16 v21, s29, v101
    v_dot2c_f32_bf16 v22, s28, v102
    v_dot2c_f32_bf16 v23, s29, v102
    v_dot2c_f32_bf16 v24, s28, v103
    v_dot2c_f32_bf16 v25, s29, v103
    v_mad_u32_u16 v66, v37, s30, v8 op_sel:[1,0,0,0]
    buffer_load_dwordx4 v[96:99], v66, s[20:23], 0 offen sc1
    v_mad_u32_u16 v67, v57, s30, v8 op_sel:[1,0,0,0]
    buffer_load_dwordx4 v[100:103], v67, s[20:23], 0 offen sc1
    s_waitcnt vmcnt(7)
    v_dot2c_f32_bf16 v10, s28, v72
    v_dot2c_f32_bf16 v11, s29, v72
    v_dot2c_f32_bf16 v12, s28, v73
    v_dot2c_f32_bf16 v13, s29, v73
    v_dot2c_f32_bf16 v14, s28, v74
    v_dot2c_f32_bf16 v15, s29, v74
    v_dot2c_f32_bf16 v16, s28, v75
    v_dot2c_f32_bf16 v17, s29, v75
    s_waitcnt vmcnt(6)
    v_dot2c_f32_bf16 v18, s28, v76
    v_dot2c_f32_bf16 v19, s29, v76
    v_dot2c_f32_bf16 v20, s28, v77
    v_dot2c_f32_bf16 v21, s29, v77
    v_dot2c_f32_bf16 v22, s28, v78
    v_dot2c_f32_bf16 v23, s29, v78
    v_dot2c_f32_bf16 v24, s28, v79
    v_dot2c_f32_bf16 v25, s29, v79
    s_waitcnt vmcnt(5)
    v_dot2c_f32_bf16 v10, s28, v80
    v_dot2c_f32_bf16 v11, s29, v80
    v_dot2c_f32_bf16 v12, s28, v81
    v_dot2c_f32_bf16 v13, s29, v81
    v_dot2c_f32_bf16 v14, s28, v82
    v_dot2c_f32_bf16 v15, s29, v82
    v_dot2c_f32_bf16 v16, s28, v83
    v_dot2c_f32_bf16 v17, s29, v83
    s_waitcnt vmcnt(4)
    v_dot2c_f32_bf16 v18, s28, v84
    v_dot2c_f32_bf16 v19, s29, v84
    v_dot2c_f32_bf16 v20, s28, v85
    v_dot2c_f32_bf16 v21, s29, v85
    v_dot2c_f32_bf16 v22, s28, v86
    v_dot2c_f32_bf16 v23, s29, v86
    v_dot2c_f32_bf16 v24, s28, v87
    v_dot2c_f32_bf16 v25, s29, v87
    s_waitcnt vmcnt(3)
    v_dot2c_f32_bf16 v10, s28, v88
    v_dot2c_f32_bf16 v11, s29, v88
    v_dot2c_f32_bf16 v12, s28, v89
    v_dot2c_f32_bf16 v13, s29, v89
    v_dot2c_f32_bf16 v14, s28, v90
    v_dot2c_f32_bf16 v15, s29, v90
    v_dot2c_f32_bf16 v16, s28, v91
    v_dot2c_f32_bf16 v17, s29, v91
    s_waitcnt vmcnt(2)
    v_dot2c_f32_bf16 v18, s28, v92
    v_dot2c_f32_bf16 v19, s29, v92
    v_dot2c_f32_bf16 v20, s28, v93
    v_dot2c_f32_bf16 v21, s29, v93
    v_dot2c_f32_bf16 v22, s28, v94
    v_dot2c_f32_bf16 v23, s29, v94
    v_dot2c_f32_bf16 v24, s28, v95
    v_dot2c_f32_bf16 v25, s29, v95
    s_waitcnt vmcnt(1)
    v_dot2c_f32_bf16 v10, s28, v96
    v_dot2c_f32_bf16 v11, s29, v96
    v_dot2c_f32_bf16 v12, s28, v97
    v_dot2c_f32_bf16 v13, s29, v97
    v_dot2c_f32_bf16 v14, s28, v98
    v_dot2c_f32_bf16 v15, s29, v98
    v_dot2c_f32_bf16 v16, s28, v99
    v_dot2c_f32_bf16 v17, s29, v99
    s_waitcnt vmcnt(0)
    v_dot2c_f32_bf16 v18, s28, v100
    v_dot2c_f32_bf16 v19, s29, v100
    v_dot2c_f32_bf16 v20, s28, v101
    v_dot2c_f32_bf16 v21, s29, v101
    v_dot2c_f32_bf16 v22, s28, v102
    v_dot2c_f32_bf16 v23, s29, v102
    v_dot2c_f32_bf16 v24, s28, v103
    v_dot2c_f32_bf16 v25, s29, v103
    s_branch hop_fin
hop_w13:
    s_setprio 3
    v_mad_u32_u16 v66, v26, s30, v8 op_sel:[0,0,0,0]
    buffer_load_dwordx4 v[72:75], v66, s[20:23], 0 offen sc1
    v_mad_u32_u16 v67, v46, s30, v8 op_sel:[0,0,0,0]
    buffer_load_dwordx4 v[76:79], v67, s[20:23], 0 offen sc1
    v_mad_u32_u16 v66, v26, s30, v8 op_sel:[1,0,0,0]
    buffer_load_dwordx4 v[80:83], v66, s[20:23], 0 offen sc1
    v_mad_u32_u16 v67, v46, s30, v8 op_sel:[1,0,0,0]
    buffer_load_dwordx4 v[84:87], v67, s[20:23], 0 offen sc1
    v_mad_u32_u16 v66, v27, s30, v8 op_sel:[0,0,0,0]
    buffer_load_dwordx4 v[88:91], v66, s[20:23], 0 offen sc1
    v_mad_u32_u16 v67, v47, s30, v8 op_sel:[0,0,0,0]
    buffer_load_dwordx4 v[92:95], v67, s[20:23], 0 offen sc1
    v_mad_u32_u16 v66, v27, s30, v8 op_sel:[1,0,0,0]
    buffer_load_dwordx4 v[96:99], v66, s[20:23], 0 offen sc1
    v_mad_u32_u16 v67, v47, s30, v8 op_sel:[1,0,0,0]
    buffer_load_dwordx4 v[100:103], v67, s[20:23], 0 offen sc1
    s_waitcnt vmcnt(7)
    v_dot2c_f32_bf16 v10, s28, v72
    v_dot2c_f32_bf16 v11, s29, v72
    v_dot2c_f32_bf16 v12, s28, v73
    v_dot2c_f32_bf16 v13, s29, v73
    v_dot2c_f32_bf16 v14, s28, v74
    v_dot2c_f32_bf16 v15, s29, v74
    v_dot2c_f32_bf16 v16, s28, v75
    v_dot2c_f32_bf16 v17, s29, v75
    s_waitcnt vmcnt(6)
    v_dot2c_f32_bf16 v18, s28, v76
    v_dot2c_f32_bf16 v19, s29, v76
    v_dot2c_f32_bf16 v20, s28, v77
    v_dot2c_f32_bf16 v21, s29, v77
    v_dot2c_f32_bf16 v22, s28, v78
    v_dot2c_f32_bf16 v23, s29, v78
    v_dot2c_f32_bf16 v24, s28, v79
    v_dot2c_f32_bf16 v25, s29, v79
    v_mad_u32_u16 v66, v28, s30, v8 op_sel:[0,0,0,0]
    buffer_load_dwordx4 v[72:75], v66, s[20:23], 0 offen sc1
    v_mad_u32_u16 v67, v48, s30, v8 op_sel:[0,0,0,0]
    buffer_load_dwordx4 v[76:79], v67, s[20:23], 0 offen sc1
    s_waitcnt vmcnt(7)
    v_dot2c_f32_bf16 v10, s28, v80
    v_dot2c_f32_bf16 v11, s29, v80
    v_dot2c_f32_bf16 v12, s28, v81
    v_dot2c_f32_bf16 v13, s29, v81
    v_dot2c_f32_bf16 v14, s28, v82
    v_dot2c_f32_bf16 v15, s29, v82
    v_dot2c_f32_bf16 v16, s28, v83
    v_dot2c_f32_bf16 v17, s29, v83
    s_waitcnt vmcnt(6)
    v_dot2c_f32_bf16 v18, s28, v84
    v_dot2c_f32_bf16 v19, s29, v84
    v_dot2c_f32_bf16 v20, s28, v85
    v_dot2c_f32_bf16 v21, s29, v85
    v_dot2c_f32_bf16 v22, s28, v86
    v_dot2c_f32_bf16 v23, s29, v86
    v_dot2c_f32_bf16 v24, s28, v87
    v_dot2c_f32_bf16 v25, s29, v87
    v_mad_u32_u16 v66, v28, s30, v8 op_sel:[1,0,0,0]
    buffer_load_dwordx4 v[80:83], v66, s[20:23], 0 offen sc1
    v_mad_u32_u16 v67, v48, s30, v8 op_sel:[1,0,0,0]
    buffer_load_dwordx4 v[84:87], v67, s[20:23], 0 offen sc1
    s_waitcnt vmcnt(7)
    v_dot2c_f32_bf16 v10, s28, v88
    v_dot2c_f32_bf16 v11, s29, v88
    v_dot2c_f32_bf16 v12, s28, v89
    v_dot2c_f32_bf16 v13, s29, v89
    v_dot2c_f32_bf16 v14, s28, v90
    v_dot2c_f32_bf16 v15, s29, v90
    v_dot2c_f32_bf16 v16, s28, v91
    v_dot2c_f32_bf16 v17, s29, v91
    s_waitcnt vmcnt(6)
    v_dot2c_f32_bf16 v18, s28, v92
    v_dot2c_f32_bf16 v19, s29, v92
    v_dot2c_f32_bf16 v20, s28, v93
    v_dot2c_f32_bf16 v21, s29, v93
    v_dot2c_f32_bf16 v22, s28, v94
    v_dot2c_f32_bf16 v23, s29, v94
    v_dot2c_f32_bf16 v24, s28, v95
    v_dot2c_f32_bf16 v25, s29, v95
    v_mad_u32_u16 v66, v29, s30, v8 op_sel:[0,0,0,0]
    buffer_load_dwordx4 v[88:91], v66, s[20:23], 0 offen sc1
    v_mad_u32_u16 v67, v49, s30, v8 op_sel:[0,0,0,0]
    buffer_load_dwordx4 v[92:95], v67, s[20:23], 0 offen sc1
    s_waitcnt vmcnt(7)
    v_dot2c_f32_bf16 v10, s28, v96
    v_dot2c_f32_bf16 v11, s29, v96
    v_dot2c_f32_bf16 v12, s28, v97
    v_dot2c_f32_bf16 v13, s29, v97
    v_dot2c_f32_bf16 v14, s28, v98
    v_dot2c_f32_bf16 v15, s29, v98
    v_dot2c_f32_bf16 v16, s28, v99
    v_dot2c_f32_bf16 v17, s29, v99
    s_waitcnt vmcnt(6)
    v_dot2c_f32_bf16 v18, s28, v100
    v_dot2c_f32_bf16 v19, s29, v100
    v_dot2c_f32_bf16 v20, s28, v101
    v_dot2c_f32_bf16 v21, s29, v101
    v_dot2c_f32_bf16 v22, s28, v102
    v_dot2c_f32_bf16 v23, s29, v102
    v_dot2c_f32_bf16 v24, s28, v103
    v_dot2c_f32_bf16 v25, s29, v103
    s_setprio 2
    v_mad_u32_u16 v66, v29, s30, v8 op_sel:[1,0,0,0]
    buffer_load_dwordx4 v[96:99], v66, s[20:23], 0 offen sc1
    v_mad_u32_u16 v67, v49, s30, v8 op_sel:[1,0,0,0]
    buffer_load_dwordx4 v[100:103], v67, s[20:23], 0 offen sc1
    s_waitcnt vmcnt(7)
    v_dot2c_f32_bf16 v10, s28, v72
    v_dot2c_f32_bf16 v11, s29, v72
    v_dot2c_f32_bf16 v12, s28, v73
    v_dot2c_f32_bf16 v13, s29, v73
    v_dot2c_f32_bf16 v14, s28, v74
    v_dot2c_f32_bf16 v15, s29, v74
    v_dot2c_f32_bf16 v16, s28, v75
    v_dot2c_f32_bf16 v17, s29, v75
    s_waitcnt vmcnt(6)
    v_dot2c_f32_bf16 v18, s28, v76
    v_dot2c_f32_bf16 v19, s29, v76
    v_dot2c_f32_bf16 v20, s28, v77
    v_dot2c_f32_bf16 v21, s29, v77
    v_dot2c_f32_bf16 v22, s28, v78
    v_dot2c_f32_bf16 v23, s29, v78
    v_dot2c_f32_bf16 v24, s28, v79
    v_dot2c_f32_bf16 v25, s29, v79
    v_mad_u32_u16 v66, v30, s30, v8 op_sel:[0,0,0,0]
    buffer_load_dwordx4 v[72:75], v66, s[20:23], 0 offen sc1
    v_mad_u32_u16 v67, v50, s30, v8 op_sel:[0,0,0,0]
    buffer_load_dwordx4 v[76:79], v67, s[20:23], 0 offen sc1
    s_waitcnt vmcnt(7)
    v_dot2c_f32_bf16 v10, s28, v80
    v_dot2c_f32_bf16 v11, s29, v80
    v_dot2c_f32_bf16 v12, s28, v81
    v_dot2c_f32_bf16 v13, s29, v81
    v_dot2c_f32_bf16 v14, s28, v82
    v_dot2c_f32_bf16 v15, s29, v82
    v_dot2c_f32_bf16 v16, s28, v83
    v_dot2c_f32_bf16 v17, s29, v83
    s_waitcnt vmcnt(6)
    v_dot2c_f32_bf16 v18, s28, v84
    v_dot2c_f32_bf16 v19, s29, v84
    v_dot2c_f32_bf16 v20, s28, v85
    v_dot2c_f32_bf16 v21, s29, v85
    v_dot2c_f32_bf16 v22, s28, v86
    v_dot2c_f32_bf16 v23, s29, v86
    v_dot2c_f32_bf16 v24, s28, v87
    v_dot2c_f32_bf16 v25, s29, v87
    v_mad_u32_u16 v66, v30, s30, v8 op_sel:[1,0,0,0]
    buffer_load_dwordx4 v[80:83], v66, s[20:23], 0 offen sc1
    v_mad_u32_u16 v67, v50, s30, v8 op_sel:[1,0,0,0]
    buffer_load_dwordx4 v[84:87], v67, s[20:23], 0 offen sc1
    s_waitcnt vmcnt(7)
    v_dot2c_f32_bf16 v10, s28, v88
    v_dot2c_f32_bf16 v11, s29, v88
    v_dot2c_f32_bf16 v12, s28, v89
    v_dot2c_f32_bf16 v13, s29, v89
    v_dot2c_f32_bf16 v14, s28, v90
    v_dot2c_f32_bf16 v15, s29, v90
    v_dot2c_f32_bf16 v16, s28, v91
    v_dot2c_f32_bf16 v17, s29, v91
    s_waitcnt vmcnt(6)
    v_dot2c_f32_bf16 v18, s28, v92
    v_dot2c_f32_bf16 v19, s29, v92
    v_dot2c_f32_bf16 v20, s28, v93
    v_dot2c_f32_bf16 v21, s29, v93
    v_dot2c_f32_bf16 v22, s28, v94
    v_dot2c_f32_bf16 v23, s29, v94
    v_dot2c_f32_bf16 v24, s28, v95
    v_dot2c_f32_bf16 v25, s29, v95
    v_mad_u32_u16 v66, v31, s30, v8 op_sel:[0,0,0,0]
    buffer_load_dwordx4 v[88:91], v66, s[20:23], 0 offen sc1
    v_mad_u32_u16 v67, v51, s30, v8 op_sel:[0,0,0,0]
    buffer_load_dwordx4 v[92:95], v67, s[20:23], 0 offen sc1
    s_waitcnt vmcnt(7)
    v_dot2c_f32_bf16 v10, s28, v96
    v_dot2c_f32_bf16 v11, s29, v96
    v_dot2c_f32_bf16 v12, s28, v97
    v_dot2c_f32_bf16 v13, s29, v97
    v_dot2c_f32_bf16 v14, s28, v98
    v_dot2c_f32_bf16 v15, s29, v98
    v_dot2c_f32_bf16 v16, s28, v99
    v_dot2c_f32_bf16 v17, s29, v99
    s_waitcnt vmcnt(6)
    v_dot2c_f32_bf16 v18, s28, v100
    v_dot2c_f32_bf16 v19, s29, v100
    v_dot2c_f32_bf16 v20, s28, v101
    v_dot2c_f32_bf16 v21, s29, v101
    v_dot2c_f32_bf16 v22, s28, v102
    v_dot2c_f32_bf16 v23, s29, v102
    v_dot2c_f32_bf16 v24, s28, v103
    v_dot2c_f32_bf16 v25, s29, v103
    v_mad_u32_u16 v66, v31, s30, v8 op_sel:[1,0,0,0]
    buffer_load_dwordx4 v[96:99], v66, s[20:23], 0 offen sc1
    v_mad_u32_u16 v67, v51, s30, v8 op_sel:[1,0,0,0]
    buffer_load_dwordx4 v[100:103], v67, s[20:23], 0 offen sc1
    s_waitcnt vmcnt(7)
    v_dot2c_f32_bf16 v10, s28, v72
    v_dot2c_f32_bf16 v11, s29, v72
    v_dot2c_f32_bf16 v12, s28, v73
    v_dot2c_f32_bf16 v13, s29, v73
    v_dot2c_f32_bf16 v14, s28, v74
    v_dot2c_f32_bf16 v15, s29, v74
    v_dot2c_f32_bf16 v16, s28, v75
    v_dot2c_f32_bf16 v17, s29, v75
    s_waitcnt vmcnt(6)
    v_dot2c_f32_bf16 v18, s28, v76
    v_dot2c_f32_bf16 v19, s29, v76
    v_dot2c_f32_bf16 v20, s28, v77
    v_dot2c_f32_bf16 v21, s29, v77
    v_dot2c_f32_bf16 v22, s28, v78
    v_dot2c_f32_bf16 v23, s29, v78
    v_dot2c_f32_bf16 v24, s28, v79
    v_dot2c_f32_bf16 v25, s29, v79
    v_mad_u32_u16 v66, v32, s30, v8 op_sel:[0,0,0,0]
    buffer_load_dwordx4 v[72:75], v66, s[20:23], 0 offen sc1
    v_mad_u32_u16 v67, v52, s30, v8 op_sel:[0,0,0,0]
    buffer_load_dwordx4 v[76:79], v67, s[20:23], 0 offen sc1
    s_waitcnt vmcnt(7)
    v_dot2c_f32_bf16 v10, s28, v80
    v_dot2c_f32_bf16 v11, s29, v80
    v_dot2c_f32_bf16 v12, s28, v81
    v_dot2c_f32_bf16 v13, s29, v81
    v_dot2c_f32_bf16 v14, s28, v82
    v_dot2c_f32_bf16 v15, s29, v82
    v_dot2c_f32_bf16 v16, s28, v83
    v_dot2c_f32_bf16 v17, s29, v83
    s_waitcnt vmcnt(6)
    v_dot2c_f32_bf16 v18, s28, v84
    v_dot2c_f32_bf16 v19, s29, v84
    v_dot2c_f32_bf16 v20, s28, v85
    v_dot2c_f32_bf16 v21, s29, v85
    v_dot2c_f32_bf16 v22, s28, v86
    v_dot2c_f32_bf16 v23, s29, v86
    v_dot2c_f32_bf16 v24, s28, v87
    v_dot2c_f32_bf16 v25, s29, v87
    s_setprio 1
    v_mad_u32_u16 v66, v32, s30, v8 op_sel:[1,0,0,0]
    buffer_load_dwordx4 v[80:83], v66, s[20:23], 0 offen sc1
    v_mad_u32_u16 v67, v52, s30, v8 op_sel:[1,0,0,0]
    buffer_load_dwordx4 v[84:87], v67, s[20:23], 0 offen sc1
    s_waitcnt vmcnt(7)
    v_dot2c_f32_bf16 v10, s28, v88
    v_dot2c_f32_bf16 v11, s29, v88
    v_dot2c_f32_bf16 v12, s28, v89
    v_dot2c_f32_bf16 v13, s29, v89
    v_dot2c_f32_bf16 v14, s28, v90
    v_dot2c_f32_bf16 v15, s29, v90
    v_dot2c_f32_bf16 v16, s28, v91
    v_dot2c_f32_bf16 v17, s29, v91
    s_waitcnt vmcnt(6)
    v_dot2c_f32_bf16 v18, s28, v92
    v_dot2c_f32_bf16 v19, s29, v92
    v_dot2c_f32_bf16 v20, s28, v93
    v_dot2c_f32_bf16 v21, s29, v93
    v_dot2c_f32_bf16 v22, s28, v94
    v_dot2c_f32_bf16 v23, s29, v94
    v_dot2c_f32_bf16 v24, s28, v95
    v_dot2c_f32_bf16 v25, s29, v95
    v_mad_u32_u16 v66, v33, s30, v8 op_sel:[0,0,0,0]
    buffer_load_dwordx4 v[88:91], v66, s[20:23], 0 offen sc1
    v_mad_u32_u16 v67, v53, s30, v8 op_sel:[0,0,0,0]
    buffer_load_dwordx4 v[92:95], v67, s[20:23], 0 offen sc1
    s_waitcnt vmcnt(7)
    v_dot2c_f32_bf16 v10, s28, v96
    v_dot2c_f32_bf16 v11, s29, v96
    v_dot2c_f32_bf16 v12, s28, v97
    v_dot2c_f32_bf16 v13, s29, v97
    v_dot2c_f32_bf16 v14, s28, v98
    v_dot2c_f32_bf16 v15, s29, v98
    v_dot2c_f32_bf16 v16, s28, v99
    v_dot2c_f32_bf16 v17, s29, v99
    s_waitcnt vmcnt(6)
    v_dot2c_f32_bf16 v18, s28, v100
    v_dot2c_f32_bf16 v19, s29, v100
    v_dot2c_f32_bf16 v20, s28, v101
    v_dot2c_f32_bf16 v21, s29, v101
    v_dot2c_f32_bf16 v22, s28, v102
    v_dot2c_f32_bf16 v23, s29, v102
    v_dot2c_f32_bf16 v24, s28, v103
    v_dot2c_f32_bf16 v25, s29, v103
    v_mad_u32_u16 v66, v33, s30, v8 op_sel:[1,0,0,0]
    buffer_load_dwordx4 v[96:99], v66, s[20:23], 0 offen sc1
    v_mad_u32_u16 v67, v53, s30, v8 op_sel:[1,0,0,0]
    buffer_load_dwordx4 v[100:103], v67, s[20:23], 0 offen sc1
    s_waitcnt vmcnt(7)
    v_dot2c_f32_bf16 v10, s28, v72
    v_dot2c_f32_bf16 v11, s29, v72
    v_dot2c_f32_bf16 v12, s28, v73
    v_dot2c_f32_bf16 v13, s29, v73
    v_dot2c_f32_bf16 v14, s28, v74
    v_dot2c_f32_bf16 v15, s29, v74
    v_dot2c_f32_bf16 v16, s28, v75
    v_dot2c_f32_bf16 v17, s29, v75
    s_waitcnt vmcnt(6)
    v_dot2c_f32_bf16 v18, s28, v76
    v_dot2c_f32_bf16 v19, s29, v76
    v_dot2c_f32_bf16 v20, s28, v77
    v_dot2c_f32_bf16 v21, s29, v77
    v_dot2c_f32_bf16 v22, s28, v78
    v_dot2c_f32_bf16 v23, s29, v78
    v_dot2c_f32_bf16 v24, s28, v79
    v_dot2c_f32_bf16 v25, s29, v79
    v_mad_u32_u16 v66, v34, s30, v8 op_sel:[0,0,0,0]
    buffer_load_dwordx4 v[72:75], v66, s[20:23], 0 offen sc1
    v_mad_u32_u16 v67, v54, s30, v8 op_sel:[0,0,0,0]
    buffer_load_dwordx4 v[76:79], v67, s[20:23], 0 offen sc1
    s_waitcnt vmcnt(7)
    v_dot2c_f32_bf16 v10, s28, v80
    v_dot2c_f32_bf16 v11, s29, v80
    v_dot2c_f32_bf16 v12, s28, v81
    v_dot2c_f32_bf16 v13, s29, v81
    v_dot2c_f32_bf16 v14, s28, v82
    v_dot2c_f32_bf16 v15, s29, v82
    v_dot2c_f32_bf16 v16, s28, v83
    v_dot2c_f32_bf16 v17, s29, v83
    s_waitcnt vmcnt(6)
    v_dot2c_f32_bf16 v18, s28, v84
    v_dot2c_f32_bf16 v19, s29, v84
    v_dot2c_f32_bf16 v20, s28, v85
    v_dot2c_f32_bf16 v21, s29, v85
    v_dot2c_f32_bf16 v22, s28, v86
    v_dot2c_f32_bf16 v23, s29, v86
    v_dot2c_f32_bf16 v24, s28, v87
    v_dot2c_f32_bf16 v25, s29, v87
    v_mad_u32_u16 v66, v34, s30, v8 op_sel:[1,0,0,0]
    buffer_load_dwordx4 v[80:83], v66, s[20:23], 0 offen sc1
    v_mad_u32_u16 v67, v54, s30, v8 op_sel:[1,0,0,0]
    buffer_load_dwordx4 v[84:87], v67, s[20:23], 0 offen sc1
    s_waitcnt vmcnt(7)
    v_dot2c_f32_bf16 v10, s28, v88
    v_dot2c_f32_bf16 v11, s29, v88
    v_dot2c_f32_bf16 v12, s28, v89
    v_dot2c_f32_bf16 v13, s29, v89
    v_dot2c_f32_bf16 v14, s28, v90
    v_dot2c_f32_bf16 v15, s29, v90
    v_dot2c_f32_bf16 v16, s28, v91
    v_dot2c_f32_bf16 v17, s29, v91
    s_waitcnt vmcnt(6)
    v_dot2c_f32_bf16 v18, s28, v92
    v_dot2c_f32_bf16 v19, s29, v92
    v_dot2c_f32_bf16 v20, s28, v93
    v_dot2c_f32_bf16 v21, s29, v93
    v_dot2c_f32_bf16 v22, s28, v94
    v_dot2c_f32_bf16 v23, s29, v94
    v_dot2c_f32_bf16 v24, s28, v95
    v_dot2c_f32_bf16 v25, s29, v95
    v_mad_u32_u16 v66, v35, s30, v8 op_sel:[0,0,0,0]
    buffer_load_dwordx4 v[88:91], v66, s[20:23], 0 offen sc1
    v_mad_u32_u16 v67, v55, s30, v8 op_sel:[0,0,0,0]
    buffer_load_dwordx4 v[92:95], v67, s[20:23], 0 offen sc1
    s_waitcnt vmcnt(7)
    v_dot2c_f32_bf16 v10, s28, v96
    v_dot2c_f32_bf16 v11, s29, v96
    v_dot2c_f32_bf16 v12, s28, v97
    v_dot2c_f32_bf16 v13, s29, v97
    v_dot2c_f32_bf16 v14, s28, v98
    v_dot2c_f32_bf16 v15, s29, v98
    v_dot2c_f32_bf16 v16, s28, v99
    v_dot2c_f32_bf16 v17, s29, v99
    s_waitcnt vmcnt(6)
    v_dot2c_f32_bf16 v18, s28, v100
    v_dot2c_f32_bf16 v19, s29, v100
    v_dot2c_f32_bf16 v20, s28, v101
    v_dot2c_f32_bf16 v21, s29, v101
    v_dot2c_f32_bf16 v22, s28, v102
    v_dot2c_f32_bf16 v23, s29, v102
    v_dot2c_f32_bf16 v24, s28, v103
    v_dot2c_f32_bf16 v25, s29, v103
    v_mad_u32_u16 v66, v35, s30, v8 op_sel:[1,0,0,0]
    buffer_load_dwordx4 v[96:99], v66, s[20:23], 0 offen sc1
    v_mad_u32_u16 v67, v55, s30, v8 op_sel:[1,0,0,0]
    buffer_load_dwordx4 v[100:103], v67, s[20:23], 0 offen sc1
    s_waitcnt vmcnt(7)
    v_dot2c_f32_bf16 v10, s28, v72
    v_dot2c_f32_bf16 v11, s29, v72
    v_dot2c_f32_bf16 v12, s28, v73
    v_dot2c_f32_bf16 v13, s29, v73
    v_dot2c_f32_bf16 v14, s28, v74
    v_dot2c_f32_bf16 v15, s29, v74
    v_dot2c_f32_bf16 v16, s28, v75
    v_dot2c_f32_bf16 v17, s29, v75
    s_waitcnt vmcnt(6)
    v_dot2c_f32_bf16 v18, s28, v76
    v_dot2c_f32_bf16 v19, s29, v76
    v_dot2c_f32_bf16 v20, s28, v77
    v_dot2c_f32_bf16 v21, s29, v77
    v_dot2c_f32_bf16 v22, s28, v78
    v_dot2c_f32_bf16 v23, s29, v78
    v_dot2c_f32_bf16 v24, s28, v79
    v_dot2c_f32_bf16 v25, s29, v79
    s_setprio 0
    v_mad_u32_u16 v66, v36, s30, v8 op_sel:[0,0,0,0]
    buffer_load_dwordx4 v[72:75], v66, s[20:23], 0 offen sc1
    v_mad_u32_u16 v67, v56, s30, v8 op_sel:[0,0,0,0]
    buffer_load_dwordx4 v[76:79], v67, s[20:23], 0 offen sc1
    s_waitcnt vmcnt(7)
    v_dot2c_f32_bf16 v10, s28, v80
    v_dot2c_f32_bf16 v11, s29, v80
    v_dot2c_f32_bf16 v12, s28, v81
    v_dot2c_f32_bf16 v13, s29, v81
    v_dot2c_f32_bf16 v14, s28, v82
    v_dot2c_f32_bf16 v15, s29, v82
    v_dot2c_f32_bf16 v16, s28, v83
    v_dot2c_f32_bf16 v17, s29, v83
    s_waitcnt vmcnt(6)
    v_dot2c_f32_bf16 v18, s28, v84
    v_dot2c_f32_bf16 v19, s29, v84
    v_dot2c_f32_bf16 v20, s28, v85
    v_dot2c_f32_bf16 v21, s29, v85
    v_dot2c_f32_bf16 v22, s28, v86
    v_dot2c_f32_bf16 v23, s29, v86
    v_dot2c_f32_bf16 v24, s28, v87
    v_dot2c_f32_bf16 v25, s29, v87
    v_mad_u32_u16 v66, v36, s30, v8 op_sel:[1,0,0,0]
    buffer_load_dwordx4 v[80:83], v66, s[20:23], 0 offen sc1
    v_mad_u32_u16 v67, v56, s30, v8 op_sel:[1,0,0,0]
    buffer_load_dwordx4 v[84:87], v67, s[20:23], 0 offen sc1
    s_waitcnt vmcnt(7)
    v_dot2c_f32_bf16 v10, s28, v88
    v_dot2c_f32_bf16 v11, s29, v88
    v_dot2c_f32_bf16 v12, s28, v89
    v_dot2c_f32_bf16 v13, s29, v89
    v_dot2c_f32_bf16 v14, s28, v90
    v_dot2c_f32_bf16 v15, s29, v90
    v_dot2c_f32_bf16 v16, s28, v91
    v_dot2c_f32_bf16 v17, s29, v91
    s_waitcnt vmcnt(6)
    v_dot2c_f32_bf16 v18, s28, v92
    v_dot2c_f32_bf16 v19, s29, v92
    v_dot2c_f32_bf16 v20, s28, v93
    v_dot2c_f32_bf16 v21, s29, v93
    v_dot2c_f32_bf16 v22, s28, v94
    v_dot2c_f32_bf16 v23, s29, v94
    v_dot2c_f32_bf16 v24, s28, v95
    v_dot2c_f32_bf16 v25, s29, v95
    v_mad_u32_u16 v66, v37, s30, v8 op_sel:[0,0,0,0]
    buffer_load_dwordx4 v[88:91], v66, s[20:23], 0 offen sc1
    v_mad_u32_u16 v67, v57, s30, v8 op_sel:[0,0,0,0]
    buffer_load_dwordx4 v[92:95], v67, s[20:23], 0 offen sc1
    s_waitcnt vmcnt(7)
    v_dot2c_f32_bf16 v10, s28, v96
    v_dot2c_f32_bf16 v11, s29, v96
    v_dot2c_f32_bf16 v12, s28, v97
    v_dot2c_f32_bf16 v13, s29, v97
    v_dot2c_f32_bf16 v14, s28, v98
    v_dot2c_f32_bf16 v15, s29, v98
    v_dot2c_f32_bf16 v16, s28, v99
    v_dot2c_f32_bf16 v17, s29, v99
    s_waitcnt vmcnt(6)
    v_dot2c_f32_bf16 v18, s28, v100
    v_dot2c_f32_bf16 v19, s29, v100
    v_dot2c_f32_bf16 v20, s28, v101
    v_dot2c_f32_bf16 v21, s29, v101
    v_dot2c_f32_bf16 v22, s28, v102
    v_dot2c_f32_bf16 v23, s29, v102
    v_dot2c_f32_bf16 v24, s28, v103
    v_dot2c_f32_bf16 v25, s29, v103
    v_mad_u32_u16 v66, v37, s30, v8 op_sel:[1,0,0,0]
    buffer_load_dwordx4 v[96:99], v66, s[20:23], 0 offen sc1
    v_mad_u32_u16 v67, v57, s30, v8 op_sel:[1,0,0,0]
    buffer_load_dwordx4 v[100:103], v67, s[20:23], 0 offen sc1
    s_waitcnt vmcnt(7)
    v_dot2c_f32_bf16 v10, s28, v72
    v_dot2c_f32_bf16 v11, s29, v72
    v_dot2c_f32_bf16 v12, s28, v73
    v_dot2c_f32_bf16 v13, s29, v73
    v_dot2c_f32_bf16 v14, s28, v74
    v_dot2c_f32_bf16 v15, s29, v74
    v_dot2c_f32_bf16 v16, s28, v75
    v_dot2c_f32_bf16 v17, s29, v75
    s_waitcnt vmcnt(6)
    v_dot2c_f32_bf16 v18, s28, v76
    v_dot2c_f32_bf16 v19, s29, v76
    v_dot2c_f32_bf16 v20, s28, v77
    v_dot2c_f32_bf16 v21, s29, v77
    v_dot2c_f32_bf16 v22, s28, v78
    v_dot2c_f32_bf16 v23, s29, v78
    v_dot2c_f32_bf16 v24, s28, v79
    v_dot2c_f32_bf16 v25, s29, v79
    v_mad_u32_u16 v66, v38, s30, v8 op_sel:[0,0,0,0]
    buffer_load_dwordx4 v[72:75], v66, s[20:23], 0 offen sc1
    v_mad_u32_u16 v67, v58, s30, v8 op_sel:[0,0,0,0]
    buffer_load_dwordx4 v[76:79], v67, s[20:23], 0 offen sc1
    s_waitcnt vmcnt(7)
    v_dot2c_f32_bf16 v10, s28, v80
    v_dot2c_f32_bf16 v11, s29, v80
    v_dot2c_f32_bf16 v12, s28, v81
    v_dot2c_f32_bf16 v13, s29, v81
    v_dot2c_f32_bf16 v14, s28, v82
    v_dot2c_f32_bf16 v15, s29, v82
    v_dot2c_f32_bf16 v16, s28, v83
    v_dot2c_f32_bf16 v17, s29, v83
    s_waitcnt vmcnt(6)
    v_dot2c_f32_bf16 v18, s28, v84
    v_dot2c_f32_bf16 v19, s29, v84
    v_dot2c_f32_bf16 v20, s28, v85
    v_dot2c_f32_bf16 v21, s29, v85
    v_dot2c_f32_bf16 v22, s28, v86
    v_dot2c_f32_bf16 v23, s29, v86
    v_dot2c_f32_bf16 v24, s28, v87
    v_dot2c_f32_bf16 v25, s29, v87
    v_mad_u32_u16 v66, v38, s30, v8 op_sel:[1,0,0,0]
    buffer_load_dwordx4 v[80:83], v66, s[20:23], 0 offen sc1
    v_mad_u32_u16 v67, v58, s30, v8 op_sel:[1,0,0,0]
    buffer_load_dwordx4 v[84:87], v67, s[20:23], 0 offen sc1
    s_waitcnt vmcnt(7)
    v_dot2c_f32_bf16 v10, s28, v88
    v_dot2c_f32_bf16 v11, s29, v88
    v_dot2c_f32_bf16 v12, s28, v89
    v_dot2c_f32_bf16 v13, s29, v89
    v_dot2c_f32_bf16 v14, s28, v90
    v_dot2c_f32_bf16 v15, s29, v90
    v_dot2c_f32_bf16 v16, s28, v91
    v_dot2c_f32_bf16 v17, s29, v91
    s_waitcnt vmcnt(6)
    v_dot2c_f32_bf16 v18, s28, v92
    v_dot2c_f32_bf16 v19, s29, v92
    v_dot2c_f32_bf16 v20, s28, v93
    v_dot2c_f32_bf16 v21, s29, v93
    v_dot2c_f32_bf16 v22, s28, v94
    v_dot2c_f32_bf16 v23, s29, v94
    v_dot2c_f32_bf16 v24, s28, v95
    v_dot2c_f32_bf16 v25, s29, v95
    s_waitcnt vmcnt(5)
    v_dot2c_f32_bf16 v10, s28, v96
    v_dot2c_f32_bf16 v11, s29, v96
    v_dot2c_f32_bf16 v12, s28, v97
    v_dot2c_f32_bf16 v13, s29, v97
    v_dot2c_f32_bf16 v14, s28, v98
    v_dot2c_f32_bf16 v15, s29, v98
    v_dot2c_f32_bf16 v16, s28, v99
    v_dot2c_f32_bf16 v17, s29, v99
    s_waitcnt vmcnt(4)
    v_dot2c_f32_bf16 v18, s28, v100
    v_dot2c_f32_bf16 v19, s29, v100
    v_dot2c_f32_bf16 v20, s28, v101
    v_dot2c_f32_bf16 v21, s29, v101
    v_dot2c_f32_bf16 v22, s28, v102
    v_dot2c_f32_bf16 v23, s29, v102
    v_dot2c_f32_bf16 v24, s28, v103
    v_dot2c_f32_bf16 v25, s29, v103
    s_waitcnt vmcnt(3)
    v_dot2c_f32_bf16 v10, s28, v72
    v_dot2c_f32_bf16 v11, s29, v72
    v_dot2c_f32_bf16 v12, s28, v73
    v_dot2c_f32_bf16 v13, s29, v73
    v_dot2c_f32_bf16 v14, s28, v74
    v_dot2c_f32_bf16 v15, s29, v74
    v_dot2c_f32_bf16 v16, s28, v75
    v_dot2c_f32_bf16 v17, s29, v75
    s_waitcnt vmcnt(2)
    v_dot2c_f32_bf16 v18, s28, v76
    v_dot2c_f32_bf16 v19, s29, v76
    v_dot2c_f32_bf16 v20, s28, v77
    v_dot2c_f32_bf16 v21, s29, v77
    v_dot2c_f32_bf16 v22, s28, v78
    v_dot2c_f32_bf16 v23, s29, v78
    v_dot2c_f32_bf16 v24, s28, v79
    v_dot2c_f32_bf16 v25, s29, v79
    s_waitcnt vmcnt(1)
    v_dot2c_f32_bf16 v10, s28, v80
    v_dot2c_f32_bf16 v11, s29, v80
    v_dot2c_f32_bf16 v12, s28, v81
    v_dot2c_f32_bf16 v13, s29, v81
    v_dot2c_f32_bf16 v14, s28, v82
    v_dot2c_f32_bf16 v15, s29, v82
    v_dot2c_f32_bf16 v16, s28, v83
    v_dot2c_f32_bf16 v17, s29, v83
    s_waitcnt vmcnt(0)
    v_dot2c_f32_bf16 v18, s28, v84
    v_dot2c_f32_bf16 v19, s29, v84
    v_dot2c_f32_bf16 v20, s28, v85
    v_dot2c_f32_bf16 v21, s29, v85
    v_dot2c_f32_bf16 v22, s28, v86
    v_dot2c_f32_bf16 v23, s29, v86
    v_dot2c_f32_bf16 v24, s28, v87
    v_dot2c_f32_bf16 v25, s29, v87
    s_branch hop_fin
hop_w14:
    s_setprio 3
    v_mad_u32_u16 v66, v26, s30, v8 op_sel:[0,0,0,0]
    buffer_load_dwordx4 v[72:75], v66, s[20:23], 0 offen sc1
    v_mad_u32_u16 v67, v46, s30, v8 op_sel:[0,0,0,0]
    buffer_load_dwordx4 v[76:79], v67, s[20:23], 0 offen sc1
    v_mad_u32_u16 v66, v26, s30, v8 op_sel:[1,0,0,0]
    buffer_load_dwordx4 v[80:83], v66, s[20:23], 0 offen sc1
    v_mad_u32_u16 v67, v46, s30, v8 op_sel:[1,0,0,0]
    buffer_load_dwordx4 v[84:87], v67, s[20:23], 0 offen sc1
    v_mad_u32_u16 v66, v27, s30, v8 op_sel:[0,0,0,0]
    buffer_load_dwordx4 v[88:91], v66, s[20:23], 0 offen sc1
    v_mad_u32_u16 v67, v47, s30, v8 op_sel:[0,0,0,0]
    buffer_load_dwordx4 v[92:95], v67, s[20:23], 0 offen sc1
    v_mad_u32_u16 v66, v27, s30, v8 op_sel:[1,0,0,0]
    buffer_load_dwordx4 v[96:99], v66, s[20:23], 0 offen sc1
    v_mad_u32_u16 v67, v47, s30, v8 op_sel:[1,0,0,0]
    buffer_load_dwordx4 v[100:103], v67, s[20:23], 0 offen sc1
    s_waitcnt vmcnt(7)
    v_dot2c_f32_bf16 v10, s28, v72
    v_dot2c_f32_bf16 v11, s29, v72
    v_dot2c_f32_bf16 v12, s28, v73
    v_dot2c_f32_bf16 v13, s29, v73
    v_dot2c_f32_bf16 v14, s28, v74
    v_dot2c_f32_bf16 v15, s29, v74
    v_dot2c_f32_bf16 v16, s28, v75
    v_dot2c_f32_bf16 v17, s29, v75
    s_waitcnt vmcnt(6)
    v_dot2c_f32_bf16 v18, s28, v76
    v_dot2c_f32_bf16 v19, s29, v76
    v_dot2c_f32_bf16 v20, s28, v77
    v_dot2c_f32_bf16 v21, s29, v77
    v_dot2c_f32_bf16 v22, s28, v78
    v_dot2c_f32_bf16 v23, s29, v78
    v_dot2c_f32_bf16 v24, s28, v79
    v_dot2c_f32_bf16 v25, s29, v79
    v_mad_u32_u16 v66, v28, s30, v8 op_sel:[0,0,0,0]
    buffer_load_dwordx4 v[72:75], v66, s[20:23], 0 offen sc1
    v_mad_u32_u16 v67, v48, s30, v8 op_sel:[0,0,0,0]
    buffer_load_dwordx4 v[76:79], v67, s[20:23], 0 offen sc1
    s_waitcnt vmcnt(7)
    v_dot2c_f32_bf16 v10, s28, v80
    v_dot2c_f32_bf16 v11, s29, v80
    v_dot2c_f32_bf16 v12, s28, v81
    v_dot2c_f32_bf16 v13, s29, v81
    v_dot2c_f32_bf16 v14, s28, v82
    v_dot2c_f32_bf16 v15, s29, v82
    v_dot2c_f32_bf16 v16, s28, v83
    v_dot2c_f32_bf16 v17, s29, v83
    s_waitcnt vmcnt(6)
    v_dot2c_f32_bf16 v18, s28, v84
    v_dot2c_f32_bf16 v19, s29, v84
    v_dot2c_f32_bf16 v20, s28, v85
    v_dot2c_f32_bf16 v21, s29, v85
    v_dot2c_f32_bf16 v22, s28, v86
    v_dot2c_f32_bf16 v23, s29, v86
    v_dot2c_f32_bf16 v24, s28, v87
    v_dot2c_f32_bf16 v25, s29, v87
    v_mad_u32_u16 v66, v28, s30, v8 op_sel:[1,0,0,0]
    buffer_load_dwordx4 v[80:83], v66, s[20:23], 0 offen sc1
    v_mad_u32_u16 v67, v48, s30, v8 op_sel:[1,0,0,0]
    buffer_load_dwordx4 v[84:87], v67, s[20:23], 0 offen sc1
    s_waitcnt vmcnt(7)
    v_dot2c_f32_bf16 v10, s28, v88
    v_dot2c_f32_bf16 v11, s29, v88
    v_dot2c_f32_bf16 v12, s28, v89
    v_dot2c_f32_bf16 v13, s29, v89
    v_dot2c_f32_bf16 v14, s28, v90
    v_dot2c_f32_bf16 v15, s29, v90
    v_dot2c_f32_bf16 v16, s28, v91
    v_dot2c_f32_bf16 v17, s29, v91
    s_waitcnt vmcnt(6)
    v_dot2c_f32_bf16 v18, s28, v92
    v_dot2c_f32_bf16 v19, s29, v92
    v_dot2c_f32_bf16 v20, s28, v93
    v_dot2c_f32_bf16 v21, s29, v93
    v_dot2c_f32_bf16 v22, s28, v94
    v_dot2c_f32_bf16 v23, s29, v94
    v_dot2c_f32_bf16 v24, s28, v95
    v_dot2c_f32_bf16 v25, s29, v95
    v_mad_u32_u16 v66, v29, s30, v8 op_sel:[0,0,0,0]
    buffer_load_dwordx4 v[88:91], v66, s[20:23], 0 offen sc1
    v_mad_u32_u16 v67, v49, s30, v8 op_sel:[0,0,0,0]
    buffer_load_dwordx4 v[92:95], v67, s[20:23], 0 offen sc1
    s_waitcnt vmcnt(7)
    v_dot2c_f32_bf16 v10, s28, v96
    v_dot2c_f32_bf16 v11, s29, v96
    v_dot2c_f32_bf16 v12, s28, v97
    v_dot2c_f32_bf16 v13, s29, v97
    v_dot2c_f32_bf16 v14, s28, v98
    v_dot2c_f32_bf16 v15, s29, v98
    v_dot2c_f32_bf16 v16, s28, v99
    v_dot2c_f32_bf16 v17, s29, v99
    s_waitcnt vmcnt(6)
    v_dot2c_f32_bf16 v18, s28, v100
    v_dot2c_f32_bf16 v19, s29, v100
    v_dot2c_f32_bf16 v20, s28, v101
    v_dot2c_f32_bf16 v21, s29, v101
    v_dot2c_f32_bf16 v22, s28, v102
    v_dot2c_f32_bf16 v23, s29, v102
    v_dot2c_f32_bf16 v24, s28, v103
    v_dot2c_f32_bf16 v25, s29, v103
    s_setprio 2
    v_mad_u32_u16 v66, v29, s30, v8 op_sel:[1,0,0,0]
    buffer_load_dwordx4 v[96:99], v66, s[20:23], 0 offen sc1
    v_mad_u32_u16 v67, v49, s30, v8 op_sel:[1,0,0,0]
    buffer_load_dwordx4 v[100:103], v67, s[20:23], 0 offen sc1
    s_waitcnt vmcnt(7)
    v_dot2c_f32_bf16 v10, s28, v72
    v_dot2c_f32_bf16 v11, s29, v72
    v_dot2c_f32_bf16 v12, s28, v73
    v_dot2c_f32_bf16 v13, s29, v73
    v_dot2c_f32_bf16 v14, s28, v74
    v_dot2c_f32_bf16 v15, s29, v74
    v_dot2c_f32_bf16 v16, s28, v75
    v_dot2c_f32_bf16 v17, s29, v75
    s_waitcnt vmcnt(6)
    v_dot2c_f32_bf16 v18, s28, v76
    v_dot2c_f32_bf16 v19, s29, v76
    v_dot2c_f32_bf16 v20, s28, v77
    v_dot2c_f32_bf16 v21, s29, v77
    v_dot2c_f32_bf16 v22, s28, v78
    v_dot2c_f32_bf16 v23, s29, v78
    v_dot2c_f32_bf16 v24, s28, v79
    v_dot2c_f32_bf16 v25, s29, v79
    v_mad_u32_u16 v66, v30, s30, v8 op_sel:[0,0,0,0]
    buffer_load_dwordx4 v[72:75], v66, s[20:23], 0 offen sc1
    v_mad_u32_u16 v67, v50, s30, v8 op_sel:[0,0,0,0]
    buffer_load_dwordx4 v[76:79], v67, s[20:23], 0 offen sc1
    s_waitcnt vmcnt(7)
    v_dot2c_f32_bf16 v10, s28, v80
    v_dot2c_f32_bf16 v11, s29, v80
    v_dot2c_f32_bf16 v12, s28, v81
    v_dot2c_f32_bf16 v13, s29, v81
    v_dot2c_f32_bf16 v14, s28, v82
    v_dot2c_f32_bf16 v15, s29, v82
    v_dot2c_f32_bf16 v16, s28, v83
    v_dot2c_f32_bf16 v17, s29, v83
    s_waitcnt vmcnt(6)
    v_dot2c_f32_bf16 v18, s28, v84
    v_dot2c_f32_bf16 v19, s29, v84
    v_dot2c_f32_bf16 v20, s28, v85
    v_dot2c_f32_bf16 v21, s29, v85
    v_dot2c_f32_bf16 v22, s28, v86
    v_dot2c_f32_bf16 v23, s29, v86
    v_dot2c_f32_bf16 v24, s28, v87
    v_dot2c_f32_bf16 v25, s29, v87
    v_mad_u32_u16 v66, v30, s30, v8 op_sel:[1,0,0,0]
    buffer_load_dwordx4 v[80:83], v66, s[20:23], 0 offen sc1
    v_mad_u32_u16 v67, v50, s30, v8 op_sel:[1,0,0,0]
    buffer_load_dwordx4 v[84:87], v67, s[20:23], 0 offen sc1
    s_waitcnt vmcnt(7)
    v_dot2c_f32_bf16 v10, s28, v88
    v_dot2c_f32_bf16 v11, s29, v88
    v_dot2c_f32_bf16 v12, s28, v89
    v_dot2c_f32_bf16 v13, s29, v89
    v_dot2c_f32_bf16 v14, s28, v90
    v_dot2c_f32_bf16 v15, s29, v90
    v_dot2c_f32_bf16 v16, s28, v91
    v_dot2c_f32_bf16 v17, s29, v91
    s_waitcnt vmcnt(6)
    v_dot2c_f32_bf16 v18, s28, v92
    v_dot2c_f32_bf16 v19, s29, v92
    v_dot2c_f32_bf16 v20, s28, v93
    v_dot2c_f32_bf16 v21, s29, v93
    v_dot2c_f32_bf16 v22, s28, v94
    v_dot2c_f32_bf16 v23, s29, v94
    v_dot2c_f32_bf16 v24, s28, v95
    v_dot2c_f32_bf16 v25, s29, v95
    v_mad_u32_u16 v66, v31, s30, v8 op_sel:[0,0,0,0]
    buffer_load_dwordx4 v[88:91], v66, s[20:23], 0 offen sc1
    v_mad_u32_u16 v67, v51, s30, v8 op_sel:[0,0,0,0]
    buffer_load_dwordx4 v[92:95], v67, s[20:23], 0 offen sc1
    s_waitcnt vmcnt(7)
    v_dot2c_f32_bf16 v10, s28, v96
    v_dot2c_f32_bf16 v11, s29, v96
    v_dot2c_f32_bf16 v12, s28, v97
    v_dot2c_f32_bf16 v13, s29, v97
    v_dot2c_f32_bf16 v14, s28, v98
    v_dot2c_f32_bf16 v15, s29, v98
    v_dot2c_f32_bf16 v16, s28, v99
    v_dot2c_f32_bf16 v17, s29, v99
    s_waitcnt vmcnt(6)
    v_dot2c_f32_bf16 v18, s28, v100
    v_dot2c_f32_bf16 v19, s29, v100
    v_dot2c_f32_bf16 v20, s28, v101
    v_dot2c_f32_bf16 v21, s29, v101
    v_dot2c_f32_bf16 v22, s28, v102
    v_dot2c_f32_bf16 v23, s29, v102
    v_dot2c_f32_bf16 v24, s28, v103
    v_dot2c_f32_bf16 v25, s29, v103
    v_mad_u32_u16 v66, v31, s30, v8 op_sel:[1,0,0,0]
    buffer_load_dwordx4 v[96:99], v66, s[20:23], 0 offen sc1
    v_mad_u32_u16 v67, v51, s30, v8 op_sel:[1,0,0,0]
    buffer_load_dwordx4 v[100:103], v67, s[20:23], 0 offen sc1
    s_waitcnt vmcnt(7)
    v_dot2c_f32_bf16 v10, s28, v72
    v_dot2c_f32_bf16 v11, s29, v72
    v_dot2c_f32_bf16 v12, s28, v73
    v_dot2c_f32_bf16 v13, s29, v73
    v_dot2c_f32_bf16 v14, s28, v74
    v_dot2c_f32_bf16 v15, s29, v74
    v_dot2c_f32_bf16 v16, s28, v75
    v_dot2c_f32_bf16 v17, s29, v75
    s_waitcnt vmcnt(6)
    v_dot2c_f32_bf16 v18, s28, v76
    v_dot2c_f32_bf16 v19, s29, v76
    v_dot2c_f32_bf16 v20, s28, v77
    v_dot2c_f32_bf16 v21, s29, v77
    v_dot2c_f32_bf16 v22, s28, v78
    v_dot2c_f32_bf16 v23, s29, v78
    v_dot2c_f32_bf16 v24, s28, v79
    v_dot2c_f32_bf16 v25, s29, v79
    v_mad_u32_u16 v66, v32, s30, v8 op_sel:[0,0,0,0]
    buffer_load_dwordx4 v[72:75], v66, s[20:23], 0 offen sc1
    v_mad_u32_u16 v67, v52, s30, v8 op_sel:[0,0,0,0]
    buffer_load_dwordx4 v[76:79], v67, s[20:23], 0 offen sc1
    s_waitcnt vmcnt(7)
    v_dot2c_f32_bf16 v10, s28, v80
    v_dot2c_f32_bf16 v11, s29, v80
    v_dot2c_f32_bf16 v12, s28, v81
    v_dot2c_f32_bf16 v13, s29, v81
    v_dot2c_f32_bf16 v14, s28, v82
    v_dot2c_f32_bf16 v15, s29, v82
    v_dot2c_f32_bf16 v16, s28, v83
    v_dot2c_f32_bf16 v17, s29, v83
    s_waitcnt vmcnt(6)
    v_dot2c_f32_bf16 v18, s28, v84
    v_dot2c_f32_bf16 v19, s29, v84
    v_dot2c_f32_bf16 v20, s28, v85
    v_dot2c_f32_bf16 v21, s29, v85
    v_dot2c_f32_bf16 v22, s28, v86
    v_dot2c_f32_bf16 v23, s29, v86
    v_dot2c_f32_bf16 v24, s28, v87
    v_dot2c_f32_bf16 v25, s29, v87
    v_mad_u32_u16 v66, v32, s30, v8 op_sel:[1,0,0,0]
    buffer_load_dwordx4 v[80:83], v66, s[20:23], 0 offen sc1
    v_mad_u32_u16 v67, v52, s30, v8 op_sel:[1,0,0,0]
    buffer_load_dwordx4 v[84:87], v67, s[20:23], 0 offen sc1
    s_waitcnt vmcnt(7)
    v_dot2c_f32_bf16 v10, s28, v88
    v_dot2c_f32_bf16 v11, s29, v88
    v_dot2c_f32_bf16 v12, s28, v89
    v_dot2c_f32_bf16 v13, s29, v89
    v_dot2c_f32_bf16 v14, s28, v90
    v_dot2c_f32_bf16 v15, s29, v90
    v_dot2c_f32_bf16 v16, s28, v91
    v_dot2c_f32_bf16 v17, s29, v91
    s_waitcnt vmcnt(6)
    v_dot2c_f32_bf16 v18, s28, v92
    v_dot2c_f32_bf16 v19, s29, v92
    v_dot2c_f32_bf16 v20, s28, v93
    v_dot2c_f32_bf16 v21, s29, v93
    v_dot2c_f32_bf16 v22, s28, v94
    v_dot2c_f32_bf16 v23, s29, v94
    v_dot2c_f32_bf16 v24, s28, v95
    v_dot2c_f32_bf16 v25, s29, v95
    s_setprio 1
    v_mad_u32_u16 v66, v33, s30, v8 op_sel:[0,0,0,0]
    buffer_load_dwordx4 v[88:91], v66, s[20:23], 0 offen sc1
    v_mad_u32_u16 v67, v53, s30, v8 op_sel:[0,0,0,0]
    buffer_load_dwordx4 v[92:95], v67, s[20:23], 0 offen sc1
    s_waitcnt vmcnt(7)
    v_dot2c_f32_bf16 v10, s28, v96
    v_dot2c_f32_bf16 v11, s29, v96
    v_dot2c_f32_bf16 v12, s28, v97
    v_dot2c_f32_bf16 v13, s29, v97
    v_dot2c_f32_bf16 v14, s28, v98
    v_dot2c_f32_bf16 v15, s29, v98
    v_dot2c_f32_bf16 v16, s28, v99
    v_dot2c_f32_bf16 v17, s29, v99
    s_waitcnt vmcnt(6)
    v_dot2c_f32_bf16 v18, s28, v100
    v_dot2c_f32_bf16 v19, s29, v100
    v_dot2c_f32_bf16 v20, s28, v101
    v_dot2c_f32_bf16 v21, s29, v101
    v_dot2c_f32_bf16 v22, s28, v102
    v_dot2c_f32_bf16 v23, s29, v102
    v_dot2c_f32_bf16 v24, s28, v103
    v_dot2c_f32_bf16 v25, s29, v103
    v_mad_u32_u16 v66, v33, s30, v8 op_sel:[1,0,0,0]
    buffer_load_dwordx4 v[96:99], v66, s[20:23], 0 offen sc1
    v_mad_u32_u16 v67, v53, s30, v8 op_sel:[1,0,0,0]
    buffer_load_dwordx4 v[100:103], v67, s[20:23], 0 offen sc1
    s_waitcnt vmcnt(7)
    v_dot2c_f32_bf16 v10, s28, v72
    v_dot2c_f32_bf16 v11, s29, v72
    v_dot2c_f32_bf16 v12, s28, v73
    v_dot2c_f32_bf16 v13, s29, v73
    v_dot2c_f32_bf16 v14, s28, v74
    v_dot2c_f32_bf16 v15, s29, v74
    v_dot2c_f32_bf16 v16, s28, v75
    v_dot2c_f32_bf16 v17, s29, v75
    s_waitcnt vmcnt(6)
    v_dot2c_f32_bf16 v18, s28, v76
    v_dot2c_f32_bf16 v19, s29, v76
    v_dot2c_f32_bf16 v20, s28, v77
    v_dot2c_f32_bf16 v21, s29, v77
    v_dot2c_f32_bf16 v22, s28, v78
    v_dot2c_f32_bf16 v23, s29, v78
    v_dot2c_f32_bf16 v24, s28, v79
    v_dot2c_f32_bf16 v25, s29, v79
    v_mad_u32_u16 v66, v34, s30, v8 op_sel:[0,0,0,0]
    buffer_load_dwordx4 v[72:75], v66, s[20:23], 0 offen sc1
    v_mad_u32_u16 v67, v54, s30, v8 op_sel:[0,0,0,0]
    buffer_load_dwordx4 v[76:79], v67, s[20:23], 0 offen sc1
    s_waitcnt vmcnt(7)
    v_dot2c_f32_bf16 v10, s28, v80
    v_dot2c_f32_bf16 v11, s29, v80
    v_dot2c_f32_bf16 v12, s28, v81
    v_dot2c_f32_bf16 v13, s29, v81
    v_dot2c_f32_bf16 v14, s28, v82
    v_dot2c_f32_bf16 v15, s29, v82
    v_dot2c_f32_bf16 v16, s28, v83
    v_dot2c_f32_bf16 v17, s29, v83
    s_waitcnt vmcnt(6)
    v_dot2c_f32_bf16 v18, s28, v84
    v_dot2c_f32_bf16 v19, s29, v84
    v_dot2c_f32_bf16 v20, s28, v85
    v_dot2c_f32_bf16 v21, s29, v85
    v_dot2c_f32_bf16 v22, s28, v86
    v_dot2c_f32_bf16 v23, s29, v86
    v_dot2c_f32_bf16 v24, s28, v87
    v_dot2c_f32_bf16 v25, s29, v87
    v_mad_u32_u16 v66, v34, s30, v8 op_sel:[1,0,0,0]
    buffer_load_dwordx4 v[80:83], v66, s[20:23], 0 offen sc1
    v_mad_u32_u16 v67, v54, s30, v8 op_sel:[1,0,0,0]
    buffer_load_dwordx4 v[84:87], v67, s[20:23], 0 offen sc1
    s_waitcnt vmcnt(7)
    v_dot2c_f32_bf16 v10, s28, v88
    v_dot2c_f32_bf16 v11, s29, v88
    v_dot2c_f32_bf16 v12, s28, v89
    v_dot2c_f32_bf16 v13, s29, v89
    v_dot2c_f32_bf16 v14, s28, v90
    v_dot2c_f32_bf16 v15, s29, v90
    v_dot2c_f32_bf16 v16, s28, v91
    v_dot2c_f32_bf16 v17, s29, v91
    s_waitcnt vmcnt(6)
    v_dot2c_f32_bf16 v18, s28, v92
    v_dot2c_f32_bf16 v19, s29, v92
    v_dot2c_f32_bf16 v20, s28, v93
    v_dot2c_f32_bf16 v21, s29, v93
    v_dot2c_f32_bf16 v22, s28, v94
    v_dot2c_f32_bf16 v23, s29, v94
    v_dot2c_f32_bf16 v24, s28, v95
    v_dot2c_f32_bf16 v25, s29, v95
    v_mad_u32_u16 v66, v35, s30, v8 op_sel:[0,0,0,0]
    buffer_load_dwordx4 v[88:91], v66, s[20:23], 0 offen sc1
    v_mad_u32_u16 v67, v55, s30, v8 op_sel:[0,0,0,0]
    buffer_load_dwordx4 v[92:95], v67, s[20:23], 0 offen sc1
    s_waitcnt vmcnt(7)
    v_dot2c_f32_bf16 v10, s28, v96
    v_dot2c_f32_bf16 v11, s29, v96
    v_dot2c_f32_bf16 v12, s28, v97
    v_dot2c_f32_bf16 v13, s29, v97
    v_dot2c_f32_bf16 v14, s28, v98
    v_dot2c_f32_bf16 v15, s29, v98
    v_dot2c_f32_bf16 v16, s28, v99
    v_dot2c_f32_bf16 v17, s29, v99
    s_waitcnt vmcnt(6)
    v_dot2c_f32_bf16 v18, s28, v100
    v_dot2c_f32_bf16 v19, s29, v100
    v_dot2c_f32_bf16 v20, s28, v101
    v_dot2c_f32_bf16 v21, s29, v101
    v_dot2c_f32_bf16 v22, s28, v102
    v_dot2c_f32_bf16 v23, s29, v102
    v_dot2c_f32_bf16 v24, s28, v103
    v_dot2c_f32_bf16 v25, s29, v103
    v_mad_u32_u16 v66, v35, s30, v8 op_sel:[1,0,0,0]
    buffer_load_dwordx4 v[96:99], v66, s[20:23], 0 offen sc1
    v_mad_u32_u16 v67, v55, s30, v8 op_sel:[1,0,0,0]
    buffer_load_dwordx4 v[100:103], v67, s[20:23], 0 offen sc1
    s_waitcnt vmcnt(7)
    v_dot2c_f32_bf16 v10, s28, v72
    v_dot2c_f32_bf16 v11, s29, v72
    v_dot2c_f32_bf16 v12, s28, v73
    v_dot2c_f32_bf16 v13, s29, v73
    v_dot2c_f32_bf16 v14, s28, v74
    v_dot2c_f32_bf16 v15, s29, v74
    v_dot2c_f32_bf16 v16, s28, v75
    v_dot2c_f32_bf16 v17, s29, v75
    s_waitcnt vmcnt(6)
    v_dot2c_f32_bf16 v18, s28, v76
    v_dot2c_f32_bf16 v19, s29, v76
    v_dot2c_f32_bf16 v20, s28, v77
    v_dot2c_f32_bf16 v21, s29, v77
    v_dot2c_f32_bf16 v22, s28, v78
    v_dot2c_f32_bf16 v23, s29, v78
    v_dot2c_f32_bf16 v24, s28, v79
    v_dot2c_f32_bf16 v25, s29, v79
    v_mad_u32_u16 v66, v36, s30, v8 op_sel:[0,0,0,0]
    buffer_load_dwordx4 v[72:75], v66, s[20:23], 0 offen sc1
    v_mad_u32_u16 v67, v56, s30, v8 op_sel:[0,0,0,0]
    buffer_load_dwordx4 v[76:79], v67, s[20:23], 0 offen sc1
    s_waitcnt vmcnt(7)
    v_dot2c_f32_bf16 v10, s28, v80
    v_dot2c_f32_bf16 v11, s29, v80
    v_dot2c_f32_bf16 v12, s28, v81
    v_dot2c_f32_bf16 v13, s29, v81
    v_dot2c_f32_bf16 v14, s28, v82
    v_dot2c_f32_bf16 v15, s29, v82
    v_dot2c_f32_bf16 v16, s28, v83
    v_dot2c_f32_bf16 v17, s29, v83
    s_waitcnt vmcnt(6)
    v_dot2c_f32_bf16 v18, s28, v84
    v_dot2c_f32_bf16 v19, s29, v84
    v_dot2c_f32_bf16 v20, s28, v85
    v_dot2c_f32_bf16 v21, s29, v85
    v_dot2c_f32_bf16 v22, s28, v86
    v_dot2c_f32_bf16 v23, s29, v86
    v_dot2c_f32_bf16 v24, s28, v87
    v_dot2c_f32_bf16 v25, s29, v87
    s_setprio 0
    v_mad_u32_u16 v66, v36, s30, v8 op_sel:[1,0,0,0]
    buffer_load_dwordx4 v[80:83], v66, s[20:23], 0 offen sc1
    v_mad_u32_u16 v67, v56, s30, v8 op_sel:[1,0,0,0]
    buffer_load_dwordx4 v[84:87], v67, s[20:23], 0 offen sc1
    s_waitcnt vmcnt(7)
    v_dot2c_f32_bf16 v10, s28, v88
    v_dot2c_f32_bf16 v11, s29, v88
    v_dot2c_f32_bf16 v12, s28, v89
    v_dot2c_f32_bf16 v13, s29, v89
    v_dot2c_f32_bf16 v14, s28, v90
    v_dot2c_f32_bf16 v15, s29, v90
    v_dot2c_f32_bf16 v16, s28, v91
    v_dot2c_f32_bf16 v17, s29, v91
    s_waitcnt vmcnt(6)
    v_dot2c_f32_bf16 v18, s28, v92
    v_dot2c_f32_bf16 v19, s29, v92
    v_dot2c_f32_bf16 v20, s28, v93
    v_dot2c_f32_bf16 v21, s29, v93
    v_dot2c_f32_bf16 v22, s28, v94
    v_dot2c_f32_bf16 v23, s29, v94
    v_dot2c_f32_bf16 v24, s28, v95
    v_dot2c_f32_bf16 v25, s29, v95
    v_mad_u32_u16 v66, v37, s30, v8 op_sel:[0,0,0,0]
    buffer_load_dwordx4 v[88:91], v66, s[20:23], 0 offen sc1
    v_mad_u32_u16 v67, v57, s30, v8 op_sel:[0,0,0,0]
    buffer_load_dwordx4 v[92:95], v67, s[20:23], 0 offen sc1
    s_waitcnt vmcnt(7)
    v_dot2c_f32_bf16 v10, s28, v96
    v_dot2c_f32_bf16 v11, s29, v96
    v_dot2c_f32_bf16 v12, s28, v97
    v_dot2c_f32_bf16 v13, s29, v97
    v_dot2c_f32_bf16 v14, s28, v98
    v_dot2c_f32_bf16 v15, s29, v98
    v_dot2c_f32_bf16 v16, s28, v99
    v_dot2c_f32_bf16 v17, s29, v99
    s_waitcnt vmcnt(6)
    v_dot2c_f32_bf16 v18, s28, v100
    v_dot2c_f32_bf16 v19, s29, v100
    v_dot2c_f32_bf16 v20, s28, v101
    v_dot2c_f32_bf16 v21, s29, v101
    v_dot2c_f32_bf16 v22, s28, v102
    v_dot2c_f32_bf16 v23, s29, v102
    v_dot2c_f32_bf16 v24, s28, v103
    v_dot2c_f32_bf16 v25, s29, v103
    v_mad_u32_u16 v66, v37, s30, v8 op_sel:[1,0,0,0]
    buffer_load_dwordx4 v[96:99], v66, s[20:23], 0 offen sc1
    v_mad_u32_u16 v67, v57, s30, v8 op_sel:[1,0,0,0]
    buffer_load_dwordx4 v[100:103], v67, s[20:23], 0 offen sc1
    s_waitcnt vmcnt(7)
    v_dot2c_f32_bf16 v10, s28, v72
    v_dot2c_f32_bf16 v11, s29, v72
    v_dot2c_f32_bf16 v12, s28, v73
    v_dot2c_f32_bf16 v13, s29, v73
    v_dot2c_f32_bf16 v14, s28, v74
    v_dot2c_f32_bf16 v15, s29, v74
    v_dot2c_f32_bf16 v16, s28, v75
    v_dot2c_f32_bf16 v17, s29, v75
    s_waitcnt vmcnt(6)
    v_dot2c_f32_bf16 v18, s28, v76
    v_dot2c_f32_bf16 v19, s29, v76
    v_dot2c_f32_bf16 v20, s28, v77
    v_dot2c_f32_bf16 v21, s29, v77
    v_dot2c_f32_bf16 v22, s28, v78
    v_dot2c_f32_bf16 v23, s29, v78
    v_dot2c_f32_bf16 v24, s28, v79
    v_dot2c_f32_bf16 v25, s29, v79
    v_mad_u32_u16 v66, v38, s30, v8 op_sel:[0,0,0,0]
    buffer_load_dwordx4 v[72:75], v66, s[20:23], 0 offen sc1
    v_mad_u32_u16 v67, v58, s30, v8 op_sel:[0,0,0,0]
    buffer_load_dwordx4 v[76:79], v67, s[20:23], 0 offen sc1
    s_waitcnt vmcnt(7)
    v_dot2c_f32_bf16 v10, s28, v80
    v_dot2c_f32_bf16 v11, s29, v80
    v_dot2c_f32_bf16 v12, s28, v81
    v_dot2c_f32_bf16 v13, s29, v81
    v_dot2c_f32_bf16 v14, s28, v82
    v_dot2c_f32_bf16 v15, s29, v82
    v_dot2c_f32_bf16 v16, s28, v83
    v_dot2c_f32_bf16 v17, s29, v83
    s_waitcnt vmcnt(6)
    v_dot2c_f32_bf16 v18, s28, v84
    v_dot2c_f32_bf16 v19, s29, v84
    v_dot2c_f32_bf16 v20, s28, v85
    v_dot2c_f32_bf16 v21, s29, v85
    v_dot2c_f32_bf16 v22, s28, v86
    v_dot2c_f32_bf16 v23, s29, v86
    v_dot2c_f32_bf16 v24, s28, v87
    v_dot2c_f32_bf16 v25, s29, v87
    v_mad_u32_u16 v66, v38, s30, v8 op_sel:[1,0,0,0]
    buffer_load_dwordx4 v[80:83], v66, s[20:23], 0 offen sc1
    v_mad_u32_u16 v67, v58, s30, v8 op_sel:[1,0,0,0]
    buffer_load_dwordx4 v[84:87], v67, s[20:23], 0 offen sc1
    s_waitcnt vmcnt(7)
    v_dot2c_f32_bf16 v10, s28, v88
    v_dot2c_f32_bf16 v11, s29, v88
    v_dot2c_f32_bf16 v12, s28, v89
    v_dot2c_f32_bf16 v13, s29, v89
    v_dot2c_f32_bf16 v14, s28, v90
    v_dot2c_f32_bf16 v15, s29, v90
    v_dot2c_f32_bf16 v16, s28, v91
    v_dot2c_f32_bf16 v17, s29, v91
    s_waitcnt vmcnt(6)
    v_dot2c_f32_bf16 v18, s28, v92
    v_dot2c_f32_bf16 v19, s29, v92
    v_dot2c_f32_bf16 v20, s28, v93
    v_dot2c_f32_bf16 v21, s29, v93
    v_dot2c_f32_bf16 v22, s28, v94
    v_dot2c_f32_bf16 v23, s29, v94
    v_dot2c_f32_bf16 v24, s28, v95
    v_dot2c_f32_bf16 v25, s29, v95
    v_mad_u32_u16 v66, v39, s30, v8 op_sel:[0,0,0,0]
    buffer_load_dwordx4 v[88:91], v66, s[20:23], 0 offen sc1
    v_mad_u32_u16 v67, v59, s30, v8 op_sel:[0,0,0,0]
    buffer_load_dwordx4 v[92:95], v67, s[20:23], 0 offen sc1
    s_waitcnt vmcnt(7)
    v_dot2c_f32_bf16 v10, s28, v96
    v_dot2c_f32_bf16 v11, s29, v96
    v_dot2c_f32_bf16 v12, s28, v97
    v_dot2c_f32_bf16 v13, s29, v97
    v_dot2c_f32_bf16 v14, s28, v98
    v_dot2c_f32_bf16 v15, s29, v98
    v_dot2c_f32_bf16 v16, s28, v99
    v_dot2c_f32_bf16 v17, s29, v99
    s_waitcnt vmcnt(6)
    v_dot2c_f32_bf16 v18, s28, v100
    v_dot2c_f32_bf16 v19, s29, v100
    v_dot2c_f32_bf16 v20, s28, v101
    v_dot2c_f32_bf16 v21, s29, v101
    v_dot2c_f32_bf16 v22, s28, v102
    v_dot2c_f32_bf16 v23, s29, v102
    v_dot2c_f32_bf16 v24, s28, v103
    v_dot2c_f32_bf16 v25, s29, v103
    v_mad_u32_u16 v66, v39, s30, v8 op_sel:[1,0,0,0]
    buffer_load_dwordx4 v[96:99], v66, s[20:23], 0 offen sc1
    v_mad_u32_u16 v67, v59, s30, v8 op_sel:[1,0,0,0]
    buffer_load_dwordx4 v[100:103], v67, s[20:23], 0 offen sc1
    s_waitcnt vmcnt(7)
    v_dot2c_f32_bf16 v10, s28, v72
    v_dot2c_f32_bf16 v11, s29, v72
    v_dot2c_f32_bf16 v12, s28, v73
    v_dot2c_f32_bf16 v13, s29, v73
    v_dot2c_f32_bf16 v14, s28, v74
    v_dot2c_f32_bf16 v15, s29, v74
    v_dot2c_f32_bf16 v16, s28, v75
    v_dot2c_f32_bf16 v17, s29, v75
    s_waitcnt vmcnt(6)
    v_dot2c_f32_bf16 v18, s28, v76
    v_dot2c_f32_bf16 v19, s29, v76
    v_dot2c_f32_bf16 v20, s28, v77
    v_dot2c_f32_bf16 v21, s29, v77
    v_dot2c_f32_bf16 v22, s28, v78
    v_dot2c_f32_bf16 v23, s29, v78
    v_dot2c_f32_bf16 v24, s28, v79
    v_dot2c_f32_bf16 v25, s29, v79
    s_waitcnt vmcnt(5)
    v_dot2c_f32_bf16 v10, s28, v80
    v_dot2c_f32_bf16 v11, s29, v80
    v_dot2c_f32_bf16 v12, s28, v81
    v_dot2c_f32_bf16 v13, s29, v81
    v_dot2c_f32_bf16 v14, s28, v82
    v_dot2c_f32_bf16 v15, s29, v82
    v_dot2c_f32_bf16 v16, s28, v83
    v_dot2c_f32_bf16 v17, s29, v83
    s_waitcnt vmcnt(4)
    v_dot2c_f32_bf16 v18, s28, v84
    v_dot2c_f32_bf16 v19, s29, v84
    v_dot2c_f32_bf16 v20, s28, v85
    v_dot2c_f32_bf16 v21, s29, v85
    v_dot2c_f32_bf16 v22, s28, v86
    v_dot2c_f32_bf16 v23, s29, v86
    v_dot2c_f32_bf16 v24, s28, v87
    v_dot2c_f32_bf16 v25, s29, v87
    s_waitcnt vmcnt(3)
    v_dot2c_f32_bf16 v10, s28, v88
    v_dot2c_f32_bf16 v11, s29, v88
    v_dot2c_f32_bf16 v12, s28, v89
    v_dot2c_f32_bf16 v13, s29, v89
    v_dot2c_f32_bf16 v14, s28, v90
    v_dot2c_f32_bf16 v15, s29, v90
    v_dot2c_f32_bf16 v16, s28, v91
    v_dot2c_f32_bf16 v17, s29, v91
    s_waitcnt vmcnt(2)
    v_dot2c_f32_bf16 v18, s28, v92
    v_dot2c_f32_bf16 v19, s29, v92
    v_dot2c_f32_bf16 v20, s28, v93
    v_dot2c_f32_bf16 v21, s29, v93
    v_dot2c_f32_bf16 v22, s28, v94
    v_dot2c_f32_bf16 v23, s29, v94
    v_dot2c_f32_bf16 v24, s28, v95
    v_dot2c_f32_bf16 v25, s29, v95
    s_waitcnt vmcnt(1)
    v_dot2c_f32_bf16 v10, s28, v96
    v_dot2c_f32_bf16 v11, s29, v96
    v_dot2c_f32_bf16 v12, s28, v97
    v_dot2c_f32_bf16 v13, s29, v97
    v_dot2c_f32_bf16 v14, s28, v98
    v_dot2c_f32_bf16 v15, s29, v98
    v_dot2c_f32_bf16 v16, s28, v99
    v_dot2c_f32_bf16 v17, s29, v99
    s_waitcnt vmcnt(0)
    v_dot2c_f32_bf16 v18, s28, v100
    v_dot2c_f32_bf16 v19, s29, v100
    v_dot2c_f32_bf16 v20, s28, v101
    v_dot2c_f32_bf16 v21, s29, v101
    v_dot2c_f32_bf16 v22, s28, v102
    v_dot2c_f32_bf16 v23, s29, v102
    v_dot2c_f32_bf16 v24, s28, v103
    v_dot2c_f32_bf16 v25, s29, v103
    s_branch hop_fin
hop_w15:
    s_setprio 3
    v_mad_u32_u16 v66, v26, s30, v8 op_sel:[0,0,0,0]
    buffer_load_dwordx4 v[72:75], v66, s[20:23], 0 offen sc1
    v_mad_u32_u16 v67, v46, s30, v8 op_sel:[0,0,0,0]
    buffer_load_dwordx4 v[76:79], v67, s[20:23], 0 offen sc1
    v_mad_u32_u16 v66, v26, s30, v8 op_sel:[1,0,0,0]
    buffer_load_dwordx4 v[80:83], v66, s[20:23], 0 offen sc1
    v_mad_u32_u16 v67, v46, s30, v8 op_sel:[1,0,0,0]
    buffer_load_dwordx4 v[84:87], v67, s[20:23], 0 offen sc1
    v_mad_u32_u16 v66, v27, s30, v8 op_sel:[0,0,0,0]
    buffer_load_dwordx4 v[88:91], v66, s[20:23], 0 offen sc1
    v_mad_u32_u16 v67, v47, s30, v8 op_sel:[0,0,0,0]
    buffer_load_dwordx4 v[92:95], v67, s[20:23], 0 offen sc1
    v_mad_u32_u16 v66, v27, s30, v8 op_sel:[1,0,0,0]
    buffer_load_dwordx4 v[96:99], v66, s[20:23], 0 offen sc1
    v_mad_u32_u16 v67, v47, s30, v8 op_sel:[1,0,0,0]
    buffer_load_dwordx4 v[100:103], v67, s[20:23], 0 offen sc1
    s_waitcnt vmcnt(7)
    v_dot2c_f32_bf16 v10, s28, v72
    v_dot2c_f32_bf16 v11, s29, v72
    v_dot2c_f32_bf16 v12, s28, v73
    v_dot2c_f32_bf16 v13, s29, v73
    v_dot2c_f32_bf16 v14, s28, v74
    v_dot2c_f32_bf16 v15, s29, v74
    v_dot2c_f32_bf16 v16, s28, v75
    v_dot2c_f32_bf16 v17, s29, v75
    s_waitcnt vmcnt(6)
    v_dot2c_f32_bf16 v18, s28, v76
    v_dot2c_f32_bf16 v19, s29, v76
    v_dot2c_f32_bf16 v20, s28, v77
    v_dot2c_f32_bf16 v21, s29, v77
    v_dot2c_f32_bf16 v22, s28, v78
    v_dot2c_f32_bf16 v23, s29, v78
    v_dot2c_f32_bf16 v24, s28, v79
    v_dot2c_f32_bf16 v25, s29, v79
    v_mad_u32_u16 v66, v28, s30, v8 op_sel:[0,0,0,0]
    buffer_load_dwordx4 v[72:75], v66, s[20:23], 0 offen sc1
    v_mad_u32_u16 v67, v48, s30, v8 op_sel:[0,0,0,0]
    buffer_load_dwordx4 v[76:79], v67, s[20:23], 0 offen sc1
    s_waitcnt vmcnt(7)
    v_dot2c_f32_bf16 v10, s28, v80
    v_dot2c_f32_bf16 v11, s29, v80
    v_dot2c_f32_bf16 v12, s28, v81
    v_dot2c_f32_bf16 v13, s29, v81
    v_dot2c_f32_bf16 v14, s28, v82
    v_dot2c_f32_bf16 v15, s29, v82
    v_dot2c_f32_bf16 v16, s28, v83
    v_dot2c_f32_bf16 v17, s29, v83
    s_waitcnt vmcnt(6)
    v_dot2c_f32_bf16 v18, s28, v84
    v_dot2c_f32_bf16 v19, s29, v84
    v_dot2c_f32_bf16 v20, s28, v85
    v_dot2c_f32_bf16 v21, s29, v85
    v_dot2c_f32_bf16 v22, s28, v86
    v_dot2c_f32_bf16 v23, s29, v86
    v_dot2c_f32_bf16 v24, s28, v87
    v_dot2c_f32_bf16 v25, s29, v87
    v_mad_u32_u16 v66, v28, s30, v8 op_sel:[1,0,0,0]
    buffer_load_dwordx4 v[80:83], v66, s[20:23], 0 offen sc1
    v_mad_u32_u16 v67, v48, s30, v8 op_sel:[1,0,0,0]
    buffer_load_dwordx4 v[84:87], v67, s[20:23], 0 offen sc1
    s_waitcnt vmcnt(7)
    v_dot2c_f32_bf16 v10, s28, v88
    v_dot2c_f32_bf16 v11, s29, v88
    v_dot2c_f32_bf16 v12, s28, v89
    v_dot2c_f32_bf16 v13, s29, v89
    v_dot2c_f32_bf16 v14, s28, v90
    v_dot2c_f32_bf16 v15, s29, v90
    v_dot2c_f32_bf16 v16, s28, v91
    v_dot2c_f32_bf16 v17, s29, v91
    s_waitcnt vmcnt(6)
    v_dot2c_f32_bf16 v18, s28, v92
    v_dot2c_f32_bf16 v19, s29, v92
    v_dot2c_f32_bf16 v20, s28, v93
    v_dot2c_f32_bf16 v21, s29, v93
    v_dot2c_f32_bf16 v22, s28, v94
    v_dot2c_f32_bf16 v23, s29, v94
    v_dot2c_f32_bf16 v24, s28, v95
    v_dot2c_f32_bf16 v25, s29, v95
    v_mad_u32_u16 v66, v29, s30, v8 op_sel:[0,0,0,0]
    buffer_load_dwordx4 v[88:91], v66, s[20:23], 0 offen sc1
    v_mad_u32_u16 v67, v49, s30, v8 op_sel:[0,0,0,0]
    buffer_load_dwordx4 v[92:95], v67, s[20:23], 0 offen sc1
    s_waitcnt vmcnt(7)
    v_dot2c_f32_bf16 v10, s28, v96
    v_dot2c_f32_bf16 v11, s29, v96
    v_dot2c_f32_bf16 v12, s28, v97
    v_dot2c_f32_bf16 v13, s29, v97
    v_dot2c_f32_bf16 v14, s28, v98
    v_dot2c_f32_bf16 v15, s29, v98
    v_dot2c_f32_bf16 v16, s28, v99
    v_dot2c_f32_bf16 v17, s29, v99
    s_waitcnt vmcnt(6)
    v_dot2c_f32_bf16 v18, s28, v100
    v_dot2c_f32_bf16 v19, s29, v100
    v_dot2c_f32_bf16 v20, s28, v101
    v_dot2c_f32_bf16 v21, s29, v101
    v_dot2c_f32_bf16 v22, s28, v102
    v_dot2c_f32_bf16 v23, s29, v102
    v_dot2c_f32_bf16 v24, s28, v103
    v_dot2c_f32_bf16 v25, s29, v103
    v_mad_u32_u16 v66, v29, s30, v8 op_sel:[1,0,0,0]
    buffer_load_dwordx4 v[96:99], v66, s[20:23], 0 offen sc1
    v_mad_u32_u16 v67, v49, s30, v8 op_sel:[1,0,0,0]
    buffer_load_dwordx4 v[100:103], v67, s[20:23], 0 offen sc1
    s_waitcnt vmcnt(7)
    v_dot2c_f32_bf16 v10, s28, v72
    v_dot2c_f32_bf16 v11, s29, v72
    v_dot2c_f32_bf16 v12, s28, v73
    v_dot2c_f32_bf16 v13, s29, v73
    v_dot2c_f32_bf16 v14, s28, v74
    v_dot2c_f32_bf16 v15, s29, v74
    v_dot2c_f32_bf16 v16, s28, v75
    v_dot2c_f32_bf16 v17, s29, v75
    s_waitcnt vmcnt(6)
    v_dot2c_f32_bf16 v18, s28, v76
    v_dot2c_f32_bf16 v19, s29, v76
    v_dot2c_f32_bf16 v20, s28, v77
    v_dot2c_f32_bf16 v21, s29, v77
    v_dot2c_f32_bf16 v22, s28, v78
    v_dot2c_f32_bf16 v23, s29, v78
    v_dot2c_f32_bf16 v24, s28, v79
    v_dot2c_f32_bf16 v25, s29, v79
    s_setprio 2
    v_mad_u32_u16 v66, v30, s30, v8 op_sel:[0,0,0,0]
    buffer_load_dwordx4 v[72:75], v66, s[20:23], 0 offen sc1
    v_mad_u32_u16 v67, v50, s30, v8 op_sel:[0,0,0,0]
    buffer_load_dwordx4 v[76:79], v67, s[20:23], 0 offen sc1
    s_waitcnt vmcnt(7)
    v_dot2c_f32_bf16 v10, s28, v80
    v_dot2c_f32_bf16 v11, s29, v80
    v_dot2c_f32_bf16 v12, s28, v81
    v_dot2c_f32_bf16 v13, s29, v81
    v_dot2c_f32_bf16 v14, s28, v82
    v_dot2c_f32_bf16 v15, s29, v82
    v_dot2c_f32_bf16 v16, s28, v83
    v_dot2c_f32_bf16 v17, s29, v83
    s_waitcnt vmcnt(6)
    v_dot2c_f32_bf16 v18, s28, v84
    v_dot2c_f32_bf16 v19, s29, v84
    v_dot2c_f32_bf16 v20, s28, v85
    v_dot2c_f32_bf16 v21, s29, v85
    v_dot2c_f32_bf16 v22, s28, v86
    v_dot2c_f32_bf16 v23, s29, v86
    v_dot2c_f32_bf16 v24, s28, v87
    v_dot2c_f32_bf16 v25, s29, v87
    v_mad_u32_u16 v66, v30, s30, v8 op_sel:[1,0,0,0]
    buffer_load_dwordx4 v[80:83], v66, s[20:23], 0 offen sc1
    v_mad_u32_u16 v67, v50, s30, v8 op_sel:[1,0,0,0]
    buffer_load_dwordx4 v[84:87], v67, s[20:23], 0 offen sc1
    s_waitcnt vmcnt(7)
    v_dot2c_f32_bf16 v10, s28, v88
    v_dot2c_f32_bf16 v11, s29, v88
    v_dot2c_f32_bf16 v12, s28, v89
    v_dot2c_f32_bf16 v13, s29, v89
    v_dot2c_f32_bf16 v14, s28, v90
    v_dot2c_f32_bf16 v15, s29, v90
    v_dot2c_f32_bf16 v16, s28, v91
    v_dot2c_f32_bf16 v17, s29, v91
    s_waitcnt vmcnt(6)
    v_dot2c_f32_bf16 v18, s28, v92
    v_dot2c_f32_bf16 v19, s29, v92
    v_dot2c_f32_bf16 v20, s28, v93
    v_dot2c_f32_bf16 v21, s29, v93
    v_dot2c_f32_bf16 v22, s28, v94
    v_dot2c_f32_bf16 v23, s29, v94
    v_dot2c_f32_bf16 v24, s28, v95
    v_dot2c_f32_bf16 v25, s29, v95
    v_mad_u32_u16 v66, v31, s30, v8 op_sel:[0,0,0,0]
    buffer_load_dwordx4 v[88:91], v66, s[20:23], 0 offen sc1
    v_mad_u32_u16 v67, v51, s30, v8 op_sel:[0,0,0,0]
    buffer_load_dwordx4 v[92:95], v67, s[20:23], 0 offen sc1
    s_waitcnt vmcnt(7)
    v_dot2c_f32_bf16 v10, s28, v96
    v_dot2c_f32_bf16 v11, s29, v96
    v_dot2c_f32_bf16 v12, s28, v97
    v_dot2c_f32_bf16 v13, s29, v97
    v_dot2c_f32_bf16 v14, s28, v98
    v_dot2c_f32_bf16 v15, s29, v98
    v_dot2c_f32_bf16 v16, s28, v99
    v_dot2c_f32_bf16 v17, s29, v99
    s_waitcnt vmcnt(6)
    v_dot2c_f32_bf16 v18, s28, v100
    v_dot2c_f32_bf16 v19, s29, v100
    v_dot2c_f32_bf16 v20, s28, v101
    v_dot2c_f32_bf16 v21, s29, v101
    v_dot2c_f32_bf16 v22, s28, v102
    v_dot2c_f32_bf16 v23, s29, v102
    v_dot2c_f32_bf16 v24, s28, v103
    v_dot2c_f32_bf16 v25, s29, v103
    v_mad_u32_u16 v66, v31, s30, v8 op_sel:[1,0,0,0]
    buffer_load_dwordx4 v[96:99], v66, s[20:23], 0 offen sc1
    v_mad_u32_u16 v67, v51, s30, v8 op_sel:[1,0,0,0]
    buffer_load_dwordx4 v[100:103], v67, s[20:23], 0 offen sc1
    s_waitcnt vmcnt(7)
    v_dot2c_f32_bf16 v10, s28, v72
    v_dot2c_f32_bf16 v11, s29, v72
    v_dot2c_f32_bf16 v12, s28, v73
    v_dot2c_f32_bf16 v13, s29, v73
    v_dot2c_f32_bf16 v14, s28, v74
    v_dot2c_f32_bf16 v15, s29, v74
    v_dot2c_f32_bf16 v16, s28, v75
    v_dot2c_f32_bf16 v17, s29, v75
    s_waitcnt vmcnt(6)
    v_dot2c_f32_bf16 v18, s28, v76
    v_dot2c_f32_bf16 v19, s29, v76
    v_dot2c_f32_bf16 v20, s28, v77
    v_dot2c_f32_bf16 v21, s29, v77
    v_dot2c_f32_bf16 v22, s28, v78
    v_dot2c_f32_bf16 v23, s29, v78
    v_dot2c_f32_bf16 v24, s28, v79
    v_dot2c_f32_bf16 v25, s29, v79
    v_mad_u32_u16 v66, v32, s30, v8 op_sel:[0,0,0,0]
    buffer_load_dwordx4 v[72:75], v66, s[20:23], 0 offen sc1
    v_mad_u32_u16 v67, v52, s30, v8 op_sel:[0,0,0,0]
    buffer_load_dwordx4 v[76:79], v67, s[20:23], 0 offen sc1
    s_waitcnt vmcnt(7)
    v_dot2c_f32_bf16 v10, s28, v80
    v_dot2c_f32_bf16 v11, s29, v80
    v_dot2c_f32_bf16 v12, s28, v81
    v_dot2c_f32_bf16 v13, s29, v81
    v_dot2c_f32_bf16 v14, s28, v82
    v_dot2c_f32_bf16 v15, s29, v82
    v_dot2c_f32_bf16 v16, s28, v83
    v_dot2c_f32_bf16 v17, s29, v83
    s_waitcnt vmcnt(6)
    v_dot2c_f32_bf16 v18, s28, v84
    v_dot2c_f32_bf16 v19, s29, v84
    v_dot2c_f32_bf16 v20, s28, v85
    v_dot2c_f32_bf16 v21, s29, v85
    v_dot2c_f32_bf16 v22, s28, v86
    v_dot2c_f32_bf16 v23, s29, v86
    v_dot2c_f32_bf16 v24, s28, v87
    v_dot2c_f32_bf16 v25, s29, v87
    v_mad_u32_u16 v66, v32, s30, v8 op_sel:[1,0,0,0]
    buffer_load_dwordx4 v[80:83], v66, s[20:23], 0 offen sc1
    v_mad_u32_u16 v67, v52, s30, v8 op_sel:[1,0,0,0]
    buffer_load_dwordx4 v[84:87], v67, s[20:23], 0 offen sc1
    s_waitcnt vmcnt(7)
    v_dot2c_f32_bf16 v10, s28, v88
    v_dot2c_f32_bf16 v11, s29, v88
    v_dot2c_f32_bf16 v12, s28, v89
    v_dot2c_f32_bf16 v13, s29, v89
    v_dot2c_f32_bf16 v14, s28, v90
    v_dot2c_f32_bf16 v15, s29, v90
    v_dot2c_f32_bf16 v16, s28, v91
    v_dot2c_f32_bf16 v17, s29, v91
    s_waitcnt vmcnt(6)
    v_dot2c_f32_bf16 v18, s28, v92
    v_dot2c_f32_bf16 v19, s29, v92
    v_dot2c_f32_bf16 v20, s28, v93
    v_dot2c_f32_bf16 v21, s29, v93
    v_dot2c_f32_bf16 v22, s28, v94
    v_dot2c_f32_bf16 v23, s29, v94
    v_dot2c_f32_bf16 v24, s28, v95
    v_dot2c_f32_bf16 v25, s29, v95
    v_mad_u32_u16 v66, v33, s30, v8 op_sel:[0,0,0,0]
    buffer_load_dwordx4 v[88:91], v66, s[20:23], 0 offen sc1
    v_mad_u32_u16 v67, v53, s30, v8 op_sel:[0,0,0,0]
    buffer_load_dwordx4 v[92:95], v67, s[20:23], 0 offen sc1
    s_waitcnt vmcnt(7)
    v_dot2c_f32_bf16 v10, s28, v96
    v_dot2c_f32_bf16 v11, s29, v96
    v_dot2c_f32_bf16 v12, s28, v97
    v_dot2c_f32_bf16 v13, s29, v97
    v_dot2c_f32_bf16 v14, s28, v98
    v_dot2c_f32_bf16 v15, s29, v98
    v_dot2c_f32_bf16 v16, s28, v99
    v_dot2c_f32_bf16 v17, s29, v99
    s_waitcnt vmcnt(6)
    v_dot2c_f32_bf16 v18, s28, v100
    v_dot2c_f32_bf16 v19, s29, v100
    v_dot2c_f32_bf16 v20, s28, v101
    v_dot2c_f32_bf16 v21, s29, v101
    v_dot2c_f32_bf16 v22, s28, v102
    v_dot2c_f32_bf16 v23, s29, v102
    v_dot2c_f32_bf16 v24, s28, v103
    v_dot2c_f32_bf16 v25, s29, v103
    s_setprio 1
    v_mad_u32_u16 v66, v33, s30, v8 op_sel:[1,0,0,0]
    buffer_load_dwordx4 v[96:99], v66, s[20:23], 0 offen sc1
    v_mad_u32_u16 v67, v53, s30, v8 op_sel:[1,0,0,0]
    buffer_load_dwordx4 v[100:103], v67, s[20:23], 0 offen sc1
    s_waitcnt vmcnt(7)
    v_dot2c_f32_bf16 v10, s28, v72
    v_dot2c_f32_bf16 v11, s29, v72
    v_dot2c_f32_bf16 v12, s28, v73
    v_dot2c_f32_bf16 v13, s29, v73
    v_dot2c_f32_bf16 v14, s28, v74
    v_dot2c_f32_bf16 v15, s29, v74
    v_dot2c_f32_bf16 v16, s28, v75
    v_dot2c_f32_bf16 v17, s29, v75
    s_waitcnt vmcnt(6)
    v_dot2c_f32_bf16 v18, s28, v76
    v_dot2c_f32_bf16 v19, s29, v76
    v_dot2c_f32_bf16 v20, s28, v77
    v_dot2c_f32_bf16 v21, s29, v77
    v_dot2c_f32_bf16 v22, s28, v78
    v_dot2c_f32_bf16 v23, s29, v78
    v_dot2c_f32_bf16 v24, s28, v79
    v_dot2c_f32_bf16 v25, s29, v79
    v_mad_u32_u16 v66, v34, s30, v8 op_sel:[0,0,0,0]
    buffer_load_dwordx4 v[72:75], v66, s[20:23], 0 offen sc1
    v_mad_u32_u16 v67, v54, s30, v8 op_sel:[0,0,0,0]
    buffer_load_dwordx4 v[76:79], v67, s[20:23], 0 offen sc1
    s_waitcnt vmcnt(7)
    v_dot2c_f32_bf16 v10, s28, v80
    v_dot2c_f32_bf16 v11, s29, v80
    v_dot2c_f32_bf16 v12, s28, v81
    v_dot2c_f32_bf16 v13, s29, v81
    v_dot2c_f32_bf16 v14, s28, v82
    v_dot2c_f32_bf16 v15, s29, v82
    v_dot2c_f32_bf16 v16, s28, v83
    v_dot2c_f32_bf16 v17, s29, v83
    s_waitcnt vmcnt(6)
    v_dot2c_f32_bf16 v18, s28, v84
    v_dot2c_f32_bf16 v19, s29, v84
    v_dot2c_f32_bf16 v20, s28, v85
    v_dot2c_f32_bf16 v21, s29, v85
    v_dot2c_f32_bf16 v22, s28, v86
    v_dot2c_f32_bf16 v23, s29, v86
    v_dot2c_f32_bf16 v24, s28, v87
    v_dot2c_f32_bf16 v25, s29, v87
    v_mad_u32_u16 v66, v34, s30, v8 op_sel:[1,0,0,0]
    buffer_load_dwordx4 v[80:83], v66, s[20:23], 0 offen sc1
    v_mad_u32_u16 v67, v54, s30, v8 op_sel:[1,0,0,0]
    buffer_load_dwordx4 v[84:87], v67, s[20:23], 0 offen sc1
    s_waitcnt vmcnt(7)
    v_dot2c_f32_bf16 v10, s28, v88
    v_dot2c_f32_bf16 v11, s29, v88
    v_dot2c_f32_bf16 v12, s28, v89
    v_dot2c_f32_bf16 v13, s29, v89
    v_dot2c_f32_bf16 v14, s28, v90
    v_dot2c_f32_bf16 v15, s29, v90
    v_dot2c_f32_bf16 v16, s28, v91
    v_dot2c_f32_bf16 v17, s29, v91
    s_waitcnt vmcnt(6)
    v_dot2c_f32_bf16 v18, s28, v92
    v_dot2c_f32_bf16 v19, s29, v92
    v_dot2c_f32_bf16 v20, s28, v93
    v_dot2c_f32_bf16 v21, s29, v93
    v_dot2c_f32_bf16 v22, s28, v94
    v_dot2c_f32_bf16 v23, s29, v94
    v_dot2c_f32_bf16 v24, s28, v95
    v_dot2c_f32_bf16 v25, s29, v95
    v_mad_u32_u16 v66, v35, s30, v8 op_sel:[0,0,0,0]
    buffer_load_dwordx4 v[88:91], v66, s[20:23], 0 offen sc1
    v_mad_u32_u16 v67, v55, s30, v8 op_sel:[0,0,0,0]
    buffer_load_dwordx4 v[92:95], v67, s[20:23], 0 offen sc1
    s_waitcnt vmcnt(7)
    v_dot2c_f32_bf16 v10, s28, v96
    v_dot2c_f32_bf16 v11, s29, v96
    v_dot2c_f32_bf16 v12, s28, v97
    v_dot2c_f32_bf16 v13, s29, v97
    v_dot2c_f32_bf16 v14, s28, v98
    v_dot2c_f32_bf16 v15, s29, v98
    v_dot2c_f32_bf16 v16, s28, v99
    v_dot2c_f32_bf16 v17, s29, v99
    s_waitcnt vmcnt(6)
    v_dot2c_f32_bf16 v18, s28, v100
    v_dot2c_f32_bf16 v19, s29, v100
    v_dot2c_f32_bf16 v20, s28, v101
    v_dot2c_f32_bf16 v21, s29, v101
    v_dot2c_f32_bf16 v22, s28, v102
    v_dot2c_f32_bf16 v23, s29, v102
    v_dot2c_f32_bf16 v24, s28, v103
    v_dot2c_f32_bf16 v25, s29, v103
    v_mad_u32_u16 v66, v35, s30, v8 op_sel:[1,0,0,0]
    buffer_load_dwordx4 v[96:99], v66, s[20:23], 0 offen sc1
    v_mad_u32_u16 v67, v55, s30, v8 op_sel:[1,0,0,0]
    buffer_load_dwordx4 v[100:103], v67, s[20:23], 0 offen sc1
    s_waitcnt vmcnt(7)
    v_dot2c_f32_bf16 v10, s28, v72
    v_dot2c_f32_bf16 v11, s29, v72
    v_dot2c_f32_bf16 v12, s28, v73
    v_dot2c_f32_bf16 v13, s29, v73
    v_dot2c_f32_bf16 v14, s28, v74
    v_dot2c_f32_bf16 v15, s29, v74
    v_dot2c_f32_bf16 v16, s28, v75
    v_dot2c_f32_bf16 v17, s29, v75
    s_waitcnt vmcnt(6)
    v_dot2c_f32_bf16 v18, s28, v76
    v_dot2c_f32_bf16 v19, s29, v76
    v_dot2c_f32_bf16 v20, s28, v77
    v_dot2c_f32_bf16 v21, s29, v77
    v_dot2c_f32_bf16 v22, s28, v78
    v_dot2c_f32_bf16 v23, s29, v78
    v_dot2c_f32_bf16 v24, s28, v79
    v_dot2c_f32_bf16 v25, s29, v79
    v_mad_u32_u16 v66, v36, s30, v8 op_sel:[0,0,0,0]
    buffer_load_dwordx4 v[72:75], v66, s[20:23], 0 offen sc1
    v_mad_u32_u16 v67, v56, s30, v8 op_sel:[0,0,0,0]
    buffer_load_dwordx4 v[76:79], v67, s[20:23], 0 offen sc1
    s_waitcnt vmcnt(7)
    v_dot2c_f32_bf16 v10, s28, v80
    v_dot2c_f32_bf16 v11, s29, v80
    v_dot2c_f32_bf16 v12, s28, v81
    v_dot2c_f32_bf16 v13, s29, v81
    v_dot2c_f32_bf16 v14, s28, v82
    v_dot2c_f32_bf16 v15, s29, v82
    v_dot2c_f32_bf16 v16, s28, v83
    v_dot2c_f32_bf16 v17, s29, v83
    s_waitcnt vmcnt(6)
    v_dot2c_f32_bf16 v18, s28, v84
    v_dot2c_f32_bf16 v19, s29, v84
    v_dot2c_f32_bf16 v20, s28, v85
    v_dot2c_f32_bf16 v21, s29, v85
    v_dot2c_f32_bf16 v22, s28, v86
    v_dot2c_f32_bf16 v23, s29, v86
    v_dot2c_f32_bf16 v24, s28, v87
    v_dot2c_f32_bf16 v25, s29, v87
    v_mad_u32_u16 v66, v36, s30, v8 op_sel:[1,0,0,0]
    buffer_load_dwordx4 v[80:83], v66, s[20:23], 0 offen sc1
    v_mad_u32_u16 v67, v56, s30, v8 op_sel:[1,0,0,0]
    buffer_load_dwordx4 v[84:87], v67, s[20:23], 0 offen sc1
    s_waitcnt vmcnt(7)
    v_dot2c_f32_bf16 v10, s28, v88
    v_dot2c_f32_bf16 v11, s29, v88
    v_dot2c_f32_bf16 v12, s28, v89
    v_dot2c_f32_bf16 v13, s29, v89
    v_dot2c_f32_bf16 v14, s28, v90
    v_dot2c_f32_bf16 v15, s29, v90
    v_dot2c_f32_bf16 v16, s28, v91
    v_dot2c_f32_bf16 v17, s29, v91
    s_waitcnt vmcnt(6)
    v_dot2c_f32_bf16 v18, s28, v92
    v_dot2c_f32_bf16 v19, s29, v92
    v_dot2c_f32_bf16 v20, s28, v93
    v_dot2c_f32_bf16 v21, s29, v93
    v_dot2c_f32_bf16 v22, s28, v94
    v_dot2c_f32_bf16 v23, s29, v94
    v_dot2c_f32_bf16 v24, s28, v95
    v_dot2c_f32_bf16 v25, s29, v95
    v_mad_u32_u16 v66, v37, s30, v8 op_sel:[0,0,0,0]
    buffer_load_dwordx4 v[88:91], v66, s[20:23], 0 offen sc1
    v_mad_u32_u16 v67, v57, s30, v8 op_sel:[0,0,0,0]
    buffer_load_dwordx4 v[92:95], v67, s[20:23], 0 offen sc1
    s_waitcnt vmcnt(7)
    v_dot2c_f32_bf16 v10, s28, v96
    v_dot2c_f32_bf16 v11, s29, v96
    v_dot2c_f32_bf16 v12, s28, v97
    v_dot2c_f32_bf16 v13, s29, v97
    v_dot2c_f32_bf16 v14, s28, v98
    v_dot2c_f32_bf16 v15, s29, v98
    v_dot2c_f32_bf16 v16, s28, v99
    v_dot2c_f32_bf16 v17, s29, v99
    s_waitcnt vmcnt(6)
    v_dot2c_f32_bf16 v18, s28, v100
    v_dot2c_f32_bf16 v19, s29, v100
    v_dot2c_f32_bf16 v20, s28, v101
    v_dot2c_f32_bf16 v21, s29, v101
    v_dot2c_f32_bf16 v22, s28, v102
    v_dot2c_f32_bf16 v23, s29, v102
    v_dot2c_f32_bf16 v24, s28, v103
    v_dot2c_f32_bf16 v25, s29, v103
    s_setprio 0
    v_mad_u32_u16 v66, v37, s30, v8 op_sel:[1,0,0,0]
    buffer_load_dwordx4 v[96:99], v66, s[20:23], 0 offen sc1
    v_mad_u32_u16 v67, v57, s30, v8 op_sel:[1,0,0,0]
    buffer_load_dwordx4 v[100:103], v67, s[20:23], 0 offen sc1
    s_waitcnt vmcnt(7)
    v_dot2c_f32_bf16 v10, s28, v72
    v_dot2c_f32_bf16 v11, s29, v72
    v_dot2c_f32_bf16 v12, s28, v73
    v_dot2c_f32_bf16 v13, s29, v73
    v_dot2c_f32_bf16 v14, s28, v74
    v_dot2c_f32_bf16 v15, s29, v74
    v_dot2c_f32_bf16 v16, s28, v75
    v_dot2c_f32_bf16 v17, s29, v75
    s_waitcnt vmcnt(6)
    v_dot2c_f32_bf16 v18, s28, v76
    v_dot2c_f32_bf16 v19, s29, v76
    v_dot2c_f32_bf16 v20, s28, v77
    v_dot2c_f32_bf16 v21, s29, v77
    v_dot2c_f32_bf16 v22, s28, v78
    v_dot2c_f32_bf16 v23, s29, v78
    v_dot2c_f32_bf16 v24, s28, v79
    v_dot2c_f32_bf16 v25, s29, v79
    v_mad_u32_u16 v66, v38, s30, v8 op_sel:[0,0,0,0]
    buffer_load_dwordx4 v[72:75], v66, s[20:23], 0 offen sc1
    v_mad_u32_u16 v67, v58, s30, v8 op_sel:[0,0,0,0]
    buffer_load_dwordx4 v[76:79], v67, s[20:23], 0 offen sc1
    s_waitcnt vmcnt(7)
    v_dot2c_f32_bf16 v10, s28, v80
    v_dot2c_f32_bf16 v11, s29, v80
    v_dot2c_f32_bf16 v12, s28, v81
    v_dot2c_f32_bf16 v13, s29, v81
    v_dot2c_f32_bf16 v14, s28, v82
    v_dot2c_f32_bf16 v15, s29, v82
    v_dot2c_f32_bf16 v16, s28, v83
    v_dot2c_f32_bf16 v17, s29, v83
    s_waitcnt vmcnt(6)
    v_dot2c_f32_bf16 v18, s28, v84
    v_dot2c_f32_bf16 v19, s29, v84
    v_dot2c_f32_bf16 v20, s28, v85
    v_dot2c_f32_bf16 v21, s29, v85
    v_dot2c_f32_bf16 v22, s28, v86
    v_dot2c_f32_bf16 v23, s29, v86
    v_dot2c_f32_bf16 v24, s28, v87
    v_dot2c_f32_bf16 v25, s29, v87
    v_mad_u32_u16 v66, v38, s30, v8 op_sel:[1,0,0,0]
    buffer_load_dwordx4 v[80:83], v66, s[20:23], 0 offen sc1
    v_mad_u32_u16 v67, v58, s30, v8 op_sel:[1,0,0,0]
    buffer_load_dwordx4 v[84:87], v67, s[20:23], 0 offen sc1
    s_waitcnt vmcnt(7)
    v_dot2c_f32_bf16 v10, s28, v88
    v_dot2c_f32_bf16 v11, s29, v88
    v_dot2c_f32_bf16 v12, s28, v89
    v_dot2c_f32_bf16 v13, s29, v89
    v_dot2c_f32_bf16 v14, s28, v90
    v_dot2c_f32_bf16 v15, s29, v90
    v_dot2c_f32_bf16 v16, s28, v91
    v_dot2c_f32_bf16 v17, s29, v91
    s_waitcnt vmcnt(6)
    v_dot2c_f32_bf16 v18, s28, v92
    v_dot2c_f32_bf16 v19, s29, v92
    v_dot2c_f32_bf16 v20, s28, v93
    v_dot2c_f32_bf16 v21, s29, v93
    v_dot2c_f32_bf16 v22, s28, v94
    v_dot2c_f32_bf16 v23, s29, v94
    v_dot2c_f32_bf16 v24, s28, v95
    v_dot2c_f32_bf16 v25, s29, v95
    v_mad_u32_u16 v66, v39, s30, v8 op_sel:[0,0,0,0]
    buffer_load_dwordx4 v[88:91], v66, s[20:23], 0 offen sc1
    v_mad_u32_u16 v67, v59, s30, v8 op_sel:[0,0,0,0]
    buffer_load_dwordx4 v[92:95], v67, s[20:23], 0 offen sc1
    s_waitcnt vmcnt(7)
    v_dot2c_f32_bf16 v10, s28, v96
    v_dot2c_f32_bf16 v11, s29, v96
    v_dot2c_f32_bf16 v12, s28, v97
    v_dot2c_f32_bf16 v13, s29, v97
    v_dot2c_f32_bf16 v14, s28, v98
    v_dot2c_f32_bf16 v15, s29, v98
    v_dot2c_f32_bf16 v16, s28, v99
    v_dot2c_f32_bf16 v17, s29, v99
    s_waitcnt vmcnt(6)
    v_dot2c_f32_bf16 v18, s28, v100
    v_dot2c_f32_bf16 v19, s29, v100
    v_dot2c_f32_bf16 v20, s28, v101
    v_dot2c_f32_bf16 v21, s29, v101
    v_dot2c_f32_bf16 v22, s28, v102
    v_dot2c_f32_bf16 v23, s29, v102
    v_dot2c_f32_bf16 v24, s28, v103
    v_dot2c_f32_bf16 v25, s29, v103
    v_mad_u32_u16 v66, v39, s30, v8 op_sel:[1,0,0,0]
    buffer_load_dwordx4 v[96:99], v66, s[20:23], 0 offen sc1
    v_mad_u32_u16 v67, v59, s30, v8 op_sel:[1,0,0,0]
    buffer_load_dwordx4 v[100:103], v67, s[20:23], 0 offen sc1
    s_waitcnt vmcnt(7)
    v_dot2c_f32_bf16 v10, s28, v72
    v_dot2c_f32_bf16 v11, s29, v72
    v_dot2c_f32_bf16 v12, s28, v73
    v_dot2c_f32_bf16 v13, s29, v73
    v_dot2c_f32_bf16 v14, s28, v74
    v_dot2c_f32_bf16 v15, s29, v74
    v_dot2c_f32_bf16 v16, s28, v75
    v_dot2c_f32_bf16 v17, s29, v75
    s_waitcnt vmcnt(6)
    v_dot2c_f32_bf16 v18, s28, v76
    v_dot2c_f32_bf16 v19, s29, v76
    v_dot2c_f32_bf16 v20, s28, v77
    v_dot2c_f32_bf16 v21, s29, v77
    v_dot2c_f32_bf16 v22, s28, v78
    v_dot2c_f32_bf16 v23, s29, v78
    v_dot2c_f32_bf16 v24, s28, v79
    v_dot2c_f32_bf16 v25, s29, v79
    v_mad_u32_u16 v66, v40, s30, v8 op_sel:[0,0,0,0]
    buffer_load_dwordx4 v[72:75], v66, s[20:23], 0 offen sc1
    v_mad_u32_u16 v67, v60, s30, v8 op_sel:[0,0,0,0]
    buffer_load_dwordx4 v[76:79], v67, s[20:23], 0 offen sc1
    s_waitcnt vmcnt(7)
    v_dot2c_f32_bf16 v10, s28, v80
    v_dot2c_f32_bf16 v11, s29, v80
    v_dot2c_f32_bf16 v12, s28, v81
    v_dot2c_f32_bf16 v13, s29, v81
    v_dot2c_f32_bf16 v14, s28, v82
    v_dot2c_f32_bf16 v15, s29, v82
    v_dot2c_f32_bf16 v16, s28, v83
    v_dot2c_f32_bf16 v17, s29, v83
    s_waitcnt vmcnt(6)
    v_dot2c_f32_bf16 v18, s28, v84
    v_dot2c_f32_bf16 v19, s29, v84
    v_dot2c_f32_bf16 v20, s28, v85
    v_dot2c_f32_bf16 v21, s29, v85
    v_dot2c_f32_bf16 v22, s28, v86
    v_dot2c_f32_bf16 v23, s29, v86
    v_dot2c_f32_bf16 v24, s28, v87
    v_dot2c_f32_bf16 v25, s29, v87
    v_mad_u32_u16 v66, v40, s30, v8 op_sel:[1,0,0,0]
    buffer_load_dwordx4 v[80:83], v66, s[20:23], 0 offen sc1
    v_mad_u32_u16 v67, v60, s30, v8 op_sel:[1,0,0,0]
    buffer_load_dwordx4 v[84:87], v67, s[20:23], 0 offen sc1
    s_waitcnt vmcnt(7)
    v_dot2c_f32_bf16 v10, s28, v88
    v_dot2c_f32_bf16 v11, s29, v88
    v_dot2c_f32_bf16 v12, s28, v89
    v_dot2c_f32_bf16 v13, s29, v89
    v_dot2c_f32_bf16 v14, s28, v90
    v_dot2c_f32_bf16 v15, s29, v90
    v_dot2c_f32_bf16 v16, s28, v91
    v_dot2c_f32_bf16 v17, s29, v91
    s_waitcnt vmcnt(6)
    v_dot2c_f32_bf16 v18, s28, v92
    v_dot2c_f32_bf16 v19, s29, v92
    v_dot2c_f32_bf16 v20, s28, v93
    v_dot2c_f32_bf16 v21, s29, v93
    v_dot2c_f32_bf16 v22, s28, v94
    v_dot2c_f32_bf16 v23, s29, v94
    v_dot2c_f32_bf16 v24, s28, v95
    v_dot2c_f32_bf16 v25, s29, v95
    s_waitcnt vmcnt(5)
    v_dot2c_f32_bf16 v10, s28, v96
    v_dot2c_f32_bf16 v11, s29, v96
    v_dot2c_f32_bf16 v12, s28, v97
    v_dot2c_f32_bf16 v13, s29, v97
    v_dot2c_f32_bf16 v14, s28, v98
    v_dot2c_f32_bf16 v15, s29, v98
    v_dot2c_f32_bf16 v16, s28, v99
    v_dot2c_f32_bf16 v17, s29, v99
    s_waitcnt vmcnt(4)
    v_dot2c_f32_bf16 v18, s28, v100
    v_dot2c_f32_bf16 v19, s29, v100
    v_dot2c_f32_bf16 v20, s28, v101
    v_dot2c_f32_bf16 v21, s29, v101
    v_dot2c_f32_bf16 v22, s28, v102
    v_dot2c_f32_bf16 v23, s29, v102
    v_dot2c_f32_bf16 v24, s28, v103
    v_dot2c_f32_bf16 v25, s29, v103
    s_waitcnt vmcnt(3)
    v_dot2c_f32_bf16 v10, s28, v72
    v_dot2c_f32_bf16 v11, s29, v72
    v_dot2c_f32_bf16 v12, s28, v73
    v_dot2c_f32_bf16 v13, s29, v73
    v_dot2c_f32_bf16 v14, s28, v74
    v_dot2c_f32_bf16 v15, s29, v74
    v_dot2c_f32_bf16 v16, s28, v75
    v_dot2c_f32_bf16 v17, s29, v75
    s_waitcnt vmcnt(2)
    v_dot2c_f32_bf16 v18, s28, v76
    v_dot2c_f32_bf16 v19, s29, v76
    v_dot2c_f32_bf16 v20, s28, v77
    v_dot2c_f32_bf16 v21, s29, v77
    v_dot2c_f32_bf16 v22, s28, v78
    v_dot2c_f32_bf16 v23, s29, v78
    v_dot2c_f32_bf16 v24, s28, v79
    v_dot2c_f32_bf16 v25, s29, v79
    s_waitcnt vmcnt(1)
    v_dot2c_f32_bf16 v10, s28, v80
    v_dot2c_f32_bf16 v11, s29, v80
    v_dot2c_f32_bf16 v12, s28, v81
    v_dot2c_f32_bf16 v13, s29, v81
    v_dot2c_f32_bf16 v14, s28, v82
    v_dot2c_f32_bf16 v15, s29, v82
    v_dot2c_f32_bf16 v16, s28, v83
    v_dot2c_f32_bf16 v17, s29, v83
    s_waitcnt vmcnt(0)
    v_dot2c_f32_bf16 v18, s28, v84
    v_dot2c_f32_bf16 v19, s29, v84
    v_dot2c_f32_bf16 v20, s28, v85
    v_dot2c_f32_bf16 v21, s29, v85
    v_dot2c_f32_bf16 v22, s28, v86
    v_dot2c_f32_bf16 v23, s29, v86
    v_dot2c_f32_bf16 v24, s28, v87
    v_dot2c_f32_bf16 v25, s29, v87
    s_branch hop_fin
hop_w16:
    s_setprio 3
    v_mad_u32_u16 v66, v26, s30, v8 op_sel:[0,0,0,0]
    buffer_load_dwordx4 v[72:75], v66, s[20:23], 0 offen sc1
    v_mad_u32_u16 v67, v46, s30, v8 op_sel:[0,0,0,0]
    buffer_load_dwordx4 v[76:79], v67, s[20:23], 0 offen sc1
    v_mad_u32_u16 v66, v26, s30, v8 op_sel:[1,0,0,0]
    buffer_load_dwordx4 v[80:83], v66, s[20:23], 0 offen sc1
    v_mad_u32_u16 v67, v46, s30, v8 op_sel:[1,0,0,0]
    buffer_load_dwordx4 v[84:87], v67, s[20:23], 0 offen sc1
    v_mad_u32_u16 v66, v27, s30, v8 op_sel:[0,0,0,0]
    buffer_load_dwordx4 v[88:91], v66, s[20:23], 0 offen sc1
    v_mad_u32_u16 v67, v47, s30, v8 op_sel:[0,0,0,0]
    buffer_load_dwordx4 v[92:95], v67, s[20:23], 0 offen sc1
    v_mad_u32_u16 v66, v27, s30, v8 op_sel:[1,0,0,0]
    buffer_load_dwordx4 v[96:99], v66, s[20:23], 0 offen sc1
    v_mad_u32_u16 v67, v47, s30, v8 op_sel:[1,0,0,0]
    buffer_load_dwordx4 v[100:103], v67, s[20:23], 0 offen sc1
    s_waitcnt vmcnt(7)
    v_dot2c_f32_bf16 v10, s28, v72
    v_dot2c_f32_bf16 v11, s29, v72
    v_dot2c_f32_bf16 v12, s28, v73
    v_dot2c_f32_bf16 v13, s29, v73
    v_dot2c_f32_bf16 v14, s28, v74
    v_dot2c_f32_bf16 v15, s29, v74
    v_dot2c_f32_bf16 v16, s28, v75
    v_dot2c_f32_bf16 v17, s29, v75
    s_waitcnt vmcnt(6)
    v_dot2c_f32_bf16 v18, s28, v76
    v_dot2c_f32_bf16 v19, s29, v76
    v_dot2c_f32_bf16 v20, s28, v77
    v_dot2c_f32_bf16 v21, s29, v77
    v_dot2c_f32_bf16 v22, s28, v78
    v_dot2c_f32_bf16 v23, s29, v78
    v_dot2c_f32_bf16 v24, s28, v79
    v_dot2c_f32_bf16 v25, s29, v79
    v_mad_u32_u16 v66, v28, s30, v8 op_sel:[0,0,0,0]
    buffer_load_dwordx4 v[72:75], v66, s[20:23], 0 offen sc1
    v_mad_u32_u16 v67, v48, s30, v8 op_sel:[0,0,0,0]
    buffer_load_dwordx4 v[76:79], v67, s[20:23], 0 offen sc1
    s_waitcnt vmcnt(7)
    v_dot2c_f32_bf16 v10, s28, v80
    v_dot2c_f32_bf16 v11, s29, v80
    v_dot2c_f32_bf16 v12, s28, v81
    v_dot2c_f32_bf16 v13, s29, v81
    v_dot2c_f32_bf16 v14, s28, v82
    v_dot2c_f32_bf16 v15, s29, v82
    v_dot2c_f32_bf16 v16, s28, v83
    v_dot2c_f32_bf16 v17, s29, v83
    s_waitcnt vmcnt(6)
    v_dot2c_f32_bf16 v18, s28, v84
    v_dot2c_f32_bf16 v19, s29, v84
    v_dot2c_f32_bf16 v20, s28, v85
    v_dot2c_f32_bf16 v21, s29, v85
    v_dot2c_f32_bf16 v22, s28, v86
    v_dot2c_f32_bf16 v23, s29, v86
    v_dot2c_f32_bf16 v24, s28, v87
    v_dot2c_f32_bf16 v25, s29, v87
    v_mad_u32_u16 v66, v28, s30, v8 op_sel:[1,0,0,0]
    buffer_load_dwordx4 v[80:83], v66, s[20:23], 0 offen sc1
    v_mad_u32_u16 v67, v48, s30, v8 op_sel:[1,0,0,0]
    buffer_load_dwordx4 v[84:87], v67, s[20:23], 0 offen sc1
    s_waitcnt vmcnt(7)
    v_dot2c_f32_bf16 v10, s28, v88
    v_dot2c_f32_bf16 v11, s29, v88
    v_dot2c_f32_bf16 v12, s28, v89
    v_dot2c_f32_bf16 v13, s29, v89
    v_dot2c_f32_bf16 v14, s28, v90
    v_dot2c_f32_bf16 v15, s29, v90
    v_dot2c_f32_bf16 v16, s28, v91
    v_dot2c_f32_bf16 v17, s29, v91
    s_waitcnt vmcnt(6)
    v_dot2c_f32_bf16 v18, s28, v92
    v_dot2c_f32_bf16 v19, s29, v92
    v_dot2c_f32_bf16 v20, s28, v93
    v_dot2c_f32_bf16 v21, s29, v93
    v_dot2c_f32_bf16 v22, s28, v94
    v_dot2c_f32_bf16 v23, s29, v94
    v_dot2c_f32_bf16 v24, s28, v95
    v_dot2c_f32_bf16 v25, s29, v95
    v_mad_u32_u16 v66, v29, s30, v8 op_sel:[0,0,0,0]
    buffer_load_dwordx4 v[88:91], v66, s[20:23], 0 offen sc1
    v_mad_u32_u16 v67, v49, s30, v8 op_sel:[0,0,0,0]
    buffer_load_dwordx4 v[92:95], v67, s[20:23], 0 offen sc1
    s_waitcnt vmcnt(7)
    v_dot2c_f32_bf16 v10, s28, v96
    v_dot2c_f32_bf16 v11, s29, v96
    v_dot2c_f32_bf16 v12, s28, v97
    v_dot2c_f32_bf16 v13, s29, v97
    v_dot2c_f32_bf16 v14, s28, v98
    v_dot2c_f32_bf16 v15, s29, v98
    v_dot2c_f32_bf16 v16, s28, v99
    v_dot2c_f32_bf16 v17, s29, v99
    s_waitcnt vmcnt(6)
    v_dot2c_f32_bf16 v18, s28, v100
    v_dot2c_f32_bf16 v19, s29, v100
    v_dot2c_f32_bf16 v20, s28, v101
    v_dot2c_f32_bf16 v21, s29, v101
    v_dot2c_f32_bf16 v22, s28, v102
    v_dot2c_f32_bf16 v23, s29, v102
    v_dot2c_f32_bf16 v24, s28, v103
    v_dot2c_f32_bf16 v25, s29, v103
    v_mad_u32_u16 v66, v29, s30, v8 op_sel:[1,0,0,0]
    buffer_load_dwordx4 v[96:99], v66, s[20:23], 0 offen sc1
    v_mad_u32_u16 v67, v49, s30, v8 op_sel:[1,0,0,0]
    buffer_load_dwordx4 v[100:103], v67, s[20:23], 0 offen sc1
    s_waitcnt vmcnt(7)
    v_dot2c_f32_bf16 v10, s28, v72
    v_dot2c_f32_bf16 v11, s29, v72
    v_dot2c_f32_bf16 v12, s28, v73
    v_dot2c_f32_bf16 v13, s29, v73
    v_dot2c_f32_bf16 v14, s28, v74
    v_dot2c_f32_bf16 v15, s29, v74
    v_dot2c_f32_bf16 v16, s28, v75
    v_dot2c_f32_bf16 v17, s29, v75
    s_waitcnt vmcnt(6)
    v_dot2c_f32_bf16 v18, s28, v76
    v_dot2c_f32_bf16 v19, s29, v76
    v_dot2c_f32_bf16 v20, s28, v77
    v_dot2c_f32_bf16 v21, s29, v77
    v_dot2c_f32_bf16 v22, s28, v78
    v_dot2c_f32_bf16 v23, s29, v78
    v_dot2c_f32_bf16 v24, s28, v79
    v_dot2c_f32_bf16 v25, s29, v79
    s_setprio 2
    v_mad_u32_u16 v66, v30, s30, v8 op_sel:[0,0,0,0]
    buffer_load_dwordx4 v[72:75], v66, s[20:23], 0 offen sc1
    v_mad_u32_u16 v67, v50, s30, v8 op_sel:[0,0,0,0]
    buffer_load_dwordx4 v[76:79], v67, s[20:23], 0 offen sc1
    s_waitcnt vmcnt(7)
    v_dot2c_f32_bf16 v10, s28, v80
    v_dot2c_f32_bf16 v11, s29, v80
    v_dot2c_f32_bf16 v12, s28, v81
    v_dot2c_f32_bf16 v13, s29, v81
    v_dot2c_f32_bf16 v14, s28, v82
    v_dot2c_f32_bf16 v15, s29, v82
    v_dot2c_f32_bf16 v16, s28, v83
    v_dot2c_f32_bf16 v17, s29, v83
    s_waitcnt vmcnt(6)
    v_dot2c_f32_bf16 v18, s28, v84
    v_dot2c_f32_bf16 v19, s29, v84
    v_dot2c_f32_bf16 v20, s28, v85
    v_dot2c_f32_bf16 v21, s29, v85
    v_dot2c_f32_bf16 v22, s28, v86
    v_dot2c_f32_bf16 v23, s29, v86
    v_dot2c_f32_bf16 v24, s28, v87
    v_dot2c_f32_bf16 v25, s29, v87
    v_mad_u32_u16 v66, v30, s30, v8 op_sel:[1,0,0,0]
    buffer_load_dwordx4 v[80:83], v66, s[20:23], 0 offen sc1
    v_mad_u32_u16 v67, v50, s30, v8 op_sel:[1,0,0,0]
    buffer_load_dwordx4 v[84:87], v67, s[20:23], 0 offen sc1
    s_waitcnt vmcnt(7)
    v_dot2c_f32_bf16 v10, s28, v88
    v_dot2c_f32_bf16 v11, s29, v88
    v_dot2c_f32_bf16 v12, s28, v89
    v_dot2c_f32_bf16 v13, s29, v89
    v_dot2c_f32_bf16 v14, s28, v90
    v_dot2c_f32_bf16 v15, s29, v90
    v_dot2c_f32_bf16 v16, s28, v91
    v_dot2c_f32_bf16 v17, s29, v91
    s_waitcnt vmcnt(6)
    v_dot2c_f32_bf16 v18, s28, v92
    v_dot2c_f32_bf16 v19, s29, v92
    v_dot2c_f32_bf16 v20, s28, v93
    v_dot2c_f32_bf16 v21, s29, v93
    v_dot2c_f32_bf16 v22, s28, v94
    v_dot2c_f32_bf16 v23, s29, v94
    v_dot2c_f32_bf16 v24, s28, v95
    v_dot2c_f32_bf16 v25, s29, v95
    v_mad_u32_u16 v66, v31, s30, v8 op_sel:[0,0,0,0]
    buffer_load_dwordx4 v[88:91], v66, s[20:23], 0 offen sc1
    v_mad_u32_u16 v67, v51, s30, v8 op_sel:[0,0,0,0]
    buffer_load_dwordx4 v[92:95], v67, s[20:23], 0 offen sc1
    s_waitcnt vmcnt(7)
    v_dot2c_f32_bf16 v10, s28, v96
    v_dot2c_f32_bf16 v11, s29, v96
    v_dot2c_f32_bf16 v12, s28, v97
    v_dot2c_f32_bf16 v13, s29, v97
    v_dot2c_f32_bf16 v14, s28, v98
    v_dot2c_f32_bf16 v15, s29, v98
    v_dot2c_f32_bf16 v16, s28, v99
    v_dot2c_f32_bf16 v17, s29, v99
    s_waitcnt vmcnt(6)
    v_dot2c_f32_bf16 v18, s28, v100
    v_dot2c_f32_bf16 v19, s29, v100
    v_dot2c_f32_bf16 v20, s28, v101
    v_dot2c_f32_bf16 v21, s29, v101
    v_dot2c_f32_bf16 v22, s28, v102
    v_dot2c_f32_bf16 v23, s29, v102
    v_dot2c_f32_bf16 v24, s28, v103
    v_dot2c_f32_bf16 v25, s29, v103
    v_mad_u32_u16 v66, v31, s30, v8 op_sel:[1,0,0,0]
    buffer_load_dwordx4 v[96:99], v66, s[20:23], 0 offen sc1
    v_mad_u32_u16 v67, v51, s30, v8 op_sel:[1,0,0,0]
    buffer_load_dwordx4 v[100:103], v67, s[20:23], 0 offen sc1
    s_waitcnt vmcnt(7)
    v_dot2c_f32_bf16 v10, s28, v72
    v_dot2c_f32_bf16 v11, s29, v72
    v_dot2c_f32_bf16 v12, s28, v73
    v_dot2c_f32_bf16 v13, s29, v73
    v_dot2c_f32_bf16 v14, s28, v74
    v_dot2c_f32_bf16 v15, s29, v74
    v_dot2c_f32_bf16 v16, s28, v75
    v_dot2c_f32_bf16 v17, s29, v75
    s_waitcnt vmcnt(6)
    v_dot2c_f32_bf16 v18, s28, v76
    v_dot2c_f32_bf16 v19, s29, v76
    v_dot2c_f32_bf16 v20, s28, v77
    v_dot2c_f32_bf16 v21, s29, v77
    v_dot2c_f32_bf16 v22, s28, v78
    v_dot2c_f32_bf16 v23, s29, v78
    v_dot2c_f32_bf16 v24, s28, v79
    v_dot2c_f32_bf16 v25, s29, v79
    v_mad_u32_u16 v66, v32, s30, v8 op_sel:[0,0,0,0]
    buffer_load_dwordx4 v[72:75], v66, s[20:23], 0 offen sc1
    v_mad_u32_u16 v67, v52, s30, v8 op_sel:[0,0,0,0]
    buffer_load_dwordx4 v[76:79], v67, s[20:23], 0 offen sc1
    s_waitcnt vmcnt(7)
    v_dot2c_f32_bf16 v10, s28, v80
    v_dot2c_f32_bf16 v11, s29, v80
    v_dot2c_f32_bf16 v12, s28, v81
    v_dot2c_f32_bf16 v13, s29, v81
    v_dot2c_f32_bf16 v14, s28, v82
    v_dot2c_f32_bf16 v15, s29, v82
    v_dot2c_f32_bf16 v16, s28, v83
    v_dot2c_f32_bf16 v17, s29, v83
    s_waitcnt vmcnt(6)
    v_dot2c_f32_bf16 v18, s28, v84
    v_dot2c_f32_bf16 v19, s29, v84
    v_dot2c_f32_bf16 v20, s28, v85
    v_dot2c_f32_bf16 v21, s29, v85
    v_dot2c_f32_bf16 v22, s28, v86
    v_dot2c_f32_bf16 v23, s29, v86
    v_dot2c_f32_bf16 v24, s28, v87
    v_dot2c_f32_bf16 v25, s29, v87
    v_mad_u32_u16 v66, v32, s30, v8 op_sel:[1,0,0,0]
    buffer_load_dwordx4 v[80:83], v66, s[20:23], 0 offen sc1
    v_mad_u32_u16 v67, v52, s30, v8 op_sel:[1,0,0,0]
    buffer_load_dwordx4 v[84:87], v67, s[20:23], 0 offen sc1
    s_waitcnt vmcnt(7)
    v_dot2c_f32_bf16 v10, s28, v88
    v_dot2c_f32_bf16 v11, s29, v88
    v_dot2c_f32_bf16 v12, s28, v89
    v_dot2c_f32_bf16 v13, s29, v89
    v_dot2c_f32_bf16 v14, s28, v90
    v_dot2c_f32_bf16 v15, s29, v90
    v_dot2c_f32_bf16 v16, s28, v91
    v_dot2c_f32_bf16 v17, s29, v91
    s_waitcnt vmcnt(6)
    v_dot2c_f32_bf16 v18, s28, v92
    v_dot2c_f32_bf16 v19, s29, v92
    v_dot2c_f32_bf16 v20, s28, v93
    v_dot2c_f32_bf16 v21, s29, v93
    v_dot2c_f32_bf16 v22, s28, v94
    v_dot2c_f32_bf16 v23, s29, v94
    v_dot2c_f32_bf16 v24, s28, v95
    v_dot2c_f32_bf16 v25, s29, v95
    v_mad_u32_u16 v66, v33, s30, v8 op_sel:[0,0,0,0]
    buffer_load_dwordx4 v[88:91], v66, s[20:23], 0 offen sc1
    v_mad_u32_u16 v67, v53, s30, v8 op_sel:[0,0,0,0]
    buffer_load_dwordx4 v[92:95], v67, s[20:23], 0 offen sc1
    s_waitcnt vmcnt(7)
    v_dot2c_f32_bf16 v10, s28, v96
    v_dot2c_f32_bf16 v11, s29, v96
    v_dot2c_f32_bf16 v12, s28, v97
    v_dot2c_f32_bf16 v13, s29, v97
    v_dot2c_f32_bf16 v14, s28, v98
    v_dot2c_f32_bf16 v15, s29, v98
    v_dot2c_f32_bf16 v16, s28, v99
    v_dot2c_f32_bf16 v17, s29, v99
    s_waitcnt vmcnt(6)
    v_dot2c_f32_bf16 v18, s28, v100
    v_dot2c_f32_bf16 v19, s29, v100
    v_dot2c_f32_bf16 v20, s28, v101
    v_dot2c_f32_bf16 v21, s29, v101
    v_dot2c_f32_bf16 v22, s28, v102
    v_dot2c_f32_bf16 v23, s29, v102
    v_dot2c_f32_bf16 v24, s28, v103
    v_dot2c_f32_bf16 v25, s29, v103
    v_mad_u32_u16 v66, v33, s30, v8 op_sel:[1,0,0,0]
    buffer_load_dwordx4 v[96:99], v66, s[20:23], 0 offen sc1
    v_mad_u32_u16 v67, v53, s30, v8 op_sel:[1,0,0,0]
    buffer_load_dwordx4 v[100:103], v67, s[20:23], 0 offen sc1
    s_waitcnt vmcnt(7)
    v_dot2c_f32_bf16 v10, s28, v72
    v_dot2c_f32_bf16 v11, s29, v72
    v_dot2c_f32_bf16 v12, s28, v73
    v_dot2c_f32_bf16 v13, s29, v73
    v_dot2c_f32_bf16 v14, s28, v74
    v_dot2c_f32_bf16 v15, s29, v74
    v_dot2c_f32_bf16 v16, s28, v75
    v_dot2c_f32_bf16 v17, s29, v75
    s_waitcnt vmcnt(6)
    v_dot2c_f32_bf16 v18, s28, v76
    v_dot2c_f32_bf16 v19, s29, v76
    v_dot2c_f32_bf16 v20, s28, v77
    v_dot2c_f32_bf16 v21, s29, v77
    v_dot2c_f32_bf16 v22, s28, v78
    v_dot2c_f32_bf16 v23, s29, v78
    v_dot2c_f32_bf16 v24, s28, v79
    v_dot2c_f32_bf16 v25, s29, v79
    s_setprio 1
    v_mad_u32_u16 v66, v34, s30, v8 op_sel:[0,0,0,0]
    buffer_load_dwordx4 v[72:75], v66, s[20:23], 0 offen sc1
    v_mad_u32_u16 v67, v54, s30, v8 op_sel:[0,0,0,0]
    buffer_load_dwordx4 v[76:79], v67, s[20:23], 0 offen sc1
    s_waitcnt vmcnt(7)
    v_dot2c_f32_bf16 v10, s28, v80
    v_dot2c_f32_bf16 v11, s29, v80
    v_dot2c_f32_bf16 v12, s28, v81
    v_dot2c_f32_bf16 v13, s29, v81
    v_dot2c_f32_bf16 v14, s28, v82
    v_dot2c_f32_bf16 v15, s29, v82
    v_dot2c_f32_bf16 v16, s28, v83
    v_dot2c_f32_bf16 v17, s29, v83
    s_waitcnt vmcnt(6)
    v_dot2c_f32_bf16 v18, s28, v84
    v_dot2c_f32_bf16 v19, s29, v84
    v_dot2c_f32_bf16 v20, s28, v85
    v_dot2c_f32_bf16 v21, s29, v85
    v_dot2c_f32_bf16 v22, s28, v86
    v_dot2c_f32_bf16 v23, s29, v86
    v_dot2c_f32_bf16 v24, s28, v87
    v_dot2c_f32_bf16 v25, s29, v87
    v_mad_u32_u16 v66, v34, s30, v8 op_sel:[1,0,0,0]
    buffer_load_dwordx4 v[80:83], v66, s[20:23], 0 offen sc1
    v_mad_u32_u16 v67, v54, s30, v8 op_sel:[1,0,0,0]
    buffer_load_dwordx4 v[84:87], v67, s[20:23], 0 offen sc1
    s_waitcnt vmcnt(7)
    v_dot2c_f32_bf16 v10, s28, v88
    v_dot2c_f32_bf16 v11, s29, v88
    v_dot2c_f32_bf16 v12, s28, v89
    v_dot2c_f32_bf16 v13, s29, v89
    v_dot2c_f32_bf16 v14, s28, v90
    v_dot2c_f32_bf16 v15, s29, v90
    v_dot2c_f32_bf16 v16, s28, v91
    v_dot2c_f32_bf16 v17, s29, v91
    s_waitcnt vmcnt(6)
    v_dot2c_f32_bf16 v18, s28, v92
    v_dot2c_f32_bf16 v19, s29, v92
    v_dot2c_f32_bf16 v20, s28, v93
    v_dot2c_f32_bf16 v21, s29, v93
    v_dot2c_f32_bf16 v22, s28, v94
    v_dot2c_f32_bf16 v23, s29, v94
    v_dot2c_f32_bf16 v24, s28, v95
    v_dot2c_f32_bf16 v25, s29, v95
    v_mad_u32_u16 v66, v35, s30, v8 op_sel:[0,0,0,0]
    buffer_load_dwordx4 v[88:91], v66, s[20:23], 0 offen sc1
    v_mad_u32_u16 v67, v55, s30, v8 op_sel:[0,0,0,0]
    buffer_load_dwordx4 v[92:95], v67, s[20:23], 0 offen sc1
    s_waitcnt vmcnt(7)
    v_dot2c_f32_bf16 v10, s28, v96
    v_dot2c_f32_bf16 v11, s29, v96
    v_dot2c_f32_bf16 v12, s28, v97
    v_dot2c_f32_bf16 v13, s29, v97
    v_dot2c_f32_bf16 v14, s28, v98
    v_dot2c_f32_bf16 v15, s29, v98
    v_dot2c_f32_bf16 v16, s28, v99
    v_dot2c_f32_bf16 v17, s29, v99
    s_waitcnt vmcnt(6)
    v_dot2c_f32_bf16 v18, s28, v100
    v_dot2c_f32_bf16 v19, s29, v100
    v_dot2c_f32_bf16 v20, s28, v101
    v_dot2c_f32_bf16 v21, s29, v101
    v_dot2c_f32_bf16 v22, s28, v102
    v_dot2c_f32_bf16 v23, s29, v102
    v_dot2c_f32_bf16 v24, s28, v103
    v_dot2c_f32_bf16 v25, s29, v103
    v_mad_u32_u16 v66, v35, s30, v8 op_sel:[1,0,0,0]
    buffer_load_dwordx4 v[96:99], v66, s[20:23], 0 offen sc1
    v_mad_u32_u16 v67, v55, s30, v8 op_sel:[1,0,0,0]
    buffer_load_dwordx4 v[100:103], v67, s[20:23], 0 offen sc1
    s_waitcnt vmcnt(7)
    v_dot2c_f32_bf16 v10, s28, v72
    v_dot2c_f32_bf16 v11, s29, v72
    v_dot2c_f32_bf16 v12, s28, v73
    v_dot2c_f32_bf16 v13, s29, v73
    v_dot2c_f32_bf16 v14, s28, v74
    v_dot2c_f32_bf16 v15, s29, v74
    v_dot2c_f32_bf16 v16, s28, v75
    v_dot2c_f32_bf16 v17, s29, v75
    s_waitcnt vmcnt(6)
    v_dot2c_f32_bf16 v18, s28, v76
    v_dot2c_f32_bf16 v19, s29, v76
    v_dot2c_f32_bf16 v20, s28, v77
    v_dot2c_f32_bf16 v21, s29, v77
    v_dot2c_f32_bf16 v22, s28, v78
    v_dot2c_f32_bf16 v23, s29, v78
    v_dot2c_f32_bf16 v24, s28, v79
    v_dot2c_f32_bf16 v25, s29, v79
    v_mad_u32_u16 v66, v36, s30, v8 op_sel:[0,0,0,0]
    buffer_load_dwordx4 v[72:75], v66, s[20:23], 0 offen sc1
    v_mad_u32_u16 v67, v56, s30, v8 op_sel:[0,0,0,0]
    buffer_load_dwordx4 v[76:79], v67, s[20:23], 0 offen sc1
    s_waitcnt vmcnt(7)
    v_dot2c_f32_bf16 v10, s28, v80
    v_dot2c_f32_bf16 v11, s29, v80
    v_dot2c_f32_bf16 v12, s28, v81
    v_dot2c_f32_bf16 v13, s29, v81
    v_dot2c_f32_bf16 v14, s28, v82
    v_dot2c_f32_bf16 v15, s29, v82
    v_dot2c_f32_bf16 v16, s28, v83
    v_dot2c_f32_bf16 v17, s29, v83
    s_waitcnt vmcnt(6)
    v_dot2c_f32_bf16 v18, s28, v84
    v_dot2c_f32_bf16 v19, s29, v84
    v_dot2c_f32_bf16 v20, s28, v85
    v_dot2c_f32_bf16 v21, s29, v85
    v_dot2c_f32_bf16 v22, s28, v86
    v_dot2c_f32_bf16 v23, s29, v86
    v_dot2c_f32_bf16 v24, s28, v87
    v_dot2c_f32_bf16 v25, s29, v87
    v_mad_u32_u16 v66, v36, s30, v8 op_sel:[1,0,0,0]
    buffer_load_dwordx4 v[80:83], v66, s[20:23], 0 offen sc1
    v_mad_u32_u16 v67, v56, s30, v8 op_sel:[1,0,0,0]
    buffer_load_dwordx4 v[84:87], v67, s[20:23], 0 offen sc1
    s_waitcnt vmcnt(7)
    v_dot2c_f32_bf16 v10, s28, v88
    v_dot2c_f32_bf16 v11, s29, v88
    v_dot2c_f32_bf16 v12, s28, v89
    v_dot2c_f32_bf16 v13, s29, v89
    v_dot2c_f32_bf16 v14, s28, v90
    v_dot2c_f32_bf16 v15, s29, v90
    v_dot2c_f32_bf16 v16, s28, v91
    v_dot2c_f32_bf16 v17, s29, v91
    s_waitcnt vmcnt(6)
    v_dot2c_f32_bf16 v18, s28, v92
    v_dot2c_f32_bf16 v19, s29, v92
    v_dot2c_f32_bf16 v20, s28, v93
    v_dot2c_f32_bf16 v21, s29, v93
    v_dot2c_f32_bf16 v22, s28, v94
    v_dot2c_f32_bf16 v23, s29, v94
    v_dot2c_f32_bf16 v24, s28, v95
    v_dot2c_f32_bf16 v25, s29, v95
    v_mad_u32_u16 v66, v37, s30, v8 op_sel:[0,0,0,0]
    buffer_load_dwordx4 v[88:91], v66, s[20:23], 0 offen sc1
    v_mad_u32_u16 v67, v57, s30, v8 op_sel:[0,0,0,0]
    buffer_load_dwordx4 v[92:95], v67, s[20:23], 0 offen sc1
    s_waitcnt vmcnt(7)
    v_dot2c_f32_bf16 v10, s28, v96
    v_dot2c_f32_bf16 v11, s29, v96
    v_dot2c_f32_bf16 v12, s28, v97
    v_dot2c_f32_bf16 v13, s29, v97
    v_dot2c_f32_bf16 v14, s28, v98
    v_dot2c_f32_bf16 v15, s29, v98
    v_dot2c_f32_bf16 v16, s28, v99
    v_dot2c_f32_bf16 v17, s29, v99
    s_waitcnt vmcnt(6)
    v_dot2c_f32_bf16 v18, s28, v100
    v_dot2c_f32_bf16 v19, s29, v100
    v_dot2c_f32_bf16 v20, s28, v101
    v_dot2c_f32_bf16 v21, s29, v101
    v_dot2c_f32_bf16 v22, s28, v102
    v_dot2c_f32_bf16 v23, s29, v102
    v_dot2c_f32_bf16 v24, s28, v103
    v_dot2c_f32_bf16 v25, s29, v103
    v_mad_u32_u16 v66, v37, s30, v8 op_sel:[1,0,0,0]
    buffer_load_dwordx4 v[96:99], v66, s[20:23], 0 offen sc1
    v_mad_u32_u16 v67, v57, s30, v8 op_sel:[1,0,0,0]
    buffer_load_dwordx4 v[100:103], v67, s[20:23], 0 offen sc1
    s_waitcnt vmcnt(7)
    v_dot2c_f32_bf16 v10, s28, v72
    v_dot2c_f32_bf16 v11, s29, v72
    v_dot2c_f32_bf16 v12, s28, v73
    v_dot2c_f32_bf16 v13, s29, v73
    v_dot2c_f32_bf16 v14, s28, v74
    v_dot2c_f32_bf16 v15, s29, v74
    v_dot2c_f32_bf16 v16, s28, v75
    v_dot2c_f32_bf16 v17, s29, v75
    s_waitcnt vmcnt(6)
    v_dot2c_f32_bf16 v18, s28, v76
    v_dot2c_f32_bf16 v19, s29, v76
    v_dot2c_f32_bf16 v20, s28, v77
    v_dot2c_f32_bf16 v21, s29, v77
    v_dot2c_f32_bf16 v22, s28, v78
    v_dot2c_f32_bf16 v23, s29, v78
    v_dot2c_f32_bf16 v24, s28, v79
    v_dot2c_f32_bf16 v25, s29, v79
    s_setprio 0
    v_mad_u32_u16 v66, v38, s30, v8 op_sel:[0,0,0,0]
    buffer_load_dwordx4 v[72:75], v66, s[20:23], 0 offen sc1
    v_mad_u32_u16 v67, v58, s30, v8 op_sel:[0,0,0,0]
    buffer_load_dwordx4 v[76:79], v67, s[20:23], 0 offen sc1
    s_waitcnt vmcnt(7)
    v_dot2c_f32_bf16 v10, s28, v80
    v_dot2c_f32_bf16 v11, s29, v80
    v_dot2c_f32_bf16 v12, s28, v81
    v_dot2c_f32_bf16 v13, s29, v81
    v_dot2c_f32_bf16 v14, s28, v82
    v_dot2c_f32_bf16 v15, s29, v82
    v_dot2c_f32_bf16 v16, s28, v83
    v_dot2c_f32_bf16 v17, s29, v83
    s_waitcnt vmcnt(6)
    v_dot2c_f32_bf16 v18, s28, v84
    v_dot2c_f32_bf16 v19, s29, v84
    v_dot2c_f32_bf16 v20, s28, v85
    v_dot2c_f32_bf16 v21, s29, v85
    v_dot2c_f32_bf16 v22, s28, v86
    v_dot2c_f32_bf16 v23, s29, v86
    v_dot2c_f32_bf16 v24, s28, v87
    v_dot2c_f32_bf16 v25, s29, v87
    v_mad_u32_u16 v66, v38, s30, v8 op_sel:[1,0,0,0]
    buffer_load_dwordx4 v[80:83], v66, s[20:23], 0 offen sc1
    v_mad_u32_u16 v67, v58, s30, v8 op_sel:[1,0,0,0]
    buffer_load_dwordx4 v[84:87], v67, s[20:23], 0 offen sc1
    s_waitcnt vmcnt(7)
    v_dot2c_f32_bf16 v10, s28, v88
    v_dot2c_f32_bf16 v11, s29, v88
    v_dot2c_f32_bf16 v12, s28, v89
    v_dot2c_f32_bf16 v13, s29, v89
    v_dot2c_f32_bf16 v14, s28, v90
    v_dot2c_f32_bf16 v15, s29, v90
    v_dot2c_f32_bf16 v16, s28, v91
    v_dot2c_f32_bf16 v17, s29, v91
    s_waitcnt vmcnt(6)
    v_dot2c_f32_bf16 v18, s28, v92
    v_dot2c_f32_bf16 v19, s29, v92
    v_dot2c_f32_bf16 v20, s28, v93
    v_dot2c_f32_bf16 v21, s29, v93
    v_dot2c_f32_bf16 v22, s28, v94
    v_dot2c_f32_bf16 v23, s29, v94
    v_dot2c_f32_bf16 v24, s28, v95
    v_dot2c_f32_bf16 v25, s29, v95
    v_mad_u32_u16 v66, v39, s30, v8 op_sel:[0,0,0,0]
    buffer_load_dwordx4 v[88:91], v66, s[20:23], 0 offen sc1
    v_mad_u32_u16 v67, v59, s30, v8 op_sel:[0,0,0,0]
    buffer_load_dwordx4 v[92:95], v67, s[20:23], 0 offen sc1
    s_waitcnt vmcnt(7)
    v_dot2c_f32_bf16 v10, s28, v96
    v_dot2c_f32_bf16 v11, s29, v96
    v_dot2c_f32_bf16 v12, s28, v97
    v_dot2c_f32_bf16 v13, s29, v97
    v_dot2c_f32_bf16 v14, s28, v98
    v_dot2c_f32_bf16 v15, s29, v98
    v_dot2c_f32_bf16 v16, s28, v99
    v_dot2c_f32_bf16 v17, s29, v99
    s_waitcnt vmcnt(6)
    v_dot2c_f32_bf16 v18, s28, v100
    v_dot2c_f32_bf16 v19, s29, v100
    v_dot2c_f32_bf16 v20, s28, v101
    v_dot2c_f32_bf16 v21, s29, v101
    v_dot2c_f32_bf16 v22, s28, v102
    v_dot2c_f32_bf16 v23, s29, v102
    v_dot2c_f32_bf16 v24, s28, v103
    v_dot2c_f32_bf16 v25, s29, v103
    v_mad_u32_u16 v66, v39, s30, v8 op_sel:[1,0,0,0]
    buffer_load_dwordx4 v[96:99], v66, s[20:23], 0 offen sc1
    v_mad_u32_u16 v67, v59, s30, v8 op_sel:[1,0,0,0]
    buffer_load_dwordx4 v[100:103], v67, s[20:23], 0 offen sc1
    s_waitcnt vmcnt(7)
    v_dot2c_f32_bf16 v10, s28, v72
    v_dot2c_f32_bf16 v11, s29, v72
    v_dot2c_f32_bf16 v12, s28, v73
    v_dot2c_f32_bf16 v13, s29, v73
    v_dot2c_f32_bf16 v14, s28, v74
    v_dot2c_f32_bf16 v15, s29, v74
    v_dot2c_f32_bf16 v16, s28, v75
    v_dot2c_f32_bf16 v17, s29, v75
    s_waitcnt vmcnt(6)
    v_dot2c_f32_bf16 v18, s28, v76
    v_dot2c_f32_bf16 v19, s29, v76
    v_dot2c_f32_bf16 v20, s28, v77
    v_dot2c_f32_bf16 v21, s29, v77
    v_dot2c_f32_bf16 v22, s28, v78
    v_dot2c_f32_bf16 v23, s29, v78
    v_dot2c_f32_bf16 v24, s28, v79
    v_dot2c_f32_bf16 v25, s29, v79
    v_mad_u32_u16 v66, v40, s30, v8 op_sel:[0,0,0,0]
    buffer_load_dwordx4 v[72:75], v66, s[20:23], 0 offen sc1
    v_mad_u32_u16 v67, v60, s30, v8 op_sel:[0,0,0,0]
    buffer_load_dwordx4 v[76:79], v67, s[20:23], 0 offen sc1
    s_waitcnt vmcnt(7)
    v_dot2c_f32_bf16 v10, s28, v80
    v_dot2c_f32_bf16 v11, s29, v80
    v_dot2c_f32_bf16 v12, s28, v81
    v_dot2c_f32_bf16 v13, s29, v81
    v_dot2c_f32_bf16 v14, s28, v82
    v_dot2c_f32_bf16 v15, s29, v82
    v_dot2c_f32_bf16 v16, s28, v83
    v_dot2c_f32_bf16 v17, s29, v83
    s_waitcnt vmcnt(6)
    v_dot2c_f32_bf16 v18, s28, v84
    v_dot2c_f32_bf16 v19, s29, v84
    v_dot2c_f32_bf16 v20, s28, v85
    v_dot2c_f32_bf16 v21, s29, v85
    v_dot2c_f32_bf16 v22, s28, v86
    v_dot2c_f32_bf16 v23, s29, v86
    v_dot2c_f32_bf16 v24, s28, v87
    v_dot2c_f32_bf16 v25, s29, v87
    v_mad_u32_u16 v66, v40, s30, v8 op_sel:[1,0,0,0]
    buffer_load_dwordx4 v[80:83], v66, s[20:23], 0 offen sc1
    v_mad_u32_u16 v67, v60, s30, v8 op_sel:[1,0,0,0]
    buffer_load_dwordx4 v[84:87], v67, s[20:23], 0 offen sc1
    s_waitcnt vmcnt(7)
    v_dot2c_f32_bf16 v10, s28, v88
    v_dot2c_f32_bf16 v11, s29, v88
    v_dot2c_f32_bf16 v12, s28, v89
    v_dot2c_f32_bf16 v13, s29, v89
    v_dot2c_f32_bf16 v14, s28, v90
    v_dot2c_f32_bf16 v15, s29, v90
    v_dot2c_f32_bf16 v16, s28, v91
    v_dot2c_f32_bf16 v17, s29, v91
    s_waitcnt vmcnt(6)
    v_dot2c_f32_bf16 v18, s28, v92
    v_dot2c_f32_bf16 v19, s29, v92
    v_dot2c_f32_bf16 v20, s28, v93
    v_dot2c_f32_bf16 v21, s29, v93
    v_dot2c_f32_bf16 v22, s28, v94
    v_dot2c_f32_bf16 v23, s29, v94
    v_dot2c_f32_bf16 v24, s28, v95
    v_dot2c_f32_bf16 v25, s29, v95
    v_mad_u32_u16 v66, v41, s30, v8 op_sel:[0,0,0,0]
    buffer_load_dwordx4 v[88:91], v66, s[20:23], 0 offen sc1
    v_mad_u32_u16 v67, v61, s30, v8 op_sel:[0,0,0,0]
    buffer_load_dwordx4 v[92:95], v67, s[20:23], 0 offen sc1
    s_waitcnt vmcnt(7)
    v_dot2c_f32_bf16 v10, s28, v96
    v_dot2c_f32_bf16 v11, s29, v96
    v_dot2c_f32_bf16 v12, s28, v97
    v_dot2c_f32_bf16 v13, s29, v97
    v_dot2c_f32_bf16 v14, s28, v98
    v_dot2c_f32_bf16 v15, s29, v98
    v_dot2c_f32_bf16 v16, s28, v99
    v_dot2c_f32_bf16 v17, s29, v99
    s_waitcnt vmcnt(6)
    v_dot2c_f32_bf16 v18, s28, v100
    v_dot2c_f32_bf16 v19, s29, v100
    v_dot2c_f32_bf16 v20, s28, v101
    v_dot2c_f32_bf16 v21, s29, v101
    v_dot2c_f32_bf16 v22, s28, v102
    v_dot2c_f32_bf16 v23, s29, v102
    v_dot2c_f32_bf16 v24, s28, v103
    v_dot2c_f32_bf16 v25, s29, v103
    v_mad_u32_u16 v66, v41, s30, v8 op_sel:[1,0,0,0]
    buffer_load_dwordx4 v[96:99], v66, s[20:23], 0 offen sc1
    v_mad_u32_u16 v67, v61, s30, v8 op_sel:[1,0,0,0]
    buffer_load_dwordx4 v[100:103], v67, s[20:23], 0 offen sc1
    s_waitcnt vmcnt(7)
    v_dot2c_f32_bf16 v10, s28, v72
    v_dot2c_f32_bf16 v11, s29, v72
    v_dot2c_f32_bf16 v12, s28, v73
    v_dot2c_f32_bf16 v13, s29, v73
    v_dot2c_f32_bf16 v14, s28, v74
    v_dot2c_f32_bf16 v15, s29, v74
    v_dot2c_f32_bf16 v16, s28, v75
    v_dot2c_f32_bf16 v17, s29, v75
    s_waitcnt vmcnt(6)
    v_dot2c_f32_bf16 v18, s28, v76
    v_dot2c_f32_bf16 v19, s29, v76
    v_dot2c_f32_bf16 v20, s28, v77
    v_dot2c_f32_bf16 v21, s29, v77
    v_dot2c_f32_bf16 v22, s28, v78
    v_dot2c_f32_bf16 v23, s29, v78
    v_dot2c_f32_bf16 v24, s28, v79
    v_dot2c_f32_bf16 v25, s29, v79
    s_waitcnt vmcnt(5)
    v_dot2c_f32_bf16 v10, s28, v80
    v_dot2c_f32_bf16 v11, s29, v80
    v_dot2c_f32_bf16 v12, s28, v81
    v_dot2c_f32_bf16 v13, s29, v81
    v_dot2c_f32_bf16 v14, s28, v82
    v_dot2c_f32_bf16 v15, s29, v82
    v_dot2c_f32_bf16 v16, s28, v83
    v_dot2c_f32_bf16 v17, s29, v83
    s_waitcnt vmcnt(4)
    v_dot2c_f32_bf16 v18, s28, v84
    v_dot2c_f32_bf16 v19, s29, v84
    v_dot2c_f32_bf16 v20, s28, v85
    v_dot2c_f32_bf16 v21, s29, v85
    v_dot2c_f32_bf16 v22, s28, v86
    v_dot2c_f32_bf16 v23, s29, v86
    v_dot2c_f32_bf16 v24, s28, v87
    v_dot2c_f32_bf16 v25, s29, v87
    s_waitcnt vmcnt(3)
    v_dot2c_f32_bf16 v10, s28, v88
    v_dot2c_f32_bf16 v11, s29, v88
    v_dot2c_f32_bf16 v12, s28, v89
    v_dot2c_f32_bf16 v13, s29, v89
    v_dot2c_f32_bf16 v14, s28, v90
    v_dot2c_f32_bf16 v15, s29, v90
    v_dot2c_f32_bf16 v16, s28, v91
    v_dot2c_f32_bf16 v17, s29, v91
    s_waitcnt vmcnt(2)
    v_dot2c_f32_bf16 v18, s28, v92
    v_dot2c_f32_bf16 v19, s29, v92
    v_dot2c_f32_bf16 v20, s28, v93
    v_dot2c_f32_bf16 v21, s29, v93
    v_dot2c_f32_bf16 v22, s28, v94
    v_dot2c_f32_bf16 v23, s29, v94
    v_dot2c_f32_bf16 v24, s28, v95
    v_dot2c_f32_bf16 v25, s29, v95
    s_waitcnt vmcnt(1)
    v_dot2c_f32_bf16 v10, s28, v96
    v_dot2c_f32_bf16 v11, s29, v96
    v_dot2c_f32_bf16 v12, s28, v97
    v_dot2c_f32_bf16 v13, s29, v97
    v_dot2c_f32_bf16 v14, s28, v98
    v_dot2c_f32_bf16 v15, s29, v98
    v_dot2c_f32_bf16 v16, s28, v99
    v_dot2c_f32_bf16 v17, s29, v99
    s_waitcnt vmcnt(0)
    v_dot2c_f32_bf16 v18, s28, v100
    v_dot2c_f32_bf16 v19, s29, v100
    v_dot2c_f32_bf16 v20, s28, v101
    v_dot2c_f32_bf16 v21, s29, v101
    v_dot2c_f32_bf16 v22, s28, v102
    v_dot2c_f32_bf16 v23, s29, v102
    v_dot2c_f32_bf16 v24, s28, v103
    v_dot2c_f32_bf16 v25, s29, v103
    s_branch hop_fin
hop_w17:
    s_setprio 3
    v_mad_u32_u16 v66, v26, s30, v8 op_sel:[0,0,0,0]
    buffer_load_dwordx4 v[72:75], v66, s[20:23], 0 offen sc1
    v_mad_u32_u16 v67, v46, s30, v8 op_sel:[0,0,0,0]
    buffer_load_dwordx4 v[76:79], v67, s[20:23], 0 offen sc1
    v_mad_u32_u16 v66, v26, s30, v8 op_sel:[1,0,0,0]
    buffer_load_dwordx4 v[80:83], v66, s[20:23], 0 offen sc1
    v_mad_u32_u16 v67, v46, s30, v8 op_sel:[1,0,0,0]
    buffer_load_dwordx4 v[84:87], v67, s[20:23], 0 offen sc1
    v_mad_u32_u16 v66, v27, s30, v8 op_sel:[0,0,0,0]
    buffer_load_dwordx4 v[88:91], v66, s[20:23], 0 offen sc1
    v_mad_u32_u16 v67, v47, s30, v8 op_sel:[0,0,0,0]
    buffer_load_dwordx4 v[92:95], v67, s[20:23], 0 offen sc1
    v_mad_u32_u16 v66, v27, s30, v8 op_sel:[1,0,0,0]
    buffer_load_dwordx4 v[96:99], v66, s[20:23], 0 offen sc1
    v_mad_u32_u16 v67, v47, s30, v8 op_sel:[1,0,0,0]
    buffer_load_dwordx4 v[100:103], v67, s[20:23], 0 offen sc1
    s_waitcnt vmcnt(7)
    v_dot2c_f32_bf16 v10, s28, v72
    v_dot2c_f32_bf16 v11, s29, v72
    v_dot2c_f32_bf16 v12, s28, v73
    v_dot2c_f32_bf16 v13, s29, v73
    v_dot2c_f32_bf16 v14, s28, v74
    v_dot2c_f32_bf16 v15, s29, v74
    v_dot2c_f32_bf16 v16, s28, v75
    v_dot2c_f32_bf16 v17, s29, v75
    s_waitcnt vmcnt(6)
    v_dot2c_f32_bf16 v18, s28, v76
    v_dot2c_f32_bf16 v19, s29, v76
    v_dot2c_f32_bf16 v20, s28, v77
    v_dot2c_f32_bf16 v21, s29, v77
    v_dot2c_f32_bf16 v22, s28, v78
    v_dot2c_f32_bf16 v23, s29, v78
    v_dot2c_f32_bf16 v24, s28, v79
    v_dot2c_f32_bf16 v25, s29, v79
    v_mad_u32_u16 v66, v28, s30, v8 op_sel:[0,0,0,0]
    buffer_load_dwordx4 v[72:75], v66, s[20:23], 0 offen sc1
    v_mad_u32_u16 v67, v48, s30, v8 op_sel:[0,0,0,0]
    buffer_load_dwordx4 v[76:79], v67, s[20:23], 0 offen sc1
    s_waitcnt vmcnt(7)
    v_dot2c_f32_bf16 v10, s28, v80
    v_dot2c_f32_bf16 v11, s29, v80
    v_dot2c_f32_bf16 v12, s28, v81
    v_dot2c_f32_bf16 v13, s29, v81
    v_dot2c_f32_bf16 v14, s28, v82
    v_dot2c_f32_bf16 v15, s29, v82
    v_dot2c_f32_bf16 v16, s28, v83
    v_dot2c_f32_bf16 v17, s29, v83
    s_waitcnt vmcnt(6)
    v_dot2c_f32_bf16 v18, s28, v84
    v_dot2c_f32_bf16 v19, s29, v84
    v_dot2c_f32_bf16 v20, s28, v85
    v_dot2c_f32_bf16 v21, s29, v85
    v_dot2c_f32_bf16 v22, s28, v86
    v_dot2c_f32_bf16 v23, s29, v86
    v_dot2c_f32_bf16 v24, s28, v87
    v_dot2c_f32_bf16 v25, s29, v87
    v_mad_u32_u16 v66, v28, s30, v8 op_sel:[1,0,0,0]
    buffer_load_dwordx4 v[80:83], v66, s[20:23], 0 offen sc1
    v_mad_u32_u16 v67, v48, s30, v8 op_sel:[1,0,0,0]
    buffer_load_dwordx4 v[84:87], v67, s[20:23], 0 offen sc1
    s_waitcnt vmcnt(7)
    v_dot2c_f32_bf16 v10, s28, v88
    v_dot2c_f32_bf16 v11, s29, v88
    v_dot2c_f32_bf16 v12, s28, v89
    v_dot2c_f32_bf16 v13, s29, v89
    v_dot2c_f32_bf16 v14, s28, v90
    v_dot2c_f32_bf16 v15, s29, v90
    v_dot2c_f32_bf16 v16, s28, v91
    v_dot2c_f32_bf16 v17, s29, v91
    s_waitcnt vmcnt(6)
    v_dot2c_f32_bf16 v18, s28, v92
    v_dot2c_f32_bf16 v19, s29, v92
    v_dot2c_f32_bf16 v20, s28, v93
    v_dot2c_f32_bf16 v21, s29, v93
    v_dot2c_f32_bf16 v22, s28, v94
    v_dot2c_f32_bf16 v23, s29, v94
    v_dot2c_f32_bf16 v24, s28, v95
    v_dot2c_f32_bf16 v25, s29, v95
    v_mad_u32_u16 v66, v29, s30, v8 op_sel:[0,0,0,0]
    buffer_load_dwordx4 v[88:91], v66, s[20:23], 0 offen sc1
    v_mad_u32_u16 v67, v49, s30, v8 op_sel:[0,0,0,0]
    buffer_load_dwordx4 v[92:95], v67, s[20:23], 0 offen sc1
    s_waitcnt vmcnt(7)
    v_dot2c_f32_bf16 v10, s28, v96
    v_dot2c_f32_bf16 v11, s29, v96
    v_dot2c_f32_bf16 v12, s28, v97
    v_dot2c_f32_bf16 v13, s29, v97
    v_dot2c_f32_bf16 v14, s28, v98
    v_dot2c_f32_bf16 v15, s29, v98
    v_dot2c_f32_bf16 v16, s28, v99
    v_dot2c_f32_bf16 v17, s29, v99
    s_waitcnt vmcnt(6)
    v_dot2c_f32_bf16 v18, s28, v100
    v_dot2c_f32_bf16 v19, s29, v100
    v_dot2c_f32_bf16 v20, s28, v101
    v_dot2c_f32_bf16 v21, s29, v101
    v_dot2c_f32_bf16 v22, s28, v102
    v_dot2c_f32_bf16 v23, s29, v102
    v_dot2c_f32_bf16 v24, s28, v103
    v_dot2c_f32_bf16 v25, s29, v103
    v_mad_u32_u16 v66, v29, s30, v8 op_sel:[1,0,0,0]
    buffer_load_dwordx4 v[96:99], v66, s[20:23], 0 offen sc1
    v_mad_u32_u16 v67, v49, s30, v8 op_sel:[1,0,0,0]
    buffer_load_dwordx4 v[100:103], v67, s[20:23], 0 offen sc1
    s_waitcnt vmcnt(7)
    v_dot2c_f32_bf16 v10, s28, v72
    v_dot2c_f32_bf16 v11, s29, v72
    v_dot2c_f32_bf16 v12, s28, v73
    v_dot2c_f32_bf16 v13, s29, v73
    v_dot2c_f32_bf16 v14, s28, v74
    v_dot2c_f32_bf16 v15, s29, v74
    v_dot2c_f32_bf16 v16, s28, v75
    v_dot2c_f32_bf16 v17, s29, v75
    s_waitcnt vmcnt(6)
    v_dot2c_f32_bf16 v18, s28, v76
    v_dot2c_f32_bf16 v19, s29, v76
    v_dot2c_f32_bf16 v20, s28, v77
    v_dot2c_f32_bf16 v21, s29, v77
    v_dot2c_f32_bf16 v22, s28, v78
    v_dot2c_f32_bf16 v23, s29, v78
    v_dot2c_f32_bf16 v24, s28, v79
    v_dot2c_f32_bf16 v25, s29, v79
    v_mad_u32_u16 v66, v30, s30, v8 op_sel:[0,0,0,0]
    buffer_load_dwordx4 v[72:75], v66, s[20:23], 0 offen sc1
    v_mad_u32_u16 v67, v50, s30, v8 op_sel:[0,0,0,0]
    buffer_load_dwordx4 v[76:79], v67, s[20:23], 0 offen sc1
    s_waitcnt vmcnt(7)
    v_dot2c_f32_bf16 v10, s28, v80
    v_dot2c_f32_bf16 v11, s29, v80
    v_dot2c_f32_bf16 v12, s28, v81
    v_dot2c_f32_bf16 v13, s29, v81
    v_dot2c_f32_bf16 v14, s28, v82
    v_dot2c_f32_bf16 v15, s29, v82
    v_dot2c_f32_bf16 v16, s28, v83
    v_dot2c_f32_bf16 v17, s29, v83
    s_waitcnt vmcnt(6)
    v_dot2c_f32_bf16 v18, s28, v84
    v_dot2c_f32_bf16 v19, s29, v84
    v_dot2c_f32_bf16 v20, s28, v85
    v_dot2c_f32_bf16 v21, s29, v85
    v_dot2c_f32_bf16 v22, s28, v86
    v_dot2c_f32_bf16 v23, s29, v86
    v_dot2c_f32_bf16 v24, s28, v87
    v_dot2c_f32_bf16 v25, s29, v87
    s_setprio 2
    v_mad_u32_u16 v66, v30, s30, v8 op_sel:[1,0,0,0]
    buffer_load_dwordx4 v[80:83], v66, s[20:23], 0 offen sc1
    v_mad_u32_u16 v67, v50, s30, v8 op_sel:[1,0,0,0]
    buffer_load_dwordx4 v[84:87], v67, s[20:23], 0 offen sc1
    s_waitcnt vmcnt(7)
    v_dot2c_f32_bf16 v10, s28, v88
    v_dot2c_f32_bf16 v11, s29, v88
    v_dot2c_f32_bf16 v12, s28, v89
    v_dot2c_f32_bf16 v13, s29, v89
    v_dot2c_f32_bf16 v14, s28, v90
    v_dot2c_f32_bf16 v15, s29, v90
    v_dot2c_f32_bf16 v16, s28, v91
    v_dot2c_f32_bf16 v17, s29, v91
    s_waitcnt vmcnt(6)
    v_dot2c_f32_bf16 v18, s28, v92
    v_dot2c_f32_bf16 v19, s29, v92
    v_dot2c_f32_bf16 v20, s28, v93
    v_dot2c_f32_bf16 v21, s29, v93
    v_dot2c_f32_bf16 v22, s28, v94
    v_dot2c_f32_bf16 v23, s29, v94
    v_dot2c_f32_bf16 v24, s28, v95
    v_dot2c_f32_bf16 v25, s29, v95
    v_mad_u32_u16 v66, v31, s30, v8 op_sel:[0,0,0,0]
    buffer_load_dwordx4 v[88:91], v66, s[20:23], 0 offen sc1
    v_mad_u32_u16 v67, v51, s30, v8 op_sel:[0,0,0,0]
    buffer_load_dwordx4 v[92:95], v67, s[20:23], 0 offen sc1
    s_waitcnt vmcnt(7)
    v_dot2c_f32_bf16 v10, s28, v96
    v_dot2c_f32_bf16 v11, s29, v96
    v_dot2c_f32_bf16 v12, s28, v97
    v_dot2c_f32_bf16 v13, s29, v97
    v_dot2c_f32_bf16 v14, s28, v98
    v_dot2c_f32_bf16 v15, s29, v98
    v_dot2c_f32_bf16 v16, s28, v99
    v_dot2c_f32_bf16 v17, s29, v99
    s_waitcnt vmcnt(6)
    v_dot2c_f32_bf16 v18, s28, v100
    v_dot2c_f32_bf16 v19, s29, v100
    v_dot2c_f32_bf16 v20, s28, v101
    v_dot2c_f32_bf16 v21, s29, v101
    v_dot2c_f32_bf16 v22, s28, v102
    v_dot2c_f32_bf16 v23, s29, v102
    v_dot2c_f32_bf16 v24, s28, v103
    v_dot2c_f32_bf16 v25, s29, v103
    v_mad_u32_u16 v66, v31, s30, v8 op_sel:[1,0,0,0]
    buffer_load_dwordx4 v[96:99], v66, s[20:23], 0 offen sc1
    v_mad_u32_u16 v67, v51, s30, v8 op_sel:[1,0,0,0]
    buffer_load_dwordx4 v[100:103], v67, s[20:23], 0 offen sc1
    s_waitcnt vmcnt(7)
    v_dot2c_f32_bf16 v10, s28, v72
    v_dot2c_f32_bf16 v11, s29, v72
    v_dot2c_f32_bf16 v12, s28, v73
    v_dot2c_f32_bf16 v13, s29, v73
    v_dot2c_f32_bf16 v14, s28, v74
    v_dot2c_f32_bf16 v15, s29, v74
    v_dot2c_f32_bf16 v16, s28, v75
    v_dot2c_f32_bf16 v17, s29, v75
    s_waitcnt vmcnt(6)
    v_dot2c_f32_bf16 v18, s28, v76
    v_dot2c_f32_bf16 v19, s29, v76
    v_dot2c_f32_bf16 v20, s28, v77
    v_dot2c_f32_bf16 v21, s29, v77
    v_dot2c_f32_bf16 v22, s28, v78
    v_dot2c_f32_bf16 v23, s29, v78
    v_dot2c_f32_bf16 v24, s28, v79
    v_dot2c_f32_bf16 v25, s29, v79
    v_mad_u32_u16 v66, v32, s30, v8 op_sel:[0,0,0,0]
    buffer_load_dwordx4 v[72:75], v66, s[20:23], 0 offen sc1
    v_mad_u32_u16 v67, v52, s30, v8 op_sel:[0,0,0,0]
    buffer_load_dwordx4 v[76:79], v67, s[20:23], 0 offen sc1
    s_waitcnt vmcnt(7)
    v_dot2c_f32_bf16 v10, s28, v80
    v_dot2c_f32_bf16 v11, s29, v80
    v_dot2c_f32_bf16 v12, s28, v81
    v_dot2c_f32_bf16 v13, s29, v81
    v_dot2c_f32_bf16 v14, s28, v82
    v_dot2c_f32_bf16 v15, s29, v82
    v_dot2c_f32_bf16 v16, s28, v83
    v_dot2c_f32_bf16 v17, s29, v83
    s_waitcnt vmcnt(6)
    v_dot2c_f32_bf16 v18, s28, v84
    v_dot2c_f32_bf16 v19, s29, v84
    v_dot2c_f32_bf16 v20, s28, v85
    v_dot2c_f32_bf16 v21, s29, v85
    v_dot2c_f32_bf16 v22, s28, v86
    v_dot2c_f32_bf16 v23, s29, v86
    v_dot2c_f32_bf16 v24, s28, v87
    v_dot2c_f32_bf16 v25, s29, v87
    v_mad_u32_u16 v66, v32, s30, v8 op_sel:[1,0,0,0]
    buffer_load_dwordx4 v[80:83], v66, s[20:23], 0 offen sc1
    v_mad_u32_u16 v67, v52, s30, v8 op_sel:[1,0,0,0]
    buffer_load_dwordx4 v[84:87], v67, s[20:23], 0 offen sc1
    s_waitcnt vmcnt(7)
    v_dot2c_f32_bf16 v10, s28, v88
    v_dot2c_f32_bf16 v11, s29, v88
    v_dot2c_f32_bf16 v12, s28, v89
    v_dot2c_f32_bf16 v13, s29, v89
    v_dot2c_f32_bf16 v14, s28, v90
    v_dot2c_f32_bf16 v15, s29, v90
    v_dot2c_f32_bf16 v16, s28, v91
    v_dot2c_f32_bf16 v17, s29, v91
    s_waitcnt vmcnt(6)
    v_dot2c_f32_bf16 v18, s28, v92
    v_dot2c_f32_bf16 v19, s29, v92
    v_dot2c_f32_bf16 v20, s28, v93
    v_dot2c_f32_bf16 v21, s29, v93
    v_dot2c_f32_bf16 v22, s28, v94
    v_dot2c_f32_bf16 v23, s29, v94
    v_dot2c_f32_bf16 v24, s28, v95
    v_dot2c_f32_bf16 v25, s29, v95
    v_mad_u32_u16 v66, v33, s30, v8 op_sel:[0,0,0,0]
    buffer_load_dwordx4 v[88:91], v66, s[20:23], 0 offen sc1
    v_mad_u32_u16 v67, v53, s30, v8 op_sel:[0,0,0,0]
    buffer_load_dwordx4 v[92:95], v67, s[20:23], 0 offen sc1
    s_waitcnt vmcnt(7)
    v_dot2c_f32_bf16 v10, s28, v96
    v_dot2c_f32_bf16 v11, s29, v96
    v_dot2c_f32_bf16 v12, s28, v97
    v_dot2c_f32_bf16 v13, s29, v97
    v_dot2c_f32_bf16 v14, s28, v98
    v_dot2c_f32_bf16 v15, s29, v98
    v_dot2c_f32_bf16 v16, s28, v99
    v_dot2c_f32_bf16 v17, s29, v99
    s_waitcnt vmcnt(6)
    v_dot2c_f32_bf16 v18, s28, v100
    v_dot2c_f32_bf16 v19, s29, v100
    v_dot2c_f32_bf16 v20, s28, v101
    v_dot2c_f32_bf16 v21, s29, v101
    v_dot2c_f32_bf16 v22, s28, v102
    v_dot2c_f32_bf16 v23, s29, v102
    v_dot2c_f32_bf16 v24, s28, v103
    v_dot2c_f32_bf16 v25, s29, v103
    v_mad_u32_u16 v66, v33, s30, v8 op_sel:[1,0,0,0]
    buffer_load_dwordx4 v[96:99], v66, s[20:23], 0 offen sc1
    v_mad_u32_u16 v67, v53, s30, v8 op_sel:[1,0,0,0]
    buffer_load_dwordx4 v[100:103], v67, s[20:23], 0 offen sc1
    s_waitcnt vmcnt(7)
    v_dot2c_f32_bf16 v10, s28, v72
    v_dot2c_f32_bf16 v11, s29, v72
    v_dot2c_f32_bf16 v12, s28, v73
    v_dot2c_f32_bf16 v13, s29, v73
    v_dot2c_f32_bf16 v14, s28, v74
    v_dot2c_f32_bf16 v15, s29, v74
    v_dot2c_f32_bf16 v16, s28, v75
    v_dot2c_f32_bf16 v17, s29, v75
    s_waitcnt vmcnt(6)
    v_dot2c_f32_bf16 v18, s28, v76
    v_dot2c_f32_bf16 v19, s29, v76
    v_dot2c_f32_bf16 v20, s28, v77
    v_dot2c_f32_bf16 v21, s29, v77
    v_dot2c_f32_bf16 v22, s28, v78
    v_dot2c_f32_bf16 v23, s29, v78
    v_dot2c_f32_bf16 v24, s28, v79
    v_dot2c_f32_bf16 v25, s29, v79
    v_mad_u32_u16 v66, v34, s30, v8 op_sel:[0,0,0,0]
    buffer_load_dwordx4 v[72:75], v66, s[20:23], 0 offen sc1
    v_mad_u32_u16 v67, v54, s30, v8 op_sel:[0,0,0,0]
    buffer_load_dwordx4 v[76:79], v67, s[20:23], 0 offen sc1
    s_waitcnt vmcnt(7)
    v_dot2c_f32_bf16 v10, s28, v80
    v_dot2c_f32_bf16 v11, s29, v80
    v_dot2c_f32_bf16 v12, s28, v81
    v_dot2c_f32_bf16 v13, s29, v81
    v_dot2c_f32_bf16 v14, s28, v82
    v_dot2c_f32_bf16 v15, s29, v82
    v_dot2c_f32_bf16 v16, s28, v83
    v_dot2c_f32_bf16 v17, s29, v83
    s_waitcnt vmcnt(6)
    v_dot2c_f32_bf16 v18, s28, v84
    v_dot2c_f32_bf16 v19, s29, v84
    v_dot2c_f32_bf16 v20, s28, v85
    v_dot2c_f32_bf16 v21, s29, v85
    v_dot2c_f32_bf16 v22, s28, v86
    v_dot2c_f32_bf16 v23, s29, v86
    v_dot2c_f32_bf16 v24, s28, v87
    v_dot2c_f32_bf16 v25, s29, v87
    s_setprio 1
    v_mad_u32_u16 v66, v34, s30, v8 op_sel:[1,0,0,0]
    buffer_load_dwordx4 v[80:83], v66, s[20:23], 0 offen sc1
    v_mad_u32_u16 v67, v54, s30, v8 op_sel:[1,0,0,0]
    buffer_load_dwordx4 v[84:87], v67, s[20:23], 0 offen sc1
    s_waitcnt vmcnt(7)
    v_dot2c_f32_bf16 v10, s28, v88
    v_dot2c_f32_bf16 v11, s29, v88
    v_dot2c_f32_bf16 v12, s28, v89
    v_dot2c_f32_bf16 v13, s29, v89
    v_dot2c_f32_bf16 v14, s28, v90
    v_dot2c_f32_bf16 v15, s29, v90
    v_dot2c_f32_bf16 v16, s28, v91
    v_dot2c_f32_bf16 v17, s29, v91
    s_waitcnt vmcnt(6)
    v_dot2c_f32_bf16 v18, s28, v92
    v_dot2c_f32_bf16 v19, s29, v92
    v_dot2c_f32_bf16 v20, s28, v93
    v_dot2c_f32_bf16 v21, s29, v93
    v_dot2c_f32_bf16 v22, s28, v94
    v_dot2c_f32_bf16 v23, s29, v94
    v_dot2c_f32_bf16 v24, s28, v95
    v_dot2c_f32_bf16 v25, s29, v95
    v_mad_u32_u16 v66, v35, s30, v8 op_sel:[0,0,0,0]
    buffer_load_dwordx4 v[88:91], v66, s[20:23], 0 offen sc1
    v_mad_u32_u16 v67, v55, s30, v8 op_sel:[0,0,0,0]
    buffer_load_dwordx4 v[92:95], v67, s[20:23], 0 offen sc1
    s_waitcnt vmcnt(7)
    v_dot2c_f32_bf16 v10, s28, v96
    v_dot2c_f32_bf16 v11, s29, v96
    v_dot2c_f32_bf16 v12, s28, v97
    v_dot2c_f32_bf16 v13, s29, v97
    v_dot2c_f32_bf16 v14, s28, v98
    v_dot2c_f32_bf16 v15, s29, v98
    v_dot2c_f32_bf16 v16, s28, v99
    v_dot2c_f32_bf16 v17, s29, v99
    s_waitcnt vmcnt(6)
    v_dot2c_f32_bf16 v18, s28, v100
    v_dot2c_f32_bf16 v19, s29, v100
    v_dot2c_f32_bf16 v20, s28, v101
    v_dot2c_f32_bf16 v21, s29, v101
    v_dot2c_f32_bf16 v22, s28, v102
    v_dot2c_f32_bf16 v23, s29, v102
    v_dot2c_f32_bf16 v24, s28, v103
    v_dot2c_f32_bf16 v25, s29, v103
    v_mad_u32_u16 v66, v35, s30, v8 op_sel:[1,0,0,0]
    buffer_load_dwordx4 v[96:99], v66, s[20:23], 0 offen sc1
    v_mad_u32_u16 v67, v55, s30, v8 op_sel:[1,0,0,0]
    buffer_load_dwordx4 v[100:103], v67, s[20:23], 0 offen sc1
    s_waitcnt vmcnt(7)
    v_dot2c_f32_bf16 v10, s28, v72
    v_dot2c_f32_bf16 v11, s29, v72
    v_dot2c_f32_bf16 v12, s28, v73
    v_dot2c_f32_bf16 v13, s29, v73
    v_dot2c_f32_bf16 v14, s28, v74
    v_dot2c_f32_bf16 v15, s29, v74
    v_dot2c_f32_bf16 v16, s28, v75
    v_dot2c_f32_bf16 v17, s29, v75
    s_waitcnt vmcnt(6)
    v_dot2c_f32_bf16 v18, s28, v76
    v_dot2c_f32_bf16 v19, s29, v76
    v_dot2c_f32_bf16 v20, s28, v77
    v_dot2c_f32_bf16 v21, s29, v77
    v_dot2c_f32_bf16 v22, s28, v78
    v_dot2c_f32_bf16 v23, s29, v78
    v_dot2c_f32_bf16 v24, s28, v79
    v_dot2c_f32_bf16 v25, s29, v79
    v_mad_u32_u16 v66, v36, s30, v8 op_sel:[0,0,0,0]
    buffer_load_dwordx4 v[72:75], v66, s[20:23], 0 offen sc1
    v_mad_u32_u16 v67, v56, s30, v8 op_sel:[0,0,0,0]
    buffer_load_dwordx4 v[76:79], v67, s[20:23], 0 offen sc1
    s_waitcnt vmcnt(7)
    v_dot2c_f32_bf16 v10, s28, v80
    v_dot2c_f32_bf16 v11, s29, v80
    v_dot2c_f32_bf16 v12, s28, v81
    v_dot2c_f32_bf16 v13, s29, v81
    v_dot2c_f32_bf16 v14, s28, v82
    v_dot2c_f32_bf16 v15, s29, v82
    v_dot2c_f32_bf16 v16, s28, v83
    v_dot2c_f32_bf16 v17, s29, v83
    s_waitcnt vmcnt(6)
    v_dot2c_f32_bf16 v18, s28, v84
    v_dot2c_f32_bf16 v19, s29, v84
    v_dot2c_f32_bf16 v20, s28, v85
    v_dot2c_f32_bf16 v21, s29, v85
    v_dot2c_f32_bf16 v22, s28, v86
    v_dot2c_f32_bf16 v23, s29, v86
    v_dot2c_f32_bf16 v24, s28, v87
    v_dot2c_f32_bf16 v25, s29, v87
    v_mad_u32_u16 v66, v36, s30, v8 op_sel:[1,0,0,0]
    buffer_load_dwordx4 v[80:83], v66, s[20:23], 0 offen sc1
    v_mad_u32_u16 v67, v56, s30, v8 op_sel:[1,0,0,0]
    buffer_load_dwordx4 v[84:87], v67, s[20:23], 0 offen sc1
    s_waitcnt vmcnt(7)
    v_dot2c_f32_bf16 v10, s28, v88
    v_dot2c_f32_bf16 v11, s29, v88
    v_dot2c_f32_bf16 v12, s28, v89
    v_dot2c_f32_bf16 v13, s29, v89
    v_dot2c_f32_bf16 v14, s28, v90
    v_dot2c_f32_bf16 v15, s29, v90
    v_dot2c_f32_bf16 v16, s28, v91
    v_dot2c_f32_bf16 v17, s29, v91
    s_waitcnt vmcnt(6)
    v_dot2c_f32_bf16 v18, s28, v92
    v_dot2c_f32_bf16 v19, s29, v92
    v_dot2c_f32_bf16 v20, s28, v93
    v_dot2c_f32_bf16 v21, s29, v93
    v_dot2c_f32_bf16 v22, s28, v94
    v_dot2c_f32_bf16 v23, s29, v94
    v_dot2c_f32_bf16 v24, s28, v95
    v_dot2c_f32_bf16 v25, s29, v95
    v_mad_u32_u16 v66, v37, s30, v8 op_sel:[0,0,0,0]
    buffer_load_dwordx4 v[88:91], v66, s[20:23], 0 offen sc1
    v_mad_u32_u16 v67, v57, s30, v8 op_sel:[0,0,0,0]
    buffer_load_dwordx4 v[92:95], v67, s[20:23], 0 offen sc1
    s_waitcnt vmcnt(7)
    v_dot2c_f32_bf16 v10, s28, v96
    v_dot2c_f32_bf16 v11, s29, v96
    v_dot2c_f32_bf16 v12, s28, v97
    v_dot2c_f32_bf16 v13, s29, v97
    v_dot2c_f32_bf16 v14, s28, v98
    v_dot2c_f32_bf16 v15, s29, v98
    v_dot2c_f32_bf16 v16, s28, v99
    v_dot2c_f32_bf16 v17, s29, v99
    s_waitcnt vmcnt(6)
    v_dot2c_f32_bf16 v18, s28, v100
    v_dot2c_f32_bf16 v19, s29, v100
    v_dot2c_f32_bf16 v20, s28, v101
    v_dot2c_f32_bf16 v21, s29, v101
    v_dot2c_f32_bf16 v22, s28, v102
    v_dot2c_f32_bf16 v23, s29, v102
    v_dot2c_f32_bf16 v24, s28, v103
    v_dot2c_f32_bf16 v25, s29, v103
    v_mad_u32_u16 v66, v37, s30, v8 op_sel:[1,0,0,0]
    buffer_load_dwordx4 v[96:99], v66, s[20:23], 0 offen sc1
    v_mad_u32_u16 v67, v57, s30, v8 op_sel:[1,0,0,0]
    buffer_load_dwordx4 v[100:103], v67, s[20:23], 0 offen sc1
    s_waitcnt vmcnt(7)
    v_dot2c_f32_bf16 v10, s28, v72
    v_dot2c_f32_bf16 v11, s29, v72
    v_dot2c_f32_bf16 v12, s28, v73
    v_dot2c_f32_bf16 v13, s29, v73
    v_dot2c_f32_bf16 v14, s28, v74
    v_dot2c_f32_bf16 v15, s29, v74
    v_dot2c_f32_bf16 v16, s28, v75
    v_dot2c_f32_bf16 v17, s29, v75
    s_waitcnt vmcnt(6)
    v_dot2c_f32_bf16 v18, s28, v76
    v_dot2c_f32_bf16 v19, s29, v76
    v_dot2c_f32_bf16 v20, s28, v77
    v_dot2c_f32_bf16 v21, s29, v77
    v_dot2c_f32_bf16 v22, s28, v78
    v_dot2c_f32_bf16 v23, s29, v78
    v_dot2c_f32_bf16 v24, s28, v79
    v_dot2c_f32_bf16 v25, s29, v79
    v_mad_u32_u16 v66, v38, s30, v8 op_sel:[0,0,0,0]
    buffer_load_dwordx4 v[72:75], v66, s[20:23], 0 offen sc1
    v_mad_u32_u16 v67, v58, s30, v8 op_sel:[0,0,0,0]
    buffer_load_dwordx4 v[76:79], v67, s[20:23], 0 offen sc1
    s_waitcnt vmcnt(7)
    v_dot2c_f32_bf16 v10, s28, v80
    v_dot2c_f32_bf16 v11, s29, v80
    v_dot2c_f32_bf16 v12, s28, v81
    v_dot2c_f32_bf16 v13, s29, v81
    v_dot2c_f32_bf16 v14, s28, v82
    v_dot2c_f32_bf16 v15, s29, v82
    v_dot2c_f32_bf16 v16, s28, v83
    v_dot2c_f32_bf16 v17, s29, v83
    s_waitcnt vmcnt(6)
    v_dot2c_f32_bf16 v18, s28, v84
    v_dot2c_f32_bf16 v19, s29, v84
    v_dot2c_f32_bf16 v20, s28, v85
    v_dot2c_f32_bf16 v21, s29, v85
    v_dot2c_f32_bf16 v22, s28, v86
    v_dot2c_f32_bf16 v23, s29, v86
    v_dot2c_f32_bf16 v24, s28, v87
    v_dot2c_f32_bf16 v25, s29, v87
    v_mad_u32_u16 v66, v38, s30, v8 op_sel:[1,0,0,0]
    buffer_load_dwordx4 v[80:83], v66, s[20:23], 0 offen sc1
    v_mad_u32_u16 v67, v58, s30, v8 op_sel:[1,0,0,0]
    buffer_load_dwordx4 v[84:87], v67, s[20:23], 0 offen sc1
    s_waitcnt vmcnt(7)
    v_dot2c_f32_bf16 v10, s28, v88
    v_dot2c_f32_bf16 v11, s29, v88
    v_dot2c_f32_bf16 v12, s28, v89
    v_dot2c_f32_bf16 v13, s29, v89
    v_dot2c_f32_bf16 v14, s28, v90
    v_dot2c_f32_bf16 v15, s29, v90
    v_dot2c_f32_bf16 v16, s28, v91
    v_dot2c_f32_bf16 v17, s29, v91
    s_waitcnt vmcnt(6)
    v_dot2c_f32_bf16 v18, s28, v92
    v_dot2c_f32_bf16 v19, s29, v92
    v_dot2c_f32_bf16 v20, s28, v93
    v_dot2c_f32_bf16 v21, s29, v93
    v_dot2c_f32_bf16 v22, s28, v94
    v_dot2c_f32_bf16 v23, s29, v94
    v_dot2c_f32_bf16 v24, s28, v95
    v_dot2c_f32_bf16 v25, s29, v95
    s_setprio 0
    v_mad_u32_u16 v66, v39, s30, v8 op_sel:[0,0,0,0]
    buffer_load_dwordx4 v[88:91], v66, s[20:23], 0 offen sc1
    v_mad_u32_u16 v67, v59, s30, v8 op_sel:[0,0,0,0]
    buffer_load_dwordx4 v[92:95], v67, s[20:23], 0 offen sc1
    s_waitcnt vmcnt(7)
    v_dot2c_f32_bf16 v10, s28, v96
    v_dot2c_f32_bf16 v11, s29, v96
    v_dot2c_f32_bf16 v12, s28, v97
    v_dot2c_f32_bf16 v13, s29, v97
    v_dot2c_f32_bf16 v14, s28, v98
    v_dot2c_f32_bf16 v15, s29, v98
    v_dot2c_f32_bf16 v16, s28, v99
    v_dot2c_f32_bf16 v17, s29, v99
    s_waitcnt vmcnt(6)
    v_dot2c_f32_bf16 v18, s28, v100
    v_dot2c_f32_bf16 v19, s29, v100
    v_dot2c_f32_bf16 v20, s28, v101
    v_dot2c_f32_bf16 v21, s29, v101
    v_dot2c_f32_bf16 v22, s28, v102
    v_dot2c_f32_bf16 v23, s29, v102
    v_dot2c_f32_bf16 v24, s28, v103
    v_dot2c_f32_bf16 v25, s29, v103
    v_mad_u32_u16 v66, v39, s30, v8 op_sel:[1,0,0,0]
    buffer_load_dwordx4 v[96:99], v66, s[20:23], 0 offen sc1
    v_mad_u32_u16 v67, v59, s30, v8 op_sel:[1,0,0,0]
    buffer_load_dwordx4 v[100:103], v67, s[20:23], 0 offen sc1
    s_waitcnt vmcnt(7)
    v_dot2c_f32_bf16 v10, s28, v72
    v_dot2c_f32_bf16 v11, s29, v72
    v_dot2c_f32_bf16 v12, s28, v73
    v_dot2c_f32_bf16 v13, s29, v73
    v_dot2c_f32_bf16 v14, s28, v74
    v_dot2c_f32_bf16 v15, s29, v74
    v_dot2c_f32_bf16 v16, s28, v75
    v_dot2c_f32_bf16 v17, s29, v75
    s_waitcnt vmcnt(6)
    v_dot2c_f32_bf16 v18, s28, v76
    v_dot2c_f32_bf16 v19, s29, v76
    v_dot2c_f32_bf16 v20, s28, v77
    v_dot2c_f32_bf16 v21, s29, v77
    v_dot2c_f32_bf16 v22, s28, v78
    v_dot2c_f32_bf16 v23, s29, v78
    v_dot2c_f32_bf16 v24, s28, v79
    v_dot2c_f32_bf16 v25, s29, v79
    v_mad_u32_u16 v66, v40, s30, v8 op_sel:[0,0,0,0]
    buffer_load_dwordx4 v[72:75], v66, s[20:23], 0 offen sc1
    v_mad_u32_u16 v67, v60, s30, v8 op_sel:[0,0,0,0]
    buffer_load_dwordx4 v[76:79], v67, s[20:23], 0 offen sc1
    s_waitcnt vmcnt(7)
    v_dot2c_f32_bf16 v10, s28, v80
    v_dot2c_f32_bf16 v11, s29, v80
    v_dot2c_f32_bf16 v12, s28, v81
    v_dot2c_f32_bf16 v13, s29, v81
    v_dot2c_f32_bf16 v14, s28, v82
    v_dot2c_f32_bf16 v15, s29, v82
    v_dot2c_f32_bf16 v16, s28, v83
    v_dot2c_f32_bf16 v17, s29, v83
    s_waitcnt vmcnt(6)
    v_dot2c_f32_bf16 v18, s28, v84
    v_dot2c_f32_bf16 v19, s29, v84
    v_dot2c_f32_bf16 v20, s28, v85
    v_dot2c_f32_bf16 v21, s29, v85
    v_dot2c_f32_bf16 v22, s28, v86
    v_dot2c_f32_bf16 v23, s29, v86
    v_dot2c_f32_bf16 v24, s28, v87
    v_dot2c_f32_bf16 v25, s29, v87
    v_mad_u32_u16 v66, v40, s30, v8 op_sel:[1,0,0,0]
    buffer_load_dwordx4 v[80:83], v66, s[20:23], 0 offen sc1
    v_mad_u32_u16 v67, v60, s30, v8 op_sel:[1,0,0,0]
    buffer_load_dwordx4 v[84:87], v67, s[20:23], 0 offen sc1
    s_waitcnt vmcnt(7)
    v_dot2c_f32_bf16 v10, s28, v88
    v_dot2c_f32_bf16 v11, s29, v88
    v_dot2c_f32_bf16 v12, s28, v89
    v_dot2c_f32_bf16 v13, s29, v89
    v_dot2c_f32_bf16 v14, s28, v90
    v_dot2c_f32_bf16 v15, s29, v90
    v_dot2c_f32_bf16 v16, s28, v91
    v_dot2c_f32_bf16 v17, s29, v91
    s_waitcnt vmcnt(6)
    v_dot2c_f32_bf16 v18, s28, v92
    v_dot2c_f32_bf16 v19, s29, v92
    v_dot2c_f32_bf16 v20, s28, v93
    v_dot2c_f32_bf16 v21, s29, v93
    v_dot2c_f32_bf16 v22, s28, v94
    v_dot2c_f32_bf16 v23, s29, v94
    v_dot2c_f32_bf16 v24, s28, v95
    v_dot2c_f32_bf16 v25, s29, v95
    v_mad_u32_u16 v66, v41, s30, v8 op_sel:[0,0,0,0]
    buffer_load_dwordx4 v[88:91], v66, s[20:23], 0 offen sc1
    v_mad_u32_u16 v67, v61, s30, v8 op_sel:[0,0,0,0]
    buffer_load_dwordx4 v[92:95], v67, s[20:23], 0 offen sc1
    s_waitcnt vmcnt(7)
    v_dot2c_f32_bf16 v10, s28, v96
    v_dot2c_f32_bf16 v11, s29, v96
    v_dot2c_f32_bf16 v12, s28, v97
    v_dot2c_f32_bf16 v13, s29, v97
    v_dot2c_f32_bf16 v14, s28, v98
    v_dot2c_f32_bf16 v15, s29, v98
    v_dot2c_f32_bf16 v16, s28, v99
    v_dot2c_f32_bf16 v17, s29, v99
    s_waitcnt vmcnt(6)
    v_dot2c_f32_bf16 v18, s28, v100
    v_dot2c_f32_bf16 v19, s29, v100
    v_dot2c_f32_bf16 v20, s28, v101
    v_dot2c_f32_bf16 v21, s29, v101
    v_dot2c_f32_bf16 v22, s28, v102
    v_dot2c_f32_bf16 v23, s29, v102
    v_dot2c_f32_bf16 v24, s28, v103
    v_dot2c_f32_bf16 v25, s29, v103
    v_mad_u32_u16 v66, v41, s30, v8 op_sel:[1,0,0,0]
    buffer_load_dwordx4 v[96:99], v66, s[20:23], 0 offen sc1
    v_mad_u32_u16 v67, v61, s30, v8 op_sel:[1,0,0,0]
    buffer_load_dwordx4 v[100:103], v67, s[20:23], 0 offen sc1
    s_waitcnt vmcnt(7)
    v_dot2c_f32_bf16 v10, s28, v72
    v_dot2c_f32_bf16 v11, s29, v72
    v_dot2c_f32_bf16 v12, s28, v73
    v_dot2c_f32_bf16 v13, s29, v73
    v_dot2c_f32_bf16 v14, s28, v74
    v_dot2c_f32_bf16 v15, s29, v74
    v_dot2c_f32_bf16 v16, s28, v75
    v_dot2c_f32_bf16 v17, s29, v75
    s_waitcnt vmcnt(6)
    v_dot2c_f32_bf16 v18, s28, v76
    v_dot2c_f32_bf16 v19, s29, v76
    v_dot2c_f32_bf16 v20, s28, v77
    v_dot2c_f32_bf16 v21, s29, v77
    v_dot2c_f32_bf16 v22, s28, v78
    v_dot2c_f32_bf16 v23, s29, v78
    v_dot2c_f32_bf16 v24, s28, v79
    v_dot2c_f32_bf16 v25, s29, v79
    v_mad_u32_u16 v66, v42, s30, v8 op_sel:[0,0,0,0]
    buffer_load_dwordx4 v[72:75], v66, s[20:23], 0 offen sc1
    v_mad_u32_u16 v67, v62, s30, v8 op_sel:[0,0,0,0]
    buffer_load_dwordx4 v[76:79], v67, s[20:23], 0 offen sc1
    s_waitcnt vmcnt(7)
    v_dot2c_f32_bf16 v10, s28, v80
    v_dot2c_f32_bf16 v11, s29, v80
    v_dot2c_f32_bf16 v12, s28, v81
    v_dot2c_f32_bf16 v13, s29, v81
    v_dot2c_f32_bf16 v14, s28, v82
    v_dot2c_f32_bf16 v15, s29, v82
    v_dot2c_f32_bf16 v16, s28, v83
    v_dot2c_f32_bf16 v17, s29, v83
    s_waitcnt vmcnt(6)
    v_dot2c_f32_bf16 v18, s28, v84
    v_dot2c_f32_bf16 v19, s29, v84
    v_dot2c_f32_bf16 v20, s28, v85
    v_dot2c_f32_bf16 v21, s29, v85
    v_dot2c_f32_bf16 v22, s28, v86
    v_dot2c_f32_bf16 v23, s29, v86
    v_dot2c_f32_bf16 v24, s28, v87
    v_dot2c_f32_bf16 v25, s29, v87
    v_mad_u32_u16 v66, v42, s30, v8 op_sel:[1,0,0,0]
    buffer_load_dwordx4 v[80:83], v66, s[20:23], 0 offen sc1
    v_mad_u32_u16 v67, v62, s30, v8 op_sel:[1,0,0,0]
    buffer_load_dwordx4 v[84:87], v67, s[20:23], 0 offen sc1
    s_waitcnt vmcnt(7)
    v_dot2c_f32_bf16 v10, s28, v88
    v_dot2c_f32_bf16 v11, s29, v88
    v_dot2c_f32_bf16 v12, s28, v89
    v_dot2c_f32_bf16 v13, s29, v89
    v_dot2c_f32_bf16 v14, s28, v90
    v_dot2c_f32_bf16 v15, s29, v90
    v_dot2c_f32_bf16 v16, s28, v91
    v_dot2c_f32_bf16 v17, s29, v91
    s_waitcnt vmcnt(6)
    v_dot2c_f32_bf16 v18, s28, v92
    v_dot2c_f32_bf16 v19, s29, v92
    v_dot2c_f32_bf16 v20, s28, v93
    v_dot2c_f32_bf16 v21, s29, v93
    v_dot2c_f32_bf16 v22, s28, v94
    v_dot2c_f32_bf16 v23, s29, v94
    v_dot2c_f32_bf16 v24, s28, v95
    v_dot2c_f32_bf16 v25, s29, v95
    s_waitcnt vmcnt(5)
    v_dot2c_f32_bf16 v10, s28, v96
    v_dot2c_f32_bf16 v11, s29, v96
    v_dot2c_f32_bf16 v12, s28, v97
    v_dot2c_f32_bf16 v13, s29, v97
    v_dot2c_f32_bf16 v14, s28, v98
    v_dot2c_f32_bf16 v15, s29, v98
    v_dot2c_f32_bf16 v16, s28, v99
    v_dot2c_f32_bf16 v17, s29, v99
    s_waitcnt vmcnt(4)
    v_dot2c_f32_bf16 v18, s28, v100
    v_dot2c_f32_bf16 v19, s29, v100
    v_dot2c_f32_bf16 v20, s28, v101
    v_dot2c_f32_bf16 v21, s29, v101
    v_dot2c_f32_bf16 v22, s28, v102
    v_dot2c_f32_bf16 v23, s29, v102
    v_dot2c_f32_bf16 v24, s28, v103
    v_dot2c_f32_bf16 v25, s29, v103
    s_waitcnt vmcnt(3)
    v_dot2c_f32_bf16 v10, s28, v72
    v_dot2c_f32_bf16 v11, s29, v72
    v_dot2c_f32_bf16 v12, s28, v73
    v_dot2c_f32_bf16 v13, s29, v73
    v_dot2c_f32_bf16 v14, s28, v74
    v_dot2c_f32_bf16 v15, s29, v74
    v_dot2c_f32_bf16 v16, s28, v75
    v_dot2c_f32_bf16 v17, s29, v75
    s_waitcnt vmcnt(2)
    v_dot2c_f32_bf16 v18, s28, v76
    v_dot2c_f32_bf16 v19, s29, v76
    v_dot2c_f32_bf16 v20, s28, v77
    v_dot2c_f32_bf16 v21, s29, v77
    v_dot2c_f32_bf16 v22, s28, v78
    v_dot2c_f32_bf16 v23, s29, v78
    v_dot2c_f32_bf16 v24, s28, v79
    v_dot2c_f32_bf16 v25, s29, v79
    s_waitcnt vmcnt(1)
    v_dot2c_f32_bf16 v10, s28, v80
    v_dot2c_f32_bf16 v11, s29, v80
    v_dot2c_f32_bf16 v12, s28, v81
    v_dot2c_f32_bf16 v13, s29, v81
    v_dot2c_f32_bf16 v14, s28, v82
    v_dot2c_f32_bf16 v15, s29, v82
    v_dot2c_f32_bf16 v16, s28, v83
    v_dot2c_f32_bf16 v17, s29, v83
    s_waitcnt vmcnt(0)
    v_dot2c_f32_bf16 v18, s28, v84
    v_dot2c_f32_bf16 v19, s29, v84
    v_dot2c_f32_bf16 v20, s28, v85
    v_dot2c_f32_bf16 v21, s29, v85
    v_dot2c_f32_bf16 v22, s28, v86
    v_dot2c_f32_bf16 v23, s29, v86
    v_dot2c_f32_bf16 v24, s28, v87
    v_dot2c_f32_bf16 v25, s29, v87
    s_branch hop_fin
hop_w18:
    s_setprio 3
    v_mad_u32_u16 v66, v26, s30, v8 op_sel:[0,0,0,0]
    buffer_load_dwordx4 v[72:75], v66, s[20:23], 0 offen sc1
    v_mad_u32_u16 v67, v46, s30, v8 op_sel:[0,0,0,0]
    buffer_load_dwordx4 v[76:79], v67, s[20:23], 0 offen sc1
    v_mad_u32_u16 v66, v26, s30, v8 op_sel:[1,0,0,0]
    buffer_load_dwordx4 v[80:83], v66, s[20:23], 0 offen sc1
    v_mad_u32_u16 v67, v46, s30, v8 op_sel:[1,0,0,0]
    buffer_load_dwordx4 v[84:87], v67, s[20:23], 0 offen sc1
    v_mad_u32_u16 v66, v27, s30, v8 op_sel:[0,0,0,0]
    buffer_load_dwordx4 v[88:91], v66, s[20:23], 0 offen sc1
    v_mad_u32_u16 v67, v47, s30, v8 op_sel:[0,0,0,0]
    buffer_load_dwordx4 v[92:95], v67, s[20:23], 0 offen sc1
    v_mad_u32_u16 v66, v27, s30, v8 op_sel:[1,0,0,0]
    buffer_load_dwordx4 v[96:99], v66, s[20:23], 0 offen sc1
    v_mad_u32_u16 v67, v47, s30, v8 op_sel:[1,0,0,0]
    buffer_load_dwordx4 v[100:103], v67, s[20:23], 0 offen sc1
    s_waitcnt vmcnt(7)
    v_dot2c_f32_bf16 v10, s28, v72
    v_dot2c_f32_bf16 v11, s29, v72
    v_dot2c_f32_bf16 v12, s28, v73
    v_dot2c_f32_bf16 v13, s29, v73
    v_dot2c_f32_bf16 v14, s28, v74
    v_dot2c_f32_bf16 v15, s29, v74
    v_dot2c_f32_bf16 v16, s28, v75
    v_dot2c_f32_bf16 v17, s29, v75
    s_waitcnt vmcnt(6)
    v_dot2c_f32_bf16 v18, s28, v76
    v_dot2c_f32_bf16 v19, s29, v76
    v_dot2c_f32_bf16 v20, s28, v77
    v_dot2c_f32_bf16 v21, s29, v77
    v_dot2c_f32_bf16 v22, s28, v78
    v_dot2c_f32_bf16 v23, s29, v78
    v_dot2c_f32_bf16 v24, s28, v79
    v_dot2c_f32_bf16 v25, s29, v79
    v_mad_u32_u16 v66, v28, s30, v8 op_sel:[0,0,0,0]
    buffer_load_dwordx4 v[72:75], v66, s[20:23], 0 offen sc1
    v_mad_u32_u16 v67, v48, s30, v8 op_sel:[0,0,0,0]
    buffer_load_dwordx4 v[76:79], v67, s[20:23], 0 offen sc1
    s_waitcnt vmcnt(7)
    v_dot2c_f32_bf16 v10, s28, v80
    v_dot2c_f32_bf16 v11, s29, v80
    v_dot2c_f32_bf16 v12, s28, v81
    v_dot2c_f32_bf16 v13, s29, v81
    v_dot2c_f32_bf16 v14, s28, v82
    v_dot2c_f32_bf16 v15, s29, v82
    v_dot2c_f32_bf16 v16, s28, v83
    v_dot2c_f32_bf16 v17, s29, v83
    s_waitcnt vmcnt(6)
    v_dot2c_f32_bf16 v18, s28, v84
    v_dot2c_f32_bf16 v19, s29, v84
    v_dot2c_f32_bf16 v20, s28, v85
    v_dot2c_f32_bf16 v21, s29, v85
    v_dot2c_f32_bf16 v22, s28, v86
    v_dot2c_f32_bf16 v23, s29, v86
    v_dot2c_f32_bf16 v24, s28, v87
    v_dot2c_f32_bf16 v25, s29, v87
    v_mad_u32_u16 v66, v28, s30, v8 op_sel:[1,0,0,0]
    buffer_load_dwordx4 v[80:83], v66, s[20:23], 0 offen sc1
    v_mad_u32_u16 v67, v48, s30, v8 op_sel:[1,0,0,0]
    buffer_load_dwordx4 v[84:87], v67, s[20:23], 0 offen sc1
    s_waitcnt vmcnt(7)
    v_dot2c_f32_bf16 v10, s28, v88
    v_dot2c_f32_bf16 v11, s29, v88
    v_dot2c_f32_bf16 v12, s28, v89
    v_dot2c_f32_bf16 v13, s29, v89
    v_dot2c_f32_bf16 v14, s28, v90
    v_dot2c_f32_bf16 v15, s29, v90
    v_dot2c_f32_bf16 v16, s28, v91
    v_dot2c_f32_bf16 v17, s29, v91
    s_waitcnt vmcnt(6)
    v_dot2c_f32_bf16 v18, s28, v92
    v_dot2c_f32_bf16 v19, s29, v92
    v_dot2c_f32_bf16 v20, s28, v93
    v_dot2c_f32_bf16 v21, s29, v93
    v_dot2c_f32_bf16 v22, s28, v94
    v_dot2c_f32_bf16 v23, s29, v94
    v_dot2c_f32_bf16 v24, s28, v95
    v_dot2c_f32_bf16 v25, s29, v95
    v_mad_u32_u16 v66, v29, s30, v8 op_sel:[0,0,0,0]
    buffer_load_dwordx4 v[88:91], v66, s[20:23], 0 offen sc1
    v_mad_u32_u16 v67, v49, s30, v8 op_sel:[0,0,0,0]
    buffer_load_dwordx4 v[92:95], v67, s[20:23], 0 offen sc1
    s_waitcnt vmcnt(7)
    v_dot2c_f32_bf16 v10, s28, v96
    v_dot2c_f32_bf16 v11, s29, v96
    v_dot2c_f32_bf16 v12, s28, v97
    v_dot2c_f32_bf16 v13, s29, v97
    v_dot2c_f32_bf16 v14, s28, v98
    v_dot2c_f32_bf16 v15, s29, v98
    v_dot2c_f32_bf16 v16, s28, v99
    v_dot2c_f32_bf16 v17, s29, v99
    s_waitcnt vmcnt(6)
    v_dot2c_f32_bf16 v18, s28, v100
    v_dot2c_f32_bf16 v19, s29, v100
    v_dot2c_f32_bf16 v20, s28, v101
    v_dot2c_f32_bf16 v21, s29, v101
    v_dot2c_f32_bf16 v22, s28, v102
    v_dot2c_f32_bf16 v23, s29, v102
    v_dot2c_f32_bf16 v24, s28, v103
    v_dot2c_f32_bf16 v25, s29, v103
    v_mad_u32_u16 v66, v29, s30, v8 op_sel:[1,0,0,0]
    buffer_load_dwordx4 v[96:99], v66, s[20:23], 0 offen sc1
    v_mad_u32_u16 v67, v49, s30, v8 op_sel:[1,0,0,0]
    buffer_load_dwordx4 v[100:103], v67, s[20:23], 0 offen sc1
    s_waitcnt vmcnt(7)
    v_dot2c_f32_bf16 v10, s28, v72
    v_dot2c_f32_bf16 v11, s29, v72
    v_dot2c_f32_bf16 v12, s28, v73
    v_dot2c_f32_bf16 v13, s29, v73
    v_dot2c_f32_bf16 v14, s28, v74
    v_dot2c_f32_bf16 v15, s29, v74
    v_dot2c_f32_bf16 v16, s28, v75
    v_dot2c_f32_bf16 v17, s29, v75
    s_waitcnt vmcnt(6)
    v_dot2c_f32_bf16 v18, s28, v76
    v_dot2c_f32_bf16 v19, s29, v76
    v_dot2c_f32_bf16 v20, s28, v77
    v_dot2c_f32_bf16 v21, s29, v77
    v_dot2c_f32_bf16 v22, s28, v78
    v_dot2c_f32_bf16 v23, s29, v78
    v_dot2c_f32_bf16 v24, s28, v79
    v_dot2c_f32_bf16 v25, s29, v79
    v_mad_u32_u16 v66, v30, s30, v8 op_sel:[0,0,0,0]
    buffer_load_dwordx4 v[72:75], v66, s[20:23], 0 offen sc1
    v_mad_u32_u16 v67, v50, s30, v8 op_sel:[0,0,0,0]
    buffer_load_dwordx4 v[76:79], v67, s[20:23], 0 offen sc1
    s_waitcnt vmcnt(7)
    v_dot2c_f32_bf16 v10, s28, v80
    v_dot2c_f32_bf16 v11, s29, v80
    v_dot2c_f32_bf16 v12, s28, v81
    v_dot2c_f32_bf16 v13, s29, v81
    v_dot2c_f32_bf16 v14, s28, v82
    v_dot2c_f32_bf16 v15, s29, v82
    v_dot2c_f32_bf16 v16, s28, v83
    v_dot2c_f32_bf16 v17, s29, v83
    s_waitcnt vmcnt(6)
    v_dot2c_f32_bf16 v18, s28, v84
    v_dot2c_f32_bf16 v19, s29, v84
    v_dot2c_f32_bf16 v20, s28, v85
    v_dot2c_f32_bf16 v21, s29, v85
    v_dot2c_f32_bf16 v22, s28, v86
    v_dot2c_f32_bf16 v23, s29, v86
    v_dot2c_f32_bf16 v24, s28, v87
    v_dot2c_f32_bf16 v25, s29, v87
    s_setprio 2
    v_mad_u32_u16 v66, v30, s30, v8 op_sel:[1,0,0,0]
    buffer_load_dwordx4 v[80:83], v66, s[20:23], 0 offen sc1
    v_mad_u32_u16 v67, v50, s30, v8 op_sel:[1,0,0,0]
    buffer_load_dwordx4 v[84:87], v67, s[20:23], 0 offen sc1
    s_waitcnt vmcnt(7)
    v_dot2c_f32_bf16 v10, s28, v88
    v_dot2c_f32_bf16 v11, s29, v88
    v_dot2c_f32_bf16 v12, s28, v89
    v_dot2c_f32_bf16 v13, s29, v89
    v_dot2c_f32_bf16 v14, s28, v90
    v_dot2c_f32_bf16 v15, s29, v90
    v_dot2c_f32_bf16 v16, s28, v91
    v_dot2c_f32_bf16 v17, s29, v91
    s_waitcnt vmcnt(6)
    v_dot2c_f32_bf16 v18, s28, v92
    v_dot2c_f32_bf16 v19, s29, v92
    v_dot2c_f32_bf16 v20, s28, v93
    v_dot2c_f32_bf16 v21, s29, v93
    v_dot2c_f32_bf16 v22, s28, v94
    v_dot2c_f32_bf16 v23, s29, v94
    v_dot2c_f32_bf16 v24, s28, v95
    v_dot2c_f32_bf16 v25, s29, v95
    v_mad_u32_u16 v66, v31, s30, v8 op_sel:[0,0,0,0]
    buffer_load_dwordx4 v[88:91], v66, s[20:23], 0 offen sc1
    v_mad_u32_u16 v67, v51, s30, v8 op_sel:[0,0,0,0]
    buffer_load_dwordx4 v[92:95], v67, s[20:23], 0 offen sc1
    s_waitcnt vmcnt(7)
    v_dot2c_f32_bf16 v10, s28, v96
    v_dot2c_f32_bf16 v11, s29, v96
    v_dot2c_f32_bf16 v12, s28, v97
    v_dot2c_f32_bf16 v13, s29, v97
    v_dot2c_f32_bf16 v14, s28, v98
    v_dot2c_f32_bf16 v15, s29, v98
    v_dot2c_f32_bf16 v16, s28, v99
    v_dot2c_f32_bf16 v17, s29, v99
    s_waitcnt vmcnt(6)
    v_dot2c_f32_bf16 v18, s28, v100
    v_dot2c_f32_bf16 v19, s29, v100
    v_dot2c_f32_bf16 v20, s28, v101
    v_dot2c_f32_bf16 v21, s29, v101
    v_dot2c_f32_bf16 v22, s28, v102
    v_dot2c_f32_bf16 v23, s29, v102
    v_dot2c_f32_bf16 v24, s28, v103
    v_dot2c_f32_bf16 v25, s29, v103
    v_mad_u32_u16 v66, v31, s30, v8 op_sel:[1,0,0,0]
    buffer_load_dwordx4 v[96:99], v66, s[20:23], 0 offen sc1
    v_mad_u32_u16 v67, v51, s30, v8 op_sel:[1,0,0,0]
    buffer_load_dwordx4 v[100:103], v67, s[20:23], 0 offen sc1
    s_waitcnt vmcnt(7)
    v_dot2c_f32_bf16 v10, s28, v72
    v_dot2c_f32_bf16 v11, s29, v72
    v_dot2c_f32_bf16 v12, s28, v73
    v_dot2c_f32_bf16 v13, s29, v73
    v_dot2c_f32_bf16 v14, s28, v74
    v_dot2c_f32_bf16 v15, s29, v74
    v_dot2c_f32_bf16 v16, s28, v75
    v_dot2c_f32_bf16 v17, s29, v75
    s_waitcnt vmcnt(6)
    v_dot2c_f32_bf16 v18, s28, v76
    v_dot2c_f32_bf16 v19, s29, v76
    v_dot2c_f32_bf16 v20, s28, v77
    v_dot2c_f32_bf16 v21, s29, v77
    v_dot2c_f32_bf16 v22, s28, v78
    v_dot2c_f32_bf16 v23, s29, v78
    v_dot2c_f32_bf16 v24, s28, v79
    v_dot2c_f32_bf16 v25, s29, v79
    v_mad_u32_u16 v66, v32, s30, v8 op_sel:[0,0,0,0]
    buffer_load_dwordx4 v[72:75], v66, s[20:23], 0 offen sc1
    v_mad_u32_u16 v67, v52, s30, v8 op_sel:[0,0,0,0]
    buffer_load_dwordx4 v[76:79], v67, s[20:23], 0 offen sc1
    s_waitcnt vmcnt(7)
    v_dot2c_f32_bf16 v10, s28, v80
    v_dot2c_f32_bf16 v11, s29, v80
    v_dot2c_f32_bf16 v12, s28, v81
    v_dot2c_f32_bf16 v13, s29, v81
    v_dot2c_f32_bf16 v14, s28, v82
    v_dot2c_f32_bf16 v15, s29, v82
    v_dot2c_f32_bf16 v16, s28, v83
    v_dot2c_f32_bf16 v17, s29, v83
    s_waitcnt vmcnt(6)
    v_dot2c_f32_bf16 v18, s28, v84
    v_dot2c_f32_bf16 v19, s29, v84
    v_dot2c_f32_bf16 v20, s28, v85
    v_dot2c_f32_bf16 v21, s29, v85
    v_dot2c_f32_bf16 v22, s28, v86
    v_dot2c_f32_bf16 v23, s29, v86
    v_dot2c_f32_bf16 v24, s28, v87
    v_dot2c_f32_bf16 v25, s29, v87
    v_mad_u32_u16 v66, v32, s30, v8 op_sel:[1,0,0,0]
    buffer_load_dwordx4 v[80:83], v66, s[20:23], 0 offen sc1
    v_mad_u32_u16 v67, v52, s30, v8 op_sel:[1,0,0,0]
    buffer_load_dwordx4 v[84:87], v67, s[20:23], 0 offen sc1
    s_waitcnt vmcnt(7)
    v_dot2c_f32_bf16 v10, s28, v88
    v_dot2c_f32_bf16 v11, s29, v88
    v_dot2c_f32_bf16 v12, s28, v89
    v_dot2c_f32_bf16 v13, s29, v89
    v_dot2c_f32_bf16 v14, s28, v90
    v_dot2c_f32_bf16 v15, s29, v90
    v_dot2c_f32_bf16 v16, s28, v91
    v_dot2c_f32_bf16 v17, s29, v91
    s_waitcnt vmcnt(6)
    v_dot2c_f32_bf16 v18, s28, v92
    v_dot2c_f32_bf16 v19, s29, v92
    v_dot2c_f32_bf16 v20, s28, v93
    v_dot2c_f32_bf16 v21, s29, v93
    v_dot2c_f32_bf16 v22, s28, v94
    v_dot2c_f32_bf16 v23, s29, v94
    v_dot2c_f32_bf16 v24, s28, v95
    v_dot2c_f32_bf16 v25, s29, v95
    v_mad_u32_u16 v66, v33, s30, v8 op_sel:[0,0,0,0]
    buffer_load_dwordx4 v[88:91], v66, s[20:23], 0 offen sc1
    v_mad_u32_u16 v67, v53, s30, v8 op_sel:[0,0,0,0]
    buffer_load_dwordx4 v[92:95], v67, s[20:23], 0 offen sc1
    s_waitcnt vmcnt(7)
    v_dot2c_f32_bf16 v10, s28, v96
    v_dot2c_f32_bf16 v11, s29, v96
    v_dot2c_f32_bf16 v12, s28, v97
    v_dot2c_f32_bf16 v13, s29, v97
    v_dot2c_f32_bf16 v14, s28, v98
    v_dot2c_f32_bf16 v15, s29, v98
    v_dot2c_f32_bf16 v16, s28, v99
    v_dot2c_f32_bf16 v17, s29, v99
    s_waitcnt vmcnt(6)
    v_dot2c_f32_bf16 v18, s28, v100
    v_dot2c_f32_bf16 v19, s29, v100
    v_dot2c_f32_bf16 v20, s28, v101
    v_dot2c_f32_bf16 v21, s29, v101
    v_dot2c_f32_bf16 v22, s28, v102
    v_dot2c_f32_bf16 v23, s29, v102
    v_dot2c_f32_bf16 v24, s28, v103
    v_dot2c_f32_bf16 v25, s29, v103
    v_mad_u32_u16 v66, v33, s30, v8 op_sel:[1,0,0,0]
    buffer_load_dwordx4 v[96:99], v66, s[20:23], 0 offen sc1
    v_mad_u32_u16 v67, v53, s30, v8 op_sel:[1,0,0,0]
    buffer_load_dwordx4 v[100:103], v67, s[20:23], 0 offen sc1
    s_waitcnt vmcnt(7)
    v_dot2c_f32_bf16 v10, s28, v72
    v_dot2c_f32_bf16 v11, s29, v72
    v_dot2c_f32_bf16 v12, s28, v73
    v_dot2c_f32_bf16 v13, s29, v73
    v_dot2c_f32_bf16 v14, s28, v74
    v_dot2c_f32_bf16 v15, s29, v74
    v_dot2c_f32_bf16 v16, s28, v75
    v_dot2c_f32_bf16 v17, s29, v75
    s_waitcnt vmcnt(6)
    v_dot2c_f32_bf16 v18, s28, v76
    v_dot2c_f32_bf16 v19, s29, v76
    v_dot2c_f32_bf16 v20, s28, v77
    v_dot2c_f32_bf16 v21, s29, v77
    v_dot2c_f32_bf16 v22, s28, v78
    v_dot2c_f32_bf16 v23, s29, v78
    v_dot2c_f32_bf16 v24, s28, v79
    v_dot2c_f32_bf16 v25, s29, v79
    v_mad_u32_u16 v66, v34, s30, v8 op_sel:[0,0,0,0]
    buffer_load_dwordx4 v[72:75], v66, s[20:23], 0 offen sc1
    v_mad_u32_u16 v67, v54, s30, v8 op_sel:[0,0,0,0]
    buffer_load_dwordx4 v[76:79], v67, s[20:23], 0 offen sc1
    s_waitcnt vmcnt(7)
    v_dot2c_f32_bf16 v10, s28, v80
    v_dot2c_f32_bf16 v11, s29, v80
    v_dot2c_f32_bf16 v12, s28, v81
    v_dot2c_f32_bf16 v13, s29, v81
    v_dot2c_f32_bf16 v14, s28, v82
    v_dot2c_f32_bf16 v15, s29, v82
    v_dot2c_f32_bf16 v16, s28, v83
    v_dot2c_f32_bf16 v17, s29, v83
    s_waitcnt vmcnt(6)
    v_dot2c_f32_bf16 v18, s28, v84
    v_dot2c_f32_bf16 v19, s29, v84
    v_dot2c_f32_bf16 v20, s28, v85
    v_dot2c_f32_bf16 v21, s29, v85
    v_dot2c_f32_bf16 v22, s28, v86
    v_dot2c_f32_bf16 v23, s29, v86
    v_dot2c_f32_bf16 v24, s28, v87
    v_dot2c_f32_bf16 v25, s29, v87
    v_mad_u32_u16 v66, v34, s30, v8 op_sel:[1,0,0,0]
    buffer_load_dwordx4 v[80:83], v66, s[20:23], 0 offen sc1
    v_mad_u32_u16 v67, v54, s30, v8 op_sel:[1,0,0,0]
    buffer_load_dwordx4 v[84:87], v67, s[20:23], 0 offen sc1
    s_waitcnt vmcnt(7)
    v_dot2c_f32_bf16 v10, s28, v88
    v_dot2c_f32_bf16 v11, s29, v88
    v_dot2c_f32_bf16 v12, s28, v89
    v_dot2c_f32_bf16 v13, s29, v89
    v_dot2c_f32_bf16 v14, s28, v90
    v_dot2c_f32_bf16 v15, s29, v90
    v_dot2c_f32_bf16 v16, s28, v91
    v_dot2c_f32_bf16 v17, s29, v91
    s_waitcnt vmcnt(6)
    v_dot2c_f32_bf16 v18, s28, v92
    v_dot2c_f32_bf16 v19, s29, v92
    v_dot2c_f32_bf16 v20, s28, v93
    v_dot2c_f32_bf16 v21, s29, v93
    v_dot2c_f32_bf16 v22, s28, v94
    v_dot2c_f32_bf16 v23, s29, v94
    v_dot2c_f32_bf16 v24, s28, v95
    v_dot2c_f32_bf16 v25, s29, v95
    s_setprio 1
    v_mad_u32_u16 v66, v35, s30, v8 op_sel:[0,0,0,0]
    buffer_load_dwordx4 v[88:91], v66, s[20:23], 0 offen sc1
    v_mad_u32_u16 v67, v55, s30, v8 op_sel:[0,0,0,0]
    buffer_load_dwordx4 v[92:95], v67, s[20:23], 0 offen sc1
    s_waitcnt vmcnt(7)
    v_dot2c_f32_bf16 v10, s28, v96
    v_dot2c_f32_bf16 v11, s29, v96
    v_dot2c_f32_bf16 v12, s28, v97
    v_dot2c_f32_bf16 v13, s29, v97
    v_dot2c_f32_bf16 v14, s28, v98
    v_dot2c_f32_bf16 v15, s29, v98
    v_dot2c_f32_bf16 v16, s28, v99
    v_dot2c_f32_bf16 v17, s29, v99
    s_waitcnt vmcnt(6)
    v_dot2c_f32_bf16 v18, s28, v100
    v_dot2c_f32_bf16 v19, s29, v100
    v_dot2c_f32_bf16 v20, s28, v101
    v_dot2c_f32_bf16 v21, s29, v101
    v_dot2c_f32_bf16 v22, s28, v102
    v_dot2c_f32_bf16 v23, s29, v102
    v_dot2c_f32_bf16 v24, s28, v103
    v_dot2c_f32_bf16 v25, s29, v103
    v_mad_u32_u16 v66, v35, s30, v8 op_sel:[1,0,0,0]
    buffer_load_dwordx4 v[96:99], v66, s[20:23], 0 offen sc1
    v_mad_u32_u16 v67, v55, s30, v8 op_sel:[1,0,0,0]
    buffer_load_dwordx4 v[100:103], v67, s[20:23], 0 offen sc1
    s_waitcnt vmcnt(7)
    v_dot2c_f32_bf16 v10, s28, v72
    v_dot2c_f32_bf16 v11, s29, v72
    v_dot2c_f32_bf16 v12, s28, v73
    v_dot2c_f32_bf16 v13, s29, v73
    v_dot2c_f32_bf16 v14, s28, v74
    v_dot2c_f32_bf16 v15, s29, v74
    v_dot2c_f32_bf16 v16, s28, v75
    v_dot2c_f32_bf16 v17, s29, v75
    s_waitcnt vmcnt(6)
    v_dot2c_f32_bf16 v18, s28, v76
    v_dot2c_f32_bf16 v19, s29, v76
    v_dot2c_f32_bf16 v20, s28, v77
    v_dot2c_f32_bf16 v21, s29, v77
    v_dot2c_f32_bf16 v22, s28, v78
    v_dot2c_f32_bf16 v23, s29, v78
    v_dot2c_f32_bf16 v24, s28, v79
    v_dot2c_f32_bf16 v25, s29, v79
    v_mad_u32_u16 v66, v36, s30, v8 op_sel:[0,0,0,0]
    buffer_load_dwordx4 v[72:75], v66, s[20:23], 0 offen sc1
    v_mad_u32_u16 v67, v56, s30, v8 op_sel:[0,0,0,0]
    buffer_load_dwordx4 v[76:79], v67, s[20:23], 0 offen sc1
    s_waitcnt vmcnt(7)
    v_dot2c_f32_bf16 v10, s28, v80
    v_dot2c_f32_bf16 v11, s29, v80
    v_dot2c_f32_bf16 v12, s28, v81
    v_dot2c_f32_bf16 v13, s29, v81
    v_dot2c_f32_bf16 v14, s28, v82
    v_dot2c_f32_bf16 v15, s29, v82
    v_dot2c_f32_bf16 v16, s28, v83
    v_dot2c_f32_bf16 v17, s29, v83
    s_waitcnt vmcnt(6)
    v_dot2c_f32_bf16 v18, s28, v84
    v_dot2c_f32_bf16 v19, s29, v84
    v_dot2c_f32_bf16 v20, s28, v85
    v_dot2c_f32_bf16 v21, s29, v85
    v_dot2c_f32_bf16 v22, s28, v86
    v_dot2c_f32_bf16 v23, s29, v86
    v_dot2c_f32_bf16 v24, s28, v87
    v_dot2c_f32_bf16 v25, s29, v87
    v_mad_u32_u16 v66, v36, s30, v8 op_sel:[1,0,0,0]
    buffer_load_dwordx4 v[80:83], v66, s[20:23], 0 offen sc1
    v_mad_u32_u16 v67, v56, s30, v8 op_sel:[1,0,0,0]
    buffer_load_dwordx4 v[84:87], v67, s[20:23], 0 offen sc1
    s_waitcnt vmcnt(7)
    v_dot2c_f32_bf16 v10, s28, v88
    v_dot2c_f32_bf16 v11, s29, v88
    v_dot2c_f32_bf16 v12, s28, v89
    v_dot2c_f32_bf16 v13, s29, v89
    v_dot2c_f32_bf16 v14, s28, v90
    v_dot2c_f32_bf16 v15, s29, v90
    v_dot2c_f32_bf16 v16, s28, v91
    v_dot2c_f32_bf16 v17, s29, v91
    s_waitcnt vmcnt(6)
    v_dot2c_f32_bf16 v18, s28, v92
    v_dot2c_f32_bf16 v19, s29, v92
    v_dot2c_f32_bf16 v20, s28, v93
    v_dot2c_f32_bf16 v21, s29, v93
    v_dot2c_f32_bf16 v22, s28, v94
    v_dot2c_f32_bf16 v23, s29, v94
    v_dot2c_f32_bf16 v24, s28, v95
    v_dot2c_f32_bf16 v25, s29, v95
    v_mad_u32_u16 v66, v37, s30, v8 op_sel:[0,0,0,0]
    buffer_load_dwordx4 v[88:91], v66, s[20:23], 0 offen sc1
    v_mad_u32_u16 v67, v57, s30, v8 op_sel:[0,0,0,0]
    buffer_load_dwordx4 v[92:95], v67, s[20:23], 0 offen sc1
    s_waitcnt vmcnt(7)
    v_dot2c_f32_bf16 v10, s28, v96
    v_dot2c_f32_bf16 v11, s29, v96
    v_dot2c_f32_bf16 v12, s28, v97
    v_dot2c_f32_bf16 v13, s29, v97
    v_dot2c_f32_bf16 v14, s28, v98
    v_dot2c_f32_bf16 v15, s29, v98
    v_dot2c_f32_bf16 v16, s28, v99
    v_dot2c_f32_bf16 v17, s29, v99
    s_waitcnt vmcnt(6)
    v_dot2c_f32_bf16 v18, s28, v100
    v_dot2c_f32_bf16 v19, s29, v100
    v_dot2c_f32_bf16 v20, s28, v101
    v_dot2c_f32_bf16 v21, s29, v101
    v_dot2c_f32_bf16 v22, s28, v102
    v_dot2c_f32_bf16 v23, s29, v102
    v_dot2c_f32_bf16 v24, s28, v103
    v_dot2c_f32_bf16 v25, s29, v103
    v_mad_u32_u16 v66, v37, s30, v8 op_sel:[1,0,0,0]
    buffer_load_dwordx4 v[96:99], v66, s[20:23], 0 offen sc1
    v_mad_u32_u16 v67, v57, s30, v8 op_sel:[1,0,0,0]
    buffer_load_dwordx4 v[100:103], v67, s[20:23], 0 offen sc1
    s_waitcnt vmcnt(7)
    v_dot2c_f32_bf16 v10, s28, v72
    v_dot2c_f32_bf16 v11, s29, v72
    v_dot2c_f32_bf16 v12, s28, v73
    v_dot2c_f32_bf16 v13, s29, v73
    v_dot2c_f32_bf16 v14, s28, v74
    v_dot2c_f32_bf16 v15, s29, v74
    v_dot2c_f32_bf16 v16, s28, v75
    v_dot2c_f32_bf16 v17, s29, v75
    s_waitcnt vmcnt(6)
    v_dot2c_f32_bf16 v18, s28, v76
    v_dot2c_f32_bf16 v19, s29, v76
    v_dot2c_f32_bf16 v20, s28, v77
    v_dot2c_f32_bf16 v21, s29, v77
    v_dot2c_f32_bf16 v22, s28, v78
    v_dot2c_f32_bf16 v23, s29, v78
    v_dot2c_f32_bf16 v24, s28, v79
    v_dot2c_f32_bf16 v25, s29, v79
    v_mad_u32_u16 v66, v38, s30, v8 op_sel:[0,0,0,0]
    buffer_load_dwordx4 v[72:75], v66, s[20:23], 0 offen sc1
    v_mad_u32_u16 v67, v58, s30, v8 op_sel:[0,0,0,0]
    buffer_load_dwordx4 v[76:79], v67, s[20:23], 0 offen sc1
    s_waitcnt vmcnt(7)
    v_dot2c_f32_bf16 v10, s28, v80
    v_dot2c_f32_bf16 v11, s29, v80
    v_dot2c_f32_bf16 v12, s28, v81
    v_dot2c_f32_bf16 v13, s29, v81
    v_dot2c_f32_bf16 v14, s28, v82
    v_dot2c_f32_bf16 v15, s29, v82
    v_dot2c_f32_bf16 v16, s28, v83
    v_dot2c_f32_bf16 v17, s29, v83
    s_waitcnt vmcnt(6)
    v_dot2c_f32_bf16 v18, s28, v84
    v_dot2c_f32_bf16 v19, s29, v84
    v_dot2c_f32_bf16 v20, s28, v85
    v_dot2c_f32_bf16 v21, s29, v85
    v_dot2c_f32_bf16 v22, s28, v86
    v_dot2c_f32_bf16 v23, s29, v86
    v_dot2c_f32_bf16 v24, s28, v87
    v_dot2c_f32_bf16 v25, s29, v87
    v_mad_u32_u16 v66, v38, s30, v8 op_sel:[1,0,0,0]
    buffer_load_dwordx4 v[80:83], v66, s[20:23], 0 offen sc1
    v_mad_u32_u16 v67, v58, s30, v8 op_sel:[1,0,0,0]
    buffer_load_dwordx4 v[84:87], v67, s[20:23], 0 offen sc1
    s_waitcnt vmcnt(7)
    v_dot2c_f32_bf16 v10, s28, v88
    v_dot2c_f32_bf16 v11, s29, v88
    v_dot2c_f32_bf16 v12, s28, v89
    v_dot2c_f32_bf16 v13, s29, v89
    v_dot2c_f32_bf16 v14, s28, v90
    v_dot2c_f32_bf16 v15, s29, v90
    v_dot2c_f32_bf16 v16, s28, v91
    v_dot2c_f32_bf16 v17, s29, v91
    s_waitcnt vmcnt(6)
    v_dot2c_f32_bf16 v18, s28, v92
    v_dot2c_f32_bf16 v19, s29, v92
    v_dot2c_f32_bf16 v20, s28, v93
    v_dot2c_f32_bf16 v21, s29, v93
    v_dot2c_f32_bf16 v22, s28, v94
    v_dot2c_f32_bf16 v23, s29, v94
    v_dot2c_f32_bf16 v24, s28, v95
    v_dot2c_f32_bf16 v25, s29, v95
    v_mad_u32_u16 v66, v39, s30, v8 op_sel:[0,0,0,0]
    buffer_load_dwordx4 v[88:91], v66, s[20:23], 0 offen sc1
    v_mad_u32_u16 v67, v59, s30, v8 op_sel:[0,0,0,0]
    buffer_load_dwordx4 v[92:95], v67, s[20:23], 0 offen sc1
    s_waitcnt vmcnt(7)
    v_dot2c_f32_bf16 v10, s28, v96
    v_dot2c_f32_bf16 v11, s29, v96
    v_dot2c_f32_bf16 v12, s28, v97
    v_dot2c_f32_bf16 v13, s29, v97
    v_dot2c_f32_bf16 v14, s28, v98
    v_dot2c_f32_bf16 v15, s29, v98
    v_dot2c_f32_bf16 v16, s28, v99
    v_dot2c_f32_bf16 v17, s29, v99
    s_waitcnt vmcnt(6)
    v_dot2c_f32_bf16 v18, s28, v100
    v_dot2c_f32_bf16 v19, s29, v100
    v_dot2c_f32_bf16 v20, s28, v101
    v_dot2c_f32_bf16 v21, s29, v101
    v_dot2c_f32_bf16 v22, s28, v102
    v_dot2c_f32_bf16 v23, s29, v102
    v_dot2c_f32_bf16 v24, s28, v103
    v_dot2c_f32_bf16 v25, s29, v103
    s_setprio 0
    v_mad_u32_u16 v66, v39, s30, v8 op_sel:[1,0,0,0]
    buffer_load_dwordx4 v[96:99], v66, s[20:23], 0 offen sc1
    v_mad_u32_u16 v67, v59, s30, v8 op_sel:[1,0,0,0]
    buffer_load_dwordx4 v[100:103], v67, s[20:23], 0 offen sc1
    s_waitcnt vmcnt(7)
    v_dot2c_f32_bf16 v10, s28, v72
    v_dot2c_f32_bf16 v11, s29, v72
    v_dot2c_f32_bf16 v12, s28, v73
    v_dot2c_f32_bf16 v13, s29, v73
    v_dot2c_f32_bf16 v14, s28, v74
    v_dot2c_f32_bf16 v15, s29, v74
    v_dot2c_f32_bf16 v16, s28, v75
    v_dot2c_f32_bf16 v17, s29, v75
    s_waitcnt vmcnt(6)
    v_dot2c_f32_bf16 v18, s28, v76
    v_dot2c_f32_bf16 v19, s29, v76
    v_dot2c_f32_bf16 v20, s28, v77
    v_dot2c_f32_bf16 v21, s29, v77
    v_dot2c_f32_bf16 v22, s28, v78
    v_dot2c_f32_bf16 v23, s29, v78
    v_dot2c_f32_bf16 v24, s28, v79
    v_dot2c_f32_bf16 v25, s29, v79
    v_mad_u32_u16 v66, v40, s30, v8 op_sel:[0,0,0,0]
    buffer_load_dwordx4 v[72:75], v66, s[20:23], 0 offen sc1
    v_mad_u32_u16 v67, v60, s30, v8 op_sel:[0,0,0,0]
    buffer_load_dwordx4 v[76:79], v67, s[20:23], 0 offen sc1
    s_waitcnt vmcnt(7)
    v_dot2c_f32_bf16 v10, s28, v80
    v_dot2c_f32_bf16 v11, s29, v80
    v_dot2c_f32_bf16 v12, s28, v81
    v_dot2c_f32_bf16 v13, s29, v81
    v_dot2c_f32_bf16 v14, s28, v82
    v_dot2c_f32_bf16 v15, s29, v82
    v_dot2c_f32_bf16 v16, s28, v83
    v_dot2c_f32_bf16 v17, s29, v83
    s_waitcnt vmcnt(6)
    v_dot2c_f32_bf16 v18, s28, v84
    v_dot2c_f32_bf16 v19, s29, v84
    v_dot2c_f32_bf16 v20, s28, v85
    v_dot2c_f32_bf16 v21, s29, v85
    v_dot2c_f32_bf16 v22, s28, v86
    v_dot2c_f32_bf16 v23, s29, v86
    v_dot2c_f32_bf16 v24, s28, v87
    v_dot2c_f32_bf16 v25, s29, v87
    v_mad_u32_u16 v66, v40, s30, v8 op_sel:[1,0,0,0]
    buffer_load_dwordx4 v[80:83], v66, s[20:23], 0 offen sc1
    v_mad_u32_u16 v67, v60, s30, v8 op_sel:[1,0,0,0]
    buffer_load_dwordx4 v[84:87], v67, s[20:23], 0 offen sc1
    s_waitcnt vmcnt(7)
    v_dot2c_f32_bf16 v10, s28, v88
    v_dot2c_f32_bf16 v11, s29, v88
    v_dot2c_f32_bf16 v12, s28, v89
    v_dot2c_f32_bf16 v13, s29, v89
    v_dot2c_f32_bf16 v14, s28, v90
    v_dot2c_f32_bf16 v15, s29, v90
    v_dot2c_f32_bf16 v16, s28, v91
    v_dot2c_f32_bf16 v17, s29, v91
    s_waitcnt vmcnt(6)
    v_dot2c_f32_bf16 v18, s28, v92
    v_dot2c_f32_bf16 v19, s29, v92
    v_dot2c_f32_bf16 v20, s28, v93
    v_dot2c_f32_bf16 v21, s29, v93
    v_dot2c_f32_bf16 v22, s28, v94
    v_dot2c_f32_bf16 v23, s29, v94
    v_dot2c_f32_bf16 v24, s28, v95
    v_dot2c_f32_bf16 v25, s29, v95
    v_mad_u32_u16 v66, v41, s30, v8 op_sel:[0,0,0,0]
    buffer_load_dwordx4 v[88:91], v66, s[20:23], 0 offen sc1
    v_mad_u32_u16 v67, v61, s30, v8 op_sel:[0,0,0,0]
    buffer_load_dwordx4 v[92:95], v67, s[20:23], 0 offen sc1
    s_waitcnt vmcnt(7)
    v_dot2c_f32_bf16 v10, s28, v96
    v_dot2c_f32_bf16 v11, s29, v96
    v_dot2c_f32_bf16 v12, s28, v97
    v_dot2c_f32_bf16 v13, s29, v97
    v_dot2c_f32_bf16 v14, s28, v98
    v_dot2c_f32_bf16 v15, s29, v98
    v_dot2c_f32_bf16 v16, s28, v99
    v_dot2c_f32_bf16 v17, s29, v99
    s_waitcnt vmcnt(6)
    v_dot2c_f32_bf16 v18, s28, v100
    v_dot2c_f32_bf16 v19, s29, v100
    v_dot2c_f32_bf16 v20, s28, v101
    v_dot2c_f32_bf16 v21, s29, v101
    v_dot2c_f32_bf16 v22, s28, v102
    v_dot2c_f32_bf16 v23, s29, v102
    v_dot2c_f32_bf16 v24, s28, v103
    v_dot2c_f32_bf16 v25, s29, v103
    v_mad_u32_u16 v66, v41, s30, v8 op_sel:[1,0,0,0]
    buffer_load_dwordx4 v[96:99], v66, s[20:23], 0 offen sc1
    v_mad_u32_u16 v67, v61, s30, v8 op_sel:[1,0,0,0]
    buffer_load_dwordx4 v[100:103], v67, s[20:23], 0 offen sc1
    s_waitcnt vmcnt(7)
    v_dot2c_f32_bf16 v10, s28, v72
    v_dot2c_f32_bf16 v11, s29, v72
    v_dot2c_f32_bf16 v12, s28, v73
    v_dot2c_f32_bf16 v13, s29, v73
    v_dot2c_f32_bf16 v14, s28, v74
    v_dot2c_f32_bf16 v15, s29, v74
    v_dot2c_f32_bf16 v16, s28, v75
    v_dot2c_f32_bf16 v17, s29, v75
    s_waitcnt vmcnt(6)
    v_dot2c_f32_bf16 v18, s28, v76
    v_dot2c_f32_bf16 v19, s29, v76
    v_dot2c_f32_bf16 v20, s28, v77
    v_dot2c_f32_bf16 v21, s29, v77
    v_dot2c_f32_bf16 v22, s28, v78
    v_dot2c_f32_bf16 v23, s29, v78
    v_dot2c_f32_bf16 v24, s28, v79
    v_dot2c_f32_bf16 v25, s29, v79
    v_mad_u32_u16 v66, v42, s30, v8 op_sel:[0,0,0,0]
    buffer_load_dwordx4 v[72:75], v66, s[20:23], 0 offen sc1
    v_mad_u32_u16 v67, v62, s30, v8 op_sel:[0,0,0,0]
    buffer_load_dwordx4 v[76:79], v67, s[20:23], 0 offen sc1
    s_waitcnt vmcnt(7)
    v_dot2c_f32_bf16 v10, s28, v80
    v_dot2c_f32_bf16 v11, s29, v80
    v_dot2c_f32_bf16 v12, s28, v81
    v_dot2c_f32_bf16 v13, s29, v81
    v_dot2c_f32_bf16 v14, s28, v82
    v_dot2c_f32_bf16 v15, s29, v82
    v_dot2c_f32_bf16 v16, s28, v83
    v_dot2c_f32_bf16 v17, s29, v83
    s_waitcnt vmcnt(6)
    v_dot2c_f32_bf16 v18, s28, v84
    v_dot2c_f32_bf16 v19, s29, v84
    v_dot2c_f32_bf16 v20, s28, v85
    v_dot2c_f32_bf16 v21, s29, v85
    v_dot2c_f32_bf16 v22, s28, v86
    v_dot2c_f32_bf16 v23, s29, v86
    v_dot2c_f32_bf16 v24, s28, v87
    v_dot2c_f32_bf16 v25, s29, v87
    v_mad_u32_u16 v66, v42, s30, v8 op_sel:[1,0,0,0]
    buffer_load_dwordx4 v[80:83], v66, s[20:23], 0 offen sc1
    v_mad_u32_u16 v67, v62, s30, v8 op_sel:[1,0,0,0]
    buffer_load_dwordx4 v[84:87], v67, s[20:23], 0 offen sc1
    s_waitcnt vmcnt(7)
    v_dot2c_f32_bf16 v10, s28, v88
    v_dot2c_f32_bf16 v11, s29, v88
    v_dot2c_f32_bf16 v12, s28, v89
    v_dot2c_f32_bf16 v13, s29, v89
    v_dot2c_f32_bf16 v14, s28, v90
    v_dot2c_f32_bf16 v15, s29, v90
    v_dot2c_f32_bf16 v16, s28, v91
    v_dot2c_f32_bf16 v17, s29, v91
    s_waitcnt vmcnt(6)
    v_dot2c_f32_bf16 v18, s28, v92
    v_dot2c_f32_bf16 v19, s29, v92
    v_dot2c_f32_bf16 v20, s28, v93
    v_dot2c_f32_bf16 v21, s29, v93
    v_dot2c_f32_bf16 v22, s28, v94
    v_dot2c_f32_bf16 v23, s29, v94
    v_dot2c_f32_bf16 v24, s28, v95
    v_dot2c_f32_bf16 v25, s29, v95
    v_mad_u32_u16 v66, v43, s30, v8 op_sel:[0,0,0,0]
    buffer_load_dwordx4 v[88:91], v66, s[20:23], 0 offen sc1
    v_mad_u32_u16 v67, v63, s30, v8 op_sel:[0,0,0,0]
    buffer_load_dwordx4 v[92:95], v67, s[20:23], 0 offen sc1
    s_waitcnt vmcnt(7)
    v_dot2c_f32_bf16 v10, s28, v96
    v_dot2c_f32_bf16 v11, s29, v96
    v_dot2c_f32_bf16 v12, s28, v97
    v_dot2c_f32_bf16 v13, s29, v97
    v_dot2c_f32_bf16 v14, s28, v98
    v_dot2c_f32_bf16 v15, s29, v98
    v_dot2c_f32_bf16 v16, s28, v99
    v_dot2c_f32_bf16 v17, s29, v99
    s_waitcnt vmcnt(6)
    v_dot2c_f32_bf16 v18, s28, v100
    v_dot2c_f32_bf16 v19, s29, v100
    v_dot2c_f32_bf16 v20, s28, v101
    v_dot2c_f32_bf16 v21, s29, v101
    v_dot2c_f32_bf16 v22, s28, v102
    v_dot2c_f32_bf16 v23, s29, v102
    v_dot2c_f32_bf16 v24, s28, v103
    v_dot2c_f32_bf16 v25, s29, v103
    v_mad_u32_u16 v66, v43, s30, v8 op_sel:[1,0,0,0]
    buffer_load_dwordx4 v[96:99], v66, s[20:23], 0 offen sc1
    v_mad_u32_u16 v67, v63, s30, v8 op_sel:[1,0,0,0]
    buffer_load_dwordx4 v[100:103], v67, s[20:23], 0 offen sc1
    s_waitcnt vmcnt(7)
    v_dot2c_f32_bf16 v10, s28, v72
    v_dot2c_f32_bf16 v11, s29, v72
    v_dot2c_f32_bf16 v12, s28, v73
    v_dot2c_f32_bf16 v13, s29, v73
    v_dot2c_f32_bf16 v14, s28, v74
    v_dot2c_f32_bf16 v15, s29, v74
    v_dot2c_f32_bf16 v16, s28, v75
    v_dot2c_f32_bf16 v17, s29, v75
    s_waitcnt vmcnt(6)
    v_dot2c_f32_bf16 v18, s28, v76
    v_dot2c_f32_bf16 v19, s29, v76
    v_dot2c_f32_bf16 v20, s28, v77
    v_dot2c_f32_bf16 v21, s29, v77
    v_dot2c_f32_bf16 v22, s28, v78
    v_dot2c_f32_bf16 v23, s29, v78
    v_dot2c_f32_bf16 v24, s28, v79
    v_dot2c_f32_bf16 v25, s29, v79
    s_waitcnt vmcnt(5)
    v_dot2c_f32_bf16 v10, s28, v80
    v_dot2c_f32_bf16 v11, s29, v80
    v_dot2c_f32_bf16 v12, s28, v81
    v_dot2c_f32_bf16 v13, s29, v81
    v_dot2c_f32_bf16 v14, s28, v82
    v_dot2c_f32_bf16 v15, s29, v82
    v_dot2c_f32_bf16 v16, s28, v83
    v_dot2c_f32_bf16 v17, s29, v83
    s_waitcnt vmcnt(4)
    v_dot2c_f32_bf16 v18, s28, v84
    v_dot2c_f32_bf16 v19, s29, v84
    v_dot2c_f32_bf16 v20, s28, v85
    v_dot2c_f32_bf16 v21, s29, v85
    v_dot2c_f32_bf16 v22, s28, v86
    v_dot2c_f32_bf16 v23, s29, v86
    v_dot2c_f32_bf16 v24, s28, v87
    v_dot2c_f32_bf16 v25, s29, v87
    s_waitcnt vmcnt(3)
    v_dot2c_f32_bf16 v10, s28, v88
    v_dot2c_f32_bf16 v11, s29, v88
    v_dot2c_f32_bf16 v12, s28, v89
    v_dot2c_f32_bf16 v13, s29, v89
    v_dot2c_f32_bf16 v14, s28, v90
    v_dot2c_f32_bf16 v15, s29, v90
    v_dot2c_f32_bf16 v16, s28, v91
    v_dot2c_f32_bf16 v17, s29, v91
    s_waitcnt vmcnt(2)
    v_dot2c_f32_bf16 v18, s28, v92
    v_dot2c_f32_bf16 v19, s29, v92
    v_dot2c_f32_bf16 v20, s28, v93
    v_dot2c_f32_bf16 v21, s29, v93
    v_dot2c_f32_bf16 v22, s28, v94
    v_dot2c_f32_bf16 v23, s29, v94
    v_dot2c_f32_bf16 v24, s28, v95
    v_dot2c_f32_bf16 v25, s29, v95
    s_waitcnt vmcnt(1)
    v_dot2c_f32_bf16 v10, s28, v96
    v_dot2c_f32_bf16 v11, s29, v96
    v_dot2c_f32_bf16 v12, s28, v97
    v_dot2c_f32_bf16 v13, s29, v97
    v_dot2c_f32_bf16 v14, s28, v98
    v_dot2c_f32_bf16 v15, s29, v98
    v_dot2c_f32_bf16 v16, s28, v99
    v_dot2c_f32_bf16 v17, s29, v99
    s_waitcnt vmcnt(0)
    v_dot2c_f32_bf16 v18, s28, v100
    v_dot2c_f32_bf16 v19, s29, v100
    v_dot2c_f32_bf16 v20, s28, v101
    v_dot2c_f32_bf16 v21, s29, v101
    v_dot2c_f32_bf16 v22, s28, v102
    v_dot2c_f32_bf16 v23, s29, v102
    v_dot2c_f32_bf16 v24, s28, v103
    v_dot2c_f32_bf16 v25, s29, v103
    s_branch hop_fin
hop_w19:
    s_setprio 3
    v_mad_u32_u16 v66, v26, s30, v8 op_sel:[0,0,0,0]
    buffer_load_dwordx4 v[72:75], v66, s[20:23], 0 offen sc1
    v_mad_u32_u16 v67, v46, s30, v8 op_sel:[0,0,0,0]
    buffer_load_dwordx4 v[76:79], v67, s[20:23], 0 offen sc1
    v_mad_u32_u16 v66, v26, s30, v8 op_sel:[1,0,0,0]
    buffer_load_dwordx4 v[80:83], v66, s[20:23], 0 offen sc1
    v_mad_u32_u16 v67, v46, s30, v8 op_sel:[1,0,0,0]
    buffer_load_dwordx4 v[84:87], v67, s[20:23], 0 offen sc1
    v_mad_u32_u16 v66, v27, s30, v8 op_sel:[0,0,0,0]
    buffer_load_dwordx4 v[88:91], v66, s[20:23], 0 offen sc1
    v_mad_u32_u16 v67, v47, s30, v8 op_sel:[0,0,0,0]
    buffer_load_dwordx4 v[92:95], v67, s[20:23], 0 offen sc1
    v_mad_u32_u16 v66, v27, s30, v8 op_sel:[1,0,0,0]
    buffer_load_dwordx4 v[96:99], v66, s[20:23], 0 offen sc1
    v_mad_u32_u16 v67, v47, s30, v8 op_sel:[1,0,0,0]
    buffer_load_dwordx4 v[100:103], v67, s[20:23], 0 offen sc1
    s_waitcnt vmcnt(7)
    v_dot2c_f32_bf16 v10, s28, v72
    v_dot2c_f32_bf16 v11, s29, v72
    v_dot2c_f32_bf16 v12, s28, v73
    v_dot2c_f32_bf16 v13, s29, v73
    v_dot2c_f32_bf16 v14, s28, v74
    v_dot2c_f32_bf16 v15, s29, v74
    v_dot2c_f32_bf16 v16, s28, v75
    v_dot2c_f32_bf16 v17, s29, v75
    s_waitcnt vmcnt(6)
    v_dot2c_f32_bf16 v18, s28, v76
    v_dot2c_f32_bf16 v19, s29, v76
    v_dot2c_f32_bf16 v20, s28, v77
    v_dot2c_f32_bf16 v21, s29, v77
    v_dot2c_f32_bf16 v22, s28, v78
    v_dot2c_f32_bf16 v23, s29, v78
    v_dot2c_f32_bf16 v24, s28, v79
    v_dot2c_f32_bf16 v25, s29, v79
    v_mad_u32_u16 v66, v28, s30, v8 op_sel:[0,0,0,0]
    buffer_load_dwordx4 v[72:75], v66, s[20:23], 0 offen sc1
    v_mad_u32_u16 v67, v48, s30, v8 op_sel:[0,0,0,0]
    buffer_load_dwordx4 v[76:79], v67, s[20:23], 0 offen sc1
    s_waitcnt vmcnt(7)
    v_dot2c_f32_bf16 v10, s28, v80
    v_dot2c_f32_bf16 v11, s29, v80
    v_dot2c_f32_bf16 v12, s28, v81
    v_dot2c_f32_bf16 v13, s29, v81
    v_dot2c_f32_bf16 v14, s28, v82
    v_dot2c_f32_bf16 v15, s29, v82
    v_dot2c_f32_bf16 v16, s28, v83
    v_dot2c_f32_bf16 v17, s29, v83
    s_waitcnt vmcnt(6)
    v_dot2c_f32_bf16 v18, s28, v84
    v_dot2c_f32_bf16 v19, s29, v84
    v_dot2c_f32_bf16 v20, s28, v85
    v_dot2c_f32_bf16 v21, s29, v85
    v_dot2c_f32_bf16 v22, s28, v86
    v_dot2c_f32_bf16 v23, s29, v86
    v_dot2c_f32_bf16 v24, s28, v87
    v_dot2c_f32_bf16 v25, s29, v87
    v_mad_u32_u16 v66, v28, s30, v8 op_sel:[1,0,0,0]
    buffer_load_dwordx4 v[80:83], v66, s[20:23], 0 offen sc1
    v_mad_u32_u16 v67, v48, s30, v8 op_sel:[1,0,0,0]
    buffer_load_dwordx4 v[84:87], v67, s[20:23], 0 offen sc1
    s_waitcnt vmcnt(7)
    v_dot2c_f32_bf16 v10, s28, v88
    v_dot2c_f32_bf16 v11, s29, v88
    v_dot2c_f32_bf16 v12, s28, v89
    v_dot2c_f32_bf16 v13, s29, v89
    v_dot2c_f32_bf16 v14, s28, v90
    v_dot2c_f32_bf16 v15, s29, v90
    v_dot2c_f32_bf16 v16, s28, v91
    v_dot2c_f32_bf16 v17, s29, v91
    s_waitcnt vmcnt(6)
    v_dot2c_f32_bf16 v18, s28, v92
    v_dot2c_f32_bf16 v19, s29, v92
    v_dot2c_f32_bf16 v20, s28, v93
    v_dot2c_f32_bf16 v21, s29, v93
    v_dot2c_f32_bf16 v22, s28, v94
    v_dot2c_f32_bf16 v23, s29, v94
    v_dot2c_f32_bf16 v24, s28, v95
    v_dot2c_f32_bf16 v25, s29, v95
    v_mad_u32_u16 v66, v29, s30, v8 op_sel:[0,0,0,0]
    buffer_load_dwordx4 v[88:91], v66, s[20:23], 0 offen sc1
    v_mad_u32_u16 v67, v49, s30, v8 op_sel:[0,0,0,0]
    buffer_load_dwordx4 v[92:95], v67, s[20:23], 0 offen sc1
    s_waitcnt vmcnt(7)
    v_dot2c_f32_bf16 v10, s28, v96
    v_dot2c_f32_bf16 v11, s29, v96
    v_dot2c_f32_bf16 v12, s28, v97
    v_dot2c_f32_bf16 v13, s29, v97
    v_dot2c_f32_bf16 v14, s28, v98
    v_dot2c_f32_bf16 v15, s29, v98
    v_dot2c_f32_bf16 v16, s28, v99
    v_dot2c_f32_bf16 v17, s29, v99
    s_waitcnt vmcnt(6)
    v_dot2c_f32_bf16 v18, s28, v100
    v_dot2c_f32_bf16 v19, s29, v100
    v_dot2c_f32_bf16 v20, s28, v101
    v_dot2c_f32_bf16 v21, s29, v101
    v_dot2c_f32_bf16 v22, s28, v102
    v_dot2c_f32_bf16 v23, s29, v102
    v_dot2c_f32_bf16 v24, s28, v103
    v_dot2c_f32_bf16 v25, s29, v103
    v_mad_u32_u16 v66, v29, s30, v8 op_sel:[1,0,0,0]
    buffer_load_dwordx4 v[96:99], v66, s[20:23], 0 offen sc1
    v_mad_u32_u16 v67, v49, s30, v8 op_sel:[1,0,0,0]
    buffer_load_dwordx4 v[100:103], v67, s[20:23], 0 offen sc1
    s_waitcnt vmcnt(7)
    v_dot2c_f32_bf16 v10, s28, v72
    v_dot2c_f32_bf16 v11, s29, v72
    v_dot2c_f32_bf16 v12, s28, v73
    v_dot2c_f32_bf16 v13, s29, v73
    v_dot2c_f32_bf16 v14, s28, v74
    v_dot2c_f32_bf16 v15, s29, v74
    v_dot2c_f32_bf16 v16, s28, v75
    v_dot2c_f32_bf16 v17, s29, v75
    s_waitcnt vmcnt(6)
    v_dot2c_f32_bf16 v18, s28, v76
    v_dot2c_f32_bf16 v19, s29, v76
    v_dot2c_f32_bf16 v20, s28, v77
    v_dot2c_f32_bf16 v21, s29, v77
    v_dot2c_f32_bf16 v22, s28, v78
    v_dot2c_f32_bf16 v23, s29, v78
    v_dot2c_f32_bf16 v24, s28, v79
    v_dot2c_f32_bf16 v25, s29, v79
    v_mad_u32_u16 v66, v30, s30, v8 op_sel:[0,0,0,0]
    buffer_load_dwordx4 v[72:75], v66, s[20:23], 0 offen sc1
    v_mad_u32_u16 v67, v50, s30, v8 op_sel:[0,0,0,0]
    buffer_load_dwordx4 v[76:79], v67, s[20:23], 0 offen sc1
    s_waitcnt vmcnt(7)
    v_dot2c_f32_bf16 v10, s28, v80
    v_dot2c_f32_bf16 v11, s29, v80
    v_dot2c_f32_bf16 v12, s28, v81
    v_dot2c_f32_bf16 v13, s29, v81
    v_dot2c_f32_bf16 v14, s28, v82
    v_dot2c_f32_bf16 v15, s29, v82
    v_dot2c_f32_bf16 v16, s28, v83
    v_dot2c_f32_bf16 v17, s29, v83
    s_waitcnt vmcnt(6)
    v_dot2c_f32_bf16 v18, s28, v84
    v_dot2c_f32_bf16 v19, s29, v84
    v_dot2c_f32_bf16 v20, s28, v85
    v_dot2c_f32_bf16 v21, s29, v85
    v_dot2c_f32_bf16 v22, s28, v86
    v_dot2c_f32_bf16 v23, s29, v86
    v_dot2c_f32_bf16 v24, s28, v87
    v_dot2c_f32_bf16 v25, s29, v87
    v_mad_u32_u16 v66, v30, s30, v8 op_sel:[1,0,0,0]
    buffer_load_dwordx4 v[80:83], v66, s[20:23], 0 offen sc1
    v_mad_u32_u16 v67, v50, s30, v8 op_sel:[1,0,0,0]
    buffer_load_dwordx4 v[84:87], v67, s[20:23], 0 offen sc1
    s_waitcnt vmcnt(7)
    v_dot2c_f32_bf16 v10, s28, v88
    v_dot2c_f32_bf16 v11, s29, v88
    v_dot2c_f32_bf16 v12, s28, v89
    v_dot2c_f32_bf16 v13, s29, v89
    v_dot2c_f32_bf16 v14, s28, v90
    v_dot2c_f32_bf16 v15, s29, v90
    v_dot2c_f32_bf16 v16, s28, v91
    v_dot2c_f32_bf16 v17, s29, v91
    s_waitcnt vmcnt(6)
    v_dot2c_f32_bf16 v18, s28, v92
    v_dot2c_f32_bf16 v19, s29, v92
    v_dot2c_f32_bf16 v20, s28, v93
    v_dot2c_f32_bf16 v21, s29, v93
    v_dot2c_f32_bf16 v22, s28, v94
    v_dot2c_f32_bf16 v23, s29, v94
    v_dot2c_f32_bf16 v24, s28, v95
    v_dot2c_f32_bf16 v25, s29, v95
    s_setprio 2
    v_mad_u32_u16 v66, v31, s30, v8 op_sel:[0,0,0,0]
    buffer_load_dwordx4 v[88:91], v66, s[20:23], 0 offen sc1
    v_mad_u32_u16 v67, v51, s30, v8 op_sel:[0,0,0,0]
    buffer_load_dwordx4 v[92:95], v67, s[20:23], 0 offen sc1
    s_waitcnt vmcnt(7)
    v_dot2c_f32_bf16 v10, s28, v96
    v_dot2c_f32_bf16 v11, s29, v96
    v_dot2c_f32_bf16 v12, s28, v97
    v_dot2c_f32_bf16 v13, s29, v97
    v_dot2c_f32_bf16 v14, s28, v98
    v_dot2c_f32_bf16 v15, s29, v98
    v_dot2c_f32_bf16 v16, s28, v99
    v_dot2c_f32_bf16 v17, s29, v99
    s_waitcnt vmcnt(6)
    v_dot2c_f32_bf16 v18, s28, v100
    v_dot2c_f32_bf16 v19, s29, v100
    v_dot2c_f32_bf16 v20, s28, v101
    v_dot2c_f32_bf16 v21, s29, v101
    v_dot2c_f32_bf16 v22, s28, v102
    v_dot2c_f32_bf16 v23, s29, v102
    v_dot2c_f32_bf16 v24, s28, v103
    v_dot2c_f32_bf16 v25, s29, v103
    v_mad_u32_u16 v66, v31, s30, v8 op_sel:[1,0,0,0]
    buffer_load_dwordx4 v[96:99], v66, s[20:23], 0 offen sc1
    v_mad_u32_u16 v67, v51, s30, v8 op_sel:[1,0,0,0]
    buffer_load_dwordx4 v[100:103], v67, s[20:23], 0 offen sc1
    s_waitcnt vmcnt(7)
    v_dot2c_f32_bf16 v10, s28, v72
    v_dot2c_f32_bf16 v11, s29, v72
    v_dot2c_f32_bf16 v12, s28, v73
    v_dot2c_f32_bf16 v13, s29, v73
    v_dot2c_f32_bf16 v14, s28, v74
    v_dot2c_f32_bf16 v15, s29, v74
    v_dot2c_f32_bf16 v16, s28, v75
    v_dot2c_f32_bf16 v17, s29, v75
    s_waitcnt vmcnt(6)
    v_dot2c_f32_bf16 v18, s28, v76
    v_dot2c_f32_bf16 v19, s29, v76
    v_dot2c_f32_bf16 v20, s28, v77
    v_dot2c_f32_bf16 v21, s29, v77
    v_dot2c_f32_bf16 v22, s28, v78
    v_dot2c_f32_bf16 v23, s29, v78
    v_dot2c_f32_bf16 v24, s28, v79
    v_dot2c_f32_bf16 v25, s29, v79
    v_mad_u32_u16 v66, v32, s30, v8 op_sel:[0,0,0,0]
    buffer_load_dwordx4 v[72:75], v66, s[20:23], 0 offen sc1
    v_mad_u32_u16 v67, v52, s30, v8 op_sel:[0,0,0,0]
    buffer_load_dwordx4 v[76:79], v67, s[20:23], 0 offen sc1
    s_waitcnt vmcnt(7)
    v_dot2c_f32_bf16 v10, s28, v80
    v_dot2c_f32_bf16 v11, s29, v80
    v_dot2c_f32_bf16 v12, s28, v81
    v_dot2c_f32_bf16 v13, s29, v81
    v_dot2c_f32_bf16 v14, s28, v82
    v_dot2c_f32_bf16 v15, s29, v82
    v_dot2c_f32_bf16 v16, s28, v83
    v_dot2c_f32_bf16 v17, s29, v83
    s_waitcnt vmcnt(6)
    v_dot2c_f32_bf16 v18, s28, v84
    v_dot2c_f32_bf16 v19, s29, v84
    v_dot2c_f32_bf16 v20, s28, v85
    v_dot2c_f32_bf16 v21, s29, v85
    v_dot2c_f32_bf16 v22, s28, v86
    v_dot2c_f32_bf16 v23, s29, v86
    v_dot2c_f32_bf16 v24, s28, v87
    v_dot2c_f32_bf16 v25, s29, v87
    v_mad_u32_u16 v66, v32, s30, v8 op_sel:[1,0,0,0]
    buffer_load_dwordx4 v[80:83], v66, s[20:23], 0 offen sc1
    v_mad_u32_u16 v67, v52, s30, v8 op_sel:[1,0,0,0]
    buffer_load_dwordx4 v[84:87], v67, s[20:23], 0 offen sc1
    s_waitcnt vmcnt(7)
    v_dot2c_f32_bf16 v10, s28, v88
    v_dot2c_f32_bf16 v11, s29, v88
    v_dot2c_f32_bf16 v12, s28, v89
    v_dot2c_f32_bf16 v13, s29, v89
    v_dot2c_f32_bf16 v14, s28, v90
    v_dot2c_f32_bf16 v15, s29, v90
    v_dot2c_f32_bf16 v16, s28, v91
    v_dot2c_f32_bf16 v17, s29, v91
    s_waitcnt vmcnt(6)
    v_dot2c_f32_bf16 v18, s28, v92
    v_dot2c_f32_bf16 v19, s29, v92
    v_dot2c_f32_bf16 v20, s28, v93
    v_dot2c_f32_bf16 v21, s29, v93
    v_dot2c_f32_bf16 v22, s28, v94
    v_dot2c_f32_bf16 v23, s29, v94
    v_dot2c_f32_bf16 v24, s28, v95
    v_dot2c_f32_bf16 v25, s29, v95
    v_mad_u32_u16 v66, v33, s30, v8 op_sel:[0,0,0,0]
    buffer_load_dwordx4 v[88:91], v66, s[20:23], 0 offen sc1
    v_mad_u32_u16 v67, v53, s30, v8 op_sel:[0,0,0,0]
    buffer_load_dwordx4 v[92:95], v67, s[20:23], 0 offen sc1
    s_waitcnt vmcnt(7)
    v_dot2c_f32_bf16 v10, s28, v96
    v_dot2c_f32_bf16 v11, s29, v96
    v_dot2c_f32_bf16 v12, s28, v97
    v_dot2c_f32_bf16 v13, s29, v97
    v_dot2c_f32_bf16 v14, s28, v98
    v_dot2c_f32_bf16 v15, s29, v98
    v_dot2c_f32_bf16 v16, s28, v99
    v_dot2c_f32_bf16 v17, s29, v99
    s_waitcnt vmcnt(6)
    v_dot2c_f32_bf16 v18, s28, v100
    v_dot2c_f32_bf16 v19, s29, v100
    v_dot2c_f32_bf16 v20, s28, v101
    v_dot2c_f32_bf16 v21, s29, v101
    v_dot2c_f32_bf16 v22, s28, v102
    v_dot2c_f32_bf16 v23, s29, v102
    v_dot2c_f32_bf16 v24, s28, v103
    v_dot2c_f32_bf16 v25, s29, v103
    v_mad_u32_u16 v66, v33, s30, v8 op_sel:[1,0,0,0]
    buffer_load_dwordx4 v[96:99], v66, s[20:23], 0 offen sc1
    v_mad_u32_u16 v67, v53, s30, v8 op_sel:[1,0,0,0]
    buffer_load_dwordx4 v[100:103], v67, s[20:23], 0 offen sc1
    s_waitcnt vmcnt(7)
    v_dot2c_f32_bf16 v10, s28, v72
    v_dot2c_f32_bf16 v11, s29, v72
    v_dot2c_f32_bf16 v12, s28, v73
    v_dot2c_f32_bf16 v13, s29, v73
    v_dot2c_f32_bf16 v14, s28, v74
    v_dot2c_f32_bf16 v15, s29, v74
    v_dot2c_f32_bf16 v16, s28, v75
    v_dot2c_f32_bf16 v17, s29, v75
    s_waitcnt vmcnt(6)
    v_dot2c_f32_bf16 v18, s28, v76
    v_dot2c_f32_bf16 v19, s29, v76
    v_dot2c_f32_bf16 v20, s28, v77
    v_dot2c_f32_bf16 v21, s29, v77
    v_dot2c_f32_bf16 v22, s28, v78
    v_dot2c_f32_bf16 v23, s29, v78
    v_dot2c_f32_bf16 v24, s28, v79
    v_dot2c_f32_bf16 v25, s29, v79
    v_mad_u32_u16 v66, v34, s30, v8 op_sel:[0,0,0,0]
    buffer_load_dwordx4 v[72:75], v66, s[20:23], 0 offen sc1
    v_mad_u32_u16 v67, v54, s30, v8 op_sel:[0,0,0,0]
    buffer_load_dwordx4 v[76:79], v67, s[20:23], 0 offen sc1
    s_waitcnt vmcnt(7)
    v_dot2c_f32_bf16 v10, s28, v80
    v_dot2c_f32_bf16 v11, s29, v80
    v_dot2c_f32_bf16 v12, s28, v81
    v_dot2c_f32_bf16 v13, s29, v81
    v_dot2c_f32_bf16 v14, s28, v82
    v_dot2c_f32_bf16 v15, s29, v82
    v_dot2c_f32_bf16 v16, s28, v83
    v_dot2c_f32_bf16 v17, s29, v83
    s_waitcnt vmcnt(6)
    v_dot2c_f32_bf16 v18, s28, v84
    v_dot2c_f32_bf16 v19, s29, v84
    v_dot2c_f32_bf16 v20, s28, v85
    v_dot2c_f32_bf16 v21, s29, v85
    v_dot2c_f32_bf16 v22, s28, v86
    v_dot2c_f32_bf16 v23, s29, v86
    v_dot2c_f32_bf16 v24, s28, v87
    v_dot2c_f32_bf16 v25, s29, v87
    v_mad_u32_u16 v66, v34, s30, v8 op_sel:[1,0,0,0]
    buffer_load_dwordx4 v[80:83], v66, s[20:23], 0 offen sc1
    v_mad_u32_u16 v67, v54, s30, v8 op_sel:[1,0,0,0]
    buffer_load_dwordx4 v[84:87], v67, s[20:23], 0 offen sc1
    s_waitcnt vmcnt(7)
    v_dot2c_f32_bf16 v10, s28, v88
    v_dot2c_f32_bf16 v11, s29, v88
    v_dot2c_f32_bf16 v12, s28, v89
    v_dot2c_f32_bf16 v13, s29, v89
    v_dot2c_f32_bf16 v14, s28, v90
    v_dot2c_f32_bf16 v15, s29, v90
    v_dot2c_f32_bf16 v16, s28, v91
    v_dot2c_f32_bf16 v17, s29, v91
    s_waitcnt vmcnt(6)
    v_dot2c_f32_bf16 v18, s28, v92
    v_dot2c_f32_bf16 v19, s29, v92
    v_dot2c_f32_bf16 v20, s28, v93
    v_dot2c_f32_bf16 v21, s29, v93
    v_dot2c_f32_bf16 v22, s28, v94
    v_dot2c_f32_bf16 v23, s29, v94
    v_dot2c_f32_bf16 v24, s28, v95
    v_dot2c_f32_bf16 v25, s29, v95
    v_mad_u32_u16 v66, v35, s30, v8 op_sel:[0,0,0,0]
    buffer_load_dwordx4 v[88:91], v66, s[20:23], 0 offen sc1
    v_mad_u32_u16 v67, v55, s30, v8 op_sel:[0,0,0,0]
    buffer_load_dwordx4 v[92:95], v67, s[20:23], 0 offen sc1
    s_waitcnt vmcnt(7)
    v_dot2c_f32_bf16 v10, s28, v96
    v_dot2c_f32_bf16 v11, s29, v96
    v_dot2c_f32_bf16 v12, s28, v97
    v_dot2c_f32_bf16 v13, s29, v97
    v_dot2c_f32_bf16 v14, s28, v98
    v_dot2c_f32_bf16 v15, s29, v98
    v_dot2c_f32_bf16 v16, s28, v99
    v_dot2c_f32_bf16 v17, s29, v99
    s_waitcnt vmcnt(6)
    v_dot2c_f32_bf16 v18, s28, v100
    v_dot2c_f32_bf16 v19, s29, v100
    v_dot2c_f32_bf16 v20, s28, v101
    v_dot2c_f32_bf16 v21, s29, v101
    v_dot2c_f32_bf16 v22, s28, v102
    v_dot2c_f32_bf16 v23, s29, v102
    v_dot2c_f32_bf16 v24, s28, v103
    v_dot2c_f32_bf16 v25, s29, v103
    s_setprio 1
    v_mad_u32_u16 v66, v35, s30, v8 op_sel:[1,0,0,0]
    buffer_load_dwordx4 v[96:99], v66, s[20:23], 0 offen sc1
    v_mad_u32_u16 v67, v55, s30, v8 op_sel:[1,0,0,0]
    buffer_load_dwordx4 v[100:103], v67, s[20:23], 0 offen sc1
    s_waitcnt vmcnt(7)
    v_dot2c_f32_bf16 v10, s28, v72
    v_dot2c_f32_bf16 v11, s29, v72
    v_dot2c_f32_bf16 v12, s28, v73
    v_dot2c_f32_bf16 v13, s29, v73
    v_dot2c_f32_bf16 v14, s28, v74
    v_dot2c_f32_bf16 v15, s29, v74
    v_dot2c_f32_bf16 v16, s28, v75
    v_dot2c_f32_bf16 v17, s29, v75
    s_waitcnt vmcnt(6)
    v_dot2c_f32_bf16 v18, s28, v76
    v_dot2c_f32_bf16 v19, s29, v76
    v_dot2c_f32_bf16 v20, s28, v77
    v_dot2c_f32_bf16 v21, s29, v77
    v_dot2c_f32_bf16 v22, s28, v78
    v_dot2c_f32_bf16 v23, s29, v78
    v_dot2c_f32_bf16 v24, s28, v79
    v_dot2c_f32_bf16 v25, s29, v79
    v_mad_u32_u16 v66, v36, s30, v8 op_sel:[0,0,0,0]
    buffer_load_dwordx4 v[72:75], v66, s[20:23], 0 offen sc1
    v_mad_u32_u16 v67, v56, s30, v8 op_sel:[0,0,0,0]
    buffer_load_dwordx4 v[76:79], v67, s[20:23], 0 offen sc1
    s_waitcnt vmcnt(7)
    v_dot2c_f32_bf16 v10, s28, v80
    v_dot2c_f32_bf16 v11, s29, v80
    v_dot2c_f32_bf16 v12, s28, v81
    v_dot2c_f32_bf16 v13, s29, v81
    v_dot2c_f32_bf16 v14, s28, v82
    v_dot2c_f32_bf16 v15, s29, v82
    v_dot2c_f32_bf16 v16, s28, v83
    v_dot2c_f32_bf16 v17, s29, v83
    s_waitcnt vmcnt(6)
    v_dot2c_f32_bf16 v18, s28, v84
    v_dot2c_f32_bf16 v19, s29, v84
    v_dot2c_f32_bf16 v20, s28, v85
    v_dot2c_f32_bf16 v21, s29, v85
    v_dot2c_f32_bf16 v22, s28, v86
    v_dot2c_f32_bf16 v23, s29, v86
    v_dot2c_f32_bf16 v24, s28, v87
    v_dot2c_f32_bf16 v25, s29, v87
    v_mad_u32_u16 v66, v36, s30, v8 op_sel:[1,0,0,0]
    buffer_load_dwordx4 v[80:83], v66, s[20:23], 0 offen sc1
    v_mad_u32_u16 v67, v56, s30, v8 op_sel:[1,0,0,0]
    buffer_load_dwordx4 v[84:87], v67, s[20:23], 0 offen sc1
    s_waitcnt vmcnt(7)
    v_dot2c_f32_bf16 v10, s28, v88
    v_dot2c_f32_bf16 v11, s29, v88
    v_dot2c_f32_bf16 v12, s28, v89
    v_dot2c_f32_bf16 v13, s29, v89
    v_dot2c_f32_bf16 v14, s28, v90
    v_dot2c_f32_bf16 v15, s29, v90
    v_dot2c_f32_bf16 v16, s28, v91
    v_dot2c_f32_bf16 v17, s29, v91
    s_waitcnt vmcnt(6)
    v_dot2c_f32_bf16 v18, s28, v92
    v_dot2c_f32_bf16 v19, s29, v92
    v_dot2c_f32_bf16 v20, s28, v93
    v_dot2c_f32_bf16 v21, s29, v93
    v_dot2c_f32_bf16 v22, s28, v94
    v_dot2c_f32_bf16 v23, s29, v94
    v_dot2c_f32_bf16 v24, s28, v95
    v_dot2c_f32_bf16 v25, s29, v95
    v_mad_u32_u16 v66, v37, s30, v8 op_sel:[0,0,0,0]
    buffer_load_dwordx4 v[88:91], v66, s[20:23], 0 offen sc1
    v_mad_u32_u16 v67, v57, s30, v8 op_sel:[0,0,0,0]
    buffer_load_dwordx4 v[92:95], v67, s[20:23], 0 offen sc1
    s_waitcnt vmcnt(7)
    v_dot2c_f32_bf16 v10, s28, v96
    v_dot2c_f32_bf16 v11, s29, v96
    v_dot2c_f32_bf16 v12, s28, v97
    v_dot2c_f32_bf16 v13, s29, v97
    v_dot2c_f32_bf16 v14, s28, v98
    v_dot2c_f32_bf16 v15, s29, v98
    v_dot2c_f32_bf16 v16, s28, v99
    v_dot2c_f32_bf16 v17, s29, v99
    s_waitcnt vmcnt(6)
    v_dot2c_f32_bf16 v18, s28, v100
    v_dot2c_f32_bf16 v19, s29, v100
    v_dot2c_f32_bf16 v20, s28, v101
    v_dot2c_f32_bf16 v21, s29, v101
    v_dot2c_f32_bf16 v22, s28, v102
    v_dot2c_f32_bf16 v23, s29, v102
    v_dot2c_f32_bf16 v24, s28, v103
    v_dot2c_f32_bf16 v25, s29, v103
    v_mad_u32_u16 v66, v37, s30, v8 op_sel:[1,0,0,0]
    buffer_load_dwordx4 v[96:99], v66, s[20:23], 0 offen sc1
    v_mad_u32_u16 v67, v57, s30, v8 op_sel:[1,0,0,0]
    buffer_load_dwordx4 v[100:103], v67, s[20:23], 0 offen sc1
    s_waitcnt vmcnt(7)
    v_dot2c_f32_bf16 v10, s28, v72
    v_dot2c_f32_bf16 v11, s29, v72
    v_dot2c_f32_bf16 v12, s28, v73
    v_dot2c_f32_bf16 v13, s29, v73
    v_dot2c_f32_bf16 v14, s28, v74
    v_dot2c_f32_bf16 v15, s29, v74
    v_dot2c_f32_bf16 v16, s28, v75
    v_dot2c_f32_bf16 v17, s29, v75
    s_waitcnt vmcnt(6)
    v_dot2c_f32_bf16 v18, s28, v76
    v_dot2c_f32_bf16 v19, s29, v76
    v_dot2c_f32_bf16 v20, s28, v77
    v_dot2c_f32_bf16 v21, s29, v77
    v_dot2c_f32_bf16 v22, s28, v78
    v_dot2c_f32_bf16 v23, s29, v78
    v_dot2c_f32_bf16 v24, s28, v79
    v_dot2c_f32_bf16 v25, s29, v79
    v_mad_u32_u16 v66, v38, s30, v8 op_sel:[0,0,0,0]
    buffer_load_dwordx4 v[72:75], v66, s[20:23], 0 offen sc1
    v_mad_u32_u16 v67, v58, s30, v8 op_sel:[0,0,0,0]
    buffer_load_dwordx4 v[76:79], v67, s[20:23], 0 offen sc1
    s_waitcnt vmcnt(7)
    v_dot2c_f32_bf16 v10, s28, v80
    v_dot2c_f32_bf16 v11, s29, v80
    v_dot2c_f32_bf16 v12, s28, v81
    v_dot2c_f32_bf16 v13, s29, v81
    v_dot2c_f32_bf16 v14, s28, v82
    v_dot2c_f32_bf16 v15, s29, v82
    v_dot2c_f32_bf16 v16, s28, v83
    v_dot2c_f32_bf16 v17, s29, v83
    s_waitcnt vmcnt(6)
    v_dot2c_f32_bf16 v18, s28, v84
    v_dot2c_f32_bf16 v19, s29, v84
    v_dot2c_f32_bf16 v20, s28, v85
    v_dot2c_f32_bf16 v21, s29, v85
    v_dot2c_f32_bf16 v22, s28, v86
    v_dot2c_f32_bf16 v23, s29, v86
    v_dot2c_f32_bf16 v24, s28, v87
    v_dot2c_f32_bf16 v25, s29, v87
    v_mad_u32_u16 v66, v38, s30, v8 op_sel:[1,0,0,0]
    buffer_load_dwordx4 v[80:83], v66, s[20:23], 0 offen sc1
    v_mad_u32_u16 v67, v58, s30, v8 op_sel:[1,0,0,0]
    buffer_load_dwordx4 v[84:87], v67, s[20:23], 0 offen sc1
    s_waitcnt vmcnt(7)
    v_dot2c_f32_bf16 v10, s28, v88
    v_dot2c_f32_bf16 v11, s29, v88
    v_dot2c_f32_bf16 v12, s28, v89
    v_dot2c_f32_bf16 v13, s29, v89
    v_dot2c_f32_bf16 v14, s28, v90
    v_dot2c_f32_bf16 v15, s29, v90
    v_dot2c_f32_bf16 v16, s28, v91
    v_dot2c_f32_bf16 v17, s29, v91
    s_waitcnt vmcnt(6)
    v_dot2c_f32_bf16 v18, s28, v92
    v_dot2c_f32_bf16 v19, s29, v92
    v_dot2c_f32_bf16 v20, s28, v93
    v_dot2c_f32_bf16 v21, s29, v93
    v_dot2c_f32_bf16 v22, s28, v94
    v_dot2c_f32_bf16 v23, s29, v94
    v_dot2c_f32_bf16 v24, s28, v95
    v_dot2c_f32_bf16 v25, s29, v95
    v_mad_u32_u16 v66, v39, s30, v8 op_sel:[0,0,0,0]
    buffer_load_dwordx4 v[88:91], v66, s[20:23], 0 offen sc1
    v_mad_u32_u16 v67, v59, s30, v8 op_sel:[0,0,0,0]
    buffer_load_dwordx4 v[92:95], v67, s[20:23], 0 offen sc1
    s_waitcnt vmcnt(7)
    v_dot2c_f32_bf16 v10, s28, v96
    v_dot2c_f32_bf16 v11, s29, v96
    v_dot2c_f32_bf16 v12, s28, v97
    v_dot2c_f32_bf16 v13, s29, v97
    v_dot2c_f32_bf16 v14, s28, v98
    v_dot2c_f32_bf16 v15, s29, v98
    v_dot2c_f32_bf16 v16, s28, v99
    v_dot2c_f32_bf16 v17, s29, v99
    s_waitcnt vmcnt(6)
    v_dot2c_f32_bf16 v18, s28, v100
    v_dot2c_f32_bf16 v19, s29, v100
    v_dot2c_f32_bf16 v20, s28, v101
    v_dot2c_f32_bf16 v21, s29, v101
    v_dot2c_f32_bf16 v22, s28, v102
    v_dot2c_f32_bf16 v23, s29, v102
    v_dot2c_f32_bf16 v24, s28, v103
    v_dot2c_f32_bf16 v25, s29, v103
    v_mad_u32_u16 v66, v39, s30, v8 op_sel:[1,0,0,0]
    buffer_load_dwordx4 v[96:99], v66, s[20:23], 0 offen sc1
    v_mad_u32_u16 v67, v59, s30, v8 op_sel:[1,0,0,0]
    buffer_load_dwordx4 v[100:103], v67, s[20:23], 0 offen sc1
    s_waitcnt vmcnt(7)
    v_dot2c_f32_bf16 v10, s28, v72
    v_dot2c_f32_bf16 v11, s29, v72
    v_dot2c_f32_bf16 v12, s28, v73
    v_dot2c_f32_bf16 v13, s29, v73
    v_dot2c_f32_bf16 v14, s28, v74
    v_dot2c_f32_bf16 v15, s29, v74
    v_dot2c_f32_bf16 v16, s28, v75
    v_dot2c_f32_bf16 v17, s29, v75
    s_waitcnt vmcnt(6)
    v_dot2c_f32_bf16 v18, s28, v76
    v_dot2c_f32_bf16 v19, s29, v76
    v_dot2c_f32_bf16 v20, s28, v77
    v_dot2c_f32_bf16 v21, s29, v77
    v_dot2c_f32_bf16 v22, s28, v78
    v_dot2c_f32_bf16 v23, s29, v78
    v_dot2c_f32_bf16 v24, s28, v79
    v_dot2c_f32_bf16 v25, s29, v79
    v_mad_u32_u16 v66, v40, s30, v8 op_sel:[0,0,0,0]
    buffer_load_dwordx4 v[72:75], v66, s[20:23], 0 offen sc1
    v_mad_u32_u16 v67, v60, s30, v8 op_sel:[0,0,0,0]
    buffer_load_dwordx4 v[76:79], v67, s[20:23], 0 offen sc1
    s_waitcnt vmcnt(7)
    v_dot2c_f32_bf16 v10, s28, v80
    v_dot2c_f32_bf16 v11, s29, v80
    v_dot2c_f32_bf16 v12, s28, v81
    v_dot2c_f32_bf16 v13, s29, v81
    v_dot2c_f32_bf16 v14, s28, v82
    v_dot2c_f32_bf16 v15, s29, v82
    v_dot2c_f32_bf16 v16, s28, v83
    v_dot2c_f32_bf16 v17, s29, v83
    s_waitcnt vmcnt(6)
    v_dot2c_f32_bf16 v18, s28, v84
    v_dot2c_f32_bf16 v19, s29, v84
    v_dot2c_f32_bf16 v20, s28, v85
    v_dot2c_f32_bf16 v21, s29, v85
    v_dot2c_f32_bf16 v22, s28, v86
    v_dot2c_f32_bf16 v23, s29, v86
    v_dot2c_f32_bf16 v24, s28, v87
    v_dot2c_f32_bf16 v25, s29, v87
    s_setprio 0
    v_mad_u32_u16 v66, v40, s30, v8 op_sel:[1,0,0,0]
    buffer_load_dwordx4 v[80:83], v66, s[20:23], 0 offen sc1
    v_mad_u32_u16 v67, v60, s30, v8 op_sel:[1,0,0,0]
    buffer_load_dwordx4 v[84:87], v67, s[20:23], 0 offen sc1
    s_waitcnt vmcnt(7)
    v_dot2c_f32_bf16 v10, s28, v88
    v_dot2c_f32_bf16 v11, s29, v88
    v_dot2c_f32_bf16 v12, s28, v89
    v_dot2c_f32_bf16 v13, s29, v89
    v_dot2c_f32_bf16 v14, s28, v90
    v_dot2c_f32_bf16 v15, s29, v90
    v_dot2c_f32_bf16 v16, s28, v91
    v_dot2c_f32_bf16 v17, s29, v91
    s_waitcnt vmcnt(6)
    v_dot2c_f32_bf16 v18, s28, v92
    v_dot2c_f32_bf16 v19, s29, v92
    v_dot2c_f32_bf16 v20, s28, v93
    v_dot2c_f32_bf16 v21, s29, v93
    v_dot2c_f32_bf16 v22, s28, v94
    v_dot2c_f32_bf16 v23, s29, v94
    v_dot2c_f32_bf16 v24, s28, v95
    v_dot2c_f32_bf16 v25, s29, v95
    v_mad_u32_u16 v66, v41, s30, v8 op_sel:[0,0,0,0]
    buffer_load_dwordx4 v[88:91], v66, s[20:23], 0 offen sc1
    v_mad_u32_u16 v67, v61, s30, v8 op_sel:[0,0,0,0]
    buffer_load_dwordx4 v[92:95], v67, s[20:23], 0 offen sc1
    s_waitcnt vmcnt(7)
    v_dot2c_f32_bf16 v10, s28, v96
    v_dot2c_f32_bf16 v11, s29, v96
    v_dot2c_f32_bf16 v12, s28, v97
    v_dot2c_f32_bf16 v13, s29, v97
    v_dot2c_f32_bf16 v14, s28, v98
    v_dot2c_f32_bf16 v15, s29, v98
    v_dot2c_f32_bf16 v16, s28, v99
    v_dot2c_f32_bf16 v17, s29, v99
    s_waitcnt vmcnt(6)
    v_dot2c_f32_bf16 v18, s28, v100
    v_dot2c_f32_bf16 v19, s29, v100
    v_dot2c_f32_bf16 v20, s28, v101
    v_dot2c_f32_bf16 v21, s29, v101
    v_dot2c_f32_bf16 v22, s28, v102
    v_dot2c_f32_bf16 v23, s29, v102
    v_dot2c_f32_bf16 v24, s28, v103
    v_dot2c_f32_bf16 v25, s29, v103
    v_mad_u32_u16 v66, v41, s30, v8 op_sel:[1,0,0,0]
    buffer_load_dwordx4 v[96:99], v66, s[20:23], 0 offen sc1
    v_mad_u32_u16 v67, v61, s30, v8 op_sel:[1,0,0,0]
    buffer_load_dwordx4 v[100:103], v67, s[20:23], 0 offen sc1
    s_waitcnt vmcnt(7)
    v_dot2c_f32_bf16 v10, s28, v72
    v_dot2c_f32_bf16 v11, s29, v72
    v_dot2c_f32_bf16 v12, s28, v73
    v_dot2c_f32_bf16 v13, s29, v73
    v_dot2c_f32_bf16 v14, s28, v74
    v_dot2c_f32_bf16 v15, s29, v74
    v_dot2c_f32_bf16 v16, s28, v75
    v_dot2c_f32_bf16 v17, s29, v75
    s_waitcnt vmcnt(6)
    v_dot2c_f32_bf16 v18, s28, v76
    v_dot2c_f32_bf16 v19, s29, v76
    v_dot2c_f32_bf16 v20, s28, v77
    v_dot2c_f32_bf16 v21, s29, v77
    v_dot2c_f32_bf16 v22, s28, v78
    v_dot2c_f32_bf16 v23, s29, v78
    v_dot2c_f32_bf16 v24, s28, v79
    v_dot2c_f32_bf16 v25, s29, v79
    v_mad_u32_u16 v66, v42, s30, v8 op_sel:[0,0,0,0]
    buffer_load_dwordx4 v[72:75], v66, s[20:23], 0 offen sc1
    v_mad_u32_u16 v67, v62, s30, v8 op_sel:[0,0,0,0]
    buffer_load_dwordx4 v[76:79], v67, s[20:23], 0 offen sc1
    s_waitcnt vmcnt(7)
    v_dot2c_f32_bf16 v10, s28, v80
    v_dot2c_f32_bf16 v11, s29, v80
    v_dot2c_f32_bf16 v12, s28, v81
    v_dot2c_f32_bf16 v13, s29, v81
    v_dot2c_f32_bf16 v14, s28, v82
    v_dot2c_f32_bf16 v15, s29, v82
    v_dot2c_f32_bf16 v16, s28, v83
    v_dot2c_f32_bf16 v17, s29, v83
    s_waitcnt vmcnt(6)
    v_dot2c_f32_bf16 v18, s28, v84
    v_dot2c_f32_bf16 v19, s29, v84
    v_dot2c_f32_bf16 v20, s28, v85
    v_dot2c_f32_bf16 v21, s29, v85
    v_dot2c_f32_bf16 v22, s28, v86
    v_dot2c_f32_bf16 v23, s29, v86
    v_dot2c_f32_bf16 v24, s28, v87
    v_dot2c_f32_bf16 v25, s29, v87
    v_mad_u32_u16 v66, v42, s30, v8 op_sel:[1,0,0,0]
    buffer_load_dwordx4 v[80:83], v66, s[20:23], 0 offen sc1
    v_mad_u32_u16 v67, v62, s30, v8 op_sel:[1,0,0,0]
    buffer_load_dwordx4 v[84:87], v67, s[20:23], 0 offen sc1
    s_waitcnt vmcnt(7)
    v_dot2c_f32_bf16 v10, s28, v88
    v_dot2c_f32_bf16 v11, s29, v88
    v_dot2c_f32_bf16 v12, s28, v89
    v_dot2c_f32_bf16 v13, s29, v89
    v_dot2c_f32_bf16 v14, s28, v90
    v_dot2c_f32_bf16 v15, s29, v90
    v_dot2c_f32_bf16 v16, s28, v91
    v_dot2c_f32_bf16 v17, s29, v91
    s_waitcnt vmcnt(6)
    v_dot2c_f32_bf16 v18, s28, v92
    v_dot2c_f32_bf16 v19, s29, v92
    v_dot2c_f32_bf16 v20, s28, v93
    v_dot2c_f32_bf16 v21, s29, v93
    v_dot2c_f32_bf16 v22, s28, v94
    v_dot2c_f32_bf16 v23, s29, v94
    v_dot2c_f32_bf16 v24, s28, v95
    v_dot2c_f32_bf16 v25, s29, v95
    v_mad_u32_u16 v66, v43, s30, v8 op_sel:[0,0,0,0]
    buffer_load_dwordx4 v[88:91], v66, s[20:23], 0 offen sc1
    v_mad_u32_u16 v67, v63, s30, v8 op_sel:[0,0,0,0]
    buffer_load_dwordx4 v[92:95], v67, s[20:23], 0 offen sc1
    s_waitcnt vmcnt(7)
    v_dot2c_f32_bf16 v10, s28, v96
    v_dot2c_f32_bf16 v11, s29, v96
    v_dot2c_f32_bf16 v12, s28, v97
    v_dot2c_f32_bf16 v13, s29, v97
    v_dot2c_f32_bf16 v14, s28, v98
    v_dot2c_f32_bf16 v15, s29, v98
    v_dot2c_f32_bf16 v16, s28, v99
    v_dot2c_f32_bf16 v17, s29, v99
    s_waitcnt vmcnt(6)
    v_dot2c_f32_bf16 v18, s28, v100
    v_dot2c_f32_bf16 v19, s29, v100
    v_dot2c_f32_bf16 v20, s28, v101
    v_dot2c_f32_bf16 v21, s29, v101
    v_dot2c_f32_bf16 v22, s28, v102
    v_dot2c_f32_bf16 v23, s29, v102
    v_dot2c_f32_bf16 v24, s28, v103
    v_dot2c_f32_bf16 v25, s29, v103
    v_mad_u32_u16 v66, v43, s30, v8 op_sel:[1,0,0,0]
    buffer_load_dwordx4 v[96:99], v66, s[20:23], 0 offen sc1
    v_mad_u32_u16 v67, v63, s30, v8 op_sel:[1,0,0,0]
    buffer_load_dwordx4 v[100:103], v67, s[20:23], 0 offen sc1
    s_waitcnt vmcnt(7)
    v_dot2c_f32_bf16 v10, s28, v72
    v_dot2c_f32_bf16 v11, s29, v72
    v_dot2c_f32_bf16 v12, s28, v73
    v_dot2c_f32_bf16 v13, s29, v73
    v_dot2c_f32_bf16 v14, s28, v74
    v_dot2c_f32_bf16 v15, s29, v74
    v_dot2c_f32_bf16 v16, s28, v75
    v_dot2c_f32_bf16 v17, s29, v75
    s_waitcnt vmcnt(6)
    v_dot2c_f32_bf16 v18, s28, v76
    v_dot2c_f32_bf16 v19, s29, v76
    v_dot2c_f32_bf16 v20, s28, v77
    v_dot2c_f32_bf16 v21, s29, v77
    v_dot2c_f32_bf16 v22, s28, v78
    v_dot2c_f32_bf16 v23, s29, v78
    v_dot2c_f32_bf16 v24, s28, v79
    v_dot2c_f32_bf16 v25, s29, v79
    v_mad_u32_u16 v66, v44, s30, v8 op_sel:[0,0,0,0]
    buffer_load_dwordx4 v[72:75], v66, s[20:23], 0 offen sc1
    v_mad_u32_u16 v67, v64, s30, v8 op_sel:[0,0,0,0]
    buffer_load_dwordx4 v[76:79], v67, s[20:23], 0 offen sc1
    s_waitcnt vmcnt(7)
    v_dot2c_f32_bf16 v10, s28, v80
    v_dot2c_f32_bf16 v11, s29, v80
    v_dot2c_f32_bf16 v12, s28, v81
    v_dot2c_f32_bf16 v13, s29, v81
    v_dot2c_f32_bf16 v14, s28, v82
    v_dot2c_f32_bf16 v15, s29, v82
    v_dot2c_f32_bf16 v16, s28, v83
    v_dot2c_f32_bf16 v17, s29, v83
    s_waitcnt vmcnt(6)
    v_dot2c_f32_bf16 v18, s28, v84
    v_dot2c_f32_bf16 v19, s29, v84
    v_dot2c_f32_bf16 v20, s28, v85
    v_dot2c_f32_bf16 v21, s29, v85
    v_dot2c_f32_bf16 v22, s28, v86
    v_dot2c_f32_bf16 v23, s29, v86
    v_dot2c_f32_bf16 v24, s28, v87
    v_dot2c_f32_bf16 v25, s29, v87
    v_mad_u32_u16 v66, v44, s30, v8 op_sel:[1,0,0,0]
    buffer_load_dwordx4 v[80:83], v66, s[20:23], 0 offen sc1
    v_mad_u32_u16 v67, v64, s30, v8 op_sel:[1,0,0,0]
    buffer_load_dwordx4 v[84:87], v67, s[20:23], 0 offen sc1
    s_waitcnt vmcnt(7)
    v_dot2c_f32_bf16 v10, s28, v88
    v_dot2c_f32_bf16 v11, s29, v88
    v_dot2c_f32_bf16 v12, s28, v89
    v_dot2c_f32_bf16 v13, s29, v89
    v_dot2c_f32_bf16 v14, s28, v90
    v_dot2c_f32_bf16 v15, s29, v90
    v_dot2c_f32_bf16 v16, s28, v91
    v_dot2c_f32_bf16 v17, s29, v91
    s_waitcnt vmcnt(6)
    v_dot2c_f32_bf16 v18, s28, v92
    v_dot2c_f32_bf16 v19, s29, v92
    v_dot2c_f32_bf16 v20, s28, v93
    v_dot2c_f32_bf16 v21, s29, v93
    v_dot2c_f32_bf16 v22, s28, v94
    v_dot2c_f32_bf16 v23, s29, v94
    v_dot2c_f32_bf16 v24, s28, v95
    v_dot2c_f32_bf16 v25, s29, v95
    s_waitcnt vmcnt(5)
    v_dot2c_f32_bf16 v10, s28, v96
    v_dot2c_f32_bf16 v11, s29, v96
    v_dot2c_f32_bf16 v12, s28, v97
    v_dot2c_f32_bf16 v13, s29, v97
    v_dot2c_f32_bf16 v14, s28, v98
    v_dot2c_f32_bf16 v15, s29, v98
    v_dot2c_f32_bf16 v16, s28, v99
    v_dot2c_f32_bf16 v17, s29, v99
    s_waitcnt vmcnt(4)
    v_dot2c_f32_bf16 v18, s28, v100
    v_dot2c_f32_bf16 v19, s29, v100
    v_dot2c_f32_bf16 v20, s28, v101
    v_dot2c_f32_bf16 v21, s29, v101
    v_dot2c_f32_bf16 v22, s28, v102
    v_dot2c_f32_bf16 v23, s29, v102
    v_dot2c_f32_bf16 v24, s28, v103
    v_dot2c_f32_bf16 v25, s29, v103
    s_waitcnt vmcnt(3)
    v_dot2c_f32_bf16 v10, s28, v72
    v_dot2c_f32_bf16 v11, s29, v72
    v_dot2c_f32_bf16 v12, s28, v73
    v_dot2c_f32_bf16 v13, s29, v73
    v_dot2c_f32_bf16 v14, s28, v74
    v_dot2c_f32_bf16 v15, s29, v74
    v_dot2c_f32_bf16 v16, s28, v75
    v_dot2c_f32_bf16 v17, s29, v75
    s_waitcnt vmcnt(2)
    v_dot2c_f32_bf16 v18, s28, v76
    v_dot2c_f32_bf16 v19, s29, v76
    v_dot2c_f32_bf16 v20, s28, v77
    v_dot2c_f32_bf16 v21, s29, v77
    v_dot2c_f32_bf16 v22, s28, v78
    v_dot2c_f32_bf16 v23, s29, v78
    v_dot2c_f32_bf16 v24, s28, v79
    v_dot2c_f32_bf16 v25, s29, v79
    s_waitcnt vmcnt(1)
    v_dot2c_f32_bf16 v10, s28, v80
    v_dot2c_f32_bf16 v11, s29, v80
    v_dot2c_f32_bf16 v12, s28, v81
    v_dot2c_f32_bf16 v13, s29, v81
    v_dot2c_f32_bf16 v14, s28, v82
    v_dot2c_f32_bf16 v15, s29, v82
    v_dot2c_f32_bf16 v16, s28, v83
    v_dot2c_f32_bf16 v17, s29, v83
    s_waitcnt vmcnt(0)
    v_dot2c_f32_bf16 v18, s28, v84
    v_dot2c_f32_bf16 v19, s29, v84
    v_dot2c_f32_bf16 v20, s28, v85
    v_dot2c_f32_bf16 v21, s29, v85
    v_dot2c_f32_bf16 v22, s28, v86
    v_dot2c_f32_bf16 v23, s29, v86
    v_dot2c_f32_bf16 v24, s28, v87
    v_dot2c_f32_bf16 v25, s29, v87
    s_branch hop_fin
hop_w20:
    s_setprio 3
    v_mad_u32_u16 v66, v26, s30, v8 op_sel:[0,0,0,0]
    buffer_load_dwordx4 v[72:75], v66, s[20:23], 0 offen sc1
    v_mad_u32_u16 v67, v46, s30, v8 op_sel:[0,0,0,0]
    buffer_load_dwordx4 v[76:79], v67, s[20:23], 0 offen sc1
    v_mad_u32_u16 v66, v26, s30, v8 op_sel:[1,0,0,0]
    buffer_load_dwordx4 v[80:83], v66, s[20:23], 0 offen sc1
    v_mad_u32_u16 v67, v46, s30, v8 op_sel:[1,0,0,0]
    buffer_load_dwordx4 v[84:87], v67, s[20:23], 0 offen sc1
    v_mad_u32_u16 v66, v27, s30, v8 op_sel:[0,0,0,0]
    buffer_load_dwordx4 v[88:91], v66, s[20:23], 0 offen sc1
    v_mad_u32_u16 v67, v47, s30, v8 op_sel:[0,0,0,0]
    buffer_load_dwordx4 v[92:95], v67, s[20:23], 0 offen sc1
    v_mad_u32_u16 v66, v27, s30, v8 op_sel:[1,0,0,0]
    buffer_load_dwordx4 v[96:99], v66, s[20:23], 0 offen sc1
    v_mad_u32_u16 v67, v47, s30, v8 op_sel:[1,0,0,0]
    buffer_load_dwordx4 v[100:103], v67, s[20:23], 0 offen sc1
    s_waitcnt vmcnt(7)
    v_dot2c_f32_bf16 v10, s28, v72
    v_dot2c_f32_bf16 v11, s29, v72
    v_dot2c_f32_bf16 v12, s28, v73
    v_dot2c_f32_bf16 v13, s29, v73
    v_dot2c_f32_bf16 v14, s28, v74
    v_dot2c_f32_bf16 v15, s29, v74
    v_dot2c_f32_bf16 v16, s28, v75
    v_dot2c_f32_bf16 v17, s29, v75
    s_waitcnt vmcnt(6)
    v_dot2c_f32_bf16 v18, s28, v76
    v_dot2c_f32_bf16 v19, s29, v76
    v_dot2c_f32_bf16 v20, s28, v77
    v_dot2c_f32_bf16 v21, s29, v77
    v_dot2c_f32_bf16 v22, s28, v78
    v_dot2c_f32_bf16 v23, s29, v78
    v_dot2c_f32_bf16 v24, s28, v79
    v_dot2c_f32_bf16 v25, s29, v79
    v_mad_u32_u16 v66, v28, s30, v8 op_sel:[0,0,0,0]
    buffer_load_dwordx4 v[72:75], v66, s[20:23], 0 offen sc1
    v_mad_u32_u16 v67, v48, s30, v8 op_sel:[0,0,0,0]
    buffer_load_dwordx4 v[76:79], v67, s[20:23], 0 offen sc1
    s_waitcnt vmcnt(7)
    v_dot2c_f32_bf16 v10, s28, v80
    v_dot2c_f32_bf16 v11, s29, v80
    v_dot2c_f32_bf16 v12, s28, v81
    v_dot2c_f32_bf16 v13, s29, v81
    v_dot2c_f32_bf16 v14, s28, v82
    v_dot2c_f32_bf16 v15, s29, v82
    v_dot2c_f32_bf16 v16, s28, v83
    v_dot2c_f32_bf16 v17, s29, v83
    s_waitcnt vmcnt(6)
    v_dot2c_f32_bf16 v18, s28, v84
    v_dot2c_f32_bf16 v19, s29, v84
    v_dot2c_f32_bf16 v20, s28, v85
    v_dot2c_f32_bf16 v21, s29, v85
    v_dot2c_f32_bf16 v22, s28, v86
    v_dot2c_f32_bf16 v23, s29, v86
    v_dot2c_f32_bf16 v24, s28, v87
    v_dot2c_f32_bf16 v25, s29, v87
    v_mad_u32_u16 v66, v28, s30, v8 op_sel:[1,0,0,0]
    buffer_load_dwordx4 v[80:83], v66, s[20:23], 0 offen sc1
    v_mad_u32_u16 v67, v48, s30, v8 op_sel:[1,0,0,0]
    buffer_load_dwordx4 v[84:87], v67, s[20:23], 0 offen sc1
    s_waitcnt vmcnt(7)
    v_dot2c_f32_bf16 v10, s28, v88
    v_dot2c_f32_bf16 v11, s29, v88
    v_dot2c_f32_bf16 v12, s28, v89
    v_dot2c_f32_bf16 v13, s29, v89
    v_dot2c_f32_bf16 v14, s28, v90
    v_dot2c_f32_bf16 v15, s29, v90
    v_dot2c_f32_bf16 v16, s28, v91
    v_dot2c_f32_bf16 v17, s29, v91
    s_waitcnt vmcnt(6)
    v_dot2c_f32_bf16 v18, s28, v92
    v_dot2c_f32_bf16 v19, s29, v92
    v_dot2c_f32_bf16 v20, s28, v93
    v_dot2c_f32_bf16 v21, s29, v93
    v_dot2c_f32_bf16 v22, s28, v94
    v_dot2c_f32_bf16 v23, s29, v94
    v_dot2c_f32_bf16 v24, s28, v95
    v_dot2c_f32_bf16 v25, s29, v95
    v_mad_u32_u16 v66, v29, s30, v8 op_sel:[0,0,0,0]
    buffer_load_dwordx4 v[88:91], v66, s[20:23], 0 offen sc1
    v_mad_u32_u16 v67, v49, s30, v8 op_sel:[0,0,0,0]
    buffer_load_dwordx4 v[92:95], v67, s[20:23], 0 offen sc1
    s_waitcnt vmcnt(7)
    v_dot2c_f32_bf16 v10, s28, v96
    v_dot2c_f32_bf16 v11, s29, v96
    v_dot2c_f32_bf16 v12, s28, v97
    v_dot2c_f32_bf16 v13, s29, v97
    v_dot2c_f32_bf16 v14, s28, v98
    v_dot2c_f32_bf16 v15, s29, v98
    v_dot2c_f32_bf16 v16, s28, v99
    v_dot2c_f32_bf16 v17, s29, v99
    s_waitcnt vmcnt(6)
    v_dot2c_f32_bf16 v18, s28, v100
    v_dot2c_f32_bf16 v19, s29, v100
    v_dot2c_f32_bf16 v20, s28, v101
    v_dot2c_f32_bf16 v21, s29, v101
    v_dot2c_f32_bf16 v22, s28, v102
    v_dot2c_f32_bf16 v23, s29, v102
    v_dot2c_f32_bf16 v24, s28, v103
    v_dot2c_f32_bf16 v25, s29, v103
    v_mad_u32_u16 v66, v29, s30, v8 op_sel:[1,0,0,0]
    buffer_load_dwordx4 v[96:99], v66, s[20:23], 0 offen sc1
    v_mad_u32_u16 v67, v49, s30, v8 op_sel:[1,0,0,0]
    buffer_load_dwordx4 v[100:103], v67, s[20:23], 0 offen sc1
    s_waitcnt vmcnt(7)
    v_dot2c_f32_bf16 v10, s28, v72
    v_dot2c_f32_bf16 v11, s29, v72
    v_dot2c_f32_bf16 v12, s28, v73
    v_dot2c_f32_bf16 v13, s29, v73
    v_dot2c_f32_bf16 v14, s28, v74
    v_dot2c_f32_bf16 v15, s29, v74
    v_dot2c_f32_bf16 v16, s28, v75
    v_dot2c_f32_bf16 v17, s29, v75
    s_waitcnt vmcnt(6)
    v_dot2c_f32_bf16 v18, s28, v76
    v_dot2c_f32_bf16 v19, s29, v76
    v_dot2c_f32_bf16 v20, s28, v77
    v_dot2c_f32_bf16 v21, s29, v77
    v_dot2c_f32_bf16 v22, s28, v78
    v_dot2c_f32_bf16 v23, s29, v78
    v_dot2c_f32_bf16 v24, s28, v79
    v_dot2c_f32_bf16 v25, s29, v79
    v_mad_u32_u16 v66, v30, s30, v8 op_sel:[0,0,0,0]
    buffer_load_dwordx4 v[72:75], v66, s[20:23], 0 offen sc1
    v_mad_u32_u16 v67, v50, s30, v8 op_sel:[0,0,0,0]
    buffer_load_dwordx4 v[76:79], v67, s[20:23], 0 offen sc1
    s_waitcnt vmcnt(7)
    v_dot2c_f32_bf16 v10, s28, v80
    v_dot2c_f32_bf16 v11, s29, v80
    v_dot2c_f32_bf16 v12, s28, v81
    v_dot2c_f32_bf16 v13, s29, v81
    v_dot2c_f32_bf16 v14, s28, v82
    v_dot2c_f32_bf16 v15, s29, v82
    v_dot2c_f32_bf16 v16, s28, v83
    v_dot2c_f32_bf16 v17, s29, v83
    s_waitcnt vmcnt(6)
    v_dot2c_f32_bf16 v18, s28, v84
    v_dot2c_f32_bf16 v19, s29, v84
    v_dot2c_f32_bf16 v20, s28, v85
    v_dot2c_f32_bf16 v21, s29, v85
    v_dot2c_f32_bf16 v22, s28, v86
    v_dot2c_f32_bf16 v23, s29, v86
    v_dot2c_f32_bf16 v24, s28, v87
    v_dot2c_f32_bf16 v25, s29, v87
    v_mad_u32_u16 v66, v30, s30, v8 op_sel:[1,0,0,0]
    buffer_load_dwordx4 v[80:83], v66, s[20:23], 0 offen sc1
    v_mad_u32_u16 v67, v50, s30, v8 op_sel:[1,0,0,0]
    buffer_load_dwordx4 v[84:87], v67, s[20:23], 0 offen sc1
    s_waitcnt vmcnt(7)
    v_dot2c_f32_bf16 v10, s28, v88
    v_dot2c_f32_bf16 v11, s29, v88
    v_dot2c_f32_bf16 v12, s28, v89
    v_dot2c_f32_bf16 v13, s29, v89
    v_dot2c_f32_bf16 v14, s28, v90
    v_dot2c_f32_bf16 v15, s29, v90
    v_dot2c_f32_bf16 v16, s28, v91
    v_dot2c_f32_bf16 v17, s29, v91
    s_waitcnt vmcnt(6)
    v_dot2c_f32_bf16 v18, s28, v92
    v_dot2c_f32_bf16 v19, s29, v92
    v_dot2c_f32_bf16 v20, s28, v93
    v_dot2c_f32_bf16 v21, s29, v93
    v_dot2c_f32_bf16 v22, s28, v94
    v_dot2c_f32_bf16 v23, s29, v94
    v_dot2c_f32_bf16 v24, s28, v95
    v_dot2c_f32_bf16 v25, s29, v95
    s_setprio 2
    v_mad_u32_u16 v66, v31, s30, v8 op_sel:[0,0,0,0]
    buffer_load_dwordx4 v[88:91], v66, s[20:23], 0 offen sc1
    v_mad_u32_u16 v67, v51, s30, v8 op_sel:[0,0,0,0]
    buffer_load_dwordx4 v[92:95], v67, s[20:23], 0 offen sc1
    s_waitcnt vmcnt(7)
    v_dot2c_f32_bf16 v10, s28, v96
    v_dot2c_f32_bf16 v11, s29, v96
    v_dot2c_f32_bf16 v12, s28, v97
    v_dot2c_f32_bf16 v13, s29, v97
    v_dot2c_f32_bf16 v14, s28, v98
    v_dot2c_f32_bf16 v15, s29, v98
    v_dot2c_f32_bf16 v16, s28, v99
    v_dot2c_f32_bf16 v17, s29, v99
    s_waitcnt vmcnt(6)
    v_dot2c_f32_bf16 v18, s28, v100
    v_dot2c_f32_bf16 v19, s29, v100
    v_dot2c_f32_bf16 v20, s28, v101
    v_dot2c_f32_bf16 v21, s29, v101
    v_dot2c_f32_bf16 v22, s28, v102
    v_dot2c_f32_bf16 v23, s29, v102
    v_dot2c_f32_bf16 v24, s28, v103
    v_dot2c_f32_bf16 v25, s29, v103
    v_mad_u32_u16 v66, v31, s30, v8 op_sel:[1,0,0,0]
    buffer_load_dwordx4 v[96:99], v66, s[20:23], 0 offen sc1
    v_mad_u32_u16 v67, v51, s30, v8 op_sel:[1,0,0,0]
    buffer_load_dwordx4 v[100:103], v67, s[20:23], 0 offen sc1
    s_waitcnt vmcnt(7)
    v_dot2c_f32_bf16 v10, s28, v72
    v_dot2c_f32_bf16 v11, s29, v72
    v_dot2c_f32_bf16 v12, s28, v73
    v_dot2c_f32_bf16 v13, s29, v73
    v_dot2c_f32_bf16 v14, s28, v74
    v_dot2c_f32_bf16 v15, s29, v74
    v_dot2c_f32_bf16 v16, s28, v75
    v_dot2c_f32_bf16 v17, s29, v75
    s_waitcnt vmcnt(6)
    v_dot2c_f32_bf16 v18, s28, v76
    v_dot2c_f32_bf16 v19, s29, v76
    v_dot2c_f32_bf16 v20, s28, v77
    v_dot2c_f32_bf16 v21, s29, v77
    v_dot2c_f32_bf16 v22, s28, v78
    v_dot2c_f32_bf16 v23, s29, v78
    v_dot2c_f32_bf16 v24, s28, v79
    v_dot2c_f32_bf16 v25, s29, v79
    v_mad_u32_u16 v66, v32, s30, v8 op_sel:[0,0,0,0]
    buffer_load_dwordx4 v[72:75], v66, s[20:23], 0 offen sc1
    v_mad_u32_u16 v67, v52, s30, v8 op_sel:[0,0,0,0]
    buffer_load_dwordx4 v[76:79], v67, s[20:23], 0 offen sc1
    s_waitcnt vmcnt(7)
    v_dot2c_f32_bf16 v10, s28, v80
    v_dot2c_f32_bf16 v11, s29, v80
    v_dot2c_f32_bf16 v12, s28, v81
    v_dot2c_f32_bf16 v13, s29, v81
    v_dot2c_f32_bf16 v14, s28, v82
    v_dot2c_f32_bf16 v15, s29, v82
    v_dot2c_f32_bf16 v16, s28, v83
    v_dot2c_f32_bf16 v17, s29, v83
    s_waitcnt vmcnt(6)
    v_dot2c_f32_bf16 v18, s28, v84
    v_dot2c_f32_bf16 v19, s29, v84
    v_dot2c_f32_bf16 v20, s28, v85
    v_dot2c_f32_bf16 v21, s29, v85
    v_dot2c_f32_bf16 v22, s28, v86
    v_dot2c_f32_bf16 v23, s29, v86
    v_dot2c_f32_bf16 v24, s28, v87
    v_dot2c_f32_bf16 v25, s29, v87
    v_mad_u32_u16 v66, v32, s30, v8 op_sel:[1,0,0,0]
    buffer_load_dwordx4 v[80:83], v66, s[20:23], 0 offen sc1
    v_mad_u32_u16 v67, v52, s30, v8 op_sel:[1,0,0,0]
    buffer_load_dwordx4 v[84:87], v67, s[20:23], 0 offen sc1
    s_waitcnt vmcnt(7)
    v_dot2c_f32_bf16 v10, s28, v88
    v_dot2c_f32_bf16 v11, s29, v88
    v_dot2c_f32_bf16 v12, s28, v89
    v_dot2c_f32_bf16 v13, s29, v89
    v_dot2c_f32_bf16 v14, s28, v90
    v_dot2c_f32_bf16 v15, s29, v90
    v_dot2c_f32_bf16 v16, s28, v91
    v_dot2c_f32_bf16 v17, s29, v91
    s_waitcnt vmcnt(6)
    v_dot2c_f32_bf16 v18, s28, v92
    v_dot2c_f32_bf16 v19, s29, v92
    v_dot2c_f32_bf16 v20, s28, v93
    v_dot2c_f32_bf16 v21, s29, v93
    v_dot2c_f32_bf16 v22, s28, v94
    v_dot2c_f32_bf16 v23, s29, v94
    v_dot2c_f32_bf16 v24, s28, v95
    v_dot2c_f32_bf16 v25, s29, v95
    v_mad_u32_u16 v66, v33, s30, v8 op_sel:[0,0,0,0]
    buffer_load_dwordx4 v[88:91], v66, s[20:23], 0 offen sc1
    v_mad_u32_u16 v67, v53, s30, v8 op_sel:[0,0,0,0]
    buffer_load_dwordx4 v[92:95], v67, s[20:23], 0 offen sc1
    s_waitcnt vmcnt(7)
    v_dot2c_f32_bf16 v10, s28, v96
    v_dot2c_f32_bf16 v11, s29, v96
    v_dot2c_f32_bf16 v12, s28, v97
    v_dot2c_f32_bf16 v13, s29, v97
    v_dot2c_f32_bf16 v14, s28, v98
    v_dot2c_f32_bf16 v15, s29, v98
    v_dot2c_f32_bf16 v16, s28, v99
    v_dot2c_f32_bf16 v17, s29, v99
    s_waitcnt vmcnt(6)
    v_dot2c_f32_bf16 v18, s28, v100
    v_dot2c_f32_bf16 v19, s29, v100
    v_dot2c_f32_bf16 v20, s28, v101
    v_dot2c_f32_bf16 v21, s29, v101
    v_dot2c_f32_bf16 v22, s28, v102
    v_dot2c_f32_bf16 v23, s29, v102
    v_dot2c_f32_bf16 v24, s28, v103
    v_dot2c_f32_bf16 v25, s29, v103
    v_mad_u32_u16 v66, v33, s30, v8 op_sel:[1,0,0,0]
    buffer_load_dwordx4 v[96:99], v66, s[20:23], 0 offen sc1
    v_mad_u32_u16 v67, v53, s30, v8 op_sel:[1,0,0,0]
    buffer_load_dwordx4 v[100:103], v67, s[20:23], 0 offen sc1
    s_waitcnt vmcnt(7)
    v_dot2c_f32_bf16 v10, s28, v72
    v_dot2c_f32_bf16 v11, s29, v72
    v_dot2c_f32_bf16 v12, s28, v73
    v_dot2c_f32_bf16 v13, s29, v73
    v_dot2c_f32_bf16 v14, s28, v74
    v_dot2c_f32_bf16 v15, s29, v74
    v_dot2c_f32_bf16 v16, s28, v75
    v_dot2c_f32_bf16 v17, s29, v75
    s_waitcnt vmcnt(6)
    v_dot2c_f32_bf16 v18, s28, v76
    v_dot2c_f32_bf16 v19, s29, v76
    v_dot2c_f32_bf16 v20, s28, v77
    v_dot2c_f32_bf16 v21, s29, v77
    v_dot2c_f32_bf16 v22, s28, v78
    v_dot2c_f32_bf16 v23, s29, v78
    v_dot2c_f32_bf16 v24, s28, v79
    v_dot2c_f32_bf16 v25, s29, v79
    v_mad_u32_u16 v66, v34, s30, v8 op_sel:[0,0,0,0]
    buffer_load_dwordx4 v[72:75], v66, s[20:23], 0 offen sc1
    v_mad_u32_u16 v67, v54, s30, v8 op_sel:[0,0,0,0]
    buffer_load_dwordx4 v[76:79], v67, s[20:23], 0 offen sc1
    s_waitcnt vmcnt(7)
    v_dot2c_f32_bf16 v10, s28, v80
    v_dot2c_f32_bf16 v11, s29, v80
    v_dot2c_f32_bf16 v12, s28, v81
    v_dot2c_f32_bf16 v13, s29, v81
    v_dot2c_f32_bf16 v14, s28, v82
    v_dot2c_f32_bf16 v15, s29, v82
    v_dot2c_f32_bf16 v16, s28, v83
    v_dot2c_f32_bf16 v17, s29, v83
    s_waitcnt vmcnt(6)
    v_dot2c_f32_bf16 v18, s28, v84
    v_dot2c_f32_bf16 v19, s29, v84
    v_dot2c_f32_bf16 v20, s28, v85
    v_dot2c_f32_bf16 v21, s29, v85
    v_dot2c_f32_bf16 v22, s28, v86
    v_dot2c_f32_bf16 v23, s29, v86
    v_dot2c_f32_bf16 v24, s28, v87
    v_dot2c_f32_bf16 v25, s29, v87
    v_mad_u32_u16 v66, v34, s30, v8 op_sel:[1,0,0,0]
    buffer_load_dwordx4 v[80:83], v66, s[20:23], 0 offen sc1
    v_mad_u32_u16 v67, v54, s30, v8 op_sel:[1,0,0,0]
    buffer_load_dwordx4 v[84:87], v67, s[20:23], 0 offen sc1
    s_waitcnt vmcnt(7)
    v_dot2c_f32_bf16 v10, s28, v88
    v_dot2c_f32_bf16 v11, s29, v88
    v_dot2c_f32_bf16 v12, s28, v89
    v_dot2c_f32_bf16 v13, s29, v89
    v_dot2c_f32_bf16 v14, s28, v90
    v_dot2c_f32_bf16 v15, s29, v90
    v_dot2c_f32_bf16 v16, s28, v91
    v_dot2c_f32_bf16 v17, s29, v91
    s_waitcnt vmcnt(6)
    v_dot2c_f32_bf16 v18, s28, v92
    v_dot2c_f32_bf16 v19, s29, v92
    v_dot2c_f32_bf16 v20, s28, v93
    v_dot2c_f32_bf16 v21, s29, v93
    v_dot2c_f32_bf16 v22, s28, v94
    v_dot2c_f32_bf16 v23, s29, v94
    v_dot2c_f32_bf16 v24, s28, v95
    v_dot2c_f32_bf16 v25, s29, v95
    v_mad_u32_u16 v66, v35, s30, v8 op_sel:[0,0,0,0]
    buffer_load_dwordx4 v[88:91], v66, s[20:23], 0 offen sc1
    v_mad_u32_u16 v67, v55, s30, v8 op_sel:[0,0,0,0]
    buffer_load_dwordx4 v[92:95], v67, s[20:23], 0 offen sc1
    s_waitcnt vmcnt(7)
    v_dot2c_f32_bf16 v10, s28, v96
    v_dot2c_f32_bf16 v11, s29, v96
    v_dot2c_f32_bf16 v12, s28, v97
    v_dot2c_f32_bf16 v13, s29, v97
    v_dot2c_f32_bf16 v14, s28, v98
    v_dot2c_f32_bf16 v15, s29, v98
    v_dot2c_f32_bf16 v16, s28, v99
    v_dot2c_f32_bf16 v17, s29, v99
    s_waitcnt vmcnt(6)
    v_dot2c_f32_bf16 v18, s28, v100
    v_dot2c_f32_bf16 v19, s29, v100
    v_dot2c_f32_bf16 v20, s28, v101
    v_dot2c_f32_bf16 v21, s29, v101
    v_dot2c_f32_bf16 v22, s28, v102
    v_dot2c_f32_bf16 v23, s29, v102
    v_dot2c_f32_bf16 v24, s28, v103
    v_dot2c_f32_bf16 v25, s29, v103
    v_mad_u32_u16 v66, v35, s30, v8 op_sel:[1,0,0,0]
    buffer_load_dwordx4 v[96:99], v66, s[20:23], 0 offen sc1
    v_mad_u32_u16 v67, v55, s30, v8 op_sel:[1,0,0,0]
    buffer_load_dwordx4 v[100:103], v67, s[20:23], 0 offen sc1
    s_waitcnt vmcnt(7)
    v_dot2c_f32_bf16 v10, s28, v72
    v_dot2c_f32_bf16 v11, s29, v72
    v_dot2c_f32_bf16 v12, s28, v73
    v_dot2c_f32_bf16 v13, s29, v73
    v_dot2c_f32_bf16 v14, s28, v74
    v_dot2c_f32_bf16 v15, s29, v74
    v_dot2c_f32_bf16 v16, s28, v75
    v_dot2c_f32_bf16 v17, s29, v75
    s_waitcnt vmcnt(6)
    v_dot2c_f32_bf16 v18, s28, v76
    v_dot2c_f32_bf16 v19, s29, v76
    v_dot2c_f32_bf16 v20, s28, v77
    v_dot2c_f32_bf16 v21, s29, v77
    v_dot2c_f32_bf16 v22, s28, v78
    v_dot2c_f32_bf16 v23, s29, v78
    v_dot2c_f32_bf16 v24, s28, v79
    v_dot2c_f32_bf16 v25, s29, v79
    s_setprio 1
    v_mad_u32_u16 v66, v36, s30, v8 op_sel:[0,0,0,0]
    buffer_load_dwordx4 v[72:75], v66, s[20:23], 0 offen sc1
    v_mad_u32_u16 v67, v56, s30, v8 op_sel:[0,0,0,0]
    buffer_load_dwordx4 v[76:79], v67, s[20:23], 0 offen sc1
    s_waitcnt vmcnt(7)
    v_dot2c_f32_bf16 v10, s28, v80
    v_dot2c_f32_bf16 v11, s29, v80
    v_dot2c_f32_bf16 v12, s28, v81
    v_dot2c_f32_bf16 v13, s29, v81
    v_dot2c_f32_bf16 v14, s28, v82
    v_dot2c_f32_bf16 v15, s29, v82
    v_dot2c_f32_bf16 v16, s28, v83
    v_dot2c_f32_bf16 v17, s29, v83
    s_waitcnt vmcnt(6)
    v_dot2c_f32_bf16 v18, s28, v84
    v_dot2c_f32_bf16 v19, s29, v84
    v_dot2c_f32_bf16 v20, s28, v85
    v_dot2c_f32_bf16 v21, s29, v85
    v_dot2c_f32_bf16 v22, s28, v86
    v_dot2c_f32_bf16 v23, s29, v86
    v_dot2c_f32_bf16 v24, s28, v87
    v_dot2c_f32_bf16 v25, s29, v87
    v_mad_u32_u16 v66, v36, s30, v8 op_sel:[1,0,0,0]
    buffer_load_dwordx4 v[80:83], v66, s[20:23], 0 offen sc1
    v_mad_u32_u16 v67, v56, s30, v8 op_sel:[1,0,0,0]
    buffer_load_dwordx4 v[84:87], v67, s[20:23], 0 offen sc1
    s_waitcnt vmcnt(7)
    v_dot2c_f32_bf16 v10, s28, v88
    v_dot2c_f32_bf16 v11, s29, v88
    v_dot2c_f32_bf16 v12, s28, v89
    v_dot2c_f32_bf16 v13, s29, v89
    v_dot2c_f32_bf16 v14, s28, v90
    v_dot2c_f32_bf16 v15, s29, v90
    v_dot2c_f32_bf16 v16, s28, v91
    v_dot2c_f32_bf16 v17, s29, v91
    s_waitcnt vmcnt(6)
    v_dot2c_f32_bf16 v18, s28, v92
    v_dot2c_f32_bf16 v19, s29, v92
    v_dot2c_f32_bf16 v20, s28, v93
    v_dot2c_f32_bf16 v21, s29, v93
    v_dot2c_f32_bf16 v22, s28, v94
    v_dot2c_f32_bf16 v23, s29, v94
    v_dot2c_f32_bf16 v24, s28, v95
    v_dot2c_f32_bf16 v25, s29, v95
    v_mad_u32_u16 v66, v37, s30, v8 op_sel:[0,0,0,0]
    buffer_load_dwordx4 v[88:91], v66, s[20:23], 0 offen sc1
    v_mad_u32_u16 v67, v57, s30, v8 op_sel:[0,0,0,0]
    buffer_load_dwordx4 v[92:95], v67, s[20:23], 0 offen sc1
    s_waitcnt vmcnt(7)
    v_dot2c_f32_bf16 v10, s28, v96
    v_dot2c_f32_bf16 v11, s29, v96
    v_dot2c_f32_bf16 v12, s28, v97
    v_dot2c_f32_bf16 v13, s29, v97
    v_dot2c_f32_bf16 v14, s28, v98
    v_dot2c_f32_bf16 v15, s29, v98
    v_dot2c_f32_bf16 v16, s28, v99
    v_dot2c_f32_bf16 v17, s29, v99
    s_waitcnt vmcnt(6)
    v_dot2c_f32_bf16 v18, s28, v100
    v_dot2c_f32_bf16 v19, s29, v100
    v_dot2c_f32_bf16 v20, s28, v101
    v_dot2c_f32_bf16 v21, s29, v101
    v_dot2c_f32_bf16 v22, s28, v102
    v_dot2c_f32_bf16 v23, s29, v102
    v_dot2c_f32_bf16 v24, s28, v103
    v_dot2c_f32_bf16 v25, s29, v103
    v_mad_u32_u16 v66, v37, s30, v8 op_sel:[1,0,0,0]
    buffer_load_dwordx4 v[96:99], v66, s[20:23], 0 offen sc1
    v_mad_u32_u16 v67, v57, s30, v8 op_sel:[1,0,0,0]
    buffer_load_dwordx4 v[100:103], v67, s[20:23], 0 offen sc1
    s_waitcnt vmcnt(7)
    v_dot2c_f32_bf16 v10, s28, v72
    v_dot2c_f32_bf16 v11, s29, v72
    v_dot2c_f32_bf16 v12, s28, v73
    v_dot2c_f32_bf16 v13, s29, v73
    v_dot2c_f32_bf16 v14, s28, v74
    v_dot2c_f32_bf16 v15, s29, v74
    v_dot2c_f32_bf16 v16, s28, v75
    v_dot2c_f32_bf16 v17, s29, v75
    s_waitcnt vmcnt(6)
    v_dot2c_f32_bf16 v18, s28, v76
    v_dot2c_f32_bf16 v19, s29, v76
    v_dot2c_f32_bf16 v20, s28, v77
    v_dot2c_f32_bf16 v21, s29, v77
    v_dot2c_f32_bf16 v22, s28, v78
    v_dot2c_f32_bf16 v23, s29, v78
    v_dot2c_f32_bf16 v24, s28, v79
    v_dot2c_f32_bf16 v25, s29, v79
    v_mad_u32_u16 v66, v38, s30, v8 op_sel:[0,0,0,0]
    buffer_load_dwordx4 v[72:75], v66, s[20:23], 0 offen sc1
    v_mad_u32_u16 v67, v58, s30, v8 op_sel:[0,0,0,0]
    buffer_load_dwordx4 v[76:79], v67, s[20:23], 0 offen sc1
    s_waitcnt vmcnt(7)
    v_dot2c_f32_bf16 v10, s28, v80
    v_dot2c_f32_bf16 v11, s29, v80
    v_dot2c_f32_bf16 v12, s28, v81
    v_dot2c_f32_bf16 v13, s29, v81
    v_dot2c_f32_bf16 v14, s28, v82
    v_dot2c_f32_bf16 v15, s29, v82
    v_dot2c_f32_bf16 v16, s28, v83
    v_dot2c_f32_bf16 v17, s29, v83
    s_waitcnt vmcnt(6)
    v_dot2c_f32_bf16 v18, s28, v84
    v_dot2c_f32_bf16 v19, s29, v84
    v_dot2c_f32_bf16 v20, s28, v85
    v_dot2c_f32_bf16 v21, s29, v85
    v_dot2c_f32_bf16 v22, s28, v86
    v_dot2c_f32_bf16 v23, s29, v86
    v_dot2c_f32_bf16 v24, s28, v87
    v_dot2c_f32_bf16 v25, s29, v87
    v_mad_u32_u16 v66, v38, s30, v8 op_sel:[1,0,0,0]
    buffer_load_dwordx4 v[80:83], v66, s[20:23], 0 offen sc1
    v_mad_u32_u16 v67, v58, s30, v8 op_sel:[1,0,0,0]
    buffer_load_dwordx4 v[84:87], v67, s[20:23], 0 offen sc1
    s_waitcnt vmcnt(7)
    v_dot2c_f32_bf16 v10, s28, v88
    v_dot2c_f32_bf16 v11, s29, v88
    v_dot2c_f32_bf16 v12, s28, v89
    v_dot2c_f32_bf16 v13, s29, v89
    v_dot2c_f32_bf16 v14, s28, v90
    v_dot2c_f32_bf16 v15, s29, v90
    v_dot2c_f32_bf16 v16, s28, v91
    v_dot2c_f32_bf16 v17, s29, v91
    s_waitcnt vmcnt(6)
    v_dot2c_f32_bf16 v18, s28, v92
    v_dot2c_f32_bf16 v19, s29, v92
    v_dot2c_f32_bf16 v20, s28, v93
    v_dot2c_f32_bf16 v21, s29, v93
    v_dot2c_f32_bf16 v22, s28, v94
    v_dot2c_f32_bf16 v23, s29, v94
    v_dot2c_f32_bf16 v24, s28, v95
    v_dot2c_f32_bf16 v25, s29, v95
    v_mad_u32_u16 v66, v39, s30, v8 op_sel:[0,0,0,0]
    buffer_load_dwordx4 v[88:91], v66, s[20:23], 0 offen sc1
    v_mad_u32_u16 v67, v59, s30, v8 op_sel:[0,0,0,0]
    buffer_load_dwordx4 v[92:95], v67, s[20:23], 0 offen sc1
    s_waitcnt vmcnt(7)
    v_dot2c_f32_bf16 v10, s28, v96
    v_dot2c_f32_bf16 v11, s29, v96
    v_dot2c_f32_bf16 v12, s28, v97
    v_dot2c_f32_bf16 v13, s29, v97
    v_dot2c_f32_bf16 v14, s28, v98
    v_dot2c_f32_bf16 v15, s29, v98
    v_dot2c_f32_bf16 v16, s28, v99
    v_dot2c_f32_bf16 v17, s29, v99
    s_waitcnt vmcnt(6)
    v_dot2c_f32_bf16 v18, s28, v100
    v_dot2c_f32_bf16 v19, s29, v100
    v_dot2c_f32_bf16 v20, s28, v101
    v_dot2c_f32_bf16 v21, s29, v101
    v_dot2c_f32_bf16 v22, s28, v102
    v_dot2c_f32_bf16 v23, s29, v102
    v_dot2c_f32_bf16 v24, s28, v103
    v_dot2c_f32_bf16 v25, s29, v103
    v_mad_u32_u16 v66, v39, s30, v8 op_sel:[1,0,0,0]
    buffer_load_dwordx4 v[96:99], v66, s[20:23], 0 offen sc1
    v_mad_u32_u16 v67, v59, s30, v8 op_sel:[1,0,0,0]
    buffer_load_dwordx4 v[100:103], v67, s[20:23], 0 offen sc1
    s_waitcnt vmcnt(7)
    v_dot2c_f32_bf16 v10, s28, v72
    v_dot2c_f32_bf16 v11, s29, v72
    v_dot2c_f32_bf16 v12, s28, v73
    v_dot2c_f32_bf16 v13, s29, v73
    v_dot2c_f32_bf16 v14, s28, v74
    v_dot2c_f32_bf16 v15, s29, v74
    v_dot2c_f32_bf16 v16, s28, v75
    v_dot2c_f32_bf16 v17, s29, v75
    s_waitcnt vmcnt(6)
    v_dot2c_f32_bf16 v18, s28, v76
    v_dot2c_f32_bf16 v19, s29, v76
    v_dot2c_f32_bf16 v20, s28, v77
    v_dot2c_f32_bf16 v21, s29, v77
    v_dot2c_f32_bf16 v22, s28, v78
    v_dot2c_f32_bf16 v23, s29, v78
    v_dot2c_f32_bf16 v24, s28, v79
    v_dot2c_f32_bf16 v25, s29, v79
    v_mad_u32_u16 v66, v40, s30, v8 op_sel:[0,0,0,0]
    buffer_load_dwordx4 v[72:75], v66, s[20:23], 0 offen sc1
    v_mad_u32_u16 v67, v60, s30, v8 op_sel:[0,0,0,0]
    buffer_load_dwordx4 v[76:79], v67, s[20:23], 0 offen sc1
    s_waitcnt vmcnt(7)
    v_dot2c_f32_bf16 v10, s28, v80
    v_dot2c_f32_bf16 v11, s29, v80
    v_dot2c_f32_bf16 v12, s28, v81
    v_dot2c_f32_bf16 v13, s29, v81
    v_dot2c_f32_bf16 v14, s28, v82
    v_dot2c_f32_bf16 v15, s29, v82
    v_dot2c_f32_bf16 v16, s28, v83
    v_dot2c_f32_bf16 v17, s29, v83
    s_waitcnt vmcnt(6)
    v_dot2c_f32_bf16 v18, s28, v84
    v_dot2c_f32_bf16 v19, s29, v84
    v_dot2c_f32_bf16 v20, s28, v85
    v_dot2c_f32_bf16 v21, s29, v85
    v_dot2c_f32_bf16 v22, s28, v86
    v_dot2c_f32_bf16 v23, s29, v86
    v_dot2c_f32_bf16 v24, s28, v87
    v_dot2c_f32_bf16 v25, s29, v87
    v_mad_u32_u16 v66, v40, s30, v8 op_sel:[1,0,0,0]
    buffer_load_dwordx4 v[80:83], v66, s[20:23], 0 offen sc1
    v_mad_u32_u16 v67, v60, s30, v8 op_sel:[1,0,0,0]
    buffer_load_dwordx4 v[84:87], v67, s[20:23], 0 offen sc1
    s_waitcnt vmcnt(7)
    v_dot2c_f32_bf16 v10, s28, v88
    v_dot2c_f32_bf16 v11, s29, v88
    v_dot2c_f32_bf16 v12, s28, v89
    v_dot2c_f32_bf16 v13, s29, v89
    v_dot2c_f32_bf16 v14, s28, v90
    v_dot2c_f32_bf16 v15, s29, v90
    v_dot2c_f32_bf16 v16, s28, v91
    v_dot2c_f32_bf16 v17, s29, v91
    s_waitcnt vmcnt(6)
    v_dot2c_f32_bf16 v18, s28, v92
    v_dot2c_f32_bf16 v19, s29, v92
    v_dot2c_f32_bf16 v20, s28, v93
    v_dot2c_f32_bf16 v21, s29, v93
    v_dot2c_f32_bf16 v22, s28, v94
    v_dot2c_f32_bf16 v23, s29, v94
    v_dot2c_f32_bf16 v24, s28, v95
    v_dot2c_f32_bf16 v25, s29, v95
    s_setprio 0
    v_mad_u32_u16 v66, v41, s30, v8 op_sel:[0,0,0,0]
    buffer_load_dwordx4 v[88:91], v66, s[20:23], 0 offen sc1
    v_mad_u32_u16 v67, v61, s30, v8 op_sel:[0,0,0,0]
    buffer_load_dwordx4 v[92:95], v67, s[20:23], 0 offen sc1
    s_waitcnt vmcnt(7)
    v_dot2c_f32_bf16 v10, s28, v96
    v_dot2c_f32_bf16 v11, s29, v96
    v_dot2c_f32_bf16 v12, s28, v97
    v_dot2c_f32_bf16 v13, s29, v97
    v_dot2c_f32_bf16 v14, s28, v98
    v_dot2c_f32_bf16 v15, s29, v98
    v_dot2c_f32_bf16 v16, s28, v99
    v_dot2c_f32_bf16 v17, s29, v99
    s_waitcnt vmcnt(6)
    v_dot2c_f32_bf16 v18, s28, v100
    v_dot2c_f32_bf16 v19, s29, v100
    v_dot2c_f32_bf16 v20, s28, v101
    v_dot2c_f32_bf16 v21, s29, v101
    v_dot2c_f32_bf16 v22, s28, v102
    v_dot2c_f32_bf16 v23, s29, v102
    v_dot2c_f32_bf16 v24, s28, v103
    v_dot2c_f32_bf16 v25, s29, v103
    v_mad_u32_u16 v66, v41, s30, v8 op_sel:[1,0,0,0]
    buffer_load_dwordx4 v[96:99], v66, s[20:23], 0 offen sc1
    v_mad_u32_u16 v67, v61, s30, v8 op_sel:[1,0,0,0]
    buffer_load_dwordx4 v[100:103], v67, s[20:23], 0 offen sc1
    s_waitcnt vmcnt(7)
    v_dot2c_f32_bf16 v10, s28, v72
    v_dot2c_f32_bf16 v11, s29, v72
    v_dot2c_f32_bf16 v12, s28, v73
    v_dot2c_f32_bf16 v13, s29, v73
    v_dot2c_f32_bf16 v14, s28, v74
    v_dot2c_f32_bf16 v15, s29, v74
    v_dot2c_f32_bf16 v16, s28, v75
    v_dot2c_f32_bf16 v17, s29, v75
    s_waitcnt vmcnt(6)
    v_dot2c_f32_bf16 v18, s28, v76
    v_dot2c_f32_bf16 v19, s29, v76
    v_dot2c_f32_bf16 v20, s28, v77
    v_dot2c_f32_bf16 v21, s29, v77
    v_dot2c_f32_bf16 v22, s28, v78
    v_dot2c_f32_bf16 v23, s29, v78
    v_dot2c_f32_bf16 v24, s28, v79
    v_dot2c_f32_bf16 v25, s29, v79
    v_mad_u32_u16 v66, v42, s30, v8 op_sel:[0,0,0,0]
    buffer_load_dwordx4 v[72:75], v66, s[20:23], 0 offen sc1
    v_mad_u32_u16 v67, v62, s30, v8 op_sel:[0,0,0,0]
    buffer_load_dwordx4 v[76:79], v67, s[20:23], 0 offen sc1
    s_waitcnt vmcnt(7)
    v_dot2c_f32_bf16 v10, s28, v80
    v_dot2c_f32_bf16 v11, s29, v80
    v_dot2c_f32_bf16 v12, s28, v81
    v_dot2c_f32_bf16 v13, s29, v81
    v_dot2c_f32_bf16 v14, s28, v82
    v_dot2c_f32_bf16 v15, s29, v82
    v_dot2c_f32_bf16 v16, s28, v83
    v_dot2c_f32_bf16 v17, s29, v83
    s_waitcnt vmcnt(6)
    v_dot2c_f32_bf16 v18, s28, v84
    v_dot2c_f32_bf16 v19, s29, v84
    v_dot2c_f32_bf16 v20, s28, v85
    v_dot2c_f32_bf16 v21, s29, v85
    v_dot2c_f32_bf16 v22, s28, v86
    v_dot2c_f32_bf16 v23, s29, v86
    v_dot2c_f32_bf16 v24, s28, v87
    v_dot2c_f32_bf16 v25, s29, v87
    v_mad_u32_u16 v66, v42, s30, v8 op_sel:[1,0,0,0]
    buffer_load_dwordx4 v[80:83], v66, s[20:23], 0 offen sc1
    v_mad_u32_u16 v67, v62, s30, v8 op_sel:[1,0,0,0]
    buffer_load_dwordx4 v[84:87], v67, s[20:23], 0 offen sc1
    s_waitcnt vmcnt(7)
    v_dot2c_f32_bf16 v10, s28, v88
    v_dot2c_f32_bf16 v11, s29, v88
    v_dot2c_f32_bf16 v12, s28, v89
    v_dot2c_f32_bf16 v13, s29, v89
    v_dot2c_f32_bf16 v14, s28, v90
    v_dot2c_f32_bf16 v15, s29, v90
    v_dot2c_f32_bf16 v16, s28, v91
    v_dot2c_f32_bf16 v17, s29, v91
    s_waitcnt vmcnt(6)
    v_dot2c_f32_bf16 v18, s28, v92
    v_dot2c_f32_bf16 v19, s29, v92
    v_dot2c_f32_bf16 v20, s28, v93
    v_dot2c_f32_bf16 v21, s29, v93
    v_dot2c_f32_bf16 v22, s28, v94
    v_dot2c_f32_bf16 v23, s29, v94
    v_dot2c_f32_bf16 v24, s28, v95
    v_dot2c_f32_bf16 v25, s29, v95
    v_mad_u32_u16 v66, v43, s30, v8 op_sel:[0,0,0,0]
    buffer_load_dwordx4 v[88:91], v66, s[20:23], 0 offen sc1
    v_mad_u32_u16 v67, v63, s30, v8 op_sel:[0,0,0,0]
    buffer_load_dwordx4 v[92:95], v67, s[20:23], 0 offen sc1
    s_waitcnt vmcnt(7)
    v_dot2c_f32_bf16 v10, s28, v96
    v_dot2c_f32_bf16 v11, s29, v96
    v_dot2c_f32_bf16 v12, s28, v97
    v_dot2c_f32_bf16 v13, s29, v97
    v_dot2c_f32_bf16 v14, s28, v98
    v_dot2c_f32_bf16 v15, s29, v98
    v_dot2c_f32_bf16 v16, s28, v99
    v_dot2c_f32_bf16 v17, s29, v99
    s_waitcnt vmcnt(6)
    v_dot2c_f32_bf16 v18, s28, v100
    v_dot2c_f32_bf16 v19, s29, v100
    v_dot2c_f32_bf16 v20, s28, v101
    v_dot2c_f32_bf16 v21, s29, v101
    v_dot2c_f32_bf16 v22, s28, v102
    v_dot2c_f32_bf16 v23, s29, v102
    v_dot2c_f32_bf16 v24, s28, v103
    v_dot2c_f32_bf16 v25, s29, v103
    v_mad_u32_u16 v66, v43, s30, v8 op_sel:[1,0,0,0]
    buffer_load_dwordx4 v[96:99], v66, s[20:23], 0 offen sc1
    v_mad_u32_u16 v67, v63, s30, v8 op_sel:[1,0,0,0]
    buffer_load_dwordx4 v[100:103], v67, s[20:23], 0 offen sc1
    s_waitcnt vmcnt(7)
    v_dot2c_f32_bf16 v10, s28, v72
    v_dot2c_f32_bf16 v11, s29, v72
    v_dot2c_f32_bf16 v12, s28, v73
    v_dot2c_f32_bf16 v13, s29, v73
    v_dot2c_f32_bf16 v14, s28, v74
    v_dot2c_f32_bf16 v15, s29, v74
    v_dot2c_f32_bf16 v16, s28, v75
    v_dot2c_f32_bf16 v17, s29, v75
    s_waitcnt vmcnt(6)
    v_dot2c_f32_bf16 v18, s28, v76
    v_dot2c_f32_bf16 v19, s29, v76
    v_dot2c_f32_bf16 v20, s28, v77
    v_dot2c_f32_bf16 v21, s29, v77
    v_dot2c_f32_bf16 v22, s28, v78
    v_dot2c_f32_bf16 v23, s29, v78
    v_dot2c_f32_bf16 v24, s28, v79
    v_dot2c_f32_bf16 v25, s29, v79
    v_mad_u32_u16 v66, v44, s30, v8 op_sel:[0,0,0,0]
    buffer_load_dwordx4 v[72:75], v66, s[20:23], 0 offen sc1
    v_mad_u32_u16 v67, v64, s30, v8 op_sel:[0,0,0,0]
    buffer_load_dwordx4 v[76:79], v67, s[20:23], 0 offen sc1
    s_waitcnt vmcnt(7)
    v_dot2c_f32_bf16 v10, s28, v80
    v_dot2c_f32_bf16 v11, s29, v80
    v_dot2c_f32_bf16 v12, s28, v81
    v_dot2c_f32_bf16 v13, s29, v81
    v_dot2c_f32_bf16 v14, s28, v82
    v_dot2c_f32_bf16 v15, s29, v82
    v_dot2c_f32_bf16 v16, s28, v83
    v_dot2c_f32_bf16 v17, s29, v83
    s_waitcnt vmcnt(6)
    v_dot2c_f32_bf16 v18, s28, v84
    v_dot2c_f32_bf16 v19, s29, v84
    v_dot2c_f32_bf16 v20, s28, v85
    v_dot2c_f32_bf16 v21, s29, v85
    v_dot2c_f32_bf16 v22, s28, v86
    v_dot2c_f32_bf16 v23, s29, v86
    v_dot2c_f32_bf16 v24, s28, v87
    v_dot2c_f32_bf16 v25, s29, v87
    v_mad_u32_u16 v66, v44, s30, v8 op_sel:[1,0,0,0]
    buffer_load_dwordx4 v[80:83], v66, s[20:23], 0 offen sc1
    v_mad_u32_u16 v67, v64, s30, v8 op_sel:[1,0,0,0]
    buffer_load_dwordx4 v[84:87], v67, s[20:23], 0 offen sc1
    s_waitcnt vmcnt(7)
    v_dot2c_f32_bf16 v10, s28, v88
    v_dot2c_f32_bf16 v11, s29, v88
    v_dot2c_f32_bf16 v12, s28, v89
    v_dot2c_f32_bf16 v13, s29, v89
    v_dot2c_f32_bf16 v14, s28, v90
    v_dot2c_f32_bf16 v15, s29, v90
    v_dot2c_f32_bf16 v16, s28, v91
    v_dot2c_f32_bf16 v17, s29, v91
    s_waitcnt vmcnt(6)
    v_dot2c_f32_bf16 v18, s28, v92
    v_dot2c_f32_bf16 v19, s29, v92
    v_dot2c_f32_bf16 v20, s28, v93
    v_dot2c_f32_bf16 v21, s29, v93
    v_dot2c_f32_bf16 v22, s28, v94
    v_dot2c_f32_bf16 v23, s29, v94
    v_dot2c_f32_bf16 v24, s28, v95
    v_dot2c_f32_bf16 v25, s29, v95
    v_mad_u32_u16 v66, v45, s30, v8 op_sel:[0,0,0,0]
    buffer_load_dwordx4 v[88:91], v66, s[20:23], 0 offen sc1
    v_mad_u32_u16 v67, v65, s30, v8 op_sel:[0,0,0,0]
    buffer_load_dwordx4 v[92:95], v67, s[20:23], 0 offen sc1
    s_waitcnt vmcnt(7)
    v_dot2c_f32_bf16 v10, s28, v96
    v_dot2c_f32_bf16 v11, s29, v96
    v_dot2c_f32_bf16 v12, s28, v97
    v_dot2c_f32_bf16 v13, s29, v97
    v_dot2c_f32_bf16 v14, s28, v98
    v_dot2c_f32_bf16 v15, s29, v98
    v_dot2c_f32_bf16 v16, s28, v99
    v_dot2c_f32_bf16 v17, s29, v99
    s_waitcnt vmcnt(6)
    v_dot2c_f32_bf16 v18, s28, v100
    v_dot2c_f32_bf16 v19, s29, v100
    v_dot2c_f32_bf16 v20, s28, v101
    v_dot2c_f32_bf16 v21, s29, v101
    v_dot2c_f32_bf16 v22, s28, v102
    v_dot2c_f32_bf16 v23, s29, v102
    v_dot2c_f32_bf16 v24, s28, v103
    v_dot2c_f32_bf16 v25, s29, v103
    v_mad_u32_u16 v66, v45, s30, v8 op_sel:[1,0,0,0]
    buffer_load_dwordx4 v[96:99], v66, s[20:23], 0 offen sc1
    v_mad_u32_u16 v67, v65, s30, v8 op_sel:[1,0,0,0]
    buffer_load_dwordx4 v[100:103], v67, s[20:23], 0 offen sc1
    s_waitcnt vmcnt(7)
    v_dot2c_f32_bf16 v10, s28, v72
    v_dot2c_f32_bf16 v11, s29, v72
    v_dot2c_f32_bf16 v12, s28, v73
    v_dot2c_f32_bf16 v13, s29, v73
    v_dot2c_f32_bf16 v14, s28, v74
    v_dot2c_f32_bf16 v15, s29, v74
    v_dot2c_f32_bf16 v16, s28, v75
    v_dot2c_f32_bf16 v17, s29, v75
    s_waitcnt vmcnt(6)
    v_dot2c_f32_bf16 v18, s28, v76
    v_dot2c_f32_bf16 v19, s29, v76
    v_dot2c_f32_bf16 v20, s28, v77
    v_dot2c_f32_bf16 v21, s29, v77
    v_dot2c_f32_bf16 v22, s28, v78
    v_dot2c_f32_bf16 v23, s29, v78
    v_dot2c_f32_bf16 v24, s28, v79
    v_dot2c_f32_bf16 v25, s29, v79
    s_waitcnt vmcnt(5)
    v_dot2c_f32_bf16 v10, s28, v80
    v_dot2c_f32_bf16 v11, s29, v80
    v_dot2c_f32_bf16 v12, s28, v81
    v_dot2c_f32_bf16 v13, s29, v81
    v_dot2c_f32_bf16 v14, s28, v82
    v_dot2c_f32_bf16 v15, s29, v82
    v_dot2c_f32_bf16 v16, s28, v83
    v_dot2c_f32_bf16 v17, s29, v83
    s_waitcnt vmcnt(4)
    v_dot2c_f32_bf16 v18, s28, v84
    v_dot2c_f32_bf16 v19, s29, v84
    v_dot2c_f32_bf16 v20, s28, v85
    v_dot2c_f32_bf16 v21, s29, v85
    v_dot2c_f32_bf16 v22, s28, v86
    v_dot2c_f32_bf16 v23, s29, v86
    v_dot2c_f32_bf16 v24, s28, v87
    v_dot2c_f32_bf16 v25, s29, v87
    s_waitcnt vmcnt(3)
    v_dot2c_f32_bf16 v10, s28, v88
    v_dot2c_f32_bf16 v11, s29, v88
    v_dot2c_f32_bf16 v12, s28, v89
    v_dot2c_f32_bf16 v13, s29, v89
    v_dot2c_f32_bf16 v14, s28, v90
    v_dot2c_f32_bf16 v15, s29, v90
    v_dot2c_f32_bf16 v16, s28, v91
    v_dot2c_f32_bf16 v17, s29, v91
    s_waitcnt vmcnt(2)
    v_dot2c_f32_bf16 v18, s28, v92
    v_dot2c_f32_bf16 v19, s29, v92
    v_dot2c_f32_bf16 v20, s28, v93
    v_dot2c_f32_bf16 v21, s29, v93
    v_dot2c_f32_bf16 v22, s28, v94
    v_dot2c_f32_bf16 v23, s29, v94
    v_dot2c_f32_bf16 v24, s28, v95
    v_dot2c_f32_bf16 v25, s29, v95
    s_waitcnt vmcnt(1)
    v_dot2c_f32_bf16 v10, s28, v96
    v_dot2c_f32_bf16 v11, s29, v96
    v_dot2c_f32_bf16 v12, s28, v97
    v_dot2c_f32_bf16 v13, s29, v97
    v_dot2c_f32_bf16 v14, s28, v98
    v_dot2c_f32_bf16 v15, s29, v98
    v_dot2c_f32_bf16 v16, s28, v99
    v_dot2c_f32_bf16 v17, s29, v99
    s_waitcnt vmcnt(0)
    v_dot2c_f32_bf16 v18, s28, v100
    v_dot2c_f32_bf16 v19, s29, v100
    v_dot2c_f32_bf16 v20, s28, v101
    v_dot2c_f32_bf16 v21, s29, v101
    v_dot2c_f32_bf16 v22, s28, v102
    v_dot2c_f32_bf16 v23, s29, v102
    v_dot2c_f32_bf16 v24, s28, v103
    v_dot2c_f32_bf16 v25, s29, v103
hop_fin:
    s_setprio 0
    s_cmp_eq_u32 s41, 0
    s_cbranch_scc1 hop_noovf
    s_mov_b32 s52, 0
og_52:
    s_lshl_b32 s53, s56, 4
    s_add_u32 s53, s53, s52
    s_add_u32 s53, s53, 0
    s_lshl_b32 s53, s53, 2
    v_mov_b32 v2, s53
    ds_read_b32 v3, v2 offset:8576
    ds_read_b32 v4, v2 offset:7744
    s_waitcnt lgkmcnt(0)
    v_readfirstlane_b32 s54, v3
    v_lshlrev_b32 v4, 2, v4
    s_nop 2
    s_cmp_le_u32 s54, 40
    s_cbranch_scc1 on_53
    ds_read_b32 v4, v4 offset:10240
    s_sub_u32 s54, s54, 40
    v_mov_b32 v72, 0
    v_mov_b32 v73, 0
    v_mov_b32 v74, 0
    v_mov_b32 v75, 0
    v_mov_b32 v76, 0
    v_mov_b32 v77, 0
    v_mov_b32 v78, 0
    v_mov_b32 v79, 0
    v_lshrrev_b32 v5, 3, v0
    s_waitcnt lgkmcnt(0)
ol_54:
    v_add_u32 v6, v4, v5
    v_lshlrev_b32 v6, 1, v6
    buffer_load_ushort v7, v6, s[48:51], 0 offen sc1
    v_cmp_gt_u32 vcc, s54, v5
    v_mov_b32 v6, 0xffff
    s_waitcnt vmcnt(0)
    v_cndmask_b32_e64 v7, v6, v7, vcc
    v_mad_u32_u24 v7, v7, s30, v8
    buffer_load_dwordx4 v[80:83], v7, s[20:23], 0 offen sc1
    v_add_u32 v5, 8, v5
    s_waitcnt vmcnt(0)
    v_dot2c_f32_bf16 v72, s28, v80
    v_dot2c_f32_bf16 v73, s29, v80
    v_dot2c_f32_bf16 v74, s28, v81
    v_dot2c_f32_bf16 v75, s29, v81
    v_dot2c_f32_bf16 v76, s28, v82
    v_dot2c_f32_bf16 v77, s29, v82
    v_dot2c_f32_bf16 v78, s28, v83
    v_dot2c_f32_bf16 v79, s29, v83
    v_min_u32 v6, v5, v5
    v_readfirstlane_b32 s55, v5
    s_nop 3
    s_cmp_lt_u32 s55, s54
    s_cbranch_scc1 ol_54
    s_nop 1
    v_add_f32_dpp v72, v72, v72 row_ror:8 row_mask:0xf bank_mask:0xf
    s_nop 1
    v_add_f32_dpp v73, v73, v73 row_ror:8 row_mask:0xf bank_mask:0xf
    s_nop 1
    v_add_f32_dpp v74, v74, v74 row_ror:8 row_mask:0xf bank_mask:0xf
    s_nop 1
    v_add_f32_dpp v75, v75, v75 row_ror:8 row_mask:0xf bank_mask:0xf
    s_nop 1
    v_add_f32_dpp v76, v76, v76 row_ror:8 row_mask:0xf bank_mask:0xf
    s_nop 1
    v_add_f32_dpp v77, v77, v77 row_ror:8 row_mask:0xf bank_mask:0xf
    s_nop 1
    v_add_f32_dpp v78, v78, v78 row_ror:8 row_mask:0xf bank_mask:0xf
    s_nop 1
    v_add_f32_dpp v79, v79, v79 row_ror:8 row_mask:0xf bank_mask:0xf
    ds_swizzle_b32 v80, v72 offset:0x401f
    ds_swizzle_b32 v81, v73 offset:0x401f
    ds_swizzle_b32 v82, v74 offset:0x401f
    ds_swizzle_b32 v83, v75 offset:0x401f
    ds_swizzle_b32 v84, v76 offset:0x401f
    ds_swizzle_b32 v85, v77 offset:0x401f
    ds_swizzle_b32 v86, v78 offset:0x401f
    ds_swizzle_b32 v87, v79 offset:0x401f
    s_waitcnt lgkmcnt(0)
    v_add_f32 v72, v72, v80
    v_mov_b32 v80, v72
    v_add_f32 v73, v73, v81
    v_mov_b32 v81, v73
    v_add_f32 v74, v74, v82
    v_mov_b32 v82, v74
    v_add_f32 v75, v75, v83
    v_mov_b32 v83, v75
    v_add_f32 v76, v76, v84
    v_mov_b32 v84, v76
    v_add_f32 v77, v77, v85
    v_mov_b32 v85, v77
    v_add_f32 v78, v78, v86
    v_mov_b32 v86, v78
    v_add_f32 v79, v79, v87
    v_mov_b32 v87, v79
    s_nop 1
    v_permlane32_swap_b32 v72, v80
    v_permlane32_swap_b32 v73, v81
    v_permlane32_swap_b32 v74, v82
    v_permlane32_swap_b32 v75, v83
    v_permlane32_swap_b32 v76, v84
    v_permlane32_swap_b32 v77, v85
    v_permlane32_swap_b32 v78, v86
    v_permlane32_swap_b32 v79, v87
    s_mov_b32 s58, 0xff
    s_mov_b32 s59, 0
    s_lshl_b32 s55, s52, 3
    s_lshl_b64 s[58:59], s[58:59], s55
    v_add_f32 v72, v72, v80
    v_add_f32 v73, v73, v81
    v_add_f32 v74, v74, v82
    v_add_f32 v75, v75, v83
    v_add_f32 v76, v76, v84
    v_add_f32 v77, v77, v85
    v_add_f32 v78, v78, v86
    v_add_f32 v79, v79, v87
    s_mov_b64 exec, s[58:59]
    v_add_f32 v10, v10, v72
    v_add_f32 v11, v11, v73
    v_add_f32 v12, v12, v74
    v_add_f32 v13, v13, v75
    v_add_f32 v14, v14, v76
    v_add_f32 v15, v15, v77
    v_add_f32 v16, v16, v78
    v_add_f32 v17, v17, v79
    s_mov_b64 exec, -1
on_53:
    s_add_u32 s52, s52, 1
    s_cmp_lt_u32 s52, 8
    s_cbranch_scc1 og_52
    s_mov_b32 s52, 0
og_56:
    s_lshl_b32 s53, s56, 4
    s_add_u32 s53, s53, s52
    s_add_u32 s53, s53, 8
    s_lshl_b32 s53, s53, 2
    v_mov_b32 v2, s53
    ds_read_b32 v3, v2 offset:8576
    ds_read_b32 v4, v2 offset:7744
    s_waitcnt lgkmcnt(0)
    v_readfirstlane_b32 s54, v3
    v_lshlrev_b32 v4, 2, v4
    s_nop 2
    s_cmp_le_u32 s54, 40
    s_cbranch_scc1 on_57
    ds_read_b32 v4, v4 offset:10240
    s_sub_u32 s54, s54, 40
    v_mov_b32 v72, 0
    v_mov_b32 v73, 0
    v_mov_b32 v74, 0
    v_mov_b32 v75, 0
    v_mov_b32 v76, 0
    v_mov_b32 v77, 0
    v_mov_b32 v78, 0
    v_mov_b32 v79, 0
    v_lshrrev_b32 v5, 3, v0
    s_waitcnt lgkmcnt(0)
ol_58:
    v_add_u32 v6, v4, v5
    v_lshlrev_b32 v6, 1, v6
    buffer_load_ushort v7, v6, s[48:51], 0 offen sc1
    v_cmp_gt_u32 vcc, s54, v5
    v_mov_b32 v6, 0xffff
    s_waitcnt vmcnt(0)
    v_cndmask_b32_e64 v7, v6, v7, vcc
    v_mad_u32_u24 v7, v7, s30, v8
    buffer_load_dwordx4 v[80:83], v7, s[20:23], 0 offen sc1
    v_add_u32 v5, 8, v5
    s_waitcnt vmcnt(0)
    v_dot2c_f32_bf16 v72, s28, v80
    v_dot2c_f32_bf16 v73, s29, v80
    v_dot2c_f32_bf16 v74, s28, v81
    v_dot2c_f32_bf16 v75, s29, v81
    v_dot2c_f32_bf16 v76, s28, v82
    v_dot2c_f32_bf16 v77, s29, v82
    v_dot2c_f32_bf16 v78, s28, v83
    v_dot2c_f32_bf16 v79, s29, v83
    v_min_u32 v6, v5, v5
    v_readfirstlane_b32 s55, v5
    s_nop 3
    s_cmp_lt_u32 s55, s54
    s_cbranch_scc1 ol_58
    s_nop 1
    v_add_f32_dpp v72, v72, v72 row_ror:8 row_mask:0xf bank_mask:0xf
    s_nop 1
    v_add_f32_dpp v73, v73, v73 row_ror:8 row_mask:0xf bank_mask:0xf
    s_nop 1
    v_add_f32_dpp v74, v74, v74 row_ror:8 row_mask:0xf bank_mask:0xf
    s_nop 1
    v_add_f32_dpp v75, v75, v75 row_ror:8 row_mask:0xf bank_mask:0xf
    s_nop 1
    v_add_f32_dpp v76, v76, v76 row_ror:8 row_mask:0xf bank_mask:0xf
    s_nop 1
    v_add_f32_dpp v77, v77, v77 row_ror:8 row_mask:0xf bank_mask:0xf
    s_nop 1
    v_add_f32_dpp v78, v78, v78 row_ror:8 row_mask:0xf bank_mask:0xf
    s_nop 1
    v_add_f32_dpp v79, v79, v79 row_ror:8 row_mask:0xf bank_mask:0xf
    ds_swizzle_b32 v80, v72 offset:0x401f
    ds_swizzle_b32 v81, v73 offset:0x401f
    ds_swizzle_b32 v82, v74 offset:0x401f
    ds_swizzle_b32 v83, v75 offset:0x401f
    ds_swizzle_b32 v84, v76 offset:0x401f
    ds_swizzle_b32 v85, v77 offset:0x401f
    ds_swizzle_b32 v86, v78 offset:0x401f
    ds_swizzle_b32 v87, v79 offset:0x401f
    s_waitcnt lgkmcnt(0)
    v_add_f32 v72, v72, v80
    v_mov_b32 v80, v72
    v_add_f32 v73, v73, v81
    v_mov_b32 v81, v73
    v_add_f32 v74, v74, v82
    v_mov_b32 v82, v74
    v_add_f32 v75, v75, v83
    v_mov_b32 v83, v75
    v_add_f32 v76, v76, v84
    v_mov_b32 v84, v76
    v_add_f32 v77, v77, v85
    v_mov_b32 v85, v77
    v_add_f32 v78, v78, v86
    v_mov_b32 v86, v78
    v_add_f32 v79, v79, v87
    v_mov_b32 v87, v79
    s_nop 1
    v_permlane32_swap_b32 v72, v80
    v_permlane32_swap_b32 v73, v81
    v_permlane32_swap_b32 v74, v82
    v_permlane32_swap_b32 v75, v83
    v_permlane32_swap_b32 v76, v84
    v_permlane32_swap_b32 v77, v85
    v_permlane32_swap_b32 v78, v86
    v_permlane32_swap_b32 v79, v87
    s_mov_b32 s58, 0xff
    s_mov_b32 s59, 0
    s_lshl_b32 s55, s52, 3
    s_lshl_b64 s[58:59], s[58:59], s55
    v_add_f32 v72, v72, v80
    v_add_f32 v73, v73, v81
    v_add_f32 v74, v74, v82
    v_add_f32 v75, v75, v83
    v_add_f32 v76, v76, v84
    v_add_f32 v77, v77, v85
    v_add_f32 v78, v78, v86
    v_add_f32 v79, v79, v87
    s_mov_b64 exec, s[58:59]
    v_add_f32 v18, v18, v72
    v_add_f32 v19, v19, v73
    v_add_f32 v20, v20, v74
    v_add_f32 v21, v21, v75
    v_add_f32 v22, v22, v76
    v_add_f32 v23, v23, v77
    v_add_f32 v24, v24, v78
    v_add_f32 v25, v25, v79
    s_mov_b64 exec, -1
on_57:
    s_add_u32 s52, s52, 1
    s_cmp_lt_u32 s52, 8
    s_cbranch_scc1 og_56
hop_noovf:
    v_mul_f32 v10, v70, v10
    v_mul_f32 v11, v70, v11
    v_mul_f32 v12, v70, v12
    v_mul_f32 v13, v70, v13
    v_mul_f32 v14, v70, v14
    v_mul_f32 v15, v70, v15
    v_mul_f32 v16, v70, v16
    v_mul_f32 v17, v70, v17
    v_cvt_pk_bf16_f32 v72, v10, v11
    v_cvt_pk_bf16_f32 v73, v12, v13
    v_cvt_pk_bf16_f32 v74, v14, v15
    v_cvt_pk_bf16_f32 v75, v16, v17
    buffer_store_dwordx4 v[72:75], v68, s[24:27], 0 offen sc0 sc1
    v_mul_f32 v18, v71, v18
    v_mul_f32 v19, v71, v19
    v_mul_f32 v20, v71, v20
    v_mul_f32 v21, v71, v21
    v_mul_f32 v22, v71, v22
    v_mul_f32 v23, v71, v23
    v_mul_f32 v24, v71, v24
    v_mul_f32 v25, v71, v25
    v_cvt_pk_bf16_f32 v76, v18, v19
    v_cvt_pk_bf16_f32 v77, v20, v21
    v_cvt_pk_bf16_f32 v78, v22, v23
    v_cvt_pk_bf16_f32 v79, v24, v25
    buffer_store_dwordx4 v[76:79], v69, s[24:27], 0 offen sc0 sc1
    s_add_u32 s36, s36, 1
    s_add_u32 s20, s20, 6400000
    s_addc_u32 s21, s21, 0
    s_add_u32 s24, s24, 6400000
    s_addc_u32 s25, s25, 0
    s_cmp_ge_u32 s36, 7
    s_cbranch_scc1 hop_last
    s_waitcnt vmcnt(0)
    s_barrier
    s_cmp_lg_u32 s6, 0
    s_cbranch_scc1 hop_barother
    s_lshl_b32 s9, s8, 7
    v_mov_b32 v2, s9
    v_mov_b32 v3, s36
    s_mov_b64 exec, 1
    buffer_store_dword v3, v2, s[32:35], 0 offen sc0 sc1
    s_mov_b64 exec, -1
    v_lshlrev_b32 v2, 7, v0
    v_add_u32 v3, 64, v0
    v_min_u32 v3, 124, v3
    v_lshlrev_b32 v3, 7, v3
    v_mov_b32 v4, v2
    v_mov_b32 v9, v3
    v_mov_b32 v6, v5
    v_add_f32 v80, v10, v11
    v_mul_f32 v81, v10, v10
    v_fmac_f32 v81, v11, v11
    v_add_f32 v80, v80, v12
    v_fmac_f32 v81, v12, v12
    v_add_f32 v80, v80, v13
    v_fmac_f32 v81, v13, v13
    v_add_f32 v80, v80, v14
    v_fmac_f32 v81, v14, v14
    v_add_f32 v80, v80, v15
    v_fmac_f32 v81, v15, v15
    v_add_f32 v80, v80, v16
    v_fmac_f32 v81, v16, v16
    v_add_f32 v80, v80, v17
    v_fmac_f32 v81, v17, v17
    v_add_f32 v82, v18, v19
    v_mul_f32 v83, v18, v18
    v_fmac_f32 v83, v19, v19
    v_add_f32 v82, v82, v20
    v_fmac_f32 v83, v20, v20
    v_add_f32 v82, v82, v21
    v_fmac_f32 v83, v21, v21
    v_add_f32 v82, v82, v22
    v_fmac_f32 v83, v22, v22
    v_add_f32 v82, v82, v23
    v_fmac_f32 v83, v23, v23
    v_add_f32 v82, v82, v24
    v_fmac_f32 v83, v24, v24
    v_add_f32 v82, v82, v25
    v_fmac_f32 v83, v25, v25
    v_add_f32_dpp v80, v80, v80 quad_perm:[1,0,3,2] row_mask:0xf bank_mask:0xf
    v_add_f32_dpp v81, v81, v81 quad_perm:[1,0,3,2] row_mask:0xf bank_mask:0xf
    v_add_f32_dpp v82, v82, v82 quad_perm:[1,0,3,2] row_mask:0xf bank_mask:0xf
    v_add_f32_dpp v83, v83, v83 quad_perm:[1,0,3,2] row_mask:0xf bank_mask:0xf
    v_add_f32_dpp v80, v80, v80 quad_perm:[2,3,0,1] row_mask:0xf bank_mask:0xf
    v_add_f32_dpp v81, v81, v81 quad_perm:[2,3,0,1] row_mask:0xf bank_mask:0xf
    v_add_f32_dpp v82, v82, v82 quad_perm:[2,3,0,1] row_mask:0xf bank_mask:0xf
    v_add_f32_dpp v83, v83, v83 quad_perm:[2,3,0,1] row_mask:0xf bank_mask:0xf
    v_add_f32_dpp v80, v80, v80 row_half_mirror row_mask:0xf bank_mask:0xf
    v_add_f32_dpp v81, v81, v81 row_half_mirror row_mask:0xf bank_mask:0xf
    v_add_f32_dpp v82, v82, v82 row_half_mirror row_mask:0xf bank_mask:0xf
    v_add_f32_dpp v83, v83, v83 row_half_mirror row_mask:0xf bank_mask:0xf
    v_lshrrev_b32 v2, 3, v68
    v_lshrrev_b32 v3, 3, v69
    s_mov_b32 exec_lo, 0x01010101
    s_mov_b32 exec_hi, 0x01010101
    buffer_store_dwordx2 v[80:81], v2, s[76:79], 0 offen
    buffer_store_dwordx2 v[82:83], v3, s[76:79], 0 offen
    s_mov_b64 exec, -1
    s_add_u32 s76, s76, 400000
    s_addc_u32 s77, s77, 0
    v_mov_b32 v2, v4
    v_mov_b32 v3, v9
    v_mov_b32 v5, v6
    s_mov_b32 s37, 0
hop_poll:
    buffer_load_dword v4, v2, s[32:35], 0 offen sc0 sc1
    buffer_load_dword v5, v3, s[32:35], 0 offen sc0 sc1
    s_add_u32 s37, s37, 1
    s_cmp_ge_u32 s37, 1000000
    s_cbranch_scc1 hop_pollok
    s_waitcnt vmcnt(0)
    v_min_u32 v4, v4, v5
    v_cmp_le_u32 s[38:39], s36, v4
    s_nop 3
    s_cmp_eq_u64 s[38:39], -1
    s_cbranch_scc1 hop_pollok
    s_sleep 1
    s_branch hop_poll
hop_pollok:
    s_waitcnt vmcnt(0)
hop_barw:
    s_barrier
    s_branch hop_loop
hop_barother:
    v_add_f32 v80, v10, v11
    v_mul_f32 v81, v10, v10
    v_fmac_f32 v81, v11, v11
    v_add_f32 v80, v80, v12
    v_fmac_f32 v81, v12, v12
    v_add_f32 v80, v80, v13
    v_fmac_f32 v81, v13, v13
    v_add_f32 v80, v80, v14
    v_fmac_f32 v81, v14, v14
    v_add_f32 v80, v80, v15
    v_fmac_f32 v81, v15, v15
    v_add_f32 v80, v80, v16
    v_fmac_f32 v81, v16, v16
    v_add_f32 v80, v80, v17
    v_fmac_f32 v81, v17, v17
    v_add_f32 v82, v18, v19
    v_mul_f32 v83, v18, v18
    v_fmac_f32 v83, v19, v19
    v_add_f32 v82, v82, v20
    v_fmac_f32 v83, v20, v20
    v_add_f32 v82, v82, v21
    v_fmac_f32 v83, v21, v21
    v_add_f32 v82, v82, v22
    v_fmac_f32 v83, v22, v22
    v_add_f32 v82, v82, v23
    v_fmac_f32 v83, v23, v23
    v_add_f32 v82, v82, v24
    v_fmac_f32 v83, v24, v24
    v_add_f32 v82, v82, v25
    v_fmac_f32 v83, v25, v25
    v_add_f32_dpp v80, v80, v80 quad_perm:[1,0,3,2] row_mask:0xf bank_mask:0xf
    v_add_f32_dpp v81, v81, v81 quad_perm:[1,0,3,2] row_mask:0xf bank_mask:0xf
    v_add_f32_dpp v82, v82, v82 quad_perm:[1,0,3,2] row_mask:0xf bank_mask:0xf
    v_add_f32_dpp v83, v83, v83 quad_perm:[1,0,3,2] row_mask:0xf bank_mask:0xf
    v_add_f32_dpp v80, v80, v80 quad_perm:[2,3,0,1] row_mask:0xf bank_mask:0xf
    v_add_f32_dpp v81, v81, v81 quad_perm:[2,3,0,1] row_mask:0xf bank_mask:0xf
    v_add_f32_dpp v82, v82, v82 quad_perm:[2,3,0,1] row_mask:0xf bank_mask:0xf
    v_add_f32_dpp v83, v83, v83 quad_perm:[2,3,0,1] row_mask:0xf bank_mask:0xf
    v_add_f32_dpp v80, v80, v80 row_half_mirror row_mask:0xf bank_mask:0xf
    v_add_f32_dpp v81, v81, v81 row_half_mirror row_mask:0xf bank_mask:0xf
    v_add_f32_dpp v82, v82, v82 row_half_mirror row_mask:0xf bank_mask:0xf
    v_add_f32_dpp v83, v83, v83 row_half_mirror row_mask:0xf bank_mask:0xf
    v_lshrrev_b32 v2, 3, v68
    v_lshrrev_b32 v3, 3, v69
    s_mov_b32 exec_lo, 0x01010101
    s_mov_b32 exec_hi, 0x01010101
    buffer_store_dwordx2 v[80:81], v2, s[76:79], 0 offen
    buffer_store_dwordx2 v[82:83], v3, s[76:79], 0 offen
    s_mov_b64 exec, -1
    s_add_u32 s76, s76, 400000
    s_addc_u32 s77, s77, 0
    s_branch hop_barw
hop_last:
    v_add_f32 v80, v10, v11
    v_mul_f32 v81, v10, v10
    v_fmac_f32 v81, v11, v11
    v_add_f32 v80, v80, v12
    v_fmac_f32 v81, v12, v12
    v_add_f32 v80, v80, v13
    v_fmac_f32 v81, v13, v13
    v_add_f32 v80, v80, v14
    v_fmac_f32 v81, v14, v14
    v_add_f32 v80, v80, v15
    v_fmac_f32 v81, v15, v15
    v_add_f32 v80, v80, v16
    v_fmac_f32 v81, v16, v16
    v_add_f32 v80, v80, v17
    v_fmac_f32 v81, v17, v17
    v_add_f32 v82, v18, v19
    v_mul_f32 v83, v18, v18
    v_fmac_f32 v83, v19, v19
    v_add_f32 v82, v82, v20
    v_fmac_f32 v83, v20, v20
    v_add_f32 v82, v82, v21
    v_fmac_f32 v83, v21, v21
    v_add_f32 v82, v82, v22
    v_fmac_f32 v83, v22, v22
    v_add_f32 v82, v82, v23
    v_fmac_f32 v83, v23, v23
    v_add_f32 v82, v82, v24
    v_fmac_f32 v83, v24, v24
    v_add_f32 v82, v82, v25
    v_fmac_f32 v83, v25, v25
    v_add_f32_dpp v80, v80, v80 quad_perm:[1,0,3,2] row_mask:0xf bank_mask:0xf
    v_add_f32_dpp v81, v81, v81 quad_perm:[1,0,3,2] row_mask:0xf bank_mask:0xf
    v_add_f32_dpp v82, v82, v82 quad_perm:[1,0,3,2] row_mask:0xf bank_mask:0xf
    v_add_f32_dpp v83, v83, v83 quad_perm:[1,0,3,2] row_mask:0xf bank_mask:0xf
    v_add_f32_dpp v80, v80, v80 quad_perm:[2,3,0,1] row_mask:0xf bank_mask:0xf
    v_add_f32_dpp v81, v81, v81 quad_perm:[2,3,0,1] row_mask:0xf bank_mask:0xf
    v_add_f32_dpp v82, v82, v82 quad_perm:[2,3,0,1] row_mask:0xf bank_mask:0xf
    v_add_f32_dpp v83, v83, v83 quad_perm:[2,3,0,1] row_mask:0xf bank_mask:0xf
    v_add_f32_dpp v80, v80, v80 row_half_mirror row_mask:0xf bank_mask:0xf
    v_add_f32_dpp v81, v81, v81 row_half_mirror row_mask:0xf bank_mask:0xf
    v_add_f32_dpp v82, v82, v82 row_half_mirror row_mask:0xf bank_mask:0xf
    v_add_f32_dpp v83, v83, v83 row_half_mirror row_mask:0xf bank_mask:0xf
    v_lshrrev_b32 v2, 3, v68
    v_lshrrev_b32 v3, 3, v69
    s_mov_b32 exec_lo, 0x01010101
    s_mov_b32 exec_hi, 0x01010101
    buffer_store_dwordx2 v[80:81], v2, s[76:79], 0 offen
    buffer_store_dwordx2 v[82:83], v3, s[76:79], 0 offen
    s_mov_b64 exec, -1
    s_add_u32 s76, s76, 400000
    s_addc_u32 s77, s77, 0
    s_endpgm
hops_done:
    s_endpgm
hops_wprep:
    s_load_dwordx4 s[8:11], s[0:1], 32
    s_load_dwordx4 s[12:15], s[0:1], 48
    s_load_dwordx2 s[28:29], s[0:1], 64
    v_lshrrev_b32 v1, 6, v0
    s_nop 0
    v_readfirstlane_b32 s6, v1
    v_and_b32 v30, 63, v0
    v_and_b32 v31, 31, v30
    v_lshrrev_b32 v32, 5, v30
    s_waitcnt lgkmcnt(0)
    s_cmp_eq_u32 s2, 250
    s_cselect_b32 s16, s8, s12
    s_cselect_b32 s17, s9, s13
    s_mov_b32 s18, 32768
    s_mov_b32 s19, 0x20000
    s_cselect_b32 s20, s10, s14
    s_cselect_b32 s21, s11, s15
    s_mov_b32 s22, 32768
    s_mov_b32 s23, 0x20000
    s_cbranch_scc1 wprep_nostage
    v_add_u32 v1, 0, v0
    v_lshlrev_b32 v2, 4, v1
    buffer_load_dwordx4 v[4:7], v2, s[20:23], 0 offen
    s_waitcnt vmcnt(0)
    v_add_u32 v2, 68096, v2
    ds_write_b128 v2, v[4:7]
    v_add_u32 v1, 832, v0
    v_lshlrev_b32 v2, 4, v1
    buffer_load_dwordx4 v[4:7], v2, s[20:23], 0 offen
    s_waitcnt vmcnt(0)
    v_add_u32 v2, 68096, v2
    ds_write_b128 v2, v[4:7]
    v_add_u32 v1, 1664, v0
    v_lshlrev_b32 v2, 4, v1
    v_cmp_gt_u32 vcc, 2048, v1
    s_and_saveexec_b64 s[24:25], vcc
    s_cbranch_execz st_60
    buffer_load_dwordx4 v[4:7], v2, s[20:23], 0 offen
    s_waitcnt vmcnt(0)
    v_add_u32 v2, 68096, v2
    ds_write_b128 v2, v[4:7]
st_60:
    s_mov_b64 exec, s[24:25]
    s_waitcnt lgkmcnt(0)
wprep_nostage:
    s_barrier
    s_cmp_ge_u32 s6, 8
    s_cbranch_scc1 wprep_mm_done
    s_lshr_b32 s24, s6, 1
    s_and_b32 s25, s6, 1
    s_lshl_b32 s25, s25, 1
    s_lshl_b32 s26, s24, 13
    v_lshlrev_b32 v1, 8, v31
    v_lshl_add_u32 v1, v32, 4, v1
    buffer_load_dwordx4 v[40:43], v1, s[16:19], s26 offen offset:0
    buffer_load_dwordx4 v[44:47], v1, s[16:19], s26 offen offset:32
    buffer_load_dwordx4 v[48:51], v1, s[16:19], s26 offen offset:64
    buffer_load_dwordx4 v[52:55], v1, s[16:19], s26 offen offset:96
    buffer_load_dwordx4 v[56:59], v1, s[16:19], s26 offen offset:128
    buffer_load_dwordx4 v[60:63], v1, s[16:19], s26 offen offset:160
    buffer_load_dwordx4 v[64:67], v1, s[16:19], s26 offen offset:192
    buffer_load_dwordx4 v[68:71], v1, s[16:19], s26 offen offset:224
    s_cmp_eq_u32 s2, 250
    s_cbranch_scc0 bw_61
    s_add_u32 s27, s25, 0
    s_lshl_b32 s27, s27, 13
    buffer_load_dwordx4 v[72:75], v1, s[20:23], s27 offen offset:0
    buffer_load_dwordx4 v[76:79], v1, s[20:23], s27 offen offset:32
    buffer_load_dwordx4 v[80:83], v1, s[20:23], s27 offen offset:64
    buffer_load_dwordx4 v[84:87], v1, s[20:23], s27 offen offset:96
    buffer_load_dwordx4 v[88:91], v1, s[20:23], s27 offen offset:128
    buffer_load_dwordx4 v[92:95], v1, s[20:23], s27 offen offset:160
    buffer_load_dwordx4 v[96:99], v1, s[20:23], s27 offen offset:192
    buffer_load_dwordx4 v[100:103], v1, s[20:23], s27 offen offset:224
    s_waitcnt vmcnt(0)
    s_branch be_62
bw_61:
    v_and_b32 v2, 15, v30
    v_lshrrev_b32 v3, 2, v2
    v_and_b32 v2, 3, v2
    v_lshl_add_u32 v3, v32, 3, v3
    v_lshlrev_b32 v3, 8, v3
    v_lshl_add_u32 v3, v2, 3, v3
    v_bfe_u32 v2, v30, 4, 1
    v_lshl_add_u32 v3, v2, 5, v3
    s_add_u32 s27, s25, 0
    s_lshl_b32 s27, s27, 6
    s_add_u32 s27, s27, 68096
    v_add_u32 v3, s27, v3
    ds_read_b64_tr_b16 v[72:73], v3 offset:0
    ds_read_b64_tr_b16 v[74:75], v3 offset:1024
    ds_read_b64_tr_b16 v[76:77], v3 offset:4096
    ds_read_b64_tr_b16 v[78:79], v3 offset:5120
    ds_read_b64_tr_b16 v[80:81], v3 offset:8192
    ds_read_b64_tr_b16 v[82:83], v3 offset:9216
    ds_read_b64_tr_b16 v[84:85], v3 offset:12288
    ds_read_b64_tr_b16 v[86:87], v3 offset:13312
    ds_read_b64_tr_b16 v[88:89], v3 offset:16384
    ds_read_b64_tr_b16 v[90:91], v3 offset:17408
    ds_read_b64_tr_b16 v[92:93], v3 offset:20480
    ds_read_b64_tr_b16 v[94:95], v3 offset:21504
    ds_read_b64_tr_b16 v[96:97], v3 offset:24576
    ds_read_b64_tr_b16 v[98:99], v3 offset:25600
    ds_read_b64_tr_b16 v[100:101], v3 offset:28672
    ds_read_b64_tr_b16 v[102:103], v3 offset:29696
    s_waitcnt vmcnt(0) lgkmcnt(0)
be_62:
    v_mfma_f32_32x32x16_bf16 v[104:119], v[40:43], v[72:75], 0
    v_mfma_f32_32x32x16_bf16 v[104:119], v[44:47], v[76:79], v[104:119]
    v_mfma_f32_32x32x16_bf16 v[104:119], v[48:51], v[80:83], v[104:119]
    v_mfma_f32_32x32x16_bf16 v[104:119], v[52:55], v[84:87], v[104:119]
    v_mfma_f32_32x32x16_bf16 v[104:119], v[56:59], v[88:91], v[104:119]
    v_mfma_f32_32x32x16_bf16 v[104:119], v[60:63], v[92:95], v[104:119]
    v_mfma_f32_32x32x16_bf16 v[104:119], v[64:67], v[96:99], v[104:119]
    v_mfma_f32_32x32x16_bf16 v[104:119], v[68:71], v[100:103], v[104:119]
    s_nop 15
    s_nop 7
    s_lshl_b32 s27, s24, 5
    v_lshlrev_b32 v2, 2, v32
    v_add_u32 v2, s27, v2
    v_mul_u32_u24 v2, 129, v2
    s_add_u32 s27, s25, 0
    s_lshl_b32 s27, s27, 5
    v_add3_u32 v2, v2, s27, v31
    v_lshlrev_b32 v2, 2, v2
    ds_write_b32 v2, v104 offset:2048
    ds_write_b32 v2, v105 offset:2564
    ds_write_b32 v2, v106 offset:3080
    ds_write_b32 v2, v107 offset:3596
    ds_write_b32 v2, v108 offset:6176
    ds_write_b32 v2, v109 offset:6692
    ds_write_b32 v2, v110 offset:7208
    ds_write_b32 v2, v111 offset:7724
    ds_write_b32 v2, v112 offset:10304
    ds_write_b32 v2, v113 offset:10820
    ds_write_b32 v2, v114 offset:11336
    ds_write_b32 v2, v115 offset:11852
    ds_write_b32 v2, v116 offset:14432
    ds_write_b32 v2, v117 offset:14948
    ds_write_b32 v2, v118 offset:15464
    ds_write_b32 v2, v119 offset:15980
    s_cmp_eq_u32 s2, 250
    s_cbranch_scc0 bw_63
    s_add_u32 s27, s25, 1
    s_lshl_b32 s27, s27, 13
    buffer_load_dwordx4 v[72:75], v1, s[20:23], s27 offen offset:0
    buffer_load_dwordx4 v[76:79], v1, s[20:23], s27 offen offset:32
    buffer_load_dwordx4 v[80:83], v1, s[20:23], s27 offen offset:64
    buffer_load_dwordx4 v[84:87], v1, s[20:23], s27 offen offset:96
    buffer_load_dwordx4 v[88:91], v1, s[20:23], s27 offen offset:128
    buffer_load_dwordx4 v[92:95], v1, s[20:23], s27 offen offset:160
    buffer_load_dwordx4 v[96:99], v1, s[20:23], s27 offen offset:192
    buffer_load_dwordx4 v[100:103], v1, s[20:23], s27 offen offset:224
    s_waitcnt vmcnt(0)
    s_branch be_64
bw_63:
    v_and_b32 v2, 15, v30
    v_lshrrev_b32 v3, 2, v2
    v_and_b32 v2, 3, v2
    v_lshl_add_u32 v3, v32, 3, v3
    v_lshlrev_b32 v3, 8, v3
    v_lshl_add_u32 v3, v2, 3, v3
    v_bfe_u32 v2, v30, 4, 1
    v_lshl_add_u32 v3, v2, 5, v3
    s_add_u32 s27, s25, 1
    s_lshl_b32 s27, s27, 6
    s_add_u32 s27, s27, 68096
    v_add_u32 v3, s27, v3
    ds_read_b64_tr_b16 v[72:73], v3 offset:0
    ds_read_b64_tr_b16 v[74:75], v3 offset:1024
    ds_read_b64_tr_b16 v[76:77], v3 offset:4096
    ds_read_b64_tr_b16 v[78:79], v3 offset:5120
    ds_read_b64_tr_b16 v[80:81], v3 offset:8192
    ds_read_b64_tr_b16 v[82:83], v3 offset:9216
    ds_read_b64_tr_b16 v[84:85], v3 offset:12288
    ds_read_b64_tr_b16 v[86:87], v3 offset:13312
    ds_read_b64_tr_b16 v[88:89], v3 offset:16384
    ds_read_b64_tr_b16 v[90:91], v3 offset:17408
    ds_read_b64_tr_b16 v[92:93], v3 offset:20480
    ds_read_b64_tr_b16 v[94:95], v3 offset:21504
    ds_read_b64_tr_b16 v[96:97], v3 offset:24576
    ds_read_b64_tr_b16 v[98:99], v3 offset:25600
    ds_read_b64_tr_b16 v[100:101], v3 offset:28672
    ds_read_b64_tr_b16 v[102:103], v3 offset:29696
    s_waitcnt vmcnt(0) lgkmcnt(0)
be_64:
    v_mfma_f32_32x32x16_bf16 v[104:119], v[40:43], v[72:75], 0
    v_mfma_f32_32x32x16_bf16 v[104:119], v[44:47], v[76:79], v[104:119]
    v_mfma_f32_32x32x16_bf16 v[104:119], v[48:51], v[80:83], v[104:119]
    v_mfma_f32_32x32x16_bf16 v[104:119], v[52:55], v[84:87], v[104:119]
    v_mfma_f32_32x32x16_bf16 v[104:119], v[56:59], v[88:91], v[104:119]
    v_mfma_f32_32x32x16_bf16 v[104:119], v[60:63], v[92:95], v[104:119]
    v_mfma_f32_32x32x16_bf16 v[104:119], v[64:67], v[96:99], v[104:119]
    v_mfma_f32_32x32x16_bf16 v[104:119], v[68:71], v[100:103], v[104:119]
    s_nop 15
    s_nop 7
    s_lshl_b32 s27, s24, 5
    v_lshlrev_b32 v2, 2, v32
    v_add_u32 v2, s27, v2
    v_mul_u32_u24 v2, 129, v2
    s_add_u32 s27, s25, 1
    s_lshl_b32 s27, s27, 5
    v_add3_u32 v2, v2, s27, v31
    v_lshlrev_b32 v2, 2, v2
    ds_write_b32 v2, v104 offset:2048
    ds_write_b32 v2, v105 offset:2564
    ds_write_b32 v2, v106 offset:3080
    ds_write_b32 v2, v107 offset:3596
    ds_write_b32 v2, v108 offset:6176
    ds_write_b32 v2, v109 offset:6692
    ds_write_b32 v2, v110 offset:7208
    ds_write_b32 v2, v111 offset:7724
    ds_write_b32 v2, v112 offset:10304
    ds_write_b32 v2, v113 offset:10820
    ds_write_b32 v2, v114 offset:11336
    ds_write_b32 v2, v115 offset:11852
    ds_write_b32 v2, v116 offset:14432
    ds_write_b32 v2, v117 offset:14948
    ds_write_b32 v2, v118 offset:15464
    ds_write_b32 v2, v119 offset:15980
wprep_mm_done:
    s_waitcnt lgkmcnt(0)
    s_barrier
    v_cmp_gt_u32 vcc, 256, v0
    s_and_saveexec_b64 s[24:25], vcc
    s_cbranch_execz mn_65
    v_and_b32 v2, 127, v0
    v_cmp_gt_u32 vcc, 128, v0
    v_mul_u32_u24 v3, 129, v2
    s_nop 1
    v_cndmask_b32_e64 v3, v3, v2, vcc
    v_mov_b32 v4, 129
    v_cndmask_b32_e64 v4, 1, v4, vcc
    v_lshlrev_b32 v3, 2, v3
    v_lshlrev_b32 v4, 2, v4
    v_mov_b32 v5, 0
    s_mov_b32 s26, 0
ml_66:
    ds_read_b32 v8, v3 offset:2048
    v_add_u32 v3, v3, v4
    ds_read_b32 v9, v3 offset:2048
    v_add_u32 v3, v3, v4
    ds_read_b32 v10, v3 offset:2048
    v_add_u32 v3, v3, v4
    ds_read_b32 v11, v3 offset:2048
    v_add_u32 v3, v3, v4
    ds_read_b32 v12, v3 offset:2048
    v_add_u32 v3, v3, v4
    ds_read_b32 v13, v3 offset:2048
    v_add_u32 v3, v3, v4
    ds_read_b32 v14, v3 offset:2048
    v_add_u32 v3, v3, v4
    ds_read_b32 v15, v3 offset:2048
    v_add_u32 v3, v3, v4
    s_waitcnt lgkmcnt(0)
    v_add_f32 v5, v5, v8
    v_add_f32 v5, v5, v9
    v_add_f32 v5, v5, v10
    v_add_f32 v5, v5, v11
    v_add_f32 v5, v5, v12
    v_add_f32 v5, v5, v13
    v_add_f32 v5, v5, v14
    v_add_f32 v5, v5, v15
    s_add_u32 s26, s26, 1
    s_cmp_lt_u32 s26, 16
    s_cbranch_scc1 ml_66
    v_mul_f32 v5, 0x3c000000, v5
    v_lshlrev_b32 v2, 2, v0
    ds_write_b32 v2, v5 offset:0
mn_65:
    s_mov_b64 exec, s[24:25]
    s_waitcnt lgkmcnt(0)
    s_barrier
    v_lshlrev_b32 v2, 3, v30
    ds_read_b64 v[4:5], v2 offset:0
    s_waitcnt lgkmcnt(0)
    v_add_f32 v4, v4, v5
    s_cmp_eq_u32 s6, 0
    s_cbranch_scc0 tm_67
    s_nop 1
    v_add_f32_dpp v4, v4, v4 row_shr:1 row_mask:0xf bank_mask:0xf
    s_nop 1
    v_add_f32_dpp v4, v4, v4 row_shr:2 row_mask:0xf bank_mask:0xf
    s_nop 1
    v_add_f32_dpp v4, v4, v4 row_shr:4 row_mask:0xf bank_mask:0xf
    s_nop 1
    v_add_f32_dpp v4, v4, v4 row_shr:8 row_mask:0xf bank_mask:0xf
    s_nop 1
    v_add_f32_dpp v4, v4, v4 row_bcast:15 row_mask:0xa bank_mask:0xf
    s_nop 1
    v_add_f32_dpp v4, v4, v4 row_bcast:31 row_mask:0xc bank_mask:0xf
    s_nop 1
    v_readlane_b32 s26, v4, 63
    s_nop 3
    v_mov_b32 v4, s26
    v_mul_f32 v4, 0x3c000000, v4
    v_mov_b32 v2, 0
    ds_write_b32 v2, v4 offset:1024
tm_67:
    s_waitcnt lgkmcnt(0)
    s_barrier
    s_cmp_eq_u32 s2, 250
    s_cselect_b32 s26, 0, 32768
    s_cselect_b32 s30, 0x3e0293ee, 1.0
    s_cselect_b32 s31, 1.0, 0
    s_add_u32 s26, s26, 52960768
    s_add_u32 s24, s4, s26
    s_addc_u32 s25, s5, 0
    s_mov_b32 s26, 32768
    s_mov_b32 s27, 0x20000
    v_mov_b32 v2, 0
    ds_read_b32 v33, v2 offset:1024
    v_add_u32 v1, 0, v0
    v_and_b32 v2, 31, v1
    v_and_b32 v3, 0x13, v2
    v_and_b32 v4, 4, v2
    v_lshl_or_b32 v3, v4, 1, v3
    v_and_b32 v4, 8, v2
    v_lshrrev_b32 v4, 1, v4
    v_or_b32 v3, v3, v4
    v_lshrrev_b32 v4, 9, v1
    v_lshl_add_u32 v3, v4, 5, v3
    v_bfe_u32 v4, v1, 6, 3
    v_bfe_u32 v5, v1, 5, 1
    v_lshlrev_b32 v4, 4, v4
    v_lshl_add_u32 v4, v5, 3, v4
    v_mul_u32_u24 v5, 129, v4
    v_add_lshl_u32 v5, v5, v3, 2
    ds_read_b32 v8, v5 offset:2048
    ds_read_b32 v9, v5 offset:2564
    ds_read_b32 v10, v5 offset:3080
    ds_read_b32 v11, v5 offset:3596
    ds_read_b32 v12, v5 offset:4112
    ds_read_b32 v13, v5 offset:4628
    ds_read_b32 v14, v5 offset:5144
    ds_read_b32 v15, v5 offset:5660
    v_lshlrev_b32 v6, 2, v3
    ds_read_b32 v16, v6 offset:0
    v_lshlrev_b32 v6, 2, v4
    ds_read_b128 v[20:23], v6 offset:512
    ds_read_b128 v[24:27], v6 offset:528
    s_waitcnt lgkmcnt(0)
    v_sub_f32 v20, v20, v33
    v_sub_f32 v8, v8, v16
    v_fma_f32 v8, -v20, s31, v8
    v_mul_f32 v8, s30, v8
    v_sub_f32 v21, v21, v33
    v_sub_f32 v9, v9, v16
    v_fma_f32 v9, -v21, s31, v9
    v_mul_f32 v9, s30, v9
    v_sub_f32 v22, v22, v33
    v_sub_f32 v10, v10, v16
    v_fma_f32 v10, -v22, s31, v10
    v_mul_f32 v10, s30, v10
    v_sub_f32 v23, v23, v33
    v_sub_f32 v11, v11, v16
    v_fma_f32 v11, -v23, s31, v11
    v_mul_f32 v11, s30, v11
    v_sub_f32 v24, v24, v33
    v_sub_f32 v12, v12, v16
    v_fma_f32 v12, -v24, s31, v12
    v_mul_f32 v12, s30, v12
    v_sub_f32 v25, v25, v33
    v_sub_f32 v13, v13, v16
    v_fma_f32 v13, -v25, s31, v13
    v_mul_f32 v13, s30, v13
    v_sub_f32 v26, v26, v33
    v_sub_f32 v14, v14, v16
    v_fma_f32 v14, -v26, s31, v14
    v_mul_f32 v14, s30, v14
    v_sub_f32 v27, v27, v33
    v_sub_f32 v15, v15, v16
    v_fma_f32 v15, -v27, s31, v15
    v_mul_f32 v15, s30, v15
    v_cvt_pk_bf16_f32 v8, v8, v9
    v_cvt_pk_bf16_f32 v9, v10, v11
    v_cvt_pk_bf16_f32 v10, v12, v13
    v_cvt_pk_bf16_f32 v11, v14, v15
    v_lshlrev_b32 v6, 4, v1
    buffer_store_dwordx4 v[8:11], v6, s[24:27], 0 offen
    v_add_u32 v1, 832, v0
    v_and_b32 v2, 31, v1
    v_and_b32 v3, 0x13, v2
    v_and_b32 v4, 4, v2
    v_lshl_or_b32 v3, v4, 1, v3
    v_and_b32 v4, 8, v2
    v_lshrrev_b32 v4, 1, v4
    v_or_b32 v3, v3, v4
    v_lshrrev_b32 v4, 9, v1
    v_lshl_add_u32 v3, v4, 5, v3
    v_bfe_u32 v4, v1, 6, 3
    v_bfe_u32 v5, v1, 5, 1
    v_lshlrev_b32 v4, 4, v4
    v_lshl_add_u32 v4, v5, 3, v4
    v_mul_u32_u24 v5, 129, v4
    v_add_lshl_u32 v5, v5, v3, 2
    ds_read_b32 v8, v5 offset:2048
    ds_read_b32 v9, v5 offset:2564
    ds_read_b32 v10, v5 offset:3080
    ds_read_b32 v11, v5 offset:3596
    ds_read_b32 v12, v5 offset:4112
    ds_read_b32 v13, v5 offset:4628
    ds_read_b32 v14, v5 offset:5144
    ds_read_b32 v15, v5 offset:5660
    v_lshlrev_b32 v6, 2, v3
    ds_read_b32 v16, v6 offset:0
    v_lshlrev_b32 v6, 2, v4
    ds_read_b128 v[20:23], v6 offset:512
    ds_read_b128 v[24:27], v6 offset:528
    s_waitcnt lgkmcnt(0)
    v_sub_f32 v20, v20, v33
    v_sub_f32 v8, v8, v16
    v_fma_f32 v8, -v20, s31, v8
    v_mul_f32 v8, s30, v8
    v_sub_f32 v21, v21, v33
    v_sub_f32 v9, v9, v16
    v_fma_f32 v9, -v21, s31, v9
    v_mul_f32 v9, s30, v9
    v_sub_f32 v22, v22, v33
    v_sub_f32 v10, v10, v16
    v_fma_f32 v10, -v22, s31, v10
    v_mul_f32 v10, s30, v10
    v_sub_f32 v23, v23, v33
    v_sub_f32 v11, v11, v16
    v_fma_f32 v11, -v23, s31, v11
    v_mul_f32 v11, s30, v11
    v_sub_f32 v24, v24, v33
    v_sub_f32 v12, v12, v16
    v_fma_f32 v12, -v24, s31, v12
    v_mul_f32 v12, s30, v12
    v_sub_f32 v25, v25, v33
    v_sub_f32 v13, v13, v16
    v_fma_f32 v13, -v25, s31, v13
    v_mul_f32 v13, s30, v13
    v_sub_f32 v26, v26, v33
    v_sub_f32 v14, v14, v16
    v_fma_f32 v14, -v26, s31, v14
    v_mul_f32 v14, s30, v14
    v_sub_f32 v27, v27, v33
    v_sub_f32 v15, v15, v16
    v_fma_f32 v15, -v27, s31, v15
    v_mul_f32 v15, s30, v15
    v_cvt_pk_bf16_f32 v8, v8, v9
    v_cvt_pk_bf16_f32 v9, v10, v11
    v_cvt_pk_bf16_f32 v10, v12, v13
    v_cvt_pk_bf16_f32 v11, v14, v15
    v_lshlrev_b32 v6, 4, v1
    buffer_store_dwordx4 v[8:11], v6, s[24:27], 0 offen
    v_add_u32 v1, 1664, v0
    v_cmp_gt_u32 vcc, 2048, v1
    s_and_saveexec_b64 s[34:35], vcc
    s_cbranch_execz em_68
    v_and_b32 v2, 31, v1
    v_and_b32 v3, 0x13, v2
    v_and_b32 v4, 4, v2
    v_lshl_or_b32 v3, v4, 1, v3
    v_and_b32 v4, 8, v2
    v_lshrrev_b32 v4, 1, v4
    v_or_b32 v3, v3, v4
    v_lshrrev_b32 v4, 9, v1
    v_lshl_add_u32 v3, v4, 5, v3
    v_bfe_u32 v4, v1, 6, 3
    v_bfe_u32 v5, v1, 5, 1
    v_lshlrev_b32 v4, 4, v4
    v_lshl_add_u32 v4, v5, 3, v4
    v_mul_u32_u24 v5, 129, v4
    v_add_lshl_u32 v5, v5, v3, 2
    ds_read_b32 v8, v5 offset:2048
    ds_read_b32 v9, v5 offset:2564
    ds_read_b32 v10, v5 offset:3080
    ds_read_b32 v11, v5 offset:3596
    ds_read_b32 v12, v5 offset:4112
    ds_read_b32 v13, v5 offset:4628
    ds_read_b32 v14, v5 offset:5144
    ds_read_b32 v15, v5 offset:5660
    v_lshlrev_b32 v6, 2, v3
    ds_read_b32 v16, v6 offset:0
    v_lshlrev_b32 v6, 2, v4
    ds_read_b128 v[20:23], v6 offset:512
    ds_read_b128 v[24:27], v6 offset:528
    s_waitcnt lgkmcnt(0)
    v_sub_f32 v20, v20, v33
    v_sub_f32 v8, v8, v16
    v_fma_f32 v8, -v20, s31, v8
    v_mul_f32 v8, s30, v8
    v_sub_f32 v21, v21, v33
    v_sub_f32 v9, v9, v16
    v_fma_f32 v9, -v21, s31, v9
    v_mul_f32 v9, s30, v9
    v_sub_f32 v22, v22, v33
    v_sub_f32 v10, v10, v16
    v_fma_f32 v10, -v22, s31, v10
    v_mul_f32 v10, s30, v10
    v_sub_f32 v23, v23, v33
    v_sub_f32 v11, v11, v16
    v_fma_f32 v11, -v23, s31, v11
    v_mul_f32 v11, s30, v11
    v_sub_f32 v24, v24, v33
    v_sub_f32 v12, v12, v16
    v_fma_f32 v12, -v24, s31, v12
    v_mul_f32 v12, s30, v12
    v_sub_f32 v25, v25, v33
    v_sub_f32 v13, v13, v16
    v_fma_f32 v13, -v25, s31, v13
    v_mul_f32 v13, s30, v13
    v_sub_f32 v26, v26, v33
    v_sub_f32 v14, v14, v16
    v_fma_f32 v14, -v26, s31, v14
    v_mul_f32 v14, s30, v14
    v_sub_f32 v27, v27, v33
    v_sub_f32 v15, v15, v16
    v_fma_f32 v15, -v27, s31, v15
    v_mul_f32 v15, s30, v15
    v_cvt_pk_bf16_f32 v8, v8, v9
    v_cvt_pk_bf16_f32 v9, v10, v11
    v_cvt_pk_bf16_f32 v10, v12, v13
    v_cvt_pk_bf16_f32 v11, v14, v15
    v_lshlrev_b32 v6, 4, v1
    buffer_store_dwordx4 v[8:11], v6, s[24:27], 0 offen
em_68:
    s_mov_b64 exec, s[34:35]
    s_cmp_eq_u32 s2, 251
    s_cbranch_scc0 wprep_done
    s_cmp_ge_u32 s6, 1
    s_cbranch_scc1 wprep_done
    s_mov_b32 s12, s28
    s_mov_b32 s13, s29
    s_mov_b32 s14, 256
    s_mov_b32 s15, 0x20000
    v_lshlrev_b32 v2, 1, v30
    buffer_load_ushort v4, v2, s[12:15], 0 offen
    buffer_load_ushort v5, v2, s[12:15], 0 offen offset:128
    s_waitcnt vmcnt(0)
    v_lshlrev_b32 v4, 16, v4
    v_lshlrev_b32 v5, 16, v5
    v_add_f32 v6, v4, v5
    s_nop 1
    v_add_f32_dpp v6, v6, v6 row_shr:1 row_mask:0xf bank_mask:0xf
    s_nop 1
    v_add_f32_dpp v6, v6, v6 row_shr:2 row_mask:0xf bank_mask:0xf
    s_nop 1
    v_add_f32_dpp v6, v6, v6 row_shr:4 row_mask:0xf bank_mask:0xf
    s_nop 1
    v_add_f32_dpp v6, v6, v6 row_shr:8 row_mask:0xf bank_mask:0xf
    s_nop 1
    v_add_f32_dpp v6, v6, v6 row_bcast:15 row_mask:0xa bank_mask:0xf
    s_nop 1
    v_add_f32_dpp v6, v6, v6 row_bcast:31 row_mask:0xc bank_mask:0xf
    s_nop 1
    v_readlane_b32 s26, v6, 63
    s_nop 3
    v_mov_b32 v6, s26
    v_mul_f32 v6, 0x3c000000, v6
    v_sub_f32 v4, v4, v6
    v_sub_f32 v5, v5, v6
    s_add_u32 s16, s4, 53026304
    s_addc_u32 s17, s5, 0
    s_mov_b32 s18, 512
    s_mov_b32 s19, 0x20000
    v_add_u32 v7, 0, v30
    v_bfe_u32 v8, v7, 3, 1
    v_lshlrev_b32 v8, 6, v8
    v_lshrrev_b32 v9, 5, v7
    v_lshl_add_u32 v8, v9, 4, v8
    v_bfe_u32 v9, v7, 4, 1
    v_lshl_add_u32 v8, v9, 3, v8
    v_and_b32 v9, 7, v7
    v_add_lshl_u32 v8, v8, v9, 2
    buffer_store_dword v4, v8, s[16:19], 0 offen
    v_add_u32 v7, 64, v30
    v_bfe_u32 v8, v7, 3, 1
    v_lshlrev_b32 v8, 6, v8
    v_lshrrev_b32 v9, 5, v7
    v_lshl_add_u32 v8, v9, 4, v8
    v_bfe_u32 v9, v7, 4, 1
    v_lshl_add_u32 v8, v9, 3, v8
    v_and_b32 v9, 7, v7
    v_add_lshl_u32 v8, v8, v9, 2
    buffer_store_dword v5, v8, s[16:19], 0 offen
wprep_done:
    s_endpgm
.globl tf_kernel
.p2align 8
.type tf_kernel,@function
tf_kernel:
    s_cmp_ge_u32 s2, 256
    s_cbranch_scc1 tf_done
    s_load_dwordx2 s[4:5], s[0:1], 88
    s_load_dwordx2 s[8:9], s[0:1], 0
    s_load_dwordx2 s[10:11], s[0:1], 24
    s_load_dwordx2 s[44:45], s[0:1], 72
    v_lshrrev_b32 v1, 6, v0
    s_nop 0
    v_readfirstlane_b32 s6, v1
    v_and_b32 v0, 63, v0
    v_lshlrev_b32 v2, 4, v0
    s_waitcnt lgkmcnt(0)
    s_mov_b32 s12, s4
    s_mov_b32 s13, s5
    s_mov_b32 s14, 51200000
    s_mov_b32 s15, 0x20000
    s_mov_b32 s16, s8
    s_mov_b32 s17, s9
    s_mov_b32 s18, 6400000
    s_mov_b32 s19, 0x20000
    s_mov_b32 s20, s10
    s_mov_b32 s21, s11
    s_mov_b32 s22, 50000
    s_mov_b32 s23, 0x20000
    s_mov_b32 s24, s44
    s_mov_b32 s25, s45
    s_mov_b32 s26, 6400000
    s_mov_b32 s27, 0x20000
    s_add_u32 s28, s4, 52960768
    s_addc_u32 s29, s5, 0
    s_mov_b32 s30, 66048
    s_mov_b32 s31, 0x20000
    s_add_u32 s92, s4, 54626816
    s_addc_u32 s93, s5, 0
    s_mov_b32 s94, 3200000
    s_mov_b32 s95, 0x20000
    s_mul_i32 s3, s6, 16384
    s_add_u32 s32, s3, 0
    s_mov_b32 m0, s32
    s_nop 0
    buffer_load_dwordx4 v2, s[28:31], s32 offen lds
    s_add_u32 s32, s3, 1024
    s_mov_b32 m0, s32
    s_nop 0
    buffer_load_dwordx4 v2, s[28:31], s32 offen lds
    s_add_u32 s32, s3, 2048
    s_mov_b32 m0, s32
    s_nop 0
    buffer_load_dwordx4 v2, s[28:31], s32 offen lds
    s_add_u32 s32, s3, 3072
    s_mov_b32 m0, s32
    s_nop 0
    buffer_load_dwordx4 v2, s[28:31], s32 offen lds
    s_add_u32 s32, s3, 4096
    s_mov_b32 m0, s32
    s_nop 0
    buffer_load_dwordx4 v2, s[28:31], s32 offen lds
    s_add_u32 s32, s3, 5120
    s_mov_b32 m0, s32
    s_nop 0
    buffer_load_dwordx4 v2, s[28:31], s32 offen lds
    s_add_u32 s32, s3, 6144
    s_mov_b32 m0, s32
    s_nop 0
    buffer_load_dwordx4 v2, s[28:31], s32 offen lds
    s_add_u32 s32, s3, 7168
    s_mov_b32 m0, s32
    s_nop 0
    buffer_load_dwordx4 v2, s[28:31], s32 offen lds
    s_add_u32 s32, s3, 8192
    s_mov_b32 m0, s32
    s_nop 0
    buffer_load_dwordx4 v2, s[28:31], s32 offen lds
    s_add_u32 s32, s3, 9216
    s_mov_b32 m0, s32
    s_nop 0
    buffer_load_dwordx4 v2, s[28:31], s32 offen lds
    s_add_u32 s32, s3, 10240
    s_mov_b32 m0, s32
    s_nop 0
    buffer_load_dwordx4 v2, s[28:31], s32 offen lds
    s_add_u32 s32, s3, 11264
    s_mov_b32 m0, s32
    s_nop 0
    buffer_load_dwordx4 v2, s[28:31], s32 offen lds
    s_add_u32 s32, s3, 12288
    s_mov_b32 m0, s32
    s_nop 0
    buffer_load_dwordx4 v2, s[28:31], s32 offen lds
    s_add_u32 s32, s3, 13312
    s_mov_b32 m0, s32
    s_nop 0
    buffer_load_dwordx4 v2, s[28:31], s32 offen lds
    s_add_u32 s32, s3, 14336
    s_mov_b32 m0, s32
    s_nop 0
    buffer_load_dwordx4 v2, s[28:31], s32 offen lds
    s_add_u32 s32, s3, 15360
    s_mov_b32 m0, s32
    s_nop 0
    buffer_load_dwordx4 v2, s[28:31], s32 offen lds
    v_lshrrev_b32 v28, 5, v0
    v_and_b32 v29, 7, v0
    v_bfe_u32 v30, v0, 3, 2
    s_mul_i32 s34, s6, 8192
    s_add_u32 s34, s34, 66560
    v_and_b32 v31, 15, v0
    v_xor_b32 v31, v31, v28
    v_lshlrev_b32 v31, 4, v31
    v_lshl_add_u32 v31, v29, 10, v31
    v_lshl_add_u32 v31, v30, 8, v31
    v_add_u32 v3, s34, v31
    v_bfe_u32 v31, v0, 2, 2
    v_lshl_add_u32 v31, v28, 2, v31
    v_bfe_u32 v20, v0, 4, 1
    v_lshlrev_b32 v20, 1, v20
    v_and_b32 v21, 1, v0
    v_or_b32 v20, v20, v21
    v_xor_b32 v20, v20, v31
    v_lshlrev_b32 v20, 4, v20
    v_lshl_add_u32 v20, v31, 10, v20
    v_bfe_u32 v21, v0, 1, 1
    v_lshl_add_u32 v20, v21, 3, v20
    v_add_u32 v20, s34, v20
    v_xor_b32 v4, 0, v20
    v_xor_b32 v5, 64, v20
    v_xor_b32 v6, 128, v20
    v_xor_b32 v7, 192, v20
    v_lshrrev_b32 v31, 4, v0
    v_bfe_u32 v20, v0, 3, 1
    v_and_b32 v21, 1, v31
    v_xor_b32 v20, v20, v21
    v_and_b32 v21, 7, v0
    v_lshlrev_b32 v21, 4, v21
    s_mov_b32 s35, 3200000
    v_lshl_add_u32 v8, v31, 7, v21
    v_mad_u32_u24 v8, v20, s35, v8
    v_lshl_add_u32 v9, v31, 8, v21
    v_lshl_add_u32 v9, v20, 7, v9
    s_mul_i32 s35, s6, 256
    s_add_u32 s35, s35, 99328
    v_and_b32 v10, 31, v0
    v_lshlrev_b32 v12, 1, v10
    v_lshlrev_b32 v10, 2, v10
    v_add_u32 v10, s35, v10
    v_add_u32 v12, s35, v12
    v_lshlrev_b32 v11, 3, v30
    v_lshl_add_u32 v11, v28, 2, v11
    v_lshlrev_b32 v13, 1, v11
    v_add_u32 v13, s35, v13
    v_lshlrev_b32 v11, 2, v11
    v_add_u32 v11, s35, v11
    v_lshrrev_b32 v12, 2, v29
    v_lshlrev_b32 v12, 4, v12
    v_lshl_add_u32 v12, v30, 2, v12
    v_and_b32 v31, 3, v29
    v_add_u32 v12, v12, v31
    v_lshlrev_b32 v12, 1, v12
    v_add_u32 v12, s35, v12
    v_lshlrev_b32 v13, 5, v28
    v_add_u32 v13, s35, v13
    s_mov_b32 s35, 400000
    v_lshlrev_b32 v14, 4, v30
    v_mad_u32_u24 v14, v29, s35, v14
    v_lshlrev_b32 v15, 8, v28
    v_add_u32 v15, 65536, v15
    v_and_b32 v31, 31, v0
    v_and_b32 v16, 0x13, v31
    v_and_b32 v20, 4, v31
    v_lshl_or_b32 v16, v20, 1, v16
    v_and_b32 v20, 8, v31
    v_lshrrev_b32 v20, 1, v20
    v_or_b32 v16, v16, v20
    v_lshlrev_b32 v16, 1, v16
    v_lshl_add_u32 v16, v28, 9, v16
    v_lshlrev_b32 v17, 1, v30
    v_mov_b32 v18, 0x7fffffff
    s_mov_b32 s46, 0xff00
    s_mov_b32 s47, 0xff00
    s_mov_b32 s48, 0xff0000
    s_mov_b32 s49, 0xff0000
    s_mov_b32 s50, 0xff000000
    s_mov_b32 s51, 0xff000000
    s_mov_b32 s52, 0xff
    s_mov_b32 s53, 0xff
    s_mov_b32 s54, 0x1010101
    s_mov_b32 s55, 0x1010101
    s_mov_b32 s64, 0x1
    s_mov_b32 s65, 0x1
    s_mov_b32 s66, 0x100
    s_mov_b32 s67, 0x100
    s_mov_b32 s68, 0x100000
    s_mov_b32 s69, 0x100000
    s_mov_b32 s90, 0x10000000
    s_mov_b32 s91, 0x10000000
    s_mov_b32 s57, 0x3727c5ac
    s_mov_b32 s58, 0x3c000000
    s_mov_b32 s59, 0x3fb8aa3b
    s_mov_b32 s60, 0xffff0000
    s_mul_i32 s37, s2, 6250
    s_add_u32 s61, s37, 6250
    s_lshr_b32 s37, s37, 8
    s_lshr_b32 s61, s61, 8
    s_sub_u32 s61, s61, 1
    s_add_u32 s36, s37, s6
    s_add_u32 s56, s37, 23
    v_xor_b32 v64, 16, v8
    v_add_u32 v64, 6398976, v64
    v_xor_b32 v65, 32, v8
    v_add_u32 v65, 12797952, v65
    v_xor_b32 v66, 48, v8
    v_add_u32 v66, 19196928, v66
    v_xor_b32 v67, 64, v8
    v_add_u32 v67, 25600000, v67
    v_xor_b32 v68, 80, v8
    v_add_u32 v68, 31998976, v68
    v_xor_b32 v69, 96, v8
    v_add_u32 v69, 38397952, v69
    v_xor_b32 v70, 112, v8
    v_add_u32 v70, 44796928, v70
    v_xor_b32 v72, 0, v3
    v_xor_b32 v73, 32, v3
    v_xor_b32 v74, 64, v3
    v_xor_b32 v75, 96, v3
    v_xor_b32 v76, 128, v3
    v_xor_b32 v77, 160, v3
    v_xor_b32 v78, 192, v3
    v_xor_b32 v79, 224, v3
    s_add_u32 s98, s34, 4096
    s_cmp_eq_u32 s6, 0
    s_cbranch_scc0 wc_69
    s_mov_b32 s33, 65536
    buffer_load_dwordx4 v[32:35], v2, s[28:31], s33 offen
    s_waitcnt vmcnt(0)
    v_add_u32 v31, 65536, v2
    ds_write_b128 v31, v[32:35]
wc_69:
    s_lshl_b32 s39, s36, 9
    s_lshl_b32 s40, s36, 10
    s_lshl_b32 s43, s36, 3
    s_lshl_b32 s33, s36, 6
    buffer_load_dwordx4 v[244:247], v14, s[92:95], s33 offen
    buffer_load_ushort v19, v17, s[20:23], s43 offen
    s_mov_b32 m0, s34
    s_nop 0
    buffer_load_dwordx4 v9, s[16:19], s40 offen lds
    s_nop 0
    buffer_load_dwordx4 v64, s[12:15], s39 offen offset:1024 lds
    s_nop 0
    buffer_load_dwordx4 v65, s[12:15], s39 offen offset:2048 lds
    s_nop 0
    buffer_load_dwordx4 v66, s[12:15], s39 offen offset:3072 lds
    s_mov_b32 m0, s98
    s_nop 0
    buffer_load_dwordx4 v67, s[12:15], s39 offen lds
    s_nop 0
    buffer_load_dwordx4 v68, s[12:15], s39 offen offset:1024 lds
    s_nop 0
    buffer_load_dwordx4 v69, s[12:15], s39 offen offset:2048 lds
    s_nop 0
    buffer_load_dwordx4 v70, s[12:15], s39 offen offset:3072 lds
    s_waitcnt vmcnt(10) lgkmcnt(0)
    s_barrier
    ds_read_b128 a[0:3], v2 offset:0
    ds_read_b128 a[4:7], v2 offset:1024
    ds_read_b128 a[8:11], v2 offset:2048
    ds_read_b128 a[12:15], v2 offset:3072
    ds_read_b128 a[16:19], v2 offset:4096
    ds_read_b128 a[20:23], v2 offset:5120
    ds_read_b128 a[24:27], v2 offset:6144
    ds_read_b128 a[28:31], v2 offset:7168
    s_waitcnt lgkmcnt(4)
    ds_read_b128 a[32:35], v2 offset:8192
    ds_read_b128 a[36:39], v2 offset:9216
    ds_read_b128 a[40:43], v2 offset:10240
    ds_read_b128 a[44:47], v2 offset:11264
    ds_read_b128 a[48:51], v2 offset:12288
    ds_read_b128 a[52:55], v2 offset:13312
    ds_read_b128 a[56:59], v2 offset:14336
    ds_read_b128 a[60:63], v2 offset:15360
    s_waitcnt lgkmcnt(4)
    ds_read_b128 a[64:67], v2 offset:16384
    ds_read_b128 a[68:71], v2 offset:17408
    ds_read_b128 a[72:75], v2 offset:18432
    ds_read_b128 a[76:79], v2 offset:19456
    ds_read_b128 a[80:83], v2 offset:20480
    ds_read_b128 a[84:87], v2 offset:21504
    ds_read_b128 a[88:91], v2 offset:22528
    ds_read_b128 a[92:95], v2 offset:23552
    s_waitcnt lgkmcnt(4)
    ds_read_b128 a[96:99], v2 offset:24576
    ds_read_b128 a[100:103], v2 offset:25600
    ds_read_b128 a[104:107], v2 offset:26624
    ds_read_b128 a[108:111], v2 offset:27648
    ds_read_b128 a[112:115], v2 offset:28672
    ds_read_b128 a[116:119], v2 offset:29696
    ds_read_b128 a[120:123], v2 offset:30720
    ds_read_b128 a[124:127], v2 offset:31744
    s_waitcnt lgkmcnt(4)
    ds_read_b128 a[128:131], v2 offset:32768
    ds_read_b128 a[132:135], v2 offset:33792
    ds_read_b128 a[136:139], v2 offset:34816
    ds_read_b128 a[140:143], v2 offset:35840
    ds_read_b128 a[144:147], v2 offset:36864
    ds_read_b128 a[148:151], v2 offset:37888
    ds_read_b128 a[152:155], v2 offset:38912
    ds_read_b128 a[156:159], v2 offset:39936
    s_waitcnt lgkmcnt(4)
    ds_read_b128 a[160:163], v2 offset:40960
    ds_read_b128 a[164:167], v2 offset:41984
    ds_read_b128 a[168:171], v2 offset:43008
    ds_read_b128 a[172:175], v2 offset:44032
    ds_read_b128 a[176:179], v2 offset:45056
    ds_read_b128 a[180:183], v2 offset:46080
    ds_read_b128 a[184:187], v2 offset:47104
    ds_read_b128 a[188:191], v2 offset:48128
    s_waitcnt lgkmcnt(4)
    ds_read_b128 a[192:195], v2 offset:49152
    ds_read_b128 a[196:199], v2 offset:50176
    ds_read_b128 a[200:203], v2 offset:51200
    ds_read_b128 a[204:207], v2 offset:52224
    ds_read_b128 a[208:211], v2 offset:53248
    ds_read_b128 a[212:215], v2 offset:54272
    ds_read_b128 a[216:219], v2 offset:55296
    ds_read_b128 a[220:223], v2 offset:56320
    s_waitcnt lgkmcnt(4)
    ds_read_b128 a[224:227], v2 offset:57344
    ds_read_b128 a[228:231], v2 offset:58368
    ds_read_b128 a[232:235], v2 offset:59392
    ds_read_b128 a[236:239], v2 offset:60416
    ds_read_b128 a[240:243], v2 offset:61440
    ds_read_b128 a[244:247], v2 offset:62464
    ds_read_b128 a[248:251], v2 offset:63488
    ds_read_b128 a[252:255], v2 offset:64512
    s_waitcnt lgkmcnt(4)
    s_waitcnt lgkmcnt(0)
    s_mov_b32 s42, 0
tf_loop:
    s_waitcnt vmcnt(0)
    ds_read_b128 v[32:35], v72
    ds_read_b128 v[36:39], v73
    ds_read_b128 v[40:43], v74
    ds_read_b128 v[44:47], v75
    ds_read_b128 v[48:51], v76
    ds_read_b128 v[52:55], v77
    ds_read_b128 v[56:59], v78
    ds_read_b128 v[60:63], v79
    v_mov_b32 v0, v30
    v_lshlrev_b32 v22, 16, v19
    v_cndmask_b32_e64 v22, v22, 1.0, s[54:55]
    v_permlane32_swap_b32 v30, v0
    v_add_f32 v30, v30, v0
    v_mov_b32 v0, v31
    v_mul_f32 v30, s58, v30
    v_cmp_eq_f32_e64 s[62:63], 0, v22
    v_permlane32_swap_b32 v31, v0
    v_add_f32 v31, v31, v0
    v_mov_b32 v0, v29
    v_mul_f32 v31, s58, v31
    v_cndmask_b32_e64 v22, v22, 1.0, s[62:63]
    v_permlane32_swap_b32 v29, v0
    v_fma_f32 v31, -v30, v30, v31
    v_add_f32 v29, v29, v0
    v_max_f32 v31, 0, v31
    v_mov_b32 v0, s57
    v_fma_f32 v31, v31, v26, v0
    v_add_f32 v245, v245, v247
    v_rsq_f32 v31, v31
    s_nop 0
    v_mul_f32 v29, v29, v31
    v_add_f32 v244, v244, v246
    v_mul_f32 v29, v29, v25
    s_waitcnt lgkmcnt(7)
    v_mfma_f32_32x32x16_bf16 v[100:115], a[0:3], v[32:35], 0
    v_mul_f32 v29, s59, v29
    v_mov_b32 v0, v29
    v_mul_f32 v245, s58, v245
    v_rcp_f32 v23, v22
    v_max_f32_dpp v0, v0, v0 quad_perm:[1,0,3,2] row_mask:0xf bank_mask:0xf
    v_mul_f32 v244, s58, v244
    s_waitcnt lgkmcnt(6)
    v_mfma_f32_32x32x16_bf16 v[100:115], a[4:7], v[36:39], v[100:115]
    v_max_f32_dpp v0, v0, v0 quad_perm:[2,3,0,1] row_mask:0xf bank_mask:0xf
    v_fma_f32 v245, -v244, v244, v245
    v_mul_f32 v24, v23, v23
    v_max_f32_dpp v0, v0, v0 row_half_mirror row_mask:0xf bank_mask:0xf
    v_max_f32 v245, 0, v245
    v_mov_b32 v244, s57
    v_sub_f32 v29, v29, v0
    s_waitcnt lgkmcnt(5)
    v_mfma_f32_32x32x16_bf16 v[100:115], a[8:11], v[40:43], v[100:115]
    v_fma_f32 v245, v245, v24, v244
    v_exp_f32 v29, v29
    v_rsq_f32 v245, v245
    v_mov_b32 v0, v29
    v_mul_f32 v27, v245, v23
    v_mfma_f32_32x32x16_bf16 v[116:131], a[32:35], v[32:35], 0
    ds_write_b32 v10, v27
    v_add_f32_dpp v0, v0, v0 quad_perm:[1,0,3,2] row_mask:0xf bank_mask:0xf
    ds_read_b128 v[248:251], v11
    s_nop 0
    v_add_f32_dpp v0, v0, v0 quad_perm:[2,3,0,1] row_mask:0xf bank_mask:0xf
    v_lshl_add_u32 v30, v17, 2, v13
    s_nop 0
    v_add_f32_dpp v0, v0, v0 row_half_mirror row_mask:0xf bank_mask:0xf
    s_waitcnt lgkmcnt(6)
    v_mfma_f32_32x32x16_bf16 v[100:115], a[12:15], v[44:47], v[100:115]
    v_rcp_f32 v0, v0
    s_nop 0
    v_mul_f32 v29, v29, v0
    v_mov_b32 v31, 0
    v_mul_f32 v29, v29, v25
    v_mul_f32 v252, v252, v29
    v_mul_f32 v253, v253, v29
    v_mul_f32 v254, v254, v29
    v_mfma_f32_32x32x16_bf16 v[116:131], a[36:39], v[36:39], v[116:131]
    v_mul_f32 v255, v255, v29
    v_add_f32_dpp v252, v252, v252 quad_perm:[1,0,3,2] row_mask:0xf bank_mask:0xf
    v_add_f32_dpp v253, v253, v253 quad_perm:[1,0,3,2] row_mask:0xf bank_mask:0xf
    v_add_f32_dpp v254, v254, v254 quad_perm:[1,0,3,2] row_mask:0xf bank_mask:0xf
    v_add_f32_dpp v255, v255, v255 quad_perm:[1,0,3,2] row_mask:0xf bank_mask:0xf
    v_cvt_pk_bf16_f32 v0, v29, v29
    ds_write_b16 v12, v0 offset:192
    s_waitcnt lgkmcnt(6)
    v_mfma_f32_32x32x16_bf16 v[100:115], a[16:19], v[48:51], v[100:115]
    v_add_f32_dpp v252, v252, v252 quad_perm:[2,3,0,1] row_mask:0xf bank_mask:0xf
    v_add_f32_dpp v253, v253, v253 quad_perm:[2,3,0,1] row_mask:0xf bank_mask:0xf
    v_add_f32_dpp v254, v254, v254 quad_perm:[2,3,0,1] row_mask:0xf bank_mask:0xf
    v_add_f32_dpp v255, v255, v255 quad_perm:[2,3,0,1] row_mask:0xf bank_mask:0xf
    ds_read_b128 v[236:239], v13 offset:192
    ds_read_b128 v[240:243], v13 offset:208
    v_mfma_f32_32x32x16_bf16 v[116:131], a[40:43], v[40:43], v[116:131]
    v_add_f32_dpp v252, v252, v252 row_half_mirror row_mask:0xf bank_mask:0xf
    v_add_f32_dpp v253, v253, v253 row_half_mirror row_mask:0xf bank_mask:0xf
    v_add_f32_dpp v254, v254, v254 row_half_mirror row_mask:0xf bank_mask:0xf
    v_add_f32_dpp v255, v255, v255 row_half_mirror row_mask:0xf bank_mask:0xf
    v_cvt_pk_bf16_f32 v0, v252, v253
    v_cvt_pk_bf16_f32 v1, v254, v255
    s_waitcnt lgkmcnt(7)
    v_mfma_f32_32x32x16_bf16 v[100:115], a[20:23], v[52:55], v[100:115]
    ds_write_b64 v30, v[0:1] offset:128
    ds_read_b128 v[228:231], v13 offset:128
    ds_read_b128 v[232:235], v13 offset:144
    v_mov_b32 v29, 0
    v_mov_b32 v30, 0
    s_add_u32 s36, s36, 4
    s_min_u32 s38, s36, s61
    v_mfma_f32_32x32x16_bf16 v[116:131], a[44:47], v[44:47], v[116:131]
    s_lshl_b32 s39, s38, 9
    s_lshl_b32 s40, s38, 10
    s_lshl_b32 s43, s38, 3
    s_lshl_b32 s33, s38, 6
    s_mov_b32 m0, s34
    v_mov_b32 v25, v23
    v_mov_b32 v26, v24
    s_waitcnt lgkmcnt(9)
    v_mfma_f32_32x32x16_bf16 v[100:115], a[24:27], v[56:59], v[100:115]
    s_waitcnt lgkmcnt(4)
    v_dot2_f32_bf16 v84, v196, v236, 0
    v_dot2_f32_bf16 v85, v198, v238, 0
    s_waitcnt lgkmcnt(3)
    v_dot2_f32_bf16 v86, v200, v240, 0
    v_mfma_f32_32x32x16_bf16 v[116:131], a[48:51], v[48:51], v[116:131]
    v_dot2_f32_bf16 v87, v202, v242, 0
    v_dot2c_f32_bf16 v84, v197, v237
    v_dot2c_f32_bf16 v85, v199, v239
    v_dot2c_f32_bf16 v86, v201, v241
    v_dot2c_f32_bf16 v87, v203, v243
    v_dot2_f32_bf16 v88, v204, v236, 0
    v_mfma_f32_32x32x16_bf16 v[100:115], a[28:31], v[60:63], v[100:115]
    s_waitcnt lgkmcnt(1)
    v_dot2c_f32_bf16 v84, v156, v228
    v_dot2c_f32_bf16 v85, v158, v230
    s_waitcnt lgkmcnt(0)
    v_dot2c_f32_bf16 v86, v160, v232
    v_dot2c_f32_bf16 v87, v162, v234
    v_dot2_f32_bf16 v89, v206, v238, 0
    v_dot2_f32_bf16 v92, v212, v236, 0
    v_mfma_f32_32x32x16_bf16 v[116:131], a[52:55], v[52:55], v[116:131]
    v_dot2_f32_bf16 v93, v214, v238, 0
    v_dot2_f32_bf16 v96, v220, v236, 0
    v_dot2_f32_bf16 v97, v222, v238, 0
    v_dot2c_f32_bf16 v84, v157, v229
    v_dot2c_f32_bf16 v85, v159, v231
    v_dot2c_f32_bf16 v86, v161, v233
    v_mfma_f32_32x32x16_bf16 v[116:131], a[56:59], v[56:59], v[116:131]
    v_cvt_pk_bf16_f32 v148, v100, v101
    v_cvt_pk_bf16_f32 v149, v102, v103
    v_cvt_pk_bf16_f32 v150, v104, v105
    v_cvt_pk_bf16_f32 v151, v106, v107
    v_cvt_pk_bf16_f32 v152, v108, v109
    v_cvt_pk_bf16_f32 v153, v110, v111
    v_mfma_f32_32x32x16_bf16 v[116:131], a[60:63], v[60:63], v[116:131]
    v_cvt_pk_bf16_f32 v154, v112, v113
    v_cvt_pk_bf16_f32 v155, v114, v115
    v_dot2c_f32_bf16 v87, v163, v235
    v_dot2c_f32_bf16 v88, v205, v237
    v_dot2c_f32_bf16 v89, v207, v239
    v_dot2c_f32_bf16 v92, v213, v237
    v_mfma_f32_32x32x16_bf16 v[100:115], a[64:67], v[32:35], 0
    v_dot2c_f32_bf16 v93, v215, v239
    v_dot2c_f32_bf16 v96, v221, v237
    v_dot2c_f32_bf16 v97, v223, v239
    v_dot2c_f32_bf16 v88, v164, v228
    v_dot2c_f32_bf16 v89, v166, v230
    v_dot2_f32_bf16 v90, v208, v240, 0
    v_mfma_f32_32x32x16_bf16 v[132:147], v[32:35], v[148:151], 0
    v_cvt_pk_bf16_f32 v148, v116, v117
    v_cvt_pk_bf16_f32 v149, v118, v119
    v_cvt_pk_bf16_f32 v150, v120, v121
    v_cvt_pk_bf16_f32 v151, v122, v123
    v_dot2_f32_bf16 v91, v210, v242, 0
    v_dot2c_f32_bf16 v92, v172, v228
    v_mfma_f32_32x32x16_bf16 v[100:115], a[68:71], v[36:39], v[100:115]
    v_dot2c_f32_bf16 v93, v174, v230
    v_dot2_f32_bf16 v94, v216, v240, 0
    v_dot2_f32_bf16 v95, v218, v242, 0
    v_dot2c_f32_bf16 v96, v180, v228
    v_dot2c_f32_bf16 v97, v182, v230
    v_dot2_f32_bf16 v98, v224, v240, 0
    v_mfma_f32_32x32x16_bf16 v[132:147], v[36:39], v[152:155], v[132:147]
    v_cvt_pk_bf16_f32 v152, v124, v125
    v_cvt_pk_bf16_f32 v153, v126, v127
    v_cvt_pk_bf16_f32 v154, v128, v129
    v_cvt_pk_bf16_f32 v155, v130, v131
    v_dot2_f32_bf16 v99, v226, v242, 0
    v_dot2c_f32_bf16 v88, v165, v229
    v_mfma_f32_32x32x16_bf16 v[100:115], a[72:75], v[40:43], v[100:115]
    v_dot2c_f32_bf16 v89, v167, v231
    v_dot2c_f32_bf16 v92, v173, v229
    v_dot2c_f32_bf16 v93, v175, v231
    v_dot2c_f32_bf16 v96, v181, v229
    v_dot2c_f32_bf16 v97, v183, v231
    ds_read_b128 v[228:231], v15 offset:0
    v_mfma_f32_32x32x16_bf16 v[116:131], a[96:99], v[32:35], 0
    v_dot2c_f32_bf16 v90, v209, v241
    v_dot2c_f32_bf16 v91, v211, v243
    v_dot2c_f32_bf16 v94, v217, v241
    v_dot2c_f32_bf16 v95, v219, v243
    v_dot2c_f32_bf16 v98, v225, v241
    v_dot2c_f32_bf16 v99, v227, v243
    v_mfma_f32_32x32x16_bf16 v[100:115], a[76:79], v[44:47], v[100:115]
    v_dot2c_f32_bf16 v90, v168, v232
    v_dot2c_f32_bf16 v91, v170, v234
    v_dot2c_f32_bf16 v94, v176, v232
    v_dot2c_f32_bf16 v95, v178, v234
    v_dot2c_f32_bf16 v98, v184, v232
    v_dot2c_f32_bf16 v99, v186, v234
    v_mfma_f32_32x32x16_bf16 v[116:131], a[100:103], v[36:39], v[116:131]
    v_dot2c_f32_bf16 v90, v169, v233
    v_dot2c_f32_bf16 v91, v171, v235
    v_dot2c_f32_bf16 v94, v177, v233
    v_dot2c_f32_bf16 v95, v179, v235
    v_dot2c_f32_bf16 v98, v185, v233
    v_dot2c_f32_bf16 v99, v187, v235
    v_mfma_f32_32x32x16_bf16 v[100:115], a[80:83], v[48:51], v[100:115]
    ds_read_b128 v[232:235], v15 offset:16
    ds_read_b128 v[236:239], v15 offset:32
    v_permlane32_swap_b32 v84, v86
    v_permlane32_swap_b32 v85, v87
    v_mfma_f32_32x32x16_bf16 v[116:131], a[104:107], v[40:43], v[116:131]
    ds_read_b128 v[240:243], v15 offset:48
    v_add_f32 v84, v84, v86
    v_permlane32_swap_b32 v88, v90
    v_cvt_pk_bf16_f32 v84, v84, v84
    v_add_f32 v85, v85, v87
    v_permlane32_swap_b32 v89, v91
    v_mfma_f32_32x32x16_bf16 v[100:115], a[84:87], v[52:55], v[100:115]
    buffer_store_short v84, v18, s[24:27], s42 offen offset:0
    v_cvt_pk_bf16_f32 v85, v85, v85
    v_add_f32 v88, v88, v90
    v_permlane32_swap_b32 v92, v94
    buffer_store_short v85, v18, s[24:27], s42 offen offset:256
    v_cvt_pk_bf16_f32 v88, v88, v88
    v_mfma_f32_32x32x16_bf16 v[116:131], a[108:111], v[44:47], v[116:131]
    v_add_f32 v89, v89, v91
    v_permlane32_swap_b32 v93, v95
    buffer_store_short v88, v18, s[24:27], s42 offen offset:64
    v_cvt_pk_bf16_f32 v89, v89, v89
    v_add_f32 v92, v92, v94
    v_permlane32_swap_b32 v96, v98
    v_mfma_f32_32x32x16_bf16 v[100:115], a[88:91], v[56:59], v[100:115]
    buffer_store_short v89, v18, s[24:27], s42 offen offset:320
    v_cvt_pk_bf16_f32 v92, v92, v92
    v_add_f32 v93, v93, v95
    v_permlane32_swap_b32 v97, v99
    buffer_store_short v92, v18, s[24:27], s42 offen offset:128
    v_cvt_pk_bf16_f32 v93, v93, v93
    v_mfma_f32_32x32x16_bf16 v[116:131], a[112:115], v[48:51], v[116:131]
    v_add_f32 v96, v96, v98
    buffer_store_short v93, v18, s[24:27], s42 offen offset:384
    v_cvt_pk_bf16_f32 v96, v96, v96
    v_add_f32 v97, v97, v99
    buffer_store_short v96, v18, s[24:27], s42 offen offset:192
    v_cvt_pk_bf16_f32 v97, v97, v97
    buffer_store_short v97, v18, s[24:27], s42 offen offset:448
    v_mfma_f32_32x32x16_bf16 v[100:115], a[92:95], v[60:63], v[100:115]
    v_lshlrev_b32 v84, 16, v40
    v_lshlrev_b32 v86, 16, v41
    v_lshlrev_b32 v88, 16, v42
    v_lshlrev_b32 v90, 16, v43
    v_lshlrev_b32 v92, 16, v44
    v_lshlrev_b32 v94, 16, v45
    v_mfma_f32_32x32x16_bf16 v[116:131], a[116:119], v[52:55], v[116:131]
    v_lshlrev_b32 v96, 16, v46
    v_lshlrev_b32 v98, 16, v47
    v_and_b32 v85, s60, v40
    v_and_b32 v87, s60, v41
    v_and_b32 v89, s60, v42
    v_and_b32 v91, s60, v43
    v_and_b32 v93, s60, v44
    v_and_b32 v95, s60, v45
    v_mfma_f32_32x32x16_bf16 v[132:147], v[40:43], v[148:151], v[132:147]
    v_cvt_pk_bf16_f32 v148, v100, v101
    v_cvt_pk_bf16_f32 v149, v102, v103
    v_cvt_pk_bf16_f32 v150, v104, v105
    v_cvt_pk_bf16_f32 v151, v106, v107
    v_and_b32 v97, s60, v46
    v_and_b32 v99, s60, v47
    ds_read_b64_tr_b16 v[196:197], v4 offset:0
    v_mfma_f32_32x32x16_bf16 v[116:131], a[120:123], v[56:59], v[116:131]
    ds_read_b64_tr_b16 v[198:199], v6 offset:256
    ds_read_b64_tr_b16 v[200:201], v4 offset:512
    ds_read_b64_tr_b16 v[202:203], v6 offset:768
    ds_read_b64_tr_b16 v[204:205], v5 offset:0
    ds_read_b64_tr_b16 v[206:207], v7 offset:256
    ds_read_b64_tr_b16 v[208:209], v5 offset:512
    v_mfma_f32_32x32x16_bf16 v[132:147], v[44:47], v[152:155], v[132:147]
    v_cvt_pk_bf16_f32 v152, v108, v109
    v_cvt_pk_bf16_f32 v153, v110, v111
    v_cvt_pk_bf16_f32 v154, v112, v113
    v_cvt_pk_bf16_f32 v155, v114, v115
    ds_read_b64_tr_b16 v[210:211], v7 offset:768
    ds_read_b64_tr_b16 v[212:213], v6 offset:0
    v_mfma_f32_32x32x16_bf16 v[100:115], v[32:35], a[128:131], 0
    ds_read_b64_tr_b16 v[214:215], v4 offset:256
    ds_read_b64_tr_b16 v[216:217], v6 offset:512
    ds_read_b64_tr_b16 v[218:219], v4 offset:768
    s_waitcnt lgkmcnt(8)
    ds_read_b64_tr_b16 v[220:221], v7 offset:0
    ds_read_b64_tr_b16 v[222:223], v5 offset:256
    ds_read_b64_tr_b16 v[224:225], v7 offset:512
    v_mfma_f32_32x32x16_bf16 v[116:131], a[124:127], v[60:63], v[116:131]
    ds_read_b64_tr_b16 v[226:227], v5 offset:768
    buffer_load_dwordx4 v[244:247], v14, s[92:95], s33 offen
    buffer_load_ushort v19, v17, s[20:23], s43 offen
    s_sub_u32 s42, s36, 4
    s_lshl_b32 s42, s42, 10
    v_mov_b32 v18, v16
    v_mfma_f32_32x32x16_bf16 v[132:147], v[48:51], v[148:151], v[132:147]
    v_mfma_f32_32x32x16_bf16 v[100:115], v[36:39], a[132:135], v[100:115]
    s_nop 3
    v_cvt_pk_bf16_f32 v148, v116, v117
    v_cvt_pk_bf16_f32 v149, v118, v119
    v_cvt_pk_bf16_f32 v150, v120, v121
    v_cvt_pk_bf16_f32 v151, v122, v123
    v_mfma_f32_32x32x16_bf16 v[132:147], v[52:55], v[152:155], v[132:147]
    v_cvt_pk_bf16_f32 v152, v124, v125
    v_cvt_pk_bf16_f32 v153, v126, v127
    v_cvt_pk_bf16_f32 v154, v128, v129
    v_cvt_pk_bf16_f32 v155, v130, v131
    v_mfma_f32_32x32x16_bf16 v[100:115], v[40:43], a[136:139], v[100:115]
    s_waitcnt lgkmcnt(0)
    buffer_load_dwordx4 v9, s[16:19], s40 offen lds
    buffer_load_dwordx4 v64, s[12:15], s39 offen offset:1024 lds
    buffer_load_dwordx4 v65, s[12:15], s39 offen offset:2048 lds
    buffer_load_dwordx4 v66, s[12:15], s39 offen offset:3072 lds
    s_mov_b32 m0, s98
    s_nop 0
    buffer_load_dwordx4 v67, s[12:15], s39 offen lds
    v_mfma_f32_32x32x16_bf16 v[132:147], v[56:59], v[148:151], v[132:147]
    buffer_load_dwordx4 v68, s[12:15], s39 offen offset:1024 lds
    buffer_load_dwordx4 v69, s[12:15], s39 offen offset:2048 lds
    buffer_load_dwordx4 v70, s[12:15], s39 offen offset:3072 lds
    v_mfma_f32_32x32x16_bf16 v[100:115], v[44:47], a[140:143], v[100:115]
    v_mfma_f32_32x32x16_bf16 v[132:147], v[60:63], v[152:155], v[132:147]
    v_mfma_f32_32x32x16_bf16 v[116:131], v[32:35], a[160:163], 0
    v_mfma_f32_32x32x16_bf16 v[100:115], v[48:51], a[144:147], v[100:115]
    s_nop 9
    v_cndmask_b32_e64 v252, v132, v136, s[46:47]
    v_cndmask_b32_e64 v253, v133, v137, s[46:47]
    v_cndmask_b32_e64 v252, v252, v140, s[48:49]
    v_cndmask_b32_e64 v253, v253, v141, s[48:49]
    v_cndmask_b32_e64 v254, v134, v138, s[46:47]
    v_cndmask_b32_e64 v255, v135, v139, s[46:47]
    v_mfma_f32_32x32x16_bf16 v[116:131], v[36:39], a[164:167], v[116:131]
    v_cndmask_b32_e64 v252, v252, v144, s[50:51]
    v_cndmask_b32_e64 v253, v253, v145, s[50:51]
    v_cndmask_b32_e64 v254, v254, v142, s[48:49]
    v_cndmask_b32_e64 v255, v255, v143, s[48:49]
    v_mul_f32 v252, v252, v248
    v_mul_f32 v253, v253, v249
    v_cndmask_b32_e64 v254, v254, v146, s[50:51]
    v_mfma_f32_32x32x16_bf16 v[100:115], v[52:55], a[148:151], v[100:115]
    v_cndmask_b32_e64 v255, v255, v147, s[50:51]
    v_mul_f32 v252, v252, v27
    v_mul_f32 v253, v253, v27
    v_mul_f32 v254, v254, v250
    v_mul_f32 v255, v255, v251
    v_max_f32 v28, v252, v253
    v_mul_f32 v254, v254, v27
    v_mul_f32 v255, v255, v27
    v_mfma_f32_32x32x16_bf16 v[116:131], v[40:43], a[168:171], v[116:131]
    v_max3_f32 v28, v28, v254, v255
    v_mov_b32 v20, v28
    v_lshlrev_b32 v132, 16, v32
    v_lshlrev_b32 v134, 16, v33
    v_permlane32_swap_b32 v28, v20
    v_max_f32 v28, v28, v20
    v_mfma_f32_32x32x16_bf16 v[100:115], v[56:59], a[152:155], v[100:115]
    v_sub_f32 v252, v252, v28
    v_sub_f32 v253, v253, v28
    v_sub_f32 v254, v254, v28
    v_sub_f32 v255, v255, v28
    v_exp_f32 v252, v252
    v_exp_f32 v253, v253
    v_mfma_f32_32x32x16_bf16 v[116:131], v[44:47], a[172:175], v[116:131]
    v_exp_f32 v254, v254
    v_exp_f32 v255, v255
    v_add_f32 v28, v252, v253
    v_add_f32 v20, v254, v255
    v_add_f32 v28, v28, v20
    v_mfma_f32_32x32x16_bf16 v[100:115], v[60:63], a[156:159], v[100:115]
    v_mov_b32 v20, v28
    v_mul_f32 v252, v252, v248
    v_mul_f32 v253, v253, v249
    v_permlane32_swap_b32 v28, v20
    v_add_f32 v28, v28, v20
    v_mul_f32 v254, v254, v250
    v_rcp_f32 v28, v28
    v_mfma_f32_32x32x16_bf16 v[116:131], v[48:51], a[176:179], v[116:131]
    v_mul_f32 v255, v255, v251
    v_mul_f32 v28, v28, v22
    v_mul_f32 v252, v252, v28
    v_mul_f32 v253, v253, v28
    v_mul_f32 v254, v254, v28
    v_mul_f32 v255, v255, v28
    v_cvt_pk_bf16_f32 v156, v100, v101
    v_cvt_pk_bf16_f32 v157, v102, v103
    v_mfma_f32_32x32x16_bf16 v[116:131], v[52:55], a[180:183], v[116:131]
    v_cvt_pk_bf16_f32 v158, v104, v105
    v_cvt_pk_bf16_f32 v159, v106, v107
    v_cvt_pk_bf16_f32 v160, v108, v109
    v_cvt_pk_bf16_f32 v161, v110, v111
    v_cvt_pk_bf16_f32 v162, v112, v113
    v_cvt_pk_bf16_f32 v163, v114, v115
    v_mfma_f32_32x32x16_bf16 v[100:115], v[32:35], a[192:195], 0
    v_cvt_pk_bf16_f32 v28, v252, v253
    v_cvt_pk_bf16_f32 v20, v254, v255
    v_cndmask_b32_e64 v188, 0, v28, s[52:53]
    v_cndmask_b32_e64 v189, 0, v20, s[52:53]
    v_cndmask_b32_e64 v190, 0, v28, s[46:47]
    v_cndmask_b32_e64 v191, 0, v20, s[46:47]
    v_mfma_f32_32x32x16_bf16 v[116:131], v[56:59], a[184:187], v[116:131]
    v_lshlrev_b32 v136, 16, v34
    v_lshlrev_b32 v138, 16, v35
    v_lshlrev_b32 v140, 16, v36
    v_lshlrev_b32 v142, 16, v37
    v_lshlrev_b32 v144, 16, v38
    v_lshlrev_b32 v146, 16, v39
    v_mfma_f32_32x32x16_bf16 v[100:115], v[36:39], a[196:199], v[100:115]
    v_and_b32 v133, s60, v32
    v_and_b32 v135, s60, v33
    v_and_b32 v137, s60, v34
    v_and_b32 v139, s60, v35
    v_and_b32 v141, s60, v36
    v_and_b32 v143, s60, v37
    v_and_b32 v145, s60, v38
    v_and_b32 v147, s60, v39
    v_mfma_f32_32x32x16_bf16 v[116:131], v[60:63], a[188:191], v[116:131]
    v_cndmask_b32_e64 v192, 0, v28, s[48:49]
    v_cndmask_b32_e64 v193, 0, v20, s[48:49]
    v_cndmask_b32_e64 v194, 0, v28, s[50:51]
    v_cndmask_b32_e64 v195, 0, v20, s[50:51]
    v_mfma_f32_32x32x16_bf16 v[132:147], v[156:159], v[188:191], v[132:147]
    v_mfma_f32_32x32x16_bf16 v[100:115], v[40:43], a[200:203], v[100:115]
    s_nop 5
    v_cvt_pk_bf16_f32 v164, v116, v117
    v_cvt_pk_bf16_f32 v165, v118, v119
    v_cvt_pk_bf16_f32 v166, v120, v121
    v_cvt_pk_bf16_f32 v167, v122, v123
    v_cvt_pk_bf16_f32 v168, v124, v125
    v_cvt_pk_bf16_f32 v169, v126, v127
    v_mfma_f32_32x32x16_bf16 v[132:147], v[160:163], v[192:195], v[132:147]
    v_cvt_pk_bf16_f32 v170, v128, v129
    v_cvt_pk_bf16_f32 v171, v130, v131
    v_mfma_f32_32x32x16_bf16 v[100:115], v[44:47], a[204:207], v[100:115]
    v_mfma_f32_32x32x16_bf16 v[116:131], v[32:35], a[224:227], 0
    s_nop 7
    v_fmac_f32 v29, v132, v228
    v_add_f32 v30, v30, v132
    v_fmac_f32 v29, v133, v229
    v_fmac_f32 v31, v132, v132
    v_fmac_f32 v29, v134, v230
    v_add_f32 v30, v30, v133
    v_fmac_f32 v29, v135, v231
    ds_read_b128 v[228:231], v15 offset:64
    v_mfma_f32_32x32x16_bf16 v[100:115], v[48:51], a[208:211], v[100:115]
    v_fmac_f32 v29, v136, v232
    v_fmac_f32 v31, v133, v133
    v_fmac_f32 v29, v137, v233
    v_add_f32 v30, v30, v134
    v_fmac_f32 v29, v138, v234
    v_fmac_f32 v31, v134, v134
    v_fmac_f32 v29, v139, v235
    ds_read_b128 v[232:235], v15 offset:80
    v_mfma_f32_32x32x16_bf16 v[116:131], v[36:39], a[228:231], v[116:131]
    v_fmac_f32 v29, v140, v236
    v_add_f32 v30, v30, v135
    v_fmac_f32 v29, v141, v237
    v_fmac_f32 v31, v135, v135
    v_fmac_f32 v29, v142, v238
    v_add_f32 v30, v30, v136
    v_fmac_f32 v29, v143, v239
    ds_read_b128 v[236:239], v15 offset:96
    v_mfma_f32_32x32x16_bf16 v[100:115], v[52:55], a[212:215], v[100:115]
    v_fmac_f32 v29, v144, v240
    v_fmac_f32 v31, v136, v136
    v_fmac_f32 v29, v145, v241
    v_add_f32 v30, v30, v137
    v_fmac_f32 v29, v146, v242
    v_fmac_f32 v31, v137, v137
    v_fmac_f32 v29, v147, v243
    ds_read_b128 v[240:243], v15 offset:112
    v_mfma_f32_32x32x16_bf16 v[84:99], v[164:167], v[188:191], v[84:99]
    v_add_f32 v30, v30, v138
    v_fmac_f32 v31, v138, v138
    v_add_f32 v30, v30, v139
    v_fmac_f32 v31, v139, v139
    v_add_f32 v30, v30, v140
    v_fmac_f32 v31, v140, v140
    v_add_f32 v30, v30, v141
    v_fmac_f32 v31, v141, v141
    v_mfma_f32_32x32x16_bf16 v[116:131], v[40:43], a[232:235], v[116:131]
    v_add_f32 v30, v30, v142
    v_fmac_f32 v31, v142, v142
    v_add_f32 v30, v30, v143
    v_fmac_f32 v31, v143, v143
    v_add_f32 v30, v30, v144
    v_fmac_f32 v31, v144, v144
    v_add_f32 v30, v30, v145
    v_fmac_f32 v31, v145, v145
    v_mfma_f32_32x32x16_bf16 v[100:115], v[56:59], a[216:219], v[100:115]
    v_add_f32 v30, v30, v146
    v_fmac_f32 v31, v146, v146
    v_add_f32 v30, v30, v147
    v_fmac_f32 v31, v147, v147
    v_lshlrev_b32 v132, 16, v48
    v_lshlrev_b32 v134, 16, v49
    v_lshlrev_b32 v136, 16, v50
    v_mfma_f32_32x32x16_bf16 v[84:99], v[168:171], v[192:195], v[84:99]
    v_lshlrev_b32 v138, 16, v51
    v_lshlrev_b32 v140, 16, v52
    v_lshlrev_b32 v142, 16, v53
    v_lshlrev_b32 v144, 16, v54
    v_lshlrev_b32 v146, 16, v55
    v_and_b32 v133, s60, v48
    v_and_b32 v135, s60, v49
    v_mfma_f32_32x32x16_bf16 v[116:131], v[44:47], a[236:239], v[116:131]
    v_and_b32 v137, s60, v50
    v_and_b32 v139, s60, v51
    v_and_b32 v141, s60, v52
    v_and_b32 v143, s60, v53
    v_and_b32 v145, s60, v54
    v_and_b32 v147, s60, v55
    s_waitcnt lgkmcnt(3)
    v_fmac_f32 v29, v84, v228
    v_mfma_f32_32x32x16_bf16 v[100:115], v[60:63], a[220:223], v[100:115]
    v_fmac_f32 v29, v85, v229
    v_add_f32 v30, v30, v84
    v_fmac_f32 v29, v86, v230
    v_fmac_f32 v31, v84, v84
    v_fmac_f32 v29, v87, v231
    ds_read_b128 v[228:231], v15 offset:128
    s_waitcnt lgkmcnt(3)
    v_fmac_f32 v29, v88, v232
    v_add_f32 v30, v30, v85
    v_mfma_f32_32x32x16_bf16 v[116:131], v[48:51], a[240:243], v[116:131]
    v_fmac_f32 v29, v89, v233
    v_fmac_f32 v31, v85, v85
    v_fmac_f32 v29, v90, v234
    v_add_f32 v30, v30, v86
    v_fmac_f32 v29, v91, v235
    ds_read_b128 v[232:235], v15 offset:144
    s_waitcnt lgkmcnt(3)
    v_fmac_f32 v29, v92, v236
    v_fmac_f32 v31, v86, v86
    v_mfma_f32_32x32x16_bf16 v[116:131], v[52:55], a[244:247], v[116:131]
    v_cvt_pk_bf16_f32 v172, v100, v101
    v_cvt_pk_bf16_f32 v173, v102, v103
    v_cvt_pk_bf16_f32 v174, v104, v105
    v_cvt_pk_bf16_f32 v175, v106, v107
    v_fmac_f32 v29, v93, v237
    v_cvt_pk_bf16_f32 v176, v108, v109
    v_fmac_f32 v29, v94, v238
    v_mfma_f32_32x32x16_bf16 v[132:147], v[172:175], v[188:191], v[132:147]
    v_cvt_pk_bf16_f32 v177, v110, v111
    v_cvt_pk_bf16_f32 v178, v112, v113
    v_cvt_pk_bf16_f32 v179, v114, v115
    v_fmac_f32 v29, v95, v239
    ds_read_b128 v[236:239], v15 offset:160
    s_waitcnt lgkmcnt(3)
    v_fmac_f32 v29, v96, v240
    v_add_f32 v30, v30, v87
    v_mfma_f32_32x32x16_bf16 v[116:131], v[56:59], a[248:251], v[116:131]
    v_fmac_f32 v29, v97, v241
    v_fmac_f32 v31, v87, v87
    v_fmac_f32 v29, v98, v242
    v_add_f32 v30, v30, v88
    v_fmac_f32 v29, v99, v243
    ds_read_b128 v[240:243], v15 offset:176
    v_fmac_f32 v31, v88, v88
    v_add_f32 v30, v30, v89
    v_mfma_f32_32x32x16_bf16 v[132:147], v[176:179], v[192:195], v[132:147]
    v_fmac_f32 v31, v89, v89
    v_add_f32 v30, v30, v90
    v_fmac_f32 v31, v90, v90
    v_add_f32 v30, v30, v91
    v_fmac_f32 v31, v91, v91
    v_add_f32 v30, v30, v92
    v_fmac_f32 v31, v92, v92
    v_add_f32 v30, v30, v93
    v_mfma_f32_32x32x16_bf16 v[116:131], v[60:63], a[252:255], v[116:131]
    v_fmac_f32 v31, v93, v93
    v_add_f32 v30, v30, v94
    v_fmac_f32 v31, v94, v94
    v_add_f32 v30, v30, v95
    v_fmac_f32 v31, v95, v95
    v_add_f32 v30, v30, v96
    v_fmac_f32 v31, v96, v96
    v_add_f32 v30, v30, v97
    s_waitcnt lgkmcnt(3)
    v_fmac_f32 v29, v132, v228
    v_fmac_f32 v31, v97, v97
    v_fmac_f32 v29, v133, v229
    v_add_f32 v30, v30, v98
    v_fmac_f32 v29, v134, v230
    v_fmac_f32 v31, v98, v98
    v_fmac_f32 v29, v135, v231
    ds_read_b128 v[228:231], v15 offset:192
    s_waitcnt lgkmcnt(3)
    v_fmac_f32 v29, v136, v232
    v_add_f32 v30, v30, v99
    v_fmac_f32 v31, v99, v99
    v_cvt_pk_bf16_f32 v180, v116, v117
    v_cvt_pk_bf16_f32 v181, v118, v119
    v_cvt_pk_bf16_f32 v182, v120, v121
    v_cvt_pk_bf16_f32 v183, v122, v123
    v_lshlrev_b32 v84, 16, v56
    v_lshlrev_b32 v86, 16, v57
    v_lshlrev_b32 v88, 16, v58
    v_lshlrev_b32 v90, 16, v59
    v_lshlrev_b32 v92, 16, v60
    v_lshlrev_b32 v94, 16, v61
    v_lshlrev_b32 v96, 16, v62
    v_lshlrev_b32 v98, 16, v63
    v_and_b32 v85, s60, v56
    v_and_b32 v87, s60, v57
    v_and_b32 v89, s60, v58
    v_and_b32 v91, s60, v59
    v_and_b32 v93, s60, v60
    v_and_b32 v95, s60, v61
    v_and_b32 v97, s60, v62
    v_and_b32 v99, s60, v63
    v_fmac_f32 v29, v137, v233
    v_add_f32 v30, v30, v132
    v_mfma_f32_32x32x16_bf16 v[84:99], v[180:183], v[188:191], v[84:99]
    v_fmac_f32 v29, v138, v234
    v_fmac_f32 v31, v132, v132
    v_fmac_f32 v29, v139, v235
    v_add_f32 v30, v30, v133
    v_fmac_f32 v31, v133, v133
    ds_read_b128 v[232:235], v15 offset:208
    s_waitcnt lgkmcnt(3)
    v_fmac_f32 v29, v140, v236
    v_add_f32 v30, v30, v134
    v_fmac_f32 v31, v134, v134
    v_fmac_f32 v29, v141, v237
    v_add_f32 v30, v30, v135
    v_fmac_f32 v31, v135, v135
    v_fmac_f32 v29, v142, v238
    v_cvt_pk_bf16_f32 v184, v124, v125
    v_cvt_pk_bf16_f32 v185, v126, v127
    v_cvt_pk_bf16_f32 v186, v128, v129
    v_cvt_pk_bf16_f32 v187, v130, v131
    v_add_f32 v30, v30, v136
    v_fmac_f32 v31, v136, v136
    v_mfma_f32_32x32x16_bf16 v[84:99], v[184:187], v[192:195], v[84:99]
    v_fmac_f32 v29, v143, v239
    v_add_f32 v30, v30, v137
    v_fmac_f32 v31, v137, v137
    ds_read_b128 v[236:239], v15 offset:224
    s_waitcnt lgkmcnt(3)
    v_fmac_f32 v29, v144, v240
    v_add_f32 v30, v30, v138
    v_fmac_f32 v31, v138, v138
    v_fmac_f32 v29, v145, v241
    v_add_f32 v30, v30, v139
    v_fmac_f32 v31, v139, v139
    v_fmac_f32 v29, v146, v242
    v_add_f32 v30, v30, v140
    v_fmac_f32 v31, v140, v140
    v_fmac_f32 v29, v147, v243
    v_add_f32 v30, v30, v141
    v_fmac_f32 v31, v141, v141
    ds_read_b128 v[240:243], v15 offset:240
    v_add_f32 v30, v30, v142
    v_fmac_f32 v31, v142, v142
    v_add_f32 v30, v30, v143
    v_fmac_f32 v31, v143, v143
    v_add_f32 v30, v30, v144
    v_fmac_f32 v31, v144, v144
    v_add_f32 v30, v30, v145
    v_fmac_f32 v31, v145, v145
    v_add_f32 v30, v30, v146
    v_fmac_f32 v31, v146, v146
    v_add_f32 v30, v30, v147
    v_fmac_f32 v31, v147, v147
    v_add_f32 v30, v30, v84
    v_fmac_f32 v31, v84, v84
    s_waitcnt lgkmcnt(3)
    v_fmac_f32 v29, v84, v228
    v_add_f32 v30, v30, v85
    v_fmac_f32 v31, v85, v85
    v_fmac_f32 v29, v85, v229
    v_add_f32 v30, v30, v86
    v_fmac_f32 v31, v86, v86
    v_fmac_f32 v29, v86, v230
    v_add_f32 v30, v30, v87
    v_fmac_f32 v31, v87, v87
    v_fmac_f32 v29, v87, v231
    v_add_f32 v30, v30, v88
    v_fmac_f32 v31, v88, v88
    s_waitcnt lgkmcnt(2)
    v_fmac_f32 v29, v88, v232
    v_add_f32 v30, v30, v89
    v_fmac_f32 v31, v89, v89
    v_fmac_f32 v29, v89, v233
    v_add_f32 v30, v30, v90
    v_fmac_f32 v31, v90, v90
    v_fmac_f32 v29, v90, v234
    v_add_f32 v30, v30, v91
    v_fmac_f32 v31, v91, v91
    v_fmac_f32 v29, v91, v235
    v_add_f32 v30, v30, v92
    v_fmac_f32 v31, v92, v92
    s_waitcnt lgkmcnt(1)
    v_fmac_f32 v29, v92, v236
    v_add_f32 v30, v30, v93
    v_fmac_f32 v31, v93, v93
    v_fmac_f32 v29, v93, v237
    v_add_f32 v30, v30, v94
    v_fmac_f32 v31, v94, v94
    v_fmac_f32 v29, v94, v238
    v_add_f32 v30, v30, v95
    v_fmac_f32 v31, v95, v95
    v_fmac_f32 v29, v95, v239
    v_add_f32 v30, v30, v96
    v_fmac_f32 v31, v96, v96
    s_waitcnt lgkmcnt(0)
    v_fmac_f32 v29, v96, v240
    v_add_f32 v30, v30, v97
    v_fmac_f32 v31, v97, v97
    v_fmac_f32 v29, v97, v241
    v_add_f32 v30, v30, v98
    v_fmac_f32 v31, v98, v98
    v_fmac_f32 v29, v98, v242
    v_add_f32 v30, v30, v99
    v_fmac_f32 v31, v99, v99
    v_fmac_f32 v29, v99, v243
    s_waitcnt lgkmcnt(0)
    s_cmp_le_u32 s36, s56
    s_cbranch_scc1 tf_loop
    s_cmp_eq_u32 s61, s56
    s_cbranch_scc1 tf_epi
    s_waitcnt vmcnt(0)
    s_cmp_lg_u32 s6, 0
    s_cbranch_scc1 tf_c1
    s_nop 7
    s_nop 7
    ds_read_b128 v[32:35], v72
    ds_read_b128 v[36:39], v73
    v_mov_b32 v0, v30
    ds_read_b128 v[40:43], v74
    ds_read_b128 v[44:47], v75
    v_permlane32_swap_b32 v30, v0
    v_add_f32 v30, v30, v0
    v_mov_b32 v0, v31
    v_mul_f32 v30, s58, v30
    ds_read_b128 v[48:51], v76
    v_permlane32_swap_b32 v31, v0
    v_add_f32 v31, v31, v0
    v_mov_b32 v0, v29
    v_mul_f32 v31, s58, v31
    ds_read_b128 v[52:55], v77
    v_permlane32_swap_b32 v29, v0
    v_fma_f32 v31, -v30, v30, v31
    v_add_f32 v29, v29, v0
    v_max_f32 v31, 0, v31
    v_mov_b32 v0, s57
    v_fma_f32 v31, v31, v26, v0
    ds_read_b128 v[56:59], v78
    v_rsq_f32 v31, v31
    s_nop 0
    v_mul_f32 v29, v29, v31
    ds_read_b128 v[60:63], v79
    v_mul_f32 v29, v29, v25
    v_lshl_add_u32 v30, v17, 2, v13
    v_mul_f32 v29, s59, v29
    v_mov_b32 v0, v29
    v_lshlrev_b32 v22, 16, v19
    v_cndmask_b32_e64 v22, v22, 1.0, s[54:55]
    v_max_f32_dpp v0, v0, v0 quad_perm:[1,0,3,2] row_mask:0xf bank_mask:0xf
    s_waitcnt lgkmcnt(7)
    v_mfma_f32_32x32x16_bf16 v[100:115], a[0:3], v[32:35], 0
    v_max_f32_dpp v0, v0, v0 quad_perm:[2,3,0,1] row_mask:0xf bank_mask:0xf
    v_cmp_eq_f32_e64 s[62:63], 0, v22
    s_nop 0
    v_max_f32_dpp v0, v0, v0 row_half_mirror row_mask:0xf bank_mask:0xf
    v_sub_f32 v29, v29, v0
    v_cndmask_b32_e64 v22, v22, 1.0, s[62:63]
    v_exp_f32 v29, v29
    s_waitcnt lgkmcnt(6)
    v_mfma_f32_32x32x16_bf16 v[100:115], a[4:7], v[36:39], v[100:115]
    v_mov_b32 v0, v29
    v_add_f32 v245, v245, v247
    v_add_f32 v244, v244, v246
    v_add_f32_dpp v0, v0, v0 quad_perm:[1,0,3,2] row_mask:0xf bank_mask:0xf
    v_mul_f32 v245, s58, v245
    v_rcp_f32 v23, v22
    s_waitcnt lgkmcnt(5)
    v_mfma_f32_32x32x16_bf16 v[100:115], a[8:11], v[40:43], v[100:115]
    v_add_f32_dpp v0, v0, v0 quad_perm:[2,3,0,1] row_mask:0xf bank_mask:0xf
    v_mul_f32 v244, s58, v244
    v_fma_f32 v245, -v244, v244, v245
    v_add_f32_dpp v0, v0, v0 row_half_mirror row_mask:0xf bank_mask:0xf
    v_rcp_f32 v0, v0
    s_nop 0
    v_mul_f32 v29, v29, v0
    s_waitcnt lgkmcnt(4)
    v_mfma_f32_32x32x16_bf16 v[100:115], a[12:15], v[44:47], v[100:115]
    v_mul_f32 v29, v29, v25
    v_mul_f32 v252, v252, v29
    v_mul_f32 v253, v253, v29
    v_mul_f32 v254, v254, v29
    v_mul_f32 v255, v255, v29
    v_add_f32_dpp v252, v252, v252 quad_perm:[1,0,3,2] row_mask:0xf bank_mask:0xf
    v_add_f32_dpp v253, v253, v253 quad_perm:[1,0,3,2] row_mask:0xf bank_mask:0xf
    v_add_f32_dpp v254, v254, v254 quad_perm:[1,0,3,2] row_mask:0xf bank_mask:0xf
    v_mfma_f32_32x32x16_bf16 v[116:131], v[32:35], a[128:131], 0
    v_add_f32_dpp v255, v255, v255 quad_perm:[1,0,3,2] row_mask:0xf bank_mask:0xf
    v_cvt_pk_bf16_f32 v0, v29, v29
    ds_write_b16 v12, v0 offset:192
    v_add_f32_dpp v252, v252, v252 quad_perm:[2,3,0,1] row_mask:0xf bank_mask:0xf
    v_add_f32_dpp v253, v253, v253 quad_perm:[2,3,0,1] row_mask:0xf bank_mask:0xf
    v_add_f32_dpp v254, v254, v254 quad_perm:[2,3,0,1] row_mask:0xf bank_mask:0xf
    s_waitcnt lgkmcnt(4)
    v_mfma_f32_32x32x16_bf16 v[100:115], a[16:19], v[48:51], v[100:115]
    v_add_f32_dpp v255, v255, v255 quad_perm:[2,3,0,1] row_mask:0xf bank_mask:0xf
    ds_read_b128 v[236:239], v13 offset:192
    ds_read_b128 v[240:243], v13 offset:208
    v_add_f32_dpp v252, v252, v252 row_half_mirror row_mask:0xf bank_mask:0xf
    v_add_f32_dpp v253, v253, v253 row_half_mirror row_mask:0xf bank_mask:0xf
    v_add_f32_dpp v254, v254, v254 row_half_mirror row_mask:0xf bank_mask:0xf
    v_mfma_f32_32x32x16_bf16 v[116:131], v[36:39], a[132:135], v[116:131]
    v_add_f32_dpp v255, v255, v255 row_half_mirror row_mask:0xf bank_mask:0xf
    v_cvt_pk_bf16_f32 v0, v252, v253
    v_cvt_pk_bf16_f32 v1, v254, v255
    ds_write_b64 v30, v[0:1] offset:128
    ds_read_b128 v[228:231], v13 offset:128
    ds_read_b128 v[232:235], v13 offset:144
    s_waitcnt lgkmcnt(8)
    v_mfma_f32_32x32x16_bf16 v[100:115], a[20:23], v[52:55], v[100:115]
    v_max_f32 v245, 0, v245
    v_mul_f32 v24, v23, v23
    v_mov_b32 v244, s57
    v_fma_f32 v245, v245, v24, v244
    v_mov_b32 v25, v23
    v_rsq_f32 v245, v245
    v_mfma_f32_32x32x16_bf16 v[116:131], v[40:43], a[136:139], v[116:131]
    v_mul_f32 v27, v245, v23
    ds_write_b32 v10, v27
    ds_read_b128 v[248:251], v11
    v_mov_b32 v26, v24
    s_waitcnt lgkmcnt(9)
    v_mfma_f32_32x32x16_bf16 v[100:115], a[24:27], v[56:59], v[100:115]
    s_waitcnt lgkmcnt(6)
    v_dot2_f32_bf16 v84, v196, v236, 0
    s_waitcnt lgkmcnt(5)
    v_dot2_f32_bf16 v86, v200, v240, 0
    v_dot2_f32_bf16 v85, v198, v238, 0
    v_dot2_f32_bf16 v87, v202, v242, 0
    v_dot2_f32_bf16 v88, v204, v236, 0
    v_mfma_f32_32x32x16_bf16 v[116:131], v[44:47], a[140:143], v[116:131]
    v_dot2_f32_bf16 v90, v208, v240, 0
    v_dot2c_f32_bf16 v84, v197, v237
    v_dot2c_f32_bf16 v86, v201, v241
    v_dot2_f32_bf16 v89, v206, v238, 0
    v_dot2_f32_bf16 v91, v210, v242, 0
    s_waitcnt lgkmcnt(3)
    v_dot2c_f32_bf16 v84, v156, v228
    v_mfma_f32_32x32x16_bf16 v[100:115], a[28:31], v[60:63], v[100:115]
    v_dot2c_f32_bf16 v85, v199, v239
    s_waitcnt lgkmcnt(2)
    v_dot2c_f32_bf16 v86, v160, v232
    v_dot2c_f32_bf16 v87, v203, v243
    v_dot2_f32_bf16 v92, v212, v236, 0
    v_dot2_f32_bf16 v94, v216, v240, 0
    v_dot2c_f32_bf16 v84, v157, v229
    v_mfma_f32_32x32x16_bf16 v[116:131], v[48:51], a[144:147], v[116:131]
    v_dot2c_f32_bf16 v85, v158, v230
    v_dot2c_f32_bf16 v86, v161, v233
    v_dot2c_f32_bf16 v87, v162, v234
    v_dot2c_f32_bf16 v88, v205, v237
    v_dot2c_f32_bf16 v90, v209, v241
    v_dot2_f32_bf16 v93, v214, v238, 0
    v_mfma_f32_32x32x16_bf16 v[116:131], v[52:55], a[148:151], v[116:131]
    v_cvt_pk_bf16_f32 v148, v100, v101
    v_cvt_pk_bf16_f32 v149, v102, v103
    v_cvt_pk_bf16_f32 v150, v104, v105
    v_cvt_pk_bf16_f32 v151, v106, v107
    v_dot2_f32_bf16 v95, v218, v242, 0
    v_cvt_pk_bf16_f32 v152, v108, v109
    v_mfma_f32_32x32x16_bf16 v[132:147], v[32:35], v[148:151], 0
    v_cvt_pk_bf16_f32 v153, v110, v111
    v_cvt_pk_bf16_f32 v154, v112, v113
    v_cvt_pk_bf16_f32 v155, v114, v115
    v_dot2c_f32_bf16 v85, v159, v231
    v_dot2c_f32_bf16 v87, v163, v235
    v_dot2c_f32_bf16 v88, v164, v228
    v_mfma_f32_32x32x16_bf16 v[116:131], v[56:59], a[152:155], v[116:131]
    v_dot2c_f32_bf16 v89, v207, v239
    v_dot2c_f32_bf16 v90, v168, v232
    v_dot2c_f32_bf16 v91, v211, v243
    v_dot2_f32_bf16 v96, v220, v236, 0
    v_dot2_f32_bf16 v98, v224, v240, 0
    v_dot2c_f32_bf16 v88, v165, v229
    v_mfma_f32_32x32x16_bf16 v[132:147], v[36:39], v[152:155], v[132:147]
    v_dot2c_f32_bf16 v89, v166, v230
    v_dot2c_f32_bf16 v90, v169, v233
    v_dot2c_f32_bf16 v91, v170, v234
    v_dot2c_f32_bf16 v92, v213, v237
    v_dot2c_f32_bf16 v94, v217, v241
    v_dot2_f32_bf16 v97, v222, v238, 0
    v_mfma_f32_32x32x16_bf16 v[116:131], v[60:63], a[156:159], v[116:131]
    v_dot2_f32_bf16 v99, v226, v242, 0
    v_permlane32_swap_b32 v84, v86
    v_dot2c_f32_bf16 v89, v167, v231
    v_dot2c_f32_bf16 v91, v171, v235
    v_dot2c_f32_bf16 v92, v172, v228
    v_dot2c_f32_bf16 v93, v215, v239
    v_dot2c_f32_bf16 v94, v176, v232
    v_dot2c_f32_bf16 v95, v219, v243
    v_permlane32_swap_b32 v85, v87
    v_dot2c_f32_bf16 v92, v173, v229
    v_dot2c_f32_bf16 v93, v174, v230
    v_dot2c_f32_bf16 v94, v177, v233
    v_dot2c_f32_bf16 v95, v178, v234
    v_dot2c_f32_bf16 v96, v221, v237
    v_dot2c_f32_bf16 v98, v225, v241
    v_add_f32 v84, v84, v86
    v_permlane32_swap_b32 v88, v90
    v_dot2c_f32_bf16 v93, v175, v231
    v_dot2c_f32_bf16 v95, v179, v235
    v_dot2c_f32_bf16 v96, v180, v228
    v_dot2c_f32_bf16 v97, v223, v239
    v_dot2c_f32_bf16 v98, v184, v232
    v_dot2c_f32_bf16 v99, v227, v243
    v_cvt_pk_bf16_f32 v84, v84, v84
    v_add_f32 v85, v85, v87
    v_permlane32_swap_b32 v89, v91
    v_dot2c_f32_bf16 v96, v181, v229
    v_dot2c_f32_bf16 v97, v182, v230
    v_dot2c_f32_bf16 v98, v185, v233
    v_dot2c_f32_bf16 v99, v186, v234
    buffer_store_short v84, v18, s[24:27], s42 offen offset:0
    v_cvt_pk_bf16_f32 v85, v85, v85
    v_add_f32 v88, v88, v90
    v_permlane32_swap_b32 v92, v94
    v_dot2c_f32_bf16 v97, v183, v231
    v_dot2c_f32_bf16 v99, v187, v235
    buffer_store_short v85, v18, s[24:27], s42 offen offset:256
    v_cvt_pk_bf16_f32 v88, v88, v88
    v_add_f32 v89, v89, v91
    v_permlane32_swap_b32 v93, v95
    buffer_store_short v88, v18, s[24:27], s42 offen offset:64
    v_cvt_pk_bf16_f32 v89, v89, v89
    v_add_f32 v92, v92, v94
    v_permlane32_swap_b32 v96, v98
    buffer_store_short v89, v18, s[24:27], s42 offen offset:320
    v_cvt_pk_bf16_f32 v92, v92, v92
    v_add_f32 v93, v93, v95
    v_permlane32_swap_b32 v97, v99
    buffer_store_short v92, v18, s[24:27], s42 offen offset:128
    v_cvt_pk_bf16_f32 v93, v93, v93
    v_add_f32 v96, v96, v98
    v_cndmask_b32_e64 v152, v132, v136, s[46:47]
    v_cndmask_b32_e64 v153, v133, v137, s[46:47]
    v_cndmask_b32_e64 v154, v134, v138, s[46:47]
    v_cndmask_b32_e64 v155, v135, v139, s[46:47]
    buffer_store_short v93, v18, s[24:27], s42 offen offset:384
    v_cvt_pk_bf16_f32 v96, v96, v96
    v_add_f32 v97, v97, v99
    v_cndmask_b32_e64 v152, v152, v140, s[48:49]
    v_cndmask_b32_e64 v153, v153, v141, s[48:49]
    v_cndmask_b32_e64 v154, v154, v142, s[48:49]
    v_cndmask_b32_e64 v155, v155, v143, s[48:49]
    buffer_store_short v96, v18, s[24:27], s42 offen offset:192
    v_cvt_pk_bf16_f32 v97, v97, v97
    v_cndmask_b32_e64 v152, v152, v144, s[50:51]
    v_cndmask_b32_e64 v153, v153, v145, s[50:51]
    v_cndmask_b32_e64 v154, v154, v146, s[50:51]
    v_cndmask_b32_e64 v155, v155, v147, s[50:51]
    buffer_store_short v97, v18, s[24:27], s42 offen offset:448
    ds_write_b128 v2, v[152:155] offset:0
    v_cvt_pk_bf16_f32 v156, v116, v117
    v_cvt_pk_bf16_f32 v157, v118, v119
    v_cvt_pk_bf16_f32 v158, v120, v121
    v_cvt_pk_bf16_f32 v159, v122, v123
    v_cvt_pk_bf16_f32 v160, v124, v125
    v_cvt_pk_bf16_f32 v161, v126, v127
    v_cvt_pk_bf16_f32 v162, v128, v129
    v_cvt_pk_bf16_f32 v163, v130, v131
    ds_read_b64_tr_b16 v[196:197], v4 offset:0
    ds_read_b64_tr_b16 v[198:199], v6 offset:256
    ds_read_b64_tr_b16 v[200:201], v4 offset:512
    ds_read_b64_tr_b16 v[202:203], v6 offset:768
    s_lshl_b32 s42, s61, 10
    v_mov_b32 v18, v16
    s_waitcnt lgkmcnt(0)
    s_barrier
    ds_read_b128 v[132:135], v2 offset:0
    ds_read_b128 v[136:139], v2 offset:1024
    ds_read_b128 v[140:143], v2 offset:2048
    ds_read_b128 v[144:147], v2 offset:3072
    ds_read_b128 v[228:231], v15 offset:0
    v_lshlrev_b32 v100, 16, v32
    v_lshlrev_b32 v102, 16, v33
    v_lshlrev_b32 v104, 16, v34
    v_lshlrev_b32 v106, 16, v35
    v_lshlrev_b32 v108, 16, v36
    v_lshlrev_b32 v110, 16, v37
    v_lshlrev_b32 v112, 16, v38
    v_lshlrev_b32 v114, 16, v39
    v_and_b32 v101, s60, v32
    v_and_b32 v103, s60, v33
    v_and_b32 v105, s60, v34
    v_and_b32 v107, s60, v35
    v_and_b32 v109, s60, v36
    v_and_b32 v111, s60, v37
    v_and_b32 v113, s60, v38
    v_and_b32 v115, s60, v39
    ds_read_b128 v[232:235], v15 offset:16
    ds_read_b128 v[236:239], v15 offset:32
    ds_read_b128 v[240:243], v15 offset:48
    v_mov_b32 v148, 0
    v_mov_b32 v149, 0
    v_mov_b32 v150, 0
    v_mov_b32 v151, 0
    s_waitcnt lgkmcnt(6)
    v_add_f32 v252, v132, v136
    v_add_f32 v253, v133, v137
    v_add_f32 v254, v134, v138
    s_waitcnt lgkmcnt(4)
    v_add_f32 v140, v140, v144
    v_add_f32 v141, v141, v145
    v_add_f32 v252, v252, v140
    v_add_f32 v253, v253, v141
    v_add_f32 v255, v135, v139
    v_add_f32 v142, v142, v146
    v_add_f32 v143, v143, v147
    v_mul_f32 v252, v252, v248
    v_mul_f32 v253, v253, v249
    v_add_f32 v254, v254, v142
    v_add_f32 v255, v255, v143
    v_mul_f32 v252, v252, v27
    v_mul_f32 v253, v253, v27
    v_mul_f32 v254, v254, v250
    v_mul_f32 v255, v255, v251
    v_max_f32 v28, v252, v253
    v_mul_f32 v254, v254, v27
    v_mul_f32 v255, v255, v27
    v_max3_f32 v28, v28, v254, v255
    v_mov_b32 v20, v28
    s_nop 1
    v_permlane32_swap_b32 v28, v20
    v_max_f32 v28, v28, v20
    v_sub_f32 v252, v252, v28
    v_sub_f32 v253, v253, v28
    v_sub_f32 v254, v254, v28
    v_sub_f32 v255, v255, v28
    v_exp_f32 v252, v252
    v_exp_f32 v253, v253
    v_exp_f32 v254, v254
    v_exp_f32 v255, v255
    v_add_f32 v28, v252, v253
    v_add_f32 v20, v254, v255
    v_add_f32 v28, v28, v20
    v_mov_b32 v20, v28
    v_mul_f32 v252, v252, v248
    v_mul_f32 v253, v253, v249
    v_permlane32_swap_b32 v28, v20
    v_add_f32 v28, v28, v20
    v_mul_f32 v254, v254, v250
    v_rcp_f32 v28, v28
    v_mul_f32 v255, v255, v251
    v_mul_f32 v28, v28, v22
    v_mul_f32 v252, v252, v28
    v_mul_f32 v253, v253, v28
    v_mul_f32 v254, v254, v28
    v_mul_f32 v255, v255, v28
    v_cvt_pk_bf16_f32 v28, v252, v253
    v_cvt_pk_bf16_f32 v20, v254, v255
    v_cndmask_b32_e64 v188, 0, v28, s[52:53]
    v_cndmask_b32_e64 v189, 0, v20, s[52:53]
    v_cndmask_b32_e64 v190, 0, v28, s[46:47]
    v_cndmask_b32_e64 v191, 0, v20, s[46:47]
    v_cndmask_b32_e64 v192, 0, v28, s[48:49]
    s_nop 0
    v_mfma_f32_32x32x16_bf16 v[100:115], v[156:159], v[188:191], v[100:115]
    v_cndmask_b32_e64 v193, 0, v20, s[48:49]
    v_cndmask_b32_e64 v194, 0, v28, s[50:51]
    v_cndmask_b32_e64 v195, 0, v20, s[50:51]
    s_nop 1
    v_mfma_f32_32x32x16_bf16 v[100:115], v[160:163], v[192:195], v[100:115]
    s_nop 11
    v_add_f32 v148, v148, v100
    v_fmac_f32 v149, v100, v100
    s_waitcnt lgkmcnt(3)
    v_fmac_f32 v150, v100, v228
    v_add_f32 v148, v148, v101
    v_fmac_f32 v149, v101, v101
    v_fmac_f32 v150, v101, v229
    v_add_f32 v148, v148, v102
    v_fmac_f32 v149, v102, v102
    v_fmac_f32 v150, v102, v230
    v_add_f32 v148, v148, v103
    v_fmac_f32 v149, v103, v103
    v_fmac_f32 v150, v103, v231
    v_add_f32 v148, v148, v104
    v_fmac_f32 v149, v104, v104
    s_waitcnt lgkmcnt(2)
    v_fmac_f32 v150, v104, v232
    v_add_f32 v148, v148, v105
    v_fmac_f32 v149, v105, v105
    v_fmac_f32 v150, v105, v233
    v_add_f32 v148, v148, v106
    v_fmac_f32 v149, v106, v106
    v_fmac_f32 v150, v106, v234
    v_add_f32 v148, v148, v107
    v_fmac_f32 v149, v107, v107
    v_fmac_f32 v150, v107, v235
    v_add_f32 v148, v148, v108
    v_fmac_f32 v149, v108, v108
    s_waitcnt lgkmcnt(1)
    v_fmac_f32 v150, v108, v236
    v_add_f32 v148, v148, v109
    v_fmac_f32 v149, v109, v109
    v_fmac_f32 v150, v109, v237
    v_add_f32 v148, v148, v110
    v_fmac_f32 v149, v110, v110
    v_fmac_f32 v150, v110, v238
    v_add_f32 v148, v148, v111
    v_fmac_f32 v149, v111, v111
    v_fmac_f32 v150, v111, v239
    v_add_f32 v148, v148, v112
    v_fmac_f32 v149, v112, v112
    s_waitcnt lgkmcnt(0)
    v_fmac_f32 v150, v112, v240
    v_add_f32 v148, v148, v113
    v_fmac_f32 v149, v113, v113
    v_fmac_f32 v150, v113, v241
    v_add_f32 v148, v148, v114
    v_fmac_f32 v149, v114, v114
    v_fmac_f32 v150, v114, v242
    v_add_f32 v148, v148, v115
    v_fmac_f32 v149, v115, v115
    v_fmac_f32 v150, v115, v243
    ds_write_b128 v2, v[148:151] offset:4096
    s_waitcnt lgkmcnt(0)
    s_barrier
    s_nop 7
    ds_read_b128 v[132:135], v2 offset:4096
    ds_read_b128 v[136:139], v2 offset:5120
    ds_read_b128 v[140:143], v2 offset:6144
    ds_read_b128 v[144:147], v2 offset:7168
    s_waitcnt lgkmcnt(2)
    v_add_f32 v30, v132, v136
    v_add_f32 v31, v133, v137
    v_add_f32 v29, v134, v138
    s_waitcnt lgkmcnt(0)
    v_add_f32 v140, v140, v144
    v_add_f32 v30, v30, v140
    v_mov_b32 v0, v30
    v_add_f32 v141, v141, v145
    v_add_f32 v31, v31, v141
    v_permlane32_swap_b32 v30, v0
    v_add_f32 v30, v30, v0
    v_mov_b32 v0, v31
    v_add_f32 v142, v142, v146
    v_add_f32 v29, v29, v142
    v_permlane32_swap_b32 v31, v0
    v_add_f32 v31, v31, v0
    v_mov_b32 v0, v29
    v_mul_f32 v31, s58, v31
    v_mul_f32 v30, s58, v30
    v_permlane32_swap_b32 v29, v0
    v_fma_f32 v31, -v30, v30, v31
    v_add_f32 v29, v29, v0
    v_max_f32 v31, 0, v31
    v_mov_b32 v0, s57
    v_fma_f32 v31, v31, v26, v0
    v_lshl_add_u32 v30, v17, 2, v13
    v_rsq_f32 v31, v31
    s_nop 0
    v_mul_f32 v29, v29, v31
    v_mul_f32 v29, v29, v25
    v_mul_f32 v29, s59, v29
    v_mov_b32 v0, v29
    s_nop 1
    v_max_f32_dpp v0, v0, v0 quad_perm:[1,0,3,2] row_mask:0xf bank_mask:0xf
    s_nop 1
    v_max_f32_dpp v0, v0, v0 quad_perm:[2,3,0,1] row_mask:0xf bank_mask:0xf
    s_nop 1
    v_max_f32_dpp v0, v0, v0 row_half_mirror row_mask:0xf bank_mask:0xf
    v_sub_f32 v29, v29, v0
    v_exp_f32 v29, v29
    s_nop 0
    v_mov_b32 v0, v29
    s_nop 1
    v_add_f32_dpp v0, v0, v0 quad_perm:[1,0,3,2] row_mask:0xf bank_mask:0xf
    s_nop 1
    v_add_f32_dpp v0, v0, v0 quad_perm:[2,3,0,1] row_mask:0xf bank_mask:0xf
    s_nop 1
    v_add_f32_dpp v0, v0, v0 row_half_mirror row_mask:0xf bank_mask:0xf
    v_rcp_f32 v0, v0
    s_nop 0
    v_mul_f32 v29, v29, v0
    v_mul_f32 v29, v29, v25
    v_mul_f32 v252, v252, v29
    v_mul_f32 v253, v253, v29
    v_mul_f32 v254, v254, v29
    v_mul_f32 v255, v255, v29
    v_add_f32_dpp v252, v252, v252 quad_perm:[1,0,3,2] row_mask:0xf bank_mask:0xf
    v_add_f32_dpp v253, v253, v253 quad_perm:[1,0,3,2] row_mask:0xf bank_mask:0xf
    v_add_f32_dpp v254, v254, v254 quad_perm:[1,0,3,2] row_mask:0xf bank_mask:0xf
    v_add_f32_dpp v255, v255, v255 quad_perm:[1,0,3,2] row_mask:0xf bank_mask:0xf
    v_cvt_pk_bf16_f32 v0, v29, v29
    ds_write_b16 v12, v0 offset:192
    v_add_f32_dpp v252, v252, v252 quad_perm:[2,3,0,1] row_mask:0xf bank_mask:0xf
    v_add_f32_dpp v253, v253, v253 quad_perm:[2,3,0,1] row_mask:0xf bank_mask:0xf
    v_add_f32_dpp v254, v254, v254 quad_perm:[2,3,0,1] row_mask:0xf bank_mask:0xf
    v_add_f32_dpp v255, v255, v255 quad_perm:[2,3,0,1] row_mask:0xf bank_mask:0xf
    ds_read_b128 v[236:239], v13 offset:192
    ds_read_b128 v[240:243], v13 offset:208
    v_add_f32_dpp v252, v252, v252 row_half_mirror row_mask:0xf bank_mask:0xf
    v_add_f32_dpp v253, v253, v253 row_half_mirror row_mask:0xf bank_mask:0xf
    v_add_f32_dpp v254, v254, v254 row_half_mirror row_mask:0xf bank_mask:0xf
    v_add_f32_dpp v255, v255, v255 row_half_mirror row_mask:0xf bank_mask:0xf
    v_cvt_pk_bf16_f32 v0, v252, v253
    v_cvt_pk_bf16_f32 v1, v254, v255
    ds_write_b64 v30, v[0:1] offset:128
    ds_read_b128 v[228:231], v13 offset:128
    ds_read_b128 v[232:235], v13 offset:144
    s_waitcnt lgkmcnt(4)
    v_dot2_f32_bf16 v84, v196, v236, 0
    s_waitcnt lgkmcnt(3)
    v_dot2_f32_bf16 v86, v200, v240, 0
    v_dot2_f32_bf16 v85, v198, v238, 0
    v_dot2_f32_bf16 v87, v202, v242, 0
    v_dot2c_f32_bf16 v84, v197, v237
    v_dot2c_f32_bf16 v86, v201, v241
    v_dot2c_f32_bf16 v85, v199, v239
    v_dot2c_f32_bf16 v87, v203, v243
    s_waitcnt lgkmcnt(1)
    v_dot2c_f32_bf16 v84, v156, v228
    s_waitcnt lgkmcnt(0)
    v_dot2c_f32_bf16 v86, v160, v232
    v_dot2c_f32_bf16 v84, v157, v229
    v_dot2c_f32_bf16 v85, v158, v230
    v_dot2c_f32_bf16 v86, v161, v233
    v_dot2c_f32_bf16 v87, v162, v234
    v_dot2c_f32_bf16 v85, v159, v231
    v_dot2c_f32_bf16 v87, v163, v235
    v_permlane32_swap_b32 v84, v86
    v_add_f32 v84, v84, v86
    s_nop 0
    v_permlane32_swap_b32 v85, v87
    v_cvt_pk_bf16_f32 v84, v84, v84
    v_add_f32 v85, v85, v87
    buffer_store_short v84, v18, s[24:27], s42 offen offset:0
    v_cvt_pk_bf16_f32 v85, v85, v85
    buffer_store_short v85, v18, s[24:27], s42 offen offset:256
    s_endpgm
tf_c1:
    s_cmp_lg_u32 s6, 1
    s_cbranch_scc1 tf_c2
    s_nop 7
    s_nop 7
    ds_read_b128 v[32:35], v72
    ds_read_b128 v[36:39], v73
    v_mov_b32 v0, v30
    ds_read_b128 v[40:43], v74
    ds_read_b128 v[44:47], v75
    v_permlane32_swap_b32 v30, v0
    v_add_f32 v30, v30, v0
    v_mov_b32 v0, v31
    v_mul_f32 v30, s58, v30
    ds_read_b128 v[48:51], v76
    v_permlane32_swap_b32 v31, v0
    v_add_f32 v31, v31, v0
    v_mov_b32 v0, v29
    v_mul_f32 v31, s58, v31
    ds_read_b128 v[52:55], v77
    v_permlane32_swap_b32 v29, v0
    v_fma_f32 v31, -v30, v30, v31
    v_add_f32 v29, v29, v0
    v_max_f32 v31, 0, v31
    v_mov_b32 v0, s57
    v_fma_f32 v31, v31, v26, v0
    ds_read_b128 v[56:59], v78
    v_rsq_f32 v31, v31
    s_nop 0
    v_mul_f32 v29, v29, v31
    ds_read_b128 v[60:63], v79
    v_mul_f32 v29, v29, v25
    v_lshl_add_u32 v30, v17, 2, v13
    v_mul_f32 v29, s59, v29
    v_mov_b32 v0, v29
    v_lshlrev_b32 v22, 16, v19
    v_cndmask_b32_e64 v22, v22, 1.0, s[54:55]
    v_max_f32_dpp v0, v0, v0 quad_perm:[1,0,3,2] row_mask:0xf bank_mask:0xf
    s_waitcnt lgkmcnt(7)
    v_mfma_f32_32x32x16_bf16 v[100:115], a[32:35], v[32:35], 0
    v_max_f32_dpp v0, v0, v0 quad_perm:[2,3,0,1] row_mask:0xf bank_mask:0xf
    v_cmp_eq_f32_e64 s[62:63], 0, v22
    s_nop 0
    v_max_f32_dpp v0, v0, v0 row_half_mirror row_mask:0xf bank_mask:0xf
    v_sub_f32 v29, v29, v0
    v_cndmask_b32_e64 v22, v22, 1.0, s[62:63]
    v_exp_f32 v29, v29
    s_waitcnt lgkmcnt(6)
    v_mfma_f32_32x32x16_bf16 v[100:115], a[36:39], v[36:39], v[100:115]
    v_mov_b32 v0, v29
    v_add_f32 v245, v245, v247
    v_add_f32 v244, v244, v246
    v_add_f32_dpp v0, v0, v0 quad_perm:[1,0,3,2] row_mask:0xf bank_mask:0xf
    v_mul_f32 v245, s58, v245
    v_rcp_f32 v23, v22
    s_waitcnt lgkmcnt(5)
    v_mfma_f32_32x32x16_bf16 v[100:115], a[40:43], v[40:43], v[100:115]
    v_add_f32_dpp v0, v0, v0 quad_perm:[2,3,0,1] row_mask:0xf bank_mask:0xf
    v_mul_f32 v244, s58, v244
    v_fma_f32 v245, -v244, v244, v245
    v_add_f32_dpp v0, v0, v0 row_half_mirror row_mask:0xf bank_mask:0xf
    v_rcp_f32 v0, v0
    s_nop 0
    v_mul_f32 v29, v29, v0
    s_waitcnt lgkmcnt(4)
    v_mfma_f32_32x32x16_bf16 v[100:115], a[44:47], v[44:47], v[100:115]
    v_mul_f32 v29, v29, v25
    v_mul_f32 v252, v252, v29
    v_mul_f32 v253, v253, v29
    v_mul_f32 v254, v254, v29
    v_mul_f32 v255, v255, v29
    v_add_f32_dpp v252, v252, v252 quad_perm:[1,0,3,2] row_mask:0xf bank_mask:0xf
    v_add_f32_dpp v253, v253, v253 quad_perm:[1,0,3,2] row_mask:0xf bank_mask:0xf
    v_add_f32_dpp v254, v254, v254 quad_perm:[1,0,3,2] row_mask:0xf bank_mask:0xf
    v_mfma_f32_32x32x16_bf16 v[116:131], v[32:35], a[160:163], 0
    v_add_f32_dpp v255, v255, v255 quad_perm:[1,0,3,2] row_mask:0xf bank_mask:0xf
    v_cvt_pk_bf16_f32 v0, v29, v29
    ds_write_b16 v12, v0 offset:192
    v_add_f32_dpp v252, v252, v252 quad_perm:[2,3,0,1] row_mask:0xf bank_mask:0xf
    v_add_f32_dpp v253, v253, v253 quad_perm:[2,3,0,1] row_mask:0xf bank_mask:0xf
    v_add_f32_dpp v254, v254, v254 quad_perm:[2,3,0,1] row_mask:0xf bank_mask:0xf
    s_waitcnt lgkmcnt(4)
    v_mfma_f32_32x32x16_bf16 v[100:115], a[48:51], v[48:51], v[100:115]
    v_add_f32_dpp v255, v255, v255 quad_perm:[2,3,0,1] row_mask:0xf bank_mask:0xf
    ds_read_b128 v[236:239], v13 offset:192
    ds_read_b128 v[240:243], v13 offset:208
    v_add_f32_dpp v252, v252, v252 row_half_mirror row_mask:0xf bank_mask:0xf
    v_add_f32_dpp v253, v253, v253 row_half_mirror row_mask:0xf bank_mask:0xf
    v_add_f32_dpp v254, v254, v254 row_half_mirror row_mask:0xf bank_mask:0xf
    v_mfma_f32_32x32x16_bf16 v[116:131], v[36:39], a[164:167], v[116:131]
    v_add_f32_dpp v255, v255, v255 row_half_mirror row_mask:0xf bank_mask:0xf
    v_cvt_pk_bf16_f32 v0, v252, v253
    v_cvt_pk_bf16_f32 v1, v254, v255
    ds_write_b64 v30, v[0:1] offset:128
    ds_read_b128 v[228:231], v13 offset:128
    ds_read_b128 v[232:235], v13 offset:144
    s_waitcnt lgkmcnt(8)
    v_mfma_f32_32x32x16_bf16 v[100:115], a[52:55], v[52:55], v[100:115]
    v_max_f32 v245, 0, v245
    v_mul_f32 v24, v23, v23
    v_mov_b32 v244, s57
    v_fma_f32 v245, v245, v24, v244
    v_mov_b32 v25, v23
    v_rsq_f32 v245, v245
    v_mfma_f32_32x32x16_bf16 v[116:131], v[40:43], a[168:171], v[116:131]
    v_mul_f32 v27, v245, v23
    ds_write_b32 v10, v27
    ds_read_b128 v[248:251], v11
    v_mov_b32 v26, v24
    s_waitcnt lgkmcnt(9)
    v_mfma_f32_32x32x16_bf16 v[100:115], a[56:59], v[56:59], v[100:115]
    s_waitcnt lgkmcnt(6)
    v_dot2_f32_bf16 v84, v196, v236, 0
    s_waitcnt lgkmcnt(5)
    v_dot2_f32_bf16 v86, v200, v240, 0
    v_dot2_f32_bf16 v85, v198, v238, 0
    v_dot2_f32_bf16 v87, v202, v242, 0
    v_dot2_f32_bf16 v88, v204, v236, 0
    v_mfma_f32_32x32x16_bf16 v[116:131], v[44:47], a[172:175], v[116:131]
    v_dot2_f32_bf16 v90, v208, v240, 0
    v_dot2c_f32_bf16 v84, v197, v237
    v_dot2c_f32_bf16 v86, v201, v241
    v_dot2_f32_bf16 v89, v206, v238, 0
    v_dot2_f32_bf16 v91, v210, v242, 0
    s_waitcnt lgkmcnt(3)
    v_dot2c_f32_bf16 v84, v156, v228
    v_mfma_f32_32x32x16_bf16 v[100:115], a[60:63], v[60:63], v[100:115]
    v_dot2c_f32_bf16 v85, v199, v239
    s_waitcnt lgkmcnt(2)
    v_dot2c_f32_bf16 v86, v160, v232
    v_dot2c_f32_bf16 v87, v203, v243
    v_dot2_f32_bf16 v92, v212, v236, 0
    v_dot2_f32_bf16 v94, v216, v240, 0
    v_dot2c_f32_bf16 v84, v157, v229
    v_mfma_f32_32x32x16_bf16 v[116:131], v[48:51], a[176:179], v[116:131]
    v_dot2c_f32_bf16 v85, v158, v230
    v_dot2c_f32_bf16 v86, v161, v233
    v_dot2c_f32_bf16 v87, v162, v234
    v_dot2c_f32_bf16 v88, v205, v237
    v_dot2c_f32_bf16 v90, v209, v241
    v_dot2_f32_bf16 v93, v214, v238, 0
    v_mfma_f32_32x32x16_bf16 v[116:131], v[52:55], a[180:183], v[116:131]
    v_cvt_pk_bf16_f32 v148, v100, v101
    v_cvt_pk_bf16_f32 v149, v102, v103
    v_cvt_pk_bf16_f32 v150, v104, v105
    v_cvt_pk_bf16_f32 v151, v106, v107
    v_dot2_f32_bf16 v95, v218, v242, 0
    v_cvt_pk_bf16_f32 v152, v108, v109
    v_mfma_f32_32x32x16_bf16 v[132:147], v[40:43], v[148:151], 0
    v_cvt_pk_bf16_f32 v153, v110, v111
    v_cvt_pk_bf16_f32 v154, v112, v113
    v_cvt_pk_bf16_f32 v155, v114, v115
    v_dot2c_f32_bf16 v85, v159, v231
    v_dot2c_f32_bf16 v87, v163, v235
    v_dot2c_f32_bf16 v88, v164, v228
    v_mfma_f32_32x32x16_bf16 v[116:131], v[56:59], a[184:187], v[116:131]
    v_dot2c_f32_bf16 v89, v207, v239
    v_dot2c_f32_bf16 v90, v168, v232
    v_dot2c_f32_bf16 v91, v211, v243
    v_dot2_f32_bf16 v96, v220, v236, 0
    v_dot2_f32_bf16 v98, v224, v240, 0
    v_dot2c_f32_bf16 v88, v165, v229
    v_mfma_f32_32x32x16_bf16 v[132:147], v[44:47], v[152:155], v[132:147]
    v_dot2c_f32_bf16 v89, v166, v230
    v_dot2c_f32_bf16 v90, v169, v233
    v_dot2c_f32_bf16 v91, v170, v234
    v_dot2c_f32_bf16 v92, v213, v237
    v_dot2c_f32_bf16 v94, v217, v241
    v_dot2_f32_bf16 v97, v222, v238, 0
    v_mfma_f32_32x32x16_bf16 v[116:131], v[60:63], a[188:191], v[116:131]
    v_dot2_f32_bf16 v99, v226, v242, 0
    v_permlane32_swap_b32 v84, v86
    v_dot2c_f32_bf16 v89, v167, v231
    v_dot2c_f32_bf16 v91, v171, v235
    v_dot2c_f32_bf16 v92, v172, v228
    v_dot2c_f32_bf16 v93, v215, v239
    v_dot2c_f32_bf16 v94, v176, v232
    v_dot2c_f32_bf16 v95, v219, v243
    v_permlane32_swap_b32 v85, v87
    v_dot2c_f32_bf16 v92, v173, v229
    v_dot2c_f32_bf16 v93, v174, v230
    v_dot2c_f32_bf16 v94, v177, v233
    v_dot2c_f32_bf16 v95, v178, v234
    v_dot2c_f32_bf16 v96, v221, v237
    v_dot2c_f32_bf16 v98, v225, v241
    v_add_f32 v84, v84, v86
    v_permlane32_swap_b32 v88, v90
    v_dot2c_f32_bf16 v93, v175, v231
    v_dot2c_f32_bf16 v95, v179, v235
    v_dot2c_f32_bf16 v96, v180, v228
    v_dot2c_f32_bf16 v97, v223, v239
    v_dot2c_f32_bf16 v98, v184, v232
    v_dot2c_f32_bf16 v99, v227, v243
    v_cvt_pk_bf16_f32 v84, v84, v84
    v_add_f32 v85, v85, v87
    v_permlane32_swap_b32 v89, v91
    v_dot2c_f32_bf16 v96, v181, v229
    v_dot2c_f32_bf16 v97, v182, v230
    v_dot2c_f32_bf16 v98, v185, v233
    v_dot2c_f32_bf16 v99, v186, v234
    buffer_store_short v84, v18, s[24:27], s42 offen offset:0
    v_cvt_pk_bf16_f32 v85, v85, v85
    v_add_f32 v88, v88, v90
    v_permlane32_swap_b32 v92, v94
    v_dot2c_f32_bf16 v97, v183, v231
    v_dot2c_f32_bf16 v99, v187, v235
    buffer_store_short v85, v18, s[24:27], s42 offen offset:256
    v_cvt_pk_bf16_f32 v88, v88, v88
    v_add_f32 v89, v89, v91
    v_permlane32_swap_b32 v93, v95
    buffer_store_short v88, v18, s[24:27], s42 offen offset:64
    v_cvt_pk_bf16_f32 v89, v89, v89
    v_add_f32 v92, v92, v94
    v_permlane32_swap_b32 v96, v98
    buffer_store_short v89, v18, s[24:27], s42 offen offset:320
    v_cvt_pk_bf16_f32 v92, v92, v92
    v_add_f32 v93, v93, v95
    v_permlane32_swap_b32 v97, v99
    buffer_store_short v92, v18, s[24:27], s42 offen offset:128
    v_cvt_pk_bf16_f32 v93, v93, v93
    v_add_f32 v96, v96, v98
    v_cndmask_b32_e64 v152, v132, v136, s[46:47]
    v_cndmask_b32_e64 v153, v133, v137, s[46:47]
    v_cndmask_b32_e64 v154, v134, v138, s[46:47]
    v_cndmask_b32_e64 v155, v135, v139, s[46:47]
    buffer_store_short v93, v18, s[24:27], s42 offen offset:384
    v_cvt_pk_bf16_f32 v96, v96, v96
    v_add_f32 v97, v97, v99
    v_cndmask_b32_e64 v152, v152, v140, s[48:49]
    v_cndmask_b32_e64 v153, v153, v141, s[48:49]
    v_cndmask_b32_e64 v154, v154, v142, s[48:49]
    v_cndmask_b32_e64 v155, v155, v143, s[48:49]
    buffer_store_short v96, v18, s[24:27], s42 offen offset:192
    v_cvt_pk_bf16_f32 v97, v97, v97
    v_cndmask_b32_e64 v152, v152, v144, s[50:51]
    v_cndmask_b32_e64 v153, v153, v145, s[50:51]
    v_cndmask_b32_e64 v154, v154, v146, s[50:51]
    v_cndmask_b32_e64 v155, v155, v147, s[50:51]
    buffer_store_short v97, v18, s[24:27], s42 offen offset:448
    ds_write_b128 v2, v[152:155] offset:1024
    v_cvt_pk_bf16_f32 v164, v116, v117
    v_cvt_pk_bf16_f32 v165, v118, v119
    v_cvt_pk_bf16_f32 v166, v120, v121
    v_cvt_pk_bf16_f32 v167, v122, v123
    v_cvt_pk_bf16_f32 v168, v124, v125
    v_cvt_pk_bf16_f32 v169, v126, v127
    v_cvt_pk_bf16_f32 v170, v128, v129
    v_cvt_pk_bf16_f32 v171, v130, v131
    ds_read_b64_tr_b16 v[204:205], v5 offset:0
    ds_read_b64_tr_b16 v[206:207], v7 offset:256
    ds_read_b64_tr_b16 v[208:209], v5 offset:512
    ds_read_b64_tr_b16 v[210:211], v7 offset:768
    s_lshl_b32 s42, s61, 10
    v_mov_b32 v18, v16
    s_waitcnt lgkmcnt(0)
    s_barrier
    ds_read_b128 v[132:135], v2 offset:0
    ds_read_b128 v[136:139], v2 offset:1024
    ds_read_b128 v[140:143], v2 offset:2048
    ds_read_b128 v[144:147], v2 offset:3072
    ds_read_b128 v[228:231], v15 offset:64
    v_lshlrev_b32 v100, 16, v40
    v_lshlrev_b32 v102, 16, v41
    v_lshlrev_b32 v104, 16, v42
    v_lshlrev_b32 v106, 16, v43
    v_lshlrev_b32 v108, 16, v44
    v_lshlrev_b32 v110, 16, v45
    v_lshlrev_b32 v112, 16, v46
    v_lshlrev_b32 v114, 16, v47
    v_and_b32 v101, s60, v40
    v_and_b32 v103, s60, v41
    v_and_b32 v105, s60, v42
    v_and_b32 v107, s60, v43
    v_and_b32 v109, s60, v44
    v_and_b32 v111, s60, v45
    v_and_b32 v113, s60, v46
    v_and_b32 v115, s60, v47
    ds_read_b128 v[232:235], v15 offset:80
    ds_read_b128 v[236:239], v15 offset:96
    ds_read_b128 v[240:243], v15 offset:112
    v_mov_b32 v148, 0
    v_mov_b32 v149, 0
    v_mov_b32 v150, 0
    v_mov_b32 v151, 0
    s_waitcnt lgkmcnt(6)
    v_add_f32 v252, v132, v136
    v_add_f32 v253, v133, v137
    v_add_f32 v254, v134, v138
    s_waitcnt lgkmcnt(4)
    v_add_f32 v140, v140, v144
    v_add_f32 v141, v141, v145
    v_add_f32 v252, v252, v140
    v_add_f32 v253, v253, v141
    v_add_f32 v255, v135, v139
    v_add_f32 v142, v142, v146
    v_add_f32 v143, v143, v147
    v_mul_f32 v252, v252, v248
    v_mul_f32 v253, v253, v249
    v_add_f32 v254, v254, v142
    v_add_f32 v255, v255, v143
    v_mul_f32 v252, v252, v27
    v_mul_f32 v253, v253, v27
    v_mul_f32 v254, v254, v250
    v_mul_f32 v255, v255, v251
    v_max_f32 v28, v252, v253
    v_mul_f32 v254, v254, v27
    v_mul_f32 v255, v255, v27
    v_max3_f32 v28, v28, v254, v255
    v_mov_b32 v20, v28
    s_nop 1
    v_permlane32_swap_b32 v28, v20
    v_max_f32 v28, v28, v20
    v_sub_f32 v252, v252, v28
    v_sub_f32 v253, v253, v28
    v_sub_f32 v254, v254, v28
    v_sub_f32 v255, v255, v28
    v_exp_f32 v252, v252
    v_exp_f32 v253, v253
    v_exp_f32 v254, v254
    v_exp_f32 v255, v255
    v_add_f32 v28, v252, v253
    v_add_f32 v20, v254, v255
    v_add_f32 v28, v28, v20
    v_mov_b32 v20, v28
    v_mul_f32 v252, v252, v248
    v_mul_f32 v253, v253, v249
    v_permlane32_swap_b32 v28, v20
    v_add_f32 v28, v28, v20
    v_mul_f32 v254, v254, v250
    v_rcp_f32 v28, v28
    v_mul_f32 v255, v255, v251
    v_mul_f32 v28, v28, v22
    v_mul_f32 v252, v252, v28
    v_mul_f32 v253, v253, v28
    v_mul_f32 v254, v254, v28
    v_mul_f32 v255, v255, v28
    v_cvt_pk_bf16_f32 v28, v252, v253
    v_cvt_pk_bf16_f32 v20, v254, v255
    v_cndmask_b32_e64 v188, 0, v28, s[52:53]
    v_cndmask_b32_e64 v189, 0, v20, s[52:53]
    v_cndmask_b32_e64 v190, 0, v28, s[46:47]
    v_cndmask_b32_e64 v191, 0, v20, s[46:47]
    v_cndmask_b32_e64 v192, 0, v28, s[48:49]
    s_nop 0
    v_mfma_f32_32x32x16_bf16 v[100:115], v[164:167], v[188:191], v[100:115]
    v_cndmask_b32_e64 v193, 0, v20, s[48:49]
    v_cndmask_b32_e64 v194, 0, v28, s[50:51]
    v_cndmask_b32_e64 v195, 0, v20, s[50:51]
    s_nop 1
    v_mfma_f32_32x32x16_bf16 v[100:115], v[168:171], v[192:195], v[100:115]
    s_nop 11
    v_add_f32 v148, v148, v100
    v_fmac_f32 v149, v100, v100
    s_waitcnt lgkmcnt(3)
    v_fmac_f32 v150, v100, v228
    v_add_f32 v148, v148, v101
    v_fmac_f32 v149, v101, v101
    v_fmac_f32 v150, v101, v229
    v_add_f32 v148, v148, v102
    v_fmac_f32 v149, v102, v102
    v_fmac_f32 v150, v102, v230
    v_add_f32 v148, v148, v103
    v_fmac_f32 v149, v103, v103
    v_fmac_f32 v150, v103, v231
    v_add_f32 v148, v148, v104
    v_fmac_f32 v149, v104, v104
    s_waitcnt lgkmcnt(2)
    v_fmac_f32 v150, v104, v232
    v_add_f32 v148, v148, v105
    v_fmac_f32 v149, v105, v105
    v_fmac_f32 v150, v105, v233
    v_add_f32 v148, v148, v106
    v_fmac_f32 v149, v106, v106
    v_fmac_f32 v150, v106, v234
    v_add_f32 v148, v148, v107
    v_fmac_f32 v149, v107, v107
    v_fmac_f32 v150, v107, v235
    v_add_f32 v148, v148, v108
    v_fmac_f32 v149, v108, v108
    s_waitcnt lgkmcnt(1)
    v_fmac_f32 v150, v108, v236
    v_add_f32 v148, v148, v109
    v_fmac_f32 v149, v109, v109
    v_fmac_f32 v150, v109, v237
    v_add_f32 v148, v148, v110
    v_fmac_f32 v149, v110, v110
    v_fmac_f32 v150, v110, v238
    v_add_f32 v148, v148, v111
    v_fmac_f32 v149, v111, v111
    v_fmac_f32 v150, v111, v239
    v_add_f32 v148, v148, v112
    v_fmac_f32 v149, v112, v112
    s_waitcnt lgkmcnt(0)
    v_fmac_f32 v150, v112, v240
    v_add_f32 v148, v148, v113
    v_fmac_f32 v149, v113, v113
    v_fmac_f32 v150, v113, v241
    v_add_f32 v148, v148, v114
    v_fmac_f32 v149, v114, v114
    v_fmac_f32 v150, v114, v242
    v_add_f32 v148, v148, v115
    v_fmac_f32 v149, v115, v115
    v_fmac_f32 v150, v115, v243
    ds_write_b128 v2, v[148:151] offset:5120
    s_waitcnt lgkmcnt(0)
    s_barrier
    s_nop 7
    ds_read_b128 v[132:135], v2 offset:4096
    ds_read_b128 v[136:139], v2 offset:5120
    ds_read_b128 v[140:143], v2 offset:6144
    ds_read_b128 v[144:147], v2 offset:7168
    s_waitcnt lgkmcnt(2)
    v_add_f32 v30, v132, v136
    v_add_f32 v31, v133, v137
    v_add_f32 v29, v134, v138
    s_waitcnt lgkmcnt(0)
    v_add_f32 v140, v140, v144
    v_add_f32 v30, v30, v140
    v_mov_b32 v0, v30
    v_add_f32 v141, v141, v145
    v_add_f32 v31, v31, v141
    v_permlane32_swap_b32 v30, v0
    v_add_f32 v30, v30, v0
    v_mov_b32 v0, v31
    v_add_f32 v142, v142, v146
    v_add_f32 v29, v29, v142
    v_permlane32_swap_b32 v31, v0
    v_add_f32 v31, v31, v0
    v_mov_b32 v0, v29
    v_mul_f32 v31, s58, v31
    v_mul_f32 v30, s58, v30
    v_permlane32_swap_b32 v29, v0
    v_fma_f32 v31, -v30, v30, v31
    v_add_f32 v29, v29, v0
    v_max_f32 v31, 0, v31
    v_mov_b32 v0, s57
    v_fma_f32 v31, v31, v26, v0
    v_lshl_add_u32 v30, v17, 2, v13
    v_rsq_f32 v31, v31
    s_nop 0
    v_mul_f32 v29, v29, v31
    v_mul_f32 v29, v29, v25
    v_mul_f32 v29, s59, v29
    v_mov_b32 v0, v29
    s_nop 1
    v_max_f32_dpp v0, v0, v0 quad_perm:[1,0,3,2] row_mask:0xf bank_mask:0xf
    s_nop 1
    v_max_f32_dpp v0, v0, v0 quad_perm:[2,3,0,1] row_mask:0xf bank_mask:0xf
    s_nop 1
    v_max_f32_dpp v0, v0, v0 row_half_mirror row_mask:0xf bank_mask:0xf
    v_sub_f32 v29, v29, v0
    v_exp_f32 v29, v29
    s_nop 0
    v_mov_b32 v0, v29
    s_nop 1
    v_add_f32_dpp v0, v0, v0 quad_perm:[1,0,3,2] row_mask:0xf bank_mask:0xf
    s_nop 1
    v_add_f32_dpp v0, v0, v0 quad_perm:[2,3,0,1] row_mask:0xf bank_mask:0xf
    s_nop 1
    v_add_f32_dpp v0, v0, v0 row_half_mirror row_mask:0xf bank_mask:0xf
    v_rcp_f32 v0, v0
    s_nop 0
    v_mul_f32 v29, v29, v0
    v_mul_f32 v29, v29, v25
    v_mul_f32 v252, v252, v29
    v_mul_f32 v253, v253, v29
    v_mul_f32 v254, v254, v29
    v_mul_f32 v255, v255, v29
    v_add_f32_dpp v252, v252, v252 quad_perm:[1,0,3,2] row_mask:0xf bank_mask:0xf
    v_add_f32_dpp v253, v253, v253 quad_perm:[1,0,3,2] row_mask:0xf bank_mask:0xf
    v_add_f32_dpp v254, v254, v254 quad_perm:[1,0,3,2] row_mask:0xf bank_mask:0xf
    v_add_f32_dpp v255, v255, v255 quad_perm:[1,0,3,2] row_mask:0xf bank_mask:0xf
    v_cvt_pk_bf16_f32 v0, v29, v29
    ds_write_b16 v12, v0 offset:192
    v_add_f32_dpp v252, v252, v252 quad_perm:[2,3,0,1] row_mask:0xf bank_mask:0xf
    v_add_f32_dpp v253, v253, v253 quad_perm:[2,3,0,1] row_mask:0xf bank_mask:0xf
    v_add_f32_dpp v254, v254, v254 quad_perm:[2,3,0,1] row_mask:0xf bank_mask:0xf
    v_add_f32_dpp v255, v255, v255 quad_perm:[2,3,0,1] row_mask:0xf bank_mask:0xf
    ds_read_b128 v[236:239], v13 offset:192
    ds_read_b128 v[240:243], v13 offset:208
    v_add_f32_dpp v252, v252, v252 row_half_mirror row_mask:0xf bank_mask:0xf
    v_add_f32_dpp v253, v253, v253 row_half_mirror row_mask:0xf bank_mask:0xf
    v_add_f32_dpp v254, v254, v254 row_half_mirror row_mask:0xf bank_mask:0xf
    v_add_f32_dpp v255, v255, v255 row_half_mirror row_mask:0xf bank_mask:0xf
    v_cvt_pk_bf16_f32 v0, v252, v253
    v_cvt_pk_bf16_f32 v1, v254, v255
    ds_write_b64 v30, v[0:1] offset:128
    ds_read_b128 v[228:231], v13 offset:128
    ds_read_b128 v[232:235], v13 offset:144
    s_waitcnt lgkmcnt(4)
    v_dot2_f32_bf16 v88, v204, v236, 0
    s_waitcnt lgkmcnt(3)
    v_dot2_f32_bf16 v90, v208, v240, 0
    v_dot2_f32_bf16 v89, v206, v238, 0
    v_dot2_f32_bf16 v91, v210, v242, 0
    v_dot2c_f32_bf16 v88, v205, v237
    v_dot2c_f32_bf16 v90, v209, v241
    v_dot2c_f32_bf16 v89, v207, v239
    v_dot2c_f32_bf16 v91, v211, v243
    s_waitcnt lgkmcnt(1)
    v_dot2c_f32_bf16 v88, v164, v228
    s_waitcnt lgkmcnt(0)
    v_dot2c_f32_bf16 v90, v168, v232
    v_dot2c_f32_bf16 v88, v165, v229
    v_dot2c_f32_bf16 v89, v166, v230
    v_dot2c_f32_bf16 v90, v169, v233
    v_dot2c_f32_bf16 v91, v170, v234
    v_dot2c_f32_bf16 v89, v167, v231
    v_dot2c_f32_bf16 v91, v171, v235
    v_permlane32_swap_b32 v88, v90
    v_add_f32 v88, v88, v90
    s_nop 0
    v_permlane32_swap_b32 v89, v91
    v_cvt_pk_bf16_f32 v88, v88, v88
    v_add_f32 v89, v89, v91
    buffer_store_short v88, v18, s[24:27], s42 offen offset:64
    v_cvt_pk_bf16_f32 v89, v89, v89
    buffer_store_short v89, v18, s[24:27], s42 offen offset:320
    s_endpgm
tf_c2:
    s_cmp_lg_u32 s6, 2
    s_cbranch_scc1 tf_c3
    s_nop 7
    s_nop 7
    ds_read_b128 v[32:35], v72
    ds_read_b128 v[36:39], v73
    v_mov_b32 v0, v30
    ds_read_b128 v[40:43], v74
    ds_read_b128 v[44:47], v75
    v_permlane32_swap_b32 v30, v0
    v_add_f32 v30, v30, v0
    v_mov_b32 v0, v31
    v_mul_f32 v30, s58, v30
    ds_read_b128 v[48:51], v76
    v_permlane32_swap_b32 v31, v0
    v_add_f32 v31, v31, v0
    v_mov_b32 v0, v29
    v_mul_f32 v31, s58, v31
    ds_read_b128 v[52:55], v77
    v_permlane32_swap_b32 v29, v0
    v_fma_f32 v31, -v30, v30, v31
    v_add_f32 v29, v29, v0
    v_max_f32 v31, 0, v31
    v_mov_b32 v0, s57
    v_fma_f32 v31, v31, v26, v0
    ds_read_b128 v[56:59], v78
    v_rsq_f32 v31, v31
    s_nop 0
    v_mul_f32 v29, v29, v31
    ds_read_b128 v[60:63], v79
    v_mul_f32 v29, v29, v25
    v_lshl_add_u32 v30, v17, 2, v13
    v_mul_f32 v29, s59, v29
    v_mov_b32 v0, v29
    v_lshlrev_b32 v22, 16, v19
    v_cndmask_b32_e64 v22, v22, 1.0, s[54:55]
    v_max_f32_dpp v0, v0, v0 quad_perm:[1,0,3,2] row_mask:0xf bank_mask:0xf
    s_waitcnt lgkmcnt(7)
    v_mfma_f32_32x32x16_bf16 v[100:115], a[64:67], v[32:35], 0
    v_max_f32_dpp v0, v0, v0 quad_perm:[2,3,0,1] row_mask:0xf bank_mask:0xf
    v_cmp_eq_f32_e64 s[62:63], 0, v22
    s_nop 0
    v_max_f32_dpp v0, v0, v0 row_half_mirror row_mask:0xf bank_mask:0xf
    v_sub_f32 v29, v29, v0
    v_cndmask_b32_e64 v22, v22, 1.0, s[62:63]
    v_exp_f32 v29, v29
    s_waitcnt lgkmcnt(6)
    v_mfma_f32_32x32x16_bf16 v[100:115], a[68:71], v[36:39], v[100:115]
    v_mov_b32 v0, v29
    v_add_f32 v245, v245, v247
    v_add_f32 v244, v244, v246
    v_add_f32_dpp v0, v0, v0 quad_perm:[1,0,3,2] row_mask:0xf bank_mask:0xf
    v_mul_f32 v245, s58, v245
    v_rcp_f32 v23, v22
    s_waitcnt lgkmcnt(5)
    v_mfma_f32_32x32x16_bf16 v[100:115], a[72:75], v[40:43], v[100:115]
    v_add_f32_dpp v0, v0, v0 quad_perm:[2,3,0,1] row_mask:0xf bank_mask:0xf
    v_mul_f32 v244, s58, v244
    v_fma_f32 v245, -v244, v244, v245
    v_add_f32_dpp v0, v0, v0 row_half_mirror row_mask:0xf bank_mask:0xf
    v_rcp_f32 v0, v0
    s_nop 0
    v_mul_f32 v29, v29, v0
    s_waitcnt lgkmcnt(4)
    v_mfma_f32_32x32x16_bf16 v[100:115], a[76:79], v[44:47], v[100:115]
    v_mul_f32 v29, v29, v25
    v_mul_f32 v252, v252, v29
    v_mul_f32 v253, v253, v29
    v_mul_f32 v254, v254, v29
    v_mul_f32 v255, v255, v29
    v_add_f32_dpp v252, v252, v252 quad_perm:[1,0,3,2] row_mask:0xf bank_mask:0xf
    v_add_f32_dpp v253, v253, v253 quad_perm:[1,0,3,2] row_mask:0xf bank_mask:0xf
    v_add_f32_dpp v254, v254, v254 quad_perm:[1,0,3,2] row_mask:0xf bank_mask:0xf
    v_mfma_f32_32x32x16_bf16 v[116:131], v[32:35], a[192:195], 0
    v_add_f32_dpp v255, v255, v255 quad_perm:[1,0,3,2] row_mask:0xf bank_mask:0xf
    v_cvt_pk_bf16_f32 v0, v29, v29
    ds_write_b16 v12, v0 offset:192
    v_add_f32_dpp v252, v252, v252 quad_perm:[2,3,0,1] row_mask:0xf bank_mask:0xf
    v_add_f32_dpp v253, v253, v253 quad_perm:[2,3,0,1] row_mask:0xf bank_mask:0xf
    v_add_f32_dpp v254, v254, v254 quad_perm:[2,3,0,1] row_mask:0xf bank_mask:0xf
    s_waitcnt lgkmcnt(4)
    v_mfma_f32_32x32x16_bf16 v[100:115], a[80:83], v[48:51], v[100:115]
    v_add_f32_dpp v255, v255, v255 quad_perm:[2,3,0,1] row_mask:0xf bank_mask:0xf
    ds_read_b128 v[236:239], v13 offset:192
    ds_read_b128 v[240:243], v13 offset:208
    v_add_f32_dpp v252, v252, v252 row_half_mirror row_mask:0xf bank_mask:0xf
    v_add_f32_dpp v253, v253, v253 row_half_mirror row_mask:0xf bank_mask:0xf
    v_add_f32_dpp v254, v254, v254 row_half_mirror row_mask:0xf bank_mask:0xf
    v_mfma_f32_32x32x16_bf16 v[116:131], v[36:39], a[196:199], v[116:131]
    v_add_f32_dpp v255, v255, v255 row_half_mirror row_mask:0xf bank_mask:0xf
    v_cvt_pk_bf16_f32 v0, v252, v253
    v_cvt_pk_bf16_f32 v1, v254, v255
    ds_write_b64 v30, v[0:1] offset:128
    ds_read_b128 v[228:231], v13 offset:128
    ds_read_b128 v[232:235], v13 offset:144
    s_waitcnt lgkmcnt(8)
    v_mfma_f32_32x32x16_bf16 v[100:115], a[84:87], v[52:55], v[100:115]
    v_max_f32 v245, 0, v245
    v_mul_f32 v24, v23, v23
    v_mov_b32 v244, s57
    v_fma_f32 v245, v245, v24, v244
    v_mov_b32 v25, v23
    v_rsq_f32 v245, v245
    v_mfma_f32_32x32x16_bf16 v[116:131], v[40:43], a[200:203], v[116:131]
    v_mul_f32 v27, v245, v23
    ds_write_b32 v10, v27
    ds_read_b128 v[248:251], v11
    v_mov_b32 v26, v24
    s_waitcnt lgkmcnt(9)
    v_mfma_f32_32x32x16_bf16 v[100:115], a[88:91], v[56:59], v[100:115]
    s_waitcnt lgkmcnt(6)
    v_dot2_f32_bf16 v84, v196, v236, 0
    s_waitcnt lgkmcnt(5)
    v_dot2_f32_bf16 v86, v200, v240, 0
    v_dot2_f32_bf16 v85, v198, v238, 0
    v_dot2_f32_bf16 v87, v202, v242, 0
    v_dot2_f32_bf16 v88, v204, v236, 0
    v_mfma_f32_32x32x16_bf16 v[116:131], v[44:47], a[204:207], v[116:131]
    v_dot2_f32_bf16 v90, v208, v240, 0
    v_dot2c_f32_bf16 v84, v197, v237
    v_dot2c_f32_bf16 v86, v201, v241
    v_dot2_f32_bf16 v89, v206, v238, 0
    v_dot2_f32_bf16 v91, v210, v242, 0
    s_waitcnt lgkmcnt(3)
    v_dot2c_f32_bf16 v84, v156, v228
    v_mfma_f32_32x32x16_bf16 v[100:115], a[92:95], v[60:63], v[100:115]
    v_dot2c_f32_bf16 v85, v199, v239
    s_waitcnt lgkmcnt(2)
    v_dot2c_f32_bf16 v86, v160, v232
    v_dot2c_f32_bf16 v87, v203, v243
    v_dot2_f32_bf16 v92, v212, v236, 0
    v_dot2_f32_bf16 v94, v216, v240, 0
    v_dot2c_f32_bf16 v84, v157, v229
    v_mfma_f32_32x32x16_bf16 v[116:131], v[48:51], a[208:211], v[116:131]
    v_dot2c_f32_bf16 v85, v158, v230
    v_dot2c_f32_bf16 v86, v161, v233
    v_dot2c_f32_bf16 v87, v162, v234
    v_dot2c_f32_bf16 v88, v205, v237
    v_dot2c_f32_bf16 v90, v209, v241
    v_dot2_f32_bf16 v93, v214, v238, 0
    v_mfma_f32_32x32x16_bf16 v[116:131], v[52:55], a[212:215], v[116:131]
    v_cvt_pk_bf16_f32 v148, v100, v101
    v_cvt_pk_bf16_f32 v149, v102, v103
    v_cvt_pk_bf16_f32 v150, v104, v105
    v_cvt_pk_bf16_f32 v151, v106, v107
    v_dot2_f32_bf16 v95, v218, v242, 0
    v_cvt_pk_bf16_f32 v152, v108, v109
    v_mfma_f32_32x32x16_bf16 v[132:147], v[48:51], v[148:151], 0
    v_cvt_pk_bf16_f32 v153, v110, v111
    v_cvt_pk_bf16_f32 v154, v112, v113
    v_cvt_pk_bf16_f32 v155, v114, v115
    v_dot2c_f32_bf16 v85, v159, v231
    v_dot2c_f32_bf16 v87, v163, v235
    v_dot2c_f32_bf16 v88, v164, v228
    v_mfma_f32_32x32x16_bf16 v[116:131], v[56:59], a[216:219], v[116:131]
    v_dot2c_f32_bf16 v89, v207, v239
    v_dot2c_f32_bf16 v90, v168, v232
    v_dot2c_f32_bf16 v91, v211, v243
    v_dot2_f32_bf16 v96, v220, v236, 0
    v_dot2_f32_bf16 v98, v224, v240, 0
    v_dot2c_f32_bf16 v88, v165, v229
    v_mfma_f32_32x32x16_bf16 v[132:147], v[52:55], v[152:155], v[132:147]
    v_dot2c_f32_bf16 v89, v166, v230
    v_dot2c_f32_bf16 v90, v169, v233
    v_dot2c_f32_bf16 v91, v170, v234
    v_dot2c_f32_bf16 v92, v213, v237
    v_dot2c_f32_bf16 v94, v217, v241
    v_dot2_f32_bf16 v97, v222, v238, 0
    v_mfma_f32_32x32x16_bf16 v[116:131], v[60:63], a[220:223], v[116:131]
    v_dot2_f32_bf16 v99, v226, v242, 0
    v_permlane32_swap_b32 v84, v86
    v_dot2c_f32_bf16 v89, v167, v231
    v_dot2c_f32_bf16 v91, v171, v235
    v_dot2c_f32_bf16 v92, v172, v228
    v_dot2c_f32_bf16 v93, v215, v239
    v_dot2c_f32_bf16 v94, v176, v232
    v_dot2c_f32_bf16 v95, v219, v243
    v_permlane32_swap_b32 v85, v87
    v_dot2c_f32_bf16 v92, v173, v229
    v_dot2c_f32_bf16 v93, v174, v230
    v_dot2c_f32_bf16 v94, v177, v233
    v_dot2c_f32_bf16 v95, v178, v234
    v_dot2c_f32_bf16 v96, v221, v237
    v_dot2c_f32_bf16 v98, v225, v241
    v_add_f32 v84, v84, v86
    v_permlane32_swap_b32 v88, v90
    v_dot2c_f32_bf16 v93, v175, v231
    v_dot2c_f32_bf16 v95, v179, v235
    v_dot2c_f32_bf16 v96, v180, v228
    v_dot2c_f32_bf16 v97, v223, v239
    v_dot2c_f32_bf16 v98, v184, v232
    v_dot2c_f32_bf16 v99, v227, v243
    v_cvt_pk_bf16_f32 v84, v84, v84
    v_add_f32 v85, v85, v87
    v_permlane32_swap_b32 v89, v91
    v_dot2c_f32_bf16 v96, v181, v229
    v_dot2c_f32_bf16 v97, v182, v230
    v_dot2c_f32_bf16 v98, v185, v233
    v_dot2c_f32_bf16 v99, v186, v234
    buffer_store_short v84, v18, s[24:27], s42 offen offset:0
    v_cvt_pk_bf16_f32 v85, v85, v85
    v_add_f32 v88, v88, v90
    v_permlane32_swap_b32 v92, v94
    v_dot2c_f32_bf16 v97, v183, v231
    v_dot2c_f32_bf16 v99, v187, v235
    buffer_store_short v85, v18, s[24:27], s42 offen offset:256
    v_cvt_pk_bf16_f32 v88, v88, v88
    v_add_f32 v89, v89, v91
    v_permlane32_swap_b32 v93, v95
    buffer_store_short v88, v18, s[24:27], s42 offen offset:64
    v_cvt_pk_bf16_f32 v89, v89, v89
    v_add_f32 v92, v92, v94
    v_permlane32_swap_b32 v96, v98
    buffer_store_short v89, v18, s[24:27], s42 offen offset:320
    v_cvt_pk_bf16_f32 v92, v92, v92
    v_add_f32 v93, v93, v95
    v_permlane32_swap_b32 v97, v99
    buffer_store_short v92, v18, s[24:27], s42 offen offset:128
    v_cvt_pk_bf16_f32 v93, v93, v93
    v_add_f32 v96, v96, v98
    v_cndmask_b32_e64 v152, v132, v136, s[46:47]
    v_cndmask_b32_e64 v153, v133, v137, s[46:47]
    v_cndmask_b32_e64 v154, v134, v138, s[46:47]
    v_cndmask_b32_e64 v155, v135, v139, s[46:47]
    buffer_store_short v93, v18, s[24:27], s42 offen offset:384
    v_cvt_pk_bf16_f32 v96, v96, v96
    v_add_f32 v97, v97, v99
    v_cndmask_b32_e64 v152, v152, v140, s[48:49]
    v_cndmask_b32_e64 v153, v153, v141, s[48:49]
    v_cndmask_b32_e64 v154, v154, v142, s[48:49]
    v_cndmask_b32_e64 v155, v155, v143, s[48:49]
    buffer_store_short v96, v18, s[24:27], s42 offen offset:192
    v_cvt_pk_bf16_f32 v97, v97, v97
    v_cndmask_b32_e64 v152, v152, v144, s[50:51]
    v_cndmask_b32_e64 v153, v153, v145, s[50:51]
    v_cndmask_b32_e64 v154, v154, v146, s[50:51]
    v_cndmask_b32_e64 v155, v155, v147, s[50:51]
    buffer_store_short v97, v18, s[24:27], s42 offen offset:448
    ds_write_b128 v2, v[152:155] offset:2048
    v_cvt_pk_bf16_f32 v172, v116, v117
    v_cvt_pk_bf16_f32 v173, v118, v119
    v_cvt_pk_bf16_f32 v174, v120, v121
    v_cvt_pk_bf16_f32 v175, v122, v123
    v_cvt_pk_bf16_f32 v176, v124, v125
    v_cvt_pk_bf16_f32 v177, v126, v127
    v_cvt_pk_bf16_f32 v178, v128, v129
    v_cvt_pk_bf16_f32 v179, v130, v131
    ds_read_b64_tr_b16 v[212:213], v6 offset:0
    ds_read_b64_tr_b16 v[214:215], v4 offset:256
    ds_read_b64_tr_b16 v[216:217], v6 offset:512
    ds_read_b64_tr_b16 v[218:219], v4 offset:768
    s_lshl_b32 s42, s61, 10
    v_mov_b32 v18, v16
    s_waitcnt lgkmcnt(0)
    s_barrier
    ds_read_b128 v[132:135], v2 offset:0
    ds_read_b128 v[136:139], v2 offset:1024
    ds_read_b128 v[140:143], v2 offset:2048
    ds_read_b128 v[144:147], v2 offset:3072
    ds_read_b128 v[228:231], v15 offset:128
    v_lshlrev_b32 v100, 16, v48
    v_lshlrev_b32 v102, 16, v49
    v_lshlrev_b32 v104, 16, v50
    v_lshlrev_b32 v106, 16, v51
    v_lshlrev_b32 v108, 16, v52
    v_lshlrev_b32 v110, 16, v53
    v_lshlrev_b32 v112, 16, v54
    v_lshlrev_b32 v114, 16, v55
    v_and_b32 v101, s60, v48
    v_and_b32 v103, s60, v49
    v_and_b32 v105, s60, v50
    v_and_b32 v107, s60, v51
    v_and_b32 v109, s60, v52
    v_and_b32 v111, s60, v53
    v_and_b32 v113, s60, v54
    v_and_b32 v115, s60, v55
    ds_read_b128 v[232:235], v15 offset:144
    ds_read_b128 v[236:239], v15 offset:160
    ds_read_b128 v[240:243], v15 offset:176
    v_mov_b32 v148, 0
    v_mov_b32 v149, 0
    v_mov_b32 v150, 0
    v_mov_b32 v151, 0
    s_waitcnt lgkmcnt(6)
    v_add_f32 v252, v132, v136
    v_add_f32 v253, v133, v137
    v_add_f32 v254, v134, v138
    s_waitcnt lgkmcnt(4)
    v_add_f32 v140, v140, v144
    v_add_f32 v141, v141, v145
    v_add_f32 v252, v252, v140
    v_add_f32 v253, v253, v141
    v_add_f32 v255, v135, v139
    v_add_f32 v142, v142, v146
    v_add_f32 v143, v143, v147
    v_mul_f32 v252, v252, v248
    v_mul_f32 v253, v253, v249
    v_add_f32 v254, v254, v142
    v_add_f32 v255, v255, v143
    v_mul_f32 v252, v252, v27
    v_mul_f32 v253, v253, v27
    v_mul_f32 v254, v254, v250
    v_mul_f32 v255, v255, v251
    v_max_f32 v28, v252, v253
    v_mul_f32 v254, v254, v27
    v_mul_f32 v255, v255, v27
    v_max3_f32 v28, v28, v254, v255
    v_mov_b32 v20, v28
    s_nop 1
    v_permlane32_swap_b32 v28, v20
    v_max_f32 v28, v28, v20
    v_sub_f32 v252, v252, v28
    v_sub_f32 v253, v253, v28
    v_sub_f32 v254, v254, v28
    v_sub_f32 v255, v255, v28
    v_exp_f32 v252, v252
    v_exp_f32 v253, v253
    v_exp_f32 v254, v254
    v_exp_f32 v255, v255
    v_add_f32 v28, v252, v253
    v_add_f32 v20, v254, v255
    v_add_f32 v28, v28, v20
    v_mov_b32 v20, v28
    v_mul_f32 v252, v252, v248
    v_mul_f32 v253, v253, v249
    v_permlane32_swap_b32 v28, v20
    v_add_f32 v28, v28, v20
    v_mul_f32 v254, v254, v250
    v_rcp_f32 v28, v28
    v_mul_f32 v255, v255, v251
    v_mul_f32 v28, v28, v22
    v_mul_f32 v252, v252, v28
    v_mul_f32 v253, v253, v28
    v_mul_f32 v254, v254, v28
    v_mul_f32 v255, v255, v28
    v_cvt_pk_bf16_f32 v28, v252, v253
    v_cvt_pk_bf16_f32 v20, v254, v255
    v_cndmask_b32_e64 v188, 0, v28, s[52:53]
    v_cndmask_b32_e64 v189, 0, v20, s[52:53]
    v_cndmask_b32_e64 v190, 0, v28, s[46:47]
    v_cndmask_b32_e64 v191, 0, v20, s[46:47]
    v_cndmask_b32_e64 v192, 0, v28, s[48:49]
    s_nop 0
    v_mfma_f32_32x32x16_bf16 v[100:115], v[172:175], v[188:191], v[100:115]
    v_cndmask_b32_e64 v193, 0, v20, s[48:49]
    v_cndmask_b32_e64 v194, 0, v28, s[50:51]
    v_cndmask_b32_e64 v195, 0, v20, s[50:51]
    s_nop 1
    v_mfma_f32_32x32x16_bf16 v[100:115], v[176:179], v[192:195], v[100:115]
    s_nop 11
    v_add_f32 v148, v148, v100
    v_fmac_f32 v149, v100, v100
    s_waitcnt lgkmcnt(3)
    v_fmac_f32 v150, v100, v228
    v_add_f32 v148, v148, v101
    v_fmac_f32 v149, v101, v101
    v_fmac_f32 v150, v101, v229
    v_add_f32 v148, v148, v102
    v_fmac_f32 v149, v102, v102
    v_fmac_f32 v150, v102, v230
    v_add_f32 v148, v148, v103
    v_fmac_f32 v149, v103, v103
    v_fmac_f32 v150, v103, v231
    v_add_f32 v148, v148, v104
    v_fmac_f32 v149, v104, v104
    s_waitcnt lgkmcnt(2)
    v_fmac_f32 v150, v104, v232
    v_add_f32 v148, v148, v105
    v_fmac_f32 v149, v105, v105
    v_fmac_f32 v150, v105, v233
    v_add_f32 v148, v148, v106
    v_fmac_f32 v149, v106, v106
    v_fmac_f32 v150, v106, v234
    v_add_f32 v148, v148, v107
    v_fmac_f32 v149, v107, v107
    v_fmac_f32 v150, v107, v235
    v_add_f32 v148, v148, v108
    v_fmac_f32 v149, v108, v108
    s_waitcnt lgkmcnt(1)
    v_fmac_f32 v150, v108, v236
    v_add_f32 v148, v148, v109
    v_fmac_f32 v149, v109, v109
    v_fmac_f32 v150, v109, v237
    v_add_f32 v148, v148, v110
    v_fmac_f32 v149, v110, v110
    v_fmac_f32 v150, v110, v238
    v_add_f32 v148, v148, v111
    v_fmac_f32 v149, v111, v111
    v_fmac_f32 v150, v111, v239
    v_add_f32 v148, v148, v112
    v_fmac_f32 v149, v112, v112
    s_waitcnt lgkmcnt(0)
    v_fmac_f32 v150, v112, v240
    v_add_f32 v148, v148, v113
    v_fmac_f32 v149, v113, v113
    v_fmac_f32 v150, v113, v241
    v_add_f32 v148, v148, v114
    v_fmac_f32 v149, v114, v114
    v_fmac_f32 v150, v114, v242
    v_add_f32 v148, v148, v115
    v_fmac_f32 v149, v115, v115
    v_fmac_f32 v150, v115, v243
    ds_write_b128 v2, v[148:151] offset:6144
    s_waitcnt lgkmcnt(0)
    s_barrier
    s_nop 7
    ds_read_b128 v[132:135], v2 offset:4096
    ds_read_b128 v[136:139], v2 offset:5120
    ds_read_b128 v[140:143], v2 offset:6144
    ds_read_b128 v[144:147], v2 offset:7168
    s_waitcnt lgkmcnt(2)
    v_add_f32 v30, v132, v136
    v_add_f32 v31, v133, v137
    v_add_f32 v29, v134, v138
    s_waitcnt lgkmcnt(0)
    v_add_f32 v140, v140, v144
    v_add_f32 v30, v30, v140
    v_mov_b32 v0, v30
    v_add_f32 v141, v141, v145
    v_add_f32 v31, v31, v141
    v_permlane32_swap_b32 v30, v0
    v_add_f32 v30, v30, v0
    v_mov_b32 v0, v31
    v_add_f32 v142, v142, v146
    v_add_f32 v29, v29, v142
    v_permlane32_swap_b32 v31, v0
    v_add_f32 v31, v31, v0
    v_mov_b32 v0, v29
    v_mul_f32 v31, s58, v31
    v_mul_f32 v30, s58, v30
    v_permlane32_swap_b32 v29, v0
    v_fma_f32 v31, -v30, v30, v31
    v_add_f32 v29, v29, v0
    v_max_f32 v31, 0, v31
    v_mov_b32 v0, s57
    v_fma_f32 v31, v31, v26, v0
    v_lshl_add_u32 v30, v17, 2, v13
    v_rsq_f32 v31, v31
    s_nop 0
    v_mul_f32 v29, v29, v31
    v_mul_f32 v29, v29, v25
    v_mul_f32 v29, s59, v29
    v_mov_b32 v0, v29
    s_nop 1
    v_max_f32_dpp v0, v0, v0 quad_perm:[1,0,3,2] row_mask:0xf bank_mask:0xf
    s_nop 1
    v_max_f32_dpp v0, v0, v0 quad_perm:[2,3,0,1] row_mask:0xf bank_mask:0xf
    s_nop 1
    v_max_f32_dpp v0, v0, v0 row_half_mirror row_mask:0xf bank_mask:0xf
    v_sub_f32 v29, v29, v0
    v_exp_f32 v29, v29
    s_nop 0
    v_mov_b32 v0, v29
    s_nop 1
    v_add_f32_dpp v0, v0, v0 quad_perm:[1,0,3,2] row_mask:0xf bank_mask:0xf
    s_nop 1
    v_add_f32_dpp v0, v0, v0 quad_perm:[2,3,0,1] row_mask:0xf bank_mask:0xf
    s_nop 1
    v_add_f32_dpp v0, v0, v0 row_half_mirror row_mask:0xf bank_mask:0xf
    v_rcp_f32 v0, v0
    s_nop 0
    v_mul_f32 v29, v29, v0
    v_mul_f32 v29, v29, v25
    v_mul_f32 v252, v252, v29
    v_mul_f32 v253, v253, v29
    v_mul_f32 v254, v254, v29
    v_mul_f32 v255, v255, v29
    v_add_f32_dpp v252, v252, v252 quad_perm:[1,0,3,2] row_mask:0xf bank_mask:0xf
    v_add_f32_dpp v253, v253, v253 quad_perm:[1,0,3,2] row_mask:0xf bank_mask:0xf
    v_add_f32_dpp v254, v254, v254 quad_perm:[1,0,3,2] row_mask:0xf bank_mask:0xf
    v_add_f32_dpp v255, v255, v255 quad_perm:[1,0,3,2] row_mask:0xf bank_mask:0xf
    v_cvt_pk_bf16_f32 v0, v29, v29
    ds_write_b16 v12, v0 offset:192
    v_add_f32_dpp v252, v252, v252 quad_perm:[2,3,0,1] row_mask:0xf bank_mask:0xf
    v_add_f32_dpp v253, v253, v253 quad_perm:[2,3,0,1] row_mask:0xf bank_mask:0xf
    v_add_f32_dpp v254, v254, v254 quad_perm:[2,3,0,1] row_mask:0xf bank_mask:0xf
    v_add_f32_dpp v255, v255, v255 quad_perm:[2,3,0,1] row_mask:0xf bank_mask:0xf
    ds_read_b128 v[236:239], v13 offset:192
    ds_read_b128 v[240:243], v13 offset:208
    v_add_f32_dpp v252, v252, v252 row_half_mirror row_mask:0xf bank_mask:0xf
    v_add_f32_dpp v253, v253, v253 row_half_mirror row_mask:0xf bank_mask:0xf
    v_add_f32_dpp v254, v254, v254 row_half_mirror row_mask:0xf bank_mask:0xf
    v_add_f32_dpp v255, v255, v255 row_half_mirror row_mask:0xf bank_mask:0xf
    v_cvt_pk_bf16_f32 v0, v252, v253
    v_cvt_pk_bf16_f32 v1, v254, v255
    ds_write_b64 v30, v[0:1] offset:128
    ds_read_b128 v[228:231], v13 offset:128
    ds_read_b128 v[232:235], v13 offset:144
    s_waitcnt lgkmcnt(4)
    v_dot2_f32_bf16 v92, v212, v236, 0
    s_waitcnt lgkmcnt(3)
    v_dot2_f32_bf16 v94, v216, v240, 0
    v_dot2_f32_bf16 v93, v214, v238, 0
    v_dot2_f32_bf16 v95, v218, v242, 0
    v_dot2c_f32_bf16 v92, v213, v237
    v_dot2c_f32_bf16 v94, v217, v241
    v_dot2c_f32_bf16 v93, v215, v239
    v_dot2c_f32_bf16 v95, v219, v243
    s_waitcnt lgkmcnt(1)
    v_dot2c_f32_bf16 v92, v172, v228
    s_waitcnt lgkmcnt(0)
    v_dot2c_f32_bf16 v94, v176, v232
    v_dot2c_f32_bf16 v92, v173, v229
    v_dot2c_f32_bf16 v93, v174, v230
    v_dot2c_f32_bf16 v94, v177, v233
    v_dot2c_f32_bf16 v95, v178, v234
    v_dot2c_f32_bf16 v93, v175, v231
    v_dot2c_f32_bf16 v95, v179, v235
    v_permlane32_swap_b32 v92, v94
    v_add_f32 v92, v92, v94
    s_nop 0
    v_permlane32_swap_b32 v93, v95
    v_cvt_pk_bf16_f32 v92, v92, v92
    v_add_f32 v93, v93, v95
    buffer_store_short v92, v18, s[24:27], s42 offen offset:128
    v_cvt_pk_bf16_f32 v93, v93, v93
    buffer_store_short v93, v18, s[24:27], s42 offen offset:384
    s_endpgm
tf_c3:
    s_nop 7
    s_nop 7
    ds_read_b128 v[32:35], v72
    ds_read_b128 v[36:39], v73
    v_mov_b32 v0, v30
    ds_read_b128 v[40:43], v74
    ds_read_b128 v[44:47], v75
    v_permlane32_swap_b32 v30, v0
    v_add_f32 v30, v30, v0
    v_mov_b32 v0, v31
    v_mul_f32 v30, s58, v30
    ds_read_b128 v[48:51], v76
    v_permlane32_swap_b32 v31, v0
    v_add_f32 v31, v31, v0
    v_mov_b32 v0, v29
    v_mul_f32 v31, s58, v31
    ds_read_b128 v[52:55], v77
    v_permlane32_swap_b32 v29, v0
    v_fma_f32 v31, -v30, v30, v31
    v_add_f32 v29, v29, v0
    v_max_f32 v31, 0, v31
    v_mov_b32 v0, s57
    v_fma_f32 v31, v31, v26, v0
    ds_read_b128 v[56:59], v78
    v_rsq_f32 v31, v31
    s_nop 0
    v_mul_f32 v29, v29, v31
    ds_read_b128 v[60:63], v79
    v_mul_f32 v29, v29, v25
    v_lshl_add_u32 v30, v17, 2, v13
    v_mul_f32 v29, s59, v29
    v_mov_b32 v0, v29
    v_lshlrev_b32 v22, 16, v19
    v_cndmask_b32_e64 v22, v22, 1.0, s[54:55]
    v_max_f32_dpp v0, v0, v0 quad_perm:[1,0,3,2] row_mask:0xf bank_mask:0xf
    s_waitcnt lgkmcnt(7)
    v_mfma_f32_32x32x16_bf16 v[100:115], a[96:99], v[32:35], 0
    v_max_f32_dpp v0, v0, v0 quad_perm:[2,3,0,1] row_mask:0xf bank_mask:0xf
    v_cmp_eq_f32_e64 s[62:63], 0, v22
    s_nop 0
    v_max_f32_dpp v0, v0, v0 row_half_mirror row_mask:0xf bank_mask:0xf
    v_sub_f32 v29, v29, v0
    v_cndmask_b32_e64 v22, v22, 1.0, s[62:63]
    v_exp_f32 v29, v29
    s_waitcnt lgkmcnt(6)
    v_mfma_f32_32x32x16_bf16 v[100:115], a[100:103], v[36:39], v[100:115]
    v_mov_b32 v0, v29
    v_add_f32 v245, v245, v247
    v_add_f32 v244, v244, v246
    v_add_f32_dpp v0, v0, v0 quad_perm:[1,0,3,2] row_mask:0xf bank_mask:0xf
    v_mul_f32 v245, s58, v245
    v_rcp_f32 v23, v22
    s_waitcnt lgkmcnt(5)
    v_mfma_f32_32x32x16_bf16 v[100:115], a[104:107], v[40:43], v[100:115]
    v_add_f32_dpp v0, v0, v0 quad_perm:[2,3,0,1] row_mask:0xf bank_mask:0xf
    v_mul_f32 v244, s58, v244
    v_fma_f32 v245, -v244, v244, v245
    v_add_f32_dpp v0, v0, v0 row_half_mirror row_mask:0xf bank_mask:0xf
    v_rcp_f32 v0, v0
    s_nop 0
    v_mul_f32 v29, v29, v0
    s_waitcnt lgkmcnt(4)
    v_mfma_f32_32x32x16_bf16 v[100:115], a[108:111], v[44:47], v[100:115]
    v_mul_f32 v29, v29, v25
    v_mul_f32 v252, v252, v29
    v_mul_f32 v253, v253, v29
    v_mul_f32 v254, v254, v29
    v_mul_f32 v255, v255, v29
    v_add_f32_dpp v252, v252, v252 quad_perm:[1,0,3,2] row_mask:0xf bank_mask:0xf
    v_add_f32_dpp v253, v253, v253 quad_perm:[1,0,3,2] row_mask:0xf bank_mask:0xf
    v_add_f32_dpp v254, v254, v254 quad_perm:[1,0,3,2] row_mask:0xf bank_mask:0xf
    v_mfma_f32_32x32x16_bf16 v[116:131], v[32:35], a[224:227], 0
    v_add_f32_dpp v255, v255, v255 quad_perm:[1,0,3,2] row_mask:0xf bank_mask:0xf
    v_cvt_pk_bf16_f32 v0, v29, v29
    ds_write_b16 v12, v0 offset:192
    v_add_f32_dpp v252, v252, v252 quad_perm:[2,3,0,1] row_mask:0xf bank_mask:0xf
    v_add_f32_dpp v253, v253, v253 quad_perm:[2,3,0,1] row_mask:0xf bank_mask:0xf
    v_add_f32_dpp v254, v254, v254 quad_perm:[2,3,0,1] row_mask:0xf bank_mask:0xf
    s_waitcnt lgkmcnt(4)
    v_mfma_f32_32x32x16_bf16 v[100:115], a[112:115], v[48:51], v[100:115]
    v_add_f32_dpp v255, v255, v255 quad_perm:[2,3,0,1] row_mask:0xf bank_mask:0xf
    ds_read_b128 v[236:239], v13 offset:192
    ds_read_b128 v[240:243], v13 offset:208
    v_add_f32_dpp v252, v252, v252 row_half_mirror row_mask:0xf bank_mask:0xf
    v_add_f32_dpp v253, v253, v253 row_half_mirror row_mask:0xf bank_mask:0xf
    v_add_f32_dpp v254, v254, v254 row_half_mirror row_mask:0xf bank_mask:0xf
    v_mfma_f32_32x32x16_bf16 v[116:131], v[36:39], a[228:231], v[116:131]
    v_add_f32_dpp v255, v255, v255 row_half_mirror row_mask:0xf bank_mask:0xf
    v_cvt_pk_bf16_f32 v0, v252, v253
    v_cvt_pk_bf16_f32 v1, v254, v255
    ds_write_b64 v30, v[0:1] offset:128
    ds_read_b128 v[228:231], v13 offset:128
    ds_read_b128 v[232:235], v13 offset:144
    s_waitcnt lgkmcnt(8)
    v_mfma_f32_32x32x16_bf16 v[100:115], a[116:119], v[52:55], v[100:115]
    v_max_f32 v245, 0, v245
    v_mul_f32 v24, v23, v23
    v_mov_b32 v244, s57
    v_fma_f32 v245, v245, v24, v244
    v_mov_b32 v25, v23
    v_rsq_f32 v245, v245
    v_mfma_f32_32x32x16_bf16 v[116:131], v[40:43], a[232:235], v[116:131]
    v_mul_f32 v27, v245, v23
    ds_write_b32 v10, v27
    ds_read_b128 v[248:251], v11
    v_mov_b32 v26, v24
    s_waitcnt lgkmcnt(9)
    v_mfma_f32_32x32x16_bf16 v[100:115], a[120:123], v[56:59], v[100:115]
    s_waitcnt lgkmcnt(6)
    v_dot2_f32_bf16 v84, v196, v236, 0
    s_waitcnt lgkmcnt(5)
    v_dot2_f32_bf16 v86, v200, v240, 0
    v_dot2_f32_bf16 v85, v198, v238, 0
    v_dot2_f32_bf16 v87, v202, v242, 0
    v_dot2_f32_bf16 v88, v204, v236, 0
    v_mfma_f32_32x32x16_bf16 v[116:131], v[44:47], a[236:239], v[116:131]
    v_dot2_f32_bf16 v90, v208, v240, 0
    v_dot2c_f32_bf16 v84, v197, v237
    v_dot2c_f32_bf16 v86, v201, v241
    v_dot2_f32_bf16 v89, v206, v238, 0
    v_dot2_f32_bf16 v91, v210, v242, 0
    s_waitcnt lgkmcnt(3)
    v_dot2c_f32_bf16 v84, v156, v228
    v_mfma_f32_32x32x16_bf16 v[100:115], a[124:127], v[60:63], v[100:115]
    v_dot2c_f32_bf16 v85, v199, v239
    s_waitcnt lgkmcnt(2)
    v_dot2c_f32_bf16 v86, v160, v232
    v_dot2c_f32_bf16 v87, v203, v243
    v_dot2_f32_bf16 v92, v212, v236, 0
    v_dot2_f32_bf16 v94, v216, v240, 0
    v_dot2c_f32_bf16 v84, v157, v229
    v_mfma_f32_32x32x16_bf16 v[116:131], v[48:51], a[240:243], v[116:131]
    v_dot2c_f32_bf16 v85, v158, v230
    v_dot2c_f32_bf16 v86, v161, v233
    v_dot2c_f32_bf16 v87, v162, v234
    v_dot2c_f32_bf16 v88, v205, v237
    v_dot2c_f32_bf16 v90, v209, v241
    v_dot2_f32_bf16 v93, v214, v238, 0
    v_mfma_f32_32x32x16_bf16 v[116:131], v[52:55], a[244:247], v[116:131]
    v_cvt_pk_bf16_f32 v148, v100, v101
    v_cvt_pk_bf16_f32 v149, v102, v103
    v_cvt_pk_bf16_f32 v150, v104, v105
    v_cvt_pk_bf16_f32 v151, v106, v107
    v_dot2_f32_bf16 v95, v218, v242, 0
    v_cvt_pk_bf16_f32 v152, v108, v109
    v_mfma_f32_32x32x16_bf16 v[132:147], v[56:59], v[148:151], 0
    v_cvt_pk_bf16_f32 v153, v110, v111
    v_cvt_pk_bf16_f32 v154, v112, v113
    v_cvt_pk_bf16_f32 v155, v114, v115
    v_dot2c_f32_bf16 v85, v159, v231
    v_dot2c_f32_bf16 v87, v163, v235
    v_dot2c_f32_bf16 v88, v164, v228
    v_mfma_f32_32x32x16_bf16 v[116:131], v[56:59], a[248:251], v[116:131]
    v_dot2c_f32_bf16 v89, v207, v239
    v_dot2c_f32_bf16 v90, v168, v232
    v_dot2c_f32_bf16 v91, v211, v243
    v_dot2_f32_bf16 v96, v220, v236, 0
    v_dot2_f32_bf16 v98, v224, v240, 0
    v_dot2c_f32_bf16 v88, v165, v229
    v_mfma_f32_32x32x16_bf16 v[132:147], v[60:63], v[152:155], v[132:147]
    v_dot2c_f32_bf16 v89, v166, v230
    v_dot2c_f32_bf16 v90, v169, v233
    v_dot2c_f32_bf16 v91, v170, v234
    v_dot2c_f32_bf16 v92, v213, v237
    v_dot2c_f32_bf16 v94, v217, v241
    v_dot2_f32_bf16 v97, v222, v238, 0
    v_mfma_f32_32x32x16_bf16 v[116:131], v[60:63], a[252:255], v[116:131]
    v_dot2_f32_bf16 v99, v226, v242, 0
    v_permlane32_swap_b32 v84, v86
    v_dot2c_f32_bf16 v89, v167, v231
    v_dot2c_f32_bf16 v91, v171, v235
    v_dot2c_f32_bf16 v92, v172, v228
    v_dot2c_f32_bf16 v93, v215, v239
    v_dot2c_f32_bf16 v94, v176, v232
    v_dot2c_f32_bf16 v95, v219, v243
    v_permlane32_swap_b32 v85, v87
    v_dot2c_f32_bf16 v92, v173, v229
    v_dot2c_f32_bf16 v93, v174, v230
    v_dot2c_f32_bf16 v94, v177, v233
    v_dot2c_f32_bf16 v95, v178, v234
    v_dot2c_f32_bf16 v96, v221, v237
    v_dot2c_f32_bf16 v98, v225, v241
    v_add_f32 v84, v84, v86
    v_permlane32_swap_b32 v88, v90
    v_dot2c_f32_bf16 v93, v175, v231
    v_dot2c_f32_bf16 v95, v179, v235
    v_dot2c_f32_bf16 v96, v180, v228
    v_dot2c_f32_bf16 v97, v223, v239
    v_dot2c_f32_bf16 v98, v184, v232
    v_dot2c_f32_bf16 v99, v227, v243
    v_cvt_pk_bf16_f32 v84, v84, v84
    v_add_f32 v85, v85, v87
    v_permlane32_swap_b32 v89, v91
    v_dot2c_f32_bf16 v96, v181, v229
    v_dot2c_f32_bf16 v97, v182, v230
    v_dot2c_f32_bf16 v98, v185, v233
    v_dot2c_f32_bf16 v99, v186, v234
    buffer_store_short v84, v18, s[24:27], s42 offen offset:0
    v_cvt_pk_bf16_f32 v85, v85, v85
    v_add_f32 v88, v88, v90
    v_permlane32_swap_b32 v92, v94
    v_dot2c_f32_bf16 v97, v183, v231
    v_dot2c_f32_bf16 v99, v187, v235
    buffer_store_short v85, v18, s[24:27], s42 offen offset:256
    v_cvt_pk_bf16_f32 v88, v88, v88
    v_add_f32 v89, v89, v91
    v_permlane32_swap_b32 v93, v95
    buffer_store_short v88, v18, s[24:27], s42 offen offset:64
    v_cvt_pk_bf16_f32 v89, v89, v89
    v_add_f32 v92, v92, v94
    v_permlane32_swap_b32 v96, v98
    buffer_store_short v89, v18, s[24:27], s42 offen offset:320
    v_cvt_pk_bf16_f32 v92, v92, v92
    v_add_f32 v93, v93, v95
    v_permlane32_swap_b32 v97, v99
    buffer_store_short v92, v18, s[24:27], s42 offen offset:128
    v_cvt_pk_bf16_f32 v93, v93, v93
    v_add_f32 v96, v96, v98
    v_cndmask_b32_e64 v152, v132, v136, s[46:47]
    v_cndmask_b32_e64 v153, v133, v137, s[46:47]
    v_cndmask_b32_e64 v154, v134, v138, s[46:47]
    v_cndmask_b32_e64 v155, v135, v139, s[46:47]
    buffer_store_short v93, v18, s[24:27], s42 offen offset:384
    v_cvt_pk_bf16_f32 v96, v96, v96
    v_add_f32 v97, v97, v99
    v_cndmask_b32_e64 v152, v152, v140, s[48:49]
    v_cndmask_b32_e64 v153, v153, v141, s[48:49]
    v_cndmask_b32_e64 v154, v154, v142, s[48:49]
    v_cndmask_b32_e64 v155, v155, v143, s[48:49]
    buffer_store_short v96, v18, s[24:27], s42 offen offset:192
    v_cvt_pk_bf16_f32 v97, v97, v97
    v_cndmask_b32_e64 v152, v152, v144, s[50:51]
    v_cndmask_b32_e64 v153, v153, v145, s[50:51]
    v_cndmask_b32_e64 v154, v154, v146, s[50:51]
    v_cndmask_b32_e64 v155, v155, v147, s[50:51]
    buffer_store_short v97, v18, s[24:27], s42 offen offset:448
    ds_write_b128 v2, v[152:155] offset:3072
    v_cvt_pk_bf16_f32 v180, v116, v117
    v_cvt_pk_bf16_f32 v181, v118, v119
    v_cvt_pk_bf16_f32 v182, v120, v121
    v_cvt_pk_bf16_f32 v183, v122, v123
    v_cvt_pk_bf16_f32 v184, v124, v125
    v_cvt_pk_bf16_f32 v185, v126, v127
    v_cvt_pk_bf16_f32 v186, v128, v129
    v_cvt_pk_bf16_f32 v187, v130, v131
    ds_read_b64_tr_b16 v[220:221], v7 offset:0
    ds_read_b64_tr_b16 v[222:223], v5 offset:256
    ds_read_b64_tr_b16 v[224:225], v7 offset:512
    ds_read_b64_tr_b16 v[226:227], v5 offset:768
    s_lshl_b32 s42, s61, 10
    v_mov_b32 v18, v16
    s_waitcnt lgkmcnt(0)
    s_barrier
    ds_read_b128 v[132:135], v2 offset:0
    ds_read_b128 v[136:139], v2 offset:1024
    ds_read_b128 v[140:143], v2 offset:2048
    ds_read_b128 v[144:147], v2 offset:3072
    ds_read_b128 v[228:231], v15 offset:192
    v_lshlrev_b32 v100, 16, v56
    v_lshlrev_b32 v102, 16, v57
    v_lshlrev_b32 v104, 16, v58
    v_lshlrev_b32 v106, 16, v59
    v_lshlrev_b32 v108, 16, v60
    v_lshlrev_b32 v110, 16, v61
    v_lshlrev_b32 v112, 16, v62
    v_lshlrev_b32 v114, 16, v63
    v_and_b32 v101, s60, v56
    v_and_b32 v103, s60, v57
    v_and_b32 v105, s60, v58
    v_and_b32 v107, s60, v59
    v_and_b32 v109, s60, v60
    v_and_b32 v111, s60, v61
    v_and_b32 v113, s60, v62
    v_and_b32 v115, s60, v63
    ds_read_b128 v[232:235], v15 offset:208
    ds_read_b128 v[236:239], v15 offset:224
    ds_read_b128 v[240:243], v15 offset:240
    v_mov_b32 v148, 0
    v_mov_b32 v149, 0
    v_mov_b32 v150, 0
    v_mov_b32 v151, 0
    s_waitcnt lgkmcnt(6)
    v_add_f32 v252, v132, v136
    v_add_f32 v253, v133, v137
    v_add_f32 v254, v134, v138
    s_waitcnt lgkmcnt(4)
    v_add_f32 v140, v140, v144
    v_add_f32 v141, v141, v145
    v_add_f32 v252, v252, v140
    v_add_f32 v253, v253, v141
    v_add_f32 v255, v135, v139
    v_add_f32 v142, v142, v146
    v_add_f32 v143, v143, v147
    v_mul_f32 v252, v252, v248
    v_mul_f32 v253, v253, v249
    v_add_f32 v254, v254, v142
    v_add_f32 v255, v255, v143
    v_mul_f32 v252, v252, v27
    v_mul_f32 v253, v253, v27
    v_mul_f32 v254, v254, v250
    v_mul_f32 v255, v255, v251
    v_max_f32 v28, v252, v253
    v_mul_f32 v254, v254, v27
    v_mul_f32 v255, v255, v27
    v_max3_f32 v28, v28, v254, v255
    v_mov_b32 v20, v28
    s_nop 1
    v_permlane32_swap_b32 v28, v20
    v_max_f32 v28, v28, v20
    v_sub_f32 v252, v252, v28
    v_sub_f32 v253, v253, v28
    v_sub_f32 v254, v254, v28
    v_sub_f32 v255, v255, v28
    v_exp_f32 v252, v252
    v_exp_f32 v253, v253
    v_exp_f32 v254, v254
    v_exp_f32 v255, v255
    v_add_f32 v28, v252, v253
    v_add_f32 v20, v254, v255
    v_add_f32 v28, v28, v20
    v_mov_b32 v20, v28
    v_mul_f32 v252, v252, v248
    v_mul_f32 v253, v253, v249
    v_permlane32_swap_b32 v28, v20
    v_add_f32 v28, v28, v20
    v_mul_f32 v254, v254, v250
    v_rcp_f32 v28, v28
    v_mul_f32 v255, v255, v251
    v_mul_f32 v28, v28, v22
    v_mul_f32 v252, v252, v28
    v_mul_f32 v253, v253, v28
    v_mul_f32 v254, v254, v28
    v_mul_f32 v255, v255, v28
    v_cvt_pk_bf16_f32 v28, v252, v253
    v_cvt_pk_bf16_f32 v20, v254, v255
    v_cndmask_b32_e64 v188, 0, v28, s[52:53]
    v_cndmask_b32_e64 v189, 0, v20, s[52:53]
    v_cndmask_b32_e64 v190, 0, v28, s[46:47]
    v_cndmask_b32_e64 v191, 0, v20, s[46:47]
    v_cndmask_b32_e64 v192, 0, v28, s[48:49]
    s_nop 0
    v_mfma_f32_32x32x16_bf16 v[100:115], v[180:183], v[188:191], v[100:115]
    v_cndmask_b32_e64 v193, 0, v20, s[48:49]
    v_cndmask_b32_e64 v194, 0, v28, s[50:51]
    v_cndmask_b32_e64 v195, 0, v20, s[50:51]
    s_nop 1
    v_mfma_f32_32x32x16_bf16 v[100:115], v[184:187], v[192:195], v[100:115]
    s_nop 11
    v_add_f32 v148, v148, v100
    v_fmac_f32 v149, v100, v100
    s_waitcnt lgkmcnt(3)
    v_fmac_f32 v150, v100, v228
    v_add_f32 v148, v148, v101
    v_fmac_f32 v149, v101, v101
    v_fmac_f32 v150, v101, v229
    v_add_f32 v148, v148, v102
    v_fmac_f32 v149, v102, v102
    v_fmac_f32 v150, v102, v230
    v_add_f32 v148, v148, v103
    v_fmac_f32 v149, v103, v103
    v_fmac_f32 v150, v103, v231
    v_add_f32 v148, v148, v104
    v_fmac_f32 v149, v104, v104
    s_waitcnt lgkmcnt(2)
    v_fmac_f32 v150, v104, v232
    v_add_f32 v148, v148, v105
    v_fmac_f32 v149, v105, v105
    v_fmac_f32 v150, v105, v233
    v_add_f32 v148, v148, v106
    v_fmac_f32 v149, v106, v106
    v_fmac_f32 v150, v106, v234
    v_add_f32 v148, v148, v107
    v_fmac_f32 v149, v107, v107
    v_fmac_f32 v150, v107, v235
    v_add_f32 v148, v148, v108
    v_fmac_f32 v149, v108, v108
    s_waitcnt lgkmcnt(1)
    v_fmac_f32 v150, v108, v236
    v_add_f32 v148, v148, v109
    v_fmac_f32 v149, v109, v109
    v_fmac_f32 v150, v109, v237
    v_add_f32 v148, v148, v110
    v_fmac_f32 v149, v110, v110
    v_fmac_f32 v150, v110, v238
    v_add_f32 v148, v148, v111
    v_fmac_f32 v149, v111, v111
    v_fmac_f32 v150, v111, v239
    v_add_f32 v148, v148, v112
    v_fmac_f32 v149, v112, v112
    s_waitcnt lgkmcnt(0)
    v_fmac_f32 v150, v112, v240
    v_add_f32 v148, v148, v113
    v_fmac_f32 v149, v113, v113
    v_fmac_f32 v150, v113, v241
    v_add_f32 v148, v148, v114
    v_fmac_f32 v149, v114, v114
    v_fmac_f32 v150, v114, v242
    v_add_f32 v148, v148, v115
    v_fmac_f32 v149, v115, v115
    v_fmac_f32 v150, v115, v243
    ds_write_b128 v2, v[148:151] offset:7168
    s_waitcnt lgkmcnt(0)
    s_barrier
    s_nop 7
    ds_read_b128 v[132:135], v2 offset:4096
    ds_read_b128 v[136:139], v2 offset:5120
    ds_read_b128 v[140:143], v2 offset:6144
    ds_read_b128 v[144:147], v2 offset:7168
    s_waitcnt lgkmcnt(2)
    v_add_f32 v30, v132, v136
    v_add_f32 v31, v133, v137
    v_add_f32 v29, v134, v138
    s_waitcnt lgkmcnt(0)
    v_add_f32 v140, v140, v144
    v_add_f32 v30, v30, v140
    v_mov_b32 v0, v30
    v_add_f32 v141, v141, v145
    v_add_f32 v31, v31, v141
    v_permlane32_swap_b32 v30, v0
    v_add_f32 v30, v30, v0
    v_mov_b32 v0, v31
    v_add_f32 v142, v142, v146
    v_add_f32 v29, v29, v142
    v_permlane32_swap_b32 v31, v0
    v_add_f32 v31, v31, v0
    v_mov_b32 v0, v29
    v_mul_f32 v31, s58, v31
    v_mul_f32 v30, s58, v30
    v_permlane32_swap_b32 v29, v0
    v_fma_f32 v31, -v30, v30, v31
    v_add_f32 v29, v29, v0
    v_max_f32 v31, 0, v31
    v_mov_b32 v0, s57
    v_fma_f32 v31, v31, v26, v0
    v_lshl_add_u32 v30, v17, 2, v13
    v_rsq_f32 v31, v31
    s_nop 0
    v_mul_f32 v29, v29, v31
    v_mul_f32 v29, v29, v25
    v_mul_f32 v29, s59, v29
    v_mov_b32 v0, v29
    s_nop 1
    v_max_f32_dpp v0, v0, v0 quad_perm:[1,0,3,2] row_mask:0xf bank_mask:0xf
    s_nop 1
    v_max_f32_dpp v0, v0, v0 quad_perm:[2,3,0,1] row_mask:0xf bank_mask:0xf
    s_nop 1
    v_max_f32_dpp v0, v0, v0 row_half_mirror row_mask:0xf bank_mask:0xf
    v_sub_f32 v29, v29, v0
    v_exp_f32 v29, v29
    s_nop 0
    v_mov_b32 v0, v29
    s_nop 1
    v_add_f32_dpp v0, v0, v0 quad_perm:[1,0,3,2] row_mask:0xf bank_mask:0xf
    s_nop 1
    v_add_f32_dpp v0, v0, v0 quad_perm:[2,3,0,1] row_mask:0xf bank_mask:0xf
    s_nop 1
    v_add_f32_dpp v0, v0, v0 row_half_mirror row_mask:0xf bank_mask:0xf
    v_rcp_f32 v0, v0
    s_nop 0
    v_mul_f32 v29, v29, v0
    v_mul_f32 v29, v29, v25
    v_mul_f32 v252, v252, v29
    v_mul_f32 v253, v253, v29
    v_mul_f32 v254, v254, v29
    v_mul_f32 v255, v255, v29
    v_add_f32_dpp v252, v252, v252 quad_perm:[1,0,3,2] row_mask:0xf bank_mask:0xf
    v_add_f32_dpp v253, v253, v253 quad_perm:[1,0,3,2] row_mask:0xf bank_mask:0xf
    v_add_f32_dpp v254, v254, v254 quad_perm:[1,0,3,2] row_mask:0xf bank_mask:0xf
    v_add_f32_dpp v255, v255, v255 quad_perm:[1,0,3,2] row_mask:0xf bank_mask:0xf
    v_cvt_pk_bf16_f32 v0, v29, v29
    ds_write_b16 v12, v0 offset:192
    v_add_f32_dpp v252, v252, v252 quad_perm:[2,3,0,1] row_mask:0xf bank_mask:0xf
    v_add_f32_dpp v253, v253, v253 quad_perm:[2,3,0,1] row_mask:0xf bank_mask:0xf
    v_add_f32_dpp v254, v254, v254 quad_perm:[2,3,0,1] row_mask:0xf bank_mask:0xf
    v_add_f32_dpp v255, v255, v255 quad_perm:[2,3,0,1] row_mask:0xf bank_mask:0xf
    ds_read_b128 v[236:239], v13 offset:192
    ds_read_b128 v[240:243], v13 offset:208
    v_add_f32_dpp v252, v252, v252 row_half_mirror row_mask:0xf bank_mask:0xf
    v_add_f32_dpp v253, v253, v253 row_half_mirror row_mask:0xf bank_mask:0xf
    v_add_f32_dpp v254, v254, v254 row_half_mirror row_mask:0xf bank_mask:0xf
    v_add_f32_dpp v255, v255, v255 row_half_mirror row_mask:0xf bank_mask:0xf
    v_cvt_pk_bf16_f32 v0, v252, v253
    v_cvt_pk_bf16_f32 v1, v254, v255
    ds_write_b64 v30, v[0:1] offset:128
    ds_read_b128 v[228:231], v13 offset:128
    ds_read_b128 v[232:235], v13 offset:144
    s_waitcnt lgkmcnt(4)
    v_dot2_f32_bf16 v96, v220, v236, 0
    s_waitcnt lgkmcnt(3)
    v_dot2_f32_bf16 v98, v224, v240, 0
    v_dot2_f32_bf16 v97, v222, v238, 0
    v_dot2_f32_bf16 v99, v226, v242, 0
    v_dot2c_f32_bf16 v96, v221, v237
    v_dot2c_f32_bf16 v98, v225, v241
    v_dot2c_f32_bf16 v97, v223, v239
    v_dot2c_f32_bf16 v99, v227, v243
    s_waitcnt lgkmcnt(1)
    v_dot2c_f32_bf16 v96, v180, v228
    s_waitcnt lgkmcnt(0)
    v_dot2c_f32_bf16 v98, v184, v232
    v_dot2c_f32_bf16 v96, v181, v229
    v_dot2c_f32_bf16 v97, v182, v230
    v_dot2c_f32_bf16 v98, v185, v233
    v_dot2c_f32_bf16 v99, v186, v234
    v_dot2c_f32_bf16 v97, v183, v231
    v_dot2c_f32_bf16 v99, v187, v235
    v_permlane32_swap_b32 v96, v98
    v_add_f32 v96, v96, v98
    s_nop 0
    v_permlane32_swap_b32 v97, v99
    v_cvt_pk_bf16_f32 v96, v96, v96
    v_add_f32 v97, v97, v99
    buffer_store_short v96, v18, s[24:27], s42 offen offset:192
    v_cvt_pk_bf16_f32 v97, v97, v97
    buffer_store_short v97, v18, s[24:27], s42 offen offset:448
    s_endpgm
tf_epi:
    s_nop 7
    s_nop 7
    v_mov_b32 v0, v30
    s_nop 1
    v_permlane32_swap_b32 v30, v0
    v_add_f32 v30, v30, v0
    v_mov_b32 v0, v31
    v_mul_f32 v30, s58, v30
    s_nop 0
    v_permlane32_swap_b32 v31, v0
    v_add_f32 v31, v31, v0
    v_mov_b32 v0, v29
    v_mul_f32 v31, s58, v31
    v_fma_f32 v31, -v30, v30, v31
    v_permlane32_swap_b32 v29, v0
    v_add_f32 v29, v29, v0
    v_max_f32 v31, 0, v31
    v_mov_b32 v0, s57
    v_fma_f32 v31, v31, v26, v0
    v_lshl_add_u32 v30, v17, 2, v13
    v_rsq_f32 v31, v31
    s_nop 0
    v_mul_f32 v29, v29, v31
    v_mul_f32 v29, v29, v25
    v_mul_f32 v29, s59, v29
    v_mov_b32 v0, v29
    s_nop 1
    v_max_f32_dpp v0, v0, v0 quad_perm:[1,0,3,2] row_mask:0xf bank_mask:0xf
    s_nop 1
    v_max_f32_dpp v0, v0, v0 quad_perm:[2,3,0,1] row_mask:0xf bank_mask:0xf
    s_nop 1
    v_max_f32_dpp v0, v0, v0 row_half_mirror row_mask:0xf bank_mask:0xf
    v_sub_f32 v29, v29, v0
    v_exp_f32 v29, v29
    s_nop 0
    v_mov_b32 v0, v29
    s_nop 1
    v_add_f32_dpp v0, v0, v0 quad_perm:[1,0,3,2] row_mask:0xf bank_mask:0xf
    s_nop 1
    v_add_f32_dpp v0, v0, v0 quad_perm:[2,3,0,1] row_mask:0xf bank_mask:0xf
    s_nop 1
    v_add_f32_dpp v0, v0, v0 row_half_mirror row_mask:0xf bank_mask:0xf
    v_rcp_f32 v0, v0
    s_nop 0
    v_mul_f32 v29, v29, v0
    v_mul_f32 v29, v29, v25
    v_mul_f32 v252, v252, v29
    v_mul_f32 v253, v253, v29
    v_mul_f32 v254, v254, v29
    v_mul_f32 v255, v255, v29
    v_add_f32_dpp v252, v252, v252 quad_perm:[1,0,3,2] row_mask:0xf bank_mask:0xf
    v_add_f32_dpp v253, v253, v253 quad_perm:[1,0,3,2] row_mask:0xf bank_mask:0xf
    v_add_f32_dpp v254, v254, v254 quad_perm:[1,0,3,2] row_mask:0xf bank_mask:0xf
    v_add_f32_dpp v255, v255, v255 quad_perm:[1,0,3,2] row_mask:0xf bank_mask:0xf
    v_cvt_pk_bf16_f32 v0, v29, v29
    ds_write_b16 v12, v0 offset:192
    v_add_f32_dpp v252, v252, v252 quad_perm:[2,3,0,1] row_mask:0xf bank_mask:0xf
    v_add_f32_dpp v253, v253, v253 quad_perm:[2,3,0,1] row_mask:0xf bank_mask:0xf
    v_add_f32_dpp v254, v254, v254 quad_perm:[2,3,0,1] row_mask:0xf bank_mask:0xf
    v_add_f32_dpp v255, v255, v255 quad_perm:[2,3,0,1] row_mask:0xf bank_mask:0xf
    ds_read_b128 v[236:239], v13 offset:192
    ds_read_b128 v[240:243], v13 offset:208
    v_add_f32_dpp v252, v252, v252 row_half_mirror row_mask:0xf bank_mask:0xf
    v_add_f32_dpp v253, v253, v253 row_half_mirror row_mask:0xf bank_mask:0xf
    v_add_f32_dpp v254, v254, v254 row_half_mirror row_mask:0xf bank_mask:0xf
    v_add_f32_dpp v255, v255, v255 row_half_mirror row_mask:0xf bank_mask:0xf
    v_cvt_pk_bf16_f32 v0, v252, v253
    v_cvt_pk_bf16_f32 v1, v254, v255
    ds_write_b64 v30, v[0:1] offset:128
    ds_read_b128 v[228:231], v13 offset:128
    ds_read_b128 v[232:235], v13 offset:144
    s_waitcnt lgkmcnt(4)
    v_dot2_f32_bf16 v84, v196, v236, 0
    s_waitcnt lgkmcnt(3)
    v_dot2_f32_bf16 v86, v200, v240, 0
    v_dot2_f32_bf16 v85, v198, v238, 0
    v_dot2_f32_bf16 v87, v202, v242, 0
    v_dot2_f32_bf16 v88, v204, v236, 0
    v_dot2_f32_bf16 v90, v208, v240, 0
    v_dot2c_f32_bf16 v84, v197, v237
    v_dot2c_f32_bf16 v86, v201, v241
    v_dot2_f32_bf16 v89, v206, v238, 0
    v_dot2_f32_bf16 v91, v210, v242, 0
    s_waitcnt lgkmcnt(1)
    v_dot2c_f32_bf16 v84, v156, v228
    v_dot2c_f32_bf16 v85, v199, v239
    s_waitcnt lgkmcnt(0)
    v_dot2c_f32_bf16 v86, v160, v232
    v_dot2c_f32_bf16 v87, v203, v243
    v_dot2_f32_bf16 v92, v212, v236, 0
    v_dot2_f32_bf16 v94, v216, v240, 0
    v_dot2c_f32_bf16 v84, v157, v229
    v_dot2c_f32_bf16 v85, v158, v230
    v_dot2c_f32_bf16 v86, v161, v233
    v_dot2c_f32_bf16 v87, v162, v234
    v_dot2c_f32_bf16 v88, v205, v237
    v_dot2c_f32_bf16 v90, v209, v241
    v_dot2_f32_bf16 v93, v214, v238, 0
    v_dot2_f32_bf16 v95, v218, v242, 0
    v_dot2c_f32_bf16 v85, v159, v231
    v_dot2c_f32_bf16 v87, v163, v235
    v_dot2c_f32_bf16 v88, v164, v228
    v_dot2c_f32_bf16 v89, v207, v239
    v_dot2c_f32_bf16 v90, v168, v232
    v_dot2c_f32_bf16 v91, v211, v243
    v_dot2_f32_bf16 v96, v220, v236, 0
    v_dot2_f32_bf16 v98, v224, v240, 0
    v_dot2c_f32_bf16 v88, v165, v229
    v_dot2c_f32_bf16 v89, v166, v230
    v_dot2c_f32_bf16 v90, v169, v233
    v_dot2c_f32_bf16 v91, v170, v234
    v_dot2c_f32_bf16 v92, v213, v237
    v_dot2c_f32_bf16 v94, v217, v241
    v_dot2_f32_bf16 v97, v222, v238, 0
    v_dot2_f32_bf16 v99, v226, v242, 0
    v_permlane32_swap_b32 v84, v86
    v_dot2c_f32_bf16 v89, v167, v231
    v_dot2c_f32_bf16 v91, v171, v235
    v_dot2c_f32_bf16 v92, v172, v228
    v_dot2c_f32_bf16 v93, v215, v239
    v_dot2c_f32_bf16 v94, v176, v232
    v_dot2c_f32_bf16 v95, v219, v243
    v_permlane32_swap_b32 v85, v87
    v_dot2c_f32_bf16 v92, v173, v229
    v_dot2c_f32_bf16 v93, v174, v230
    v_dot2c_f32_bf16 v94, v177, v233
    v_dot2c_f32_bf16 v95, v178, v234
    v_dot2c_f32_bf16 v96, v221, v237
    v_dot2c_f32_bf16 v98, v225, v241
    v_add_f32 v84, v84, v86
    v_permlane32_swap_b32 v88, v90
    v_dot2c_f32_bf16 v93, v175, v231
    v_dot2c_f32_bf16 v95, v179, v235
    v_dot2c_f32_bf16 v96, v180, v228
    v_dot2c_f32_bf16 v97, v223, v239
    v_dot2c_f32_bf16 v98, v184, v232
    v_dot2c_f32_bf16 v99, v227, v243
    v_cvt_pk_bf16_f32 v84, v84, v84
    v_add_f32 v85, v85, v87
    v_permlane32_swap_b32 v89, v91
    v_dot2c_f32_bf16 v96, v181, v229
    v_dot2c_f32_bf16 v97, v182, v230
    v_dot2c_f32_bf16 v98, v185, v233
    v_dot2c_f32_bf16 v99, v186, v234
    buffer_store_short v84, v18, s[24:27], s42 offen offset:0
    v_cvt_pk_bf16_f32 v85, v85, v85
    v_add_f32 v88, v88, v90
    v_permlane32_swap_b32 v92, v94
    v_dot2c_f32_bf16 v97, v183, v231
    v_dot2c_f32_bf16 v99, v187, v235
    buffer_store_short v85, v18, s[24:27], s42 offen offset:256
    v_cvt_pk_bf16_f32 v88, v88, v88
    v_add_f32 v89, v89, v91
    v_permlane32_swap_b32 v93, v95
    buffer_store_short v88, v18, s[24:27], s42 offen offset:64
    v_cvt_pk_bf16_f32 v89, v89, v89
    v_add_f32 v92, v92, v94
    v_permlane32_swap_b32 v96, v98
    buffer_store_short v89, v18, s[24:27], s42 offen offset:320
    v_cvt_pk_bf16_f32 v92, v92, v92
    v_add_f32 v93, v93, v95
    v_permlane32_swap_b32 v97, v99
    buffer_store_short v92, v18, s[24:27], s42 offen offset:128
    v_cvt_pk_bf16_f32 v93, v93, v93
    v_add_f32 v96, v96, v98
    buffer_store_short v93, v18, s[24:27], s42 offen offset:384
    v_cvt_pk_bf16_f32 v96, v96, v96
    v_add_f32 v97, v97, v99
    buffer_store_short v96, v18, s[24:27], s42 offen offset:192
    v_cvt_pk_bf16_f32 v97, v97, v97
    buffer_store_short v97, v18, s[24:27], s42 offen offset:448
tf_done:
    s_endpgm
.section .rodata,"a"
.p2align 6
.amdhsa_kernel prep_kernel
  .amdhsa_next_free_vgpr 40
  .amdhsa_next_free_sgpr 64
  .amdhsa_accum_offset 40
  .amdhsa_group_segment_fixed_size 0
  .amdhsa_kernarg_size 96
  .amdhsa_user_sgpr_count 2
  .amdhsa_user_sgpr_kernarg_segment_ptr 1
  .amdhsa_system_sgpr_workgroup_id_x 1
  .amdhsa_float_denorm_mode_32 3
  .amdhsa_float_denorm_mode_16_64 3
.end_amdhsa_kernel
.p2align 6
.amdhsa_kernel hops_kernel
  .amdhsa_next_free_vgpr 128
  .amdhsa_next_free_sgpr 80
  .amdhsa_accum_offset 128
  .amdhsa_group_segment_fixed_size 0
  .amdhsa_kernarg_size 96
  .amdhsa_user_sgpr_count 2
  .amdhsa_user_sgpr_kernarg_segment_ptr 1
  .amdhsa_system_sgpr_workgroup_id_x 1
  .amdhsa_float_denorm_mode_32 3
  .amdhsa_float_denorm_mode_16_64 3
.end_amdhsa_kernel
.p2align 6
.amdhsa_kernel tf_kernel
  .amdhsa_next_free_vgpr 512
  .amdhsa_next_free_sgpr 100
  .amdhsa_accum_offset 256
  .amdhsa_group_segment_fixed_size 0
  .amdhsa_kernarg_size 96
  .amdhsa_user_sgpr_count 2
  .amdhsa_user_sgpr_kernarg_segment_ptr 1
  .amdhsa_system_sgpr_workgroup_id_x 1
  .amdhsa_float_denorm_mode_32 3
  .amdhsa_float_denorm_mode_16_64 3
.end_amdhsa_kernel
```
